```python
import torch

def _softmax(x, axis=-1):
    return torch.softmax(x, dim=axis)
def _gelu(x):
    return torch.nn.functional.gelu(x, approximate="tanh")
def _silu(x):
    return torch.nn.functional.silu(x)
def _sigmoid(x):
    return torch.sigmoid(x)
def _layernorm(x, axis=-1, eps=1e-5):
    m = x.mean(dim=axis, keepdim=True)
    v = x.var(dim=axis, keepdim=True, unbiased=False)
    return (x - m) / torch.sqrt(v + eps)
def _scatter_add(tgt, idx, src, axis=0):
    return tgt.clone().index_add_(axis, idx, src)
def _segment_sum(src, seg, n):
    out = torch.zeros((n,) + src.shape[1:], dtype=src.dtype)
    return out.index_add_(0, seg, src)
def _pad(x, pw):
    flat = tuple(v for pair in reversed(pw) for v in pair)
    return torch.nn.functional.pad(x, flat)

kernel_name = 'sequential_preLN__grouped_kv_mqa__dense_activation_relu__prompt'

def setup_inputs():

    _w = (lambda a: (lambda t: t.to(torch.bfloat16) if t.is_floating_point() else t)(torch.as_tensor(a)))
    def _A_setup():
        B, S, D, H = 1, 2048, 576, 32
        Dh = D // H
        return {
            "x": _w((lambda *s: torch.randn(*s, dtype=torch.bfloat16) * 0.05)(B, S, D)),
            "wq": _w((lambda *s: torch.randn(*s, dtype=torch.bfloat16) * 0.05)(D, H * Dh)),
            "wk": _w((lambda *s: torch.randn(*s, dtype=torch.bfloat16) * 0.05)(D, Dh)),
            "wv": _w((lambda *s: torch.randn(*s, dtype=torch.bfloat16) * 0.05)(D, Dh)),
            "wo": _w((lambda *s: torch.randn(*s, dtype=torch.bfloat16) * 0.05)(H * Dh, D)),
        }
    _A_in = _A_setup()

    def _B_setup():
        B, S, D, Dff = 1, 2048, 576, 4608
        return {
            "x": _w((lambda *s: torch.randn(*s, dtype=torch.bfloat16) * 0.05)(B, S, D)),
            "w1": _w((lambda *s: torch.randn(*s, dtype=torch.bfloat16) * 0.05)(D, Dff)),
            "w2": _w((lambda *s: torch.randn(*s, dtype=torch.bfloat16) * 0.05)(Dff, D)),
        }
    _B_in = _B_setup()

    return {
        "A_x": _A_in["x"],
        "A_wq": _A_in["wq"],
        "A_wk": _A_in["wk"],
        "A_wv": _A_in["wv"],
        "A_wo": _A_in["wo"],
        "B_x": _B_in["x"],
        "B_w1": _B_in["w1"],
        "B_w2": _B_in["w2"],
    }

def reference(A_x, A_wq, A_wk, A_wv, A_wo, B_x, B_w1, B_w2):
    def _A_ref(x, wq, wk, wv, wo):
        B, S, D = x.shape
        H = 32
        Dh = D // H
        q = (lambda x, *d: x.permute(*d))((x @ wq).reshape(B, S, H, Dh), 0, 2, 1, 3)
        k = x @ wk
        v = x @ wv
        scores = torch.einsum("bhqd,bkd->bhqk", q, k) * (Dh ** -0.5)
        p = _softmax(scores, axis=-1)
        o = torch.einsum("bhqk,bkd->bhqd", p, v)
        return (lambda x, *d: x.permute(*d))(o, 0, 2, 1, 3).reshape(B, S, H * Dh) @ wo

    def _B_ref(x, w1, w2):
        h = torch.einsum("bsd,df->bsf", x, w1)
        zero = torch.zeros_like(h)
        h = torch.maximum(h, zero)
        return torch.einsum("bsf,fd->bsd", h, w2)

    x = A_x
    h = x + _A_ref(_layernorm(x, axis=-1), A_wq, A_wk, A_wv, A_wo)
    h2 = h + _B_ref(_layernorm(h, axis=-1), B_w1, B_w2)
    return h2
```

```asm
; @launch grid=(256,1,1) block=(512,1,1) lds=161024
.amdgcn_target "amdgcn-amd-amdhsa--gfx950"
.text
.globl sequential_preLN__grouped_kv_mqa__dense_activation_relu__prompt_kernel
.p2align 8
.type sequential_preLN__grouped_kv_mqa__dense_activation_relu__prompt_kernel,@function
sequential_preLN__grouped_kv_mqa__dense_activation_relu__prompt_kernel:
    s_cmp_ge_u32 s2, 256
    s_cbranch_scc1 K1_nopf
    s_getpc_b64 s[58:59]
K1_pc:
    v_lshlrev_b32 v252, 7, v0
    v_min_u32 v252, K2_out-K1_pc, v252
    global_load_dword v253, v252, s[58:59]
K1_nopf:
    s_cmp_lt_u32 s2, 256
    s_cbranch_scc1 K1_go
    s_endpgm
K1_go:
    s_load_dwordx4 s[4:7], s[0:1], 0
    s_load_dwordx4 s[8:11], s[0:1], 16
    s_load_dwordx2 s[12:13], s[0:1], 32
    s_load_dwordx2 s[14:15], s[0:1], 80
    v_lshrrev_b32 v1, 6, v0
    v_and_b32 v0, 63, v0
    s_nop 0
    v_readfirstlane_b32 s3, v1
    v_and_b32 v1, 15, v0
    v_lshrrev_b32 v2, 4, v0
    s_mov_b32 s100, s3
    s_bfe_u32 s44, s2, 0x20001
    s_lshl_b32 s44, s44, 3
    s_bfe_u32 s61, s2, 0x30003
    s_add_u32 s44, s44, s61
    s_and_b32 s45, s2, 1
    s_lshl_b32 s45, s45, 2
    s_lshr_b32 s62, s2, 6
    s_add_u32 s45, s45, s62
    s_mul_i32 s60, s62, 9
    s_lshr_b32 s60, s60, 2
    s_add_u32 s60, s60, s61
    s_and_b32 s61, s2, 7
    s_add_u32 s60, s60, s61
    s_mul_i32 s61, s60, 1024
    s_lshr_b32 s61, s61, 12
    s_mul_i32 s61, s61, 4
    s_sub_u32 s71, s60, s61
    s_cmp_ge_u32 s45, 6
    s_cselect_b32 s71, 0, s71
    s_add_u32 s71, s71, 5
    s_mul_i32 s61, s60, 820
    s_lshr_b32 s61, s61, 12
    s_mul_i32 s61, s61, 5
    s_sub_u32 s60, s60, s61
    s_cmp_ge_u32 s45, 6
    s_cselect_b32 s60, 0, s60
    s_mov_b32 s63, 73728
    s_cselect_b32 s63, 86016, s63
    v_lshrrev_b32 v4, 3, v0
    v_and_b32 v5, 7, v0
    s_lshl_b32 s90, s45, 5
    s_add_u32 s90, s90, s44
    s_cmp_ge_u32 s3, 4
    s_cbranch_scc1 K1_ld
    s_lshl_b32 s46, s44, 6
    s_lshl_b32 s47, s3, 4
    s_add_u32 s46, s46, s47
    s_mul_i32 s47, s46, 1152
    v_xor_b32 v6, v4, v5
    v_mul_u32_u24 v3, 1152, v4
    v_lshl_add_u32 v3, v6, 4, v3
    v_add_u32 v6, 8192, v3
    s_lshl_b32 s61, s60, 7
    s_lshl_b32 s64, s3, 11
    s_add_u32 s64, s63, s64
    s_mov_b32 s66, s64
    s_waitcnt lgkmcnt(0)
    s_load_dword s101, s[14:15], 0
    s_mov_b32 s16, s4
    s_mov_b32 s17, s5
    s_mov_b32 s18, 2359296
    s_mov_b32 s19, 0x00020000
    s_mov_b32 s70, 3
K1_xl:
    s_mov_b32 m0, s64
    s_add_u32 s62, s47, s61
    s_add_u32 s64, s64, 8192
    buffer_load_dwordx4 v3, s[16:19], s62 offen lds
    buffer_load_dwordx4 v6, s[16:19], s62 offen offset:1024 lds
    s_add_u32 s61, s61, 128
    s_cmp_eq_u32 s61, 640
    s_cselect_b32 s61, 0, s61
    s_sub_u32 s70, s70, 1
    s_cmp_lg_u32 s70, 0
    s_cbranch_scc1 K1_xl
    s_branch K1_comp
K1_ld:
    s_setprio 3
    s_cmp_eq_u32 s45, 7
    s_cbranch_scc1 K1_worp
    s_sub_u32 s3, s3, 4
    s_cmp_lg_u32 s45, 6
    s_cbranch_scc1 K1_qld
    v_lshlrev_b32 v3, 4, v0
    s_and_b32 s48, s3, 1
    s_lshl_b32 s48, s48, 2
    s_mul_i32 s49, s3, 21504
    s_waitcnt lgkmcnt(0)
    s_load_dword s101, s[14:15], 0
    s_cmp_lt_u32 s3, 2
    s_cselect_b32 s24, s8, s10
    s_cselect_b32 s25, s9, s11
    s_mov_b32 s26, 20736
    s_mov_b32 s27, 0x00020000
    s_add_u32 s70, s49, 21504
K1_kl:
    s_mov_b32 m0, s49
    s_add_u32 s49, s49, 1024
    buffer_load_dwordx4 v3, s[24:27], s48 offen lds
    s_add_u32 s48, s48, 1024
    s_cmp_lg_u32 s49, s70
    s_cbranch_scc1 K1_kl
    s_branch K1_kvload
K1_qld:
    v_and_b32 v6, 1, v2
    s_and_b32 s48, s3, 1
    s_lshl_b32 s48, s48, 2
    v_lshlrev_b32 v6, 1, v6
    v_or_b32 v6, s48, v6
    v_xor_b32 v6, v6, v5
    v_mul_u32_u24 v3, 1152, v4
    v_lshl_add_u32 v3, v6, 4, v3
    v_lshrrev_b32 v7, 5, v0
    v_lshlrev_b32 v7, 1, v7
    v_and_b32 v6, 3, v0
    v_xor_b32 v7, v7, v6
    v_lshrrev_b32 v6, 2, v0
    v_mul_u32_u24 v6, 1152, v6
    v_lshl_add_u32 v6, v7, 4, v6
    s_mul_i32 s48, s45, 192
    s_and_b32 s53, s45, 1
    s_lshl_b32 s54, s53, 6
    s_add_u32 s49, s48, s54
    s_xor_b32 s53, s53, 1
    s_lshl_b32 s53, s53, 7
    s_add_u32 s50, s48, s53
    s_mul_i32 s53, s3, 9216
    s_add_u32 s49, s49, s53
    s_mul_i32 s53, s3, 18432
    s_add_u32 s50, s50, s53
    s_lshl_b32 s51, s3, 10
    s_lshr_b32 s52, s3, 1
    s_mul_i32 s52, s52, 6144
    s_and_b32 s53, s3, 1
    s_lshl_b32 s53, s53, 10
    s_add_u32 s52, s52, s53
    s_add_u32 s52, s52, 4096
    s_mul_i32 s61, s60, 73728
    s_waitcnt lgkmcnt(0)
    s_load_dword s101, s[14:15], 0
    s_mov_b32 s20, s6
    s_mov_b32 s21, s7
    s_mov_b32 s22, 663552
    s_mov_b32 s23, 0x00020000
    s_mov_b32 s70, 2
K1_wl:
    s_add_u32 s62, s49, s61
    s_add_u32 s65, s50, s61
    s_add_u32 s64, s62, 36864
    s_mov_b32 m0, s51
    s_add_u32 s51, s51, 6144
    buffer_load_dwordx4 v3, s[20:23], s62 offen lds
    s_mov_b32 m0, s52
    s_add_u32 s52, s52, 12288
    buffer_load_dwordx4 v6, s[20:23], s65 offen lds
    s_mov_b32 m0, s51
    s_add_u32 s51, s51, 6144
    buffer_load_dwordx4 v3, s[20:23], s64 offen lds
    s_add_u32 s61, s61, 73728
    s_cmp_eq_u32 s61, 368640
    s_cselect_b32 s61, 0, s61
    s_sub_u32 s70, s70, 1
    s_cmp_lg_u32 s70, 0
    s_cbranch_scc1 K1_wl
    v_lshrrev_b32 v10, 2, v1
    v_and_b32 v11, 3, v1
    v_lshl_add_u32 v12, v2, 3, v10
    s_lshl_b32 s66, s3, 11
    s_add_u32 s66, s66, s63
    s_lshr_b32 s67, s3, 1
    v_and_b32 v7, 7, v1
    v_xor_b32 v8, v2, v7
    v_lshlrev_b32 v8, 4, v8
    v_lshl_add_u32 v8, v1, 7, v8
    v_add_u32 v8, s66, v8
    v_xor_b32 v9, 64, v8
    v_add_u32 v190, 0x8000, v8
    v_add_u32 v191, 0x8000, v9
    v_lshrrev_b32 v13, 1, v10
    v_and_b32 v14, 1, v2
    v_lshl_add_u32 v13, v14, 1, v13
    v_lshlrev_b32 v15, 7, v12
    v_lshl_add_u32 v15, v11, 3, v15
    v_lshlrev_b32 v7, 6, v12
    v_lshl_add_u32 v7, v11, 3, v7
    v_add_u32 v7, 4096, v7
    s_cmp_eq_u32 s67, 1
    s_cselect_b64 vcc, -1, 0
    s_mul_i32 s55, s67, 3
    v_xor_b32 v184, s55, v13
    v_lshl_add_u32 v172, v184, 5, v15
    v_add_u32 v175, 512, v172
    v_xor_b32 v184, 1, v13
    v_lshl_add_u32 v184, v184, 5, v15
    v_xor_b32 v185, 0, v14
    v_lshl_add_u32 v185, v185, 5, v7
    v_cndmask_b32 v173, v184, v185, vcc
    v_add_u32 v184, 512, v184
    v_add_u32 v185, 256, v185
    v_cndmask_b32 v176, v184, v185, vcc
    v_xor_b32 v184, 2, v13
    v_lshl_add_u32 v184, v184, 5, v15
    v_xor_b32 v185, 1, v14
    v_lshl_add_u32 v185, v185, 5, v7
    v_cndmask_b32 v174, v184, v185, vcc
    v_add_u32 v184, 512, v184
    v_add_u32 v185, 256, v185
    v_cndmask_b32 v177, v184, v185, vcc
    v_add_u32 v178, 55296, v172
    v_add_u32 v179, 55296, v173
    v_add_u32 v180, 55296, v174
    v_add_u32 v181, 55296, v175
    v_add_u32 v182, 55296, v176
    v_add_u32 v183, 55296, v177
    s_and_b32 s55, s3, 1
    s_mul_i32 s55, s55, 6144
    v_add_u32 v172, s55, v172
    v_add_u32 v173, s55, v173
    v_add_u32 v174, s55, v174
    v_add_u32 v175, s55, v175
    v_add_u32 v176, s55, v176
    v_add_u32 v177, s55, v177
    v_add_u32 v178, s55, v178
    v_add_u32 v179, s55, v179
    v_add_u32 v180, s55, v180
    v_add_u32 v181, s55, v181
    v_add_u32 v182, s55, v182
    v_add_u32 v183, s55, v183
    v_mov_b32 v168, 1065369472
    v_mov_b32 v169, 1065369472
    v_mov_b32 v170, 1065369472
    v_mov_b32 v171, 1065369472
    s_waitcnt vmcnt(3) lgkmcnt(0)
    s_barrier
    ds_read_b128 v[16:19], v8 offset:0
    ds_read_b128 v[20:23], v9 offset:0
    ds_read_b64_tr_b16 v[24:25], v172 offset:0
    ds_read_b64_tr_b16 v[26:27], v175 offset:0
    ds_read_b64_tr_b16 v[28:29], v173 offset:0
    ds_read_b64_tr_b16 v[30:31], v176 offset:0
    ds_read_b64_tr_b16 v[32:33], v174 offset:0
    ds_read_b64_tr_b16 v[34:35], v177 offset:0
    s_add_u32 s62, s49, s61
    s_add_u32 s65, s50, s61
    s_add_u32 s64, s62, 36864
    s_mov_b32 m0, s51
    s_add_u32 s51, s51, 6144
    buffer_load_dwordx4 v3, s[20:23], s62 offen lds
    s_mov_b32 m0, s52
    s_add_u32 s52, s52, 12288
    buffer_load_dwordx4 v6, s[20:23], s65 offen lds
    s_mov_b32 m0, s51
    s_add_u32 s51, s51, 6144
    buffer_load_dwordx4 v3, s[20:23], s64 offen lds
    s_add_u32 s61, s61, 73728
    s_cmp_eq_u32 s61, 368640
    s_cselect_b32 s61, 0, s61
    s_waitcnt vmcnt(3) lgkmcnt(0)
    s_barrier
    ds_read_b128 v[36:39], v8 offset:8192
    ds_read_b128 v[40:43], v9 offset:8192
    ds_read_b64_tr_b16 v[44:45], v172 offset:12288
    ds_read_b64_tr_b16 v[46:47], v175 offset:12288
    ds_read_b64_tr_b16 v[48:49], v173 offset:12288
    ds_read_b64_tr_b16 v[50:51], v176 offset:12288
    ds_read_b64_tr_b16 v[52:53], v174 offset:12288
    ds_read_b64_tr_b16 v[54:55], v177 offset:12288
    v_mfma_f32_16x16x32_bf16 v[112:115], v[168:171], v[16:19], 0
    v_mfma_f32_16x16x32_bf16 v[116:119], v[16:19], v[16:19], 0
    v_mfma_f32_16x16x32_bf16 v[112:115], v[168:171], v[20:23], v[112:115]
    v_mfma_f32_16x16x32_bf16 v[116:119], v[20:23], v[20:23], v[116:119]
    v_mfma_f32_16x16x32_bf16 v[192:195], v[24:27], v[168:171], 0
    v_mfma_f32_16x16x32_bf16 v[196:199], v[28:31], v[168:171], 0
    v_mfma_f32_16x16x32_bf16 v[200:203], v[32:35], v[168:171], 0
    s_add_u32 s62, s49, s61
    s_add_u32 s65, s50, s61
    s_add_u32 s64, s62, 36864
    s_mov_b32 m0, s51
    s_add_u32 s51, s51, 6144
    buffer_load_dwordx4 v3, s[20:23], s62 offen lds
    s_mov_b32 m0, s52
    s_add_u32 s52, s52, 12288
    buffer_load_dwordx4 v6, s[20:23], s65 offen lds
    s_mov_b32 m0, s51
    s_add_u32 s51, s51, 6144
    buffer_load_dwordx4 v3, s[20:23], s64 offen lds
    s_add_u32 s61, s61, 73728
    s_cmp_eq_u32 s61, 368640
    s_cselect_b32 s61, 0, s61
    s_waitcnt vmcnt(3) lgkmcnt(0)
    s_barrier
    ds_read_b128 v[16:19], v8 offset:16384
    ds_read_b128 v[20:23], v9 offset:16384
    ds_read_b64_tr_b16 v[24:25], v172 offset:24576
    ds_read_b64_tr_b16 v[26:27], v175 offset:24576
    ds_read_b64_tr_b16 v[28:29], v173 offset:24576
    ds_read_b64_tr_b16 v[30:31], v176 offset:24576
    ds_read_b64_tr_b16 v[32:33], v174 offset:24576
    ds_read_b64_tr_b16 v[34:35], v177 offset:24576
    v_mfma_f32_16x16x32_bf16 v[112:115], v[168:171], v[36:39], v[112:115]
    v_mfma_f32_16x16x32_bf16 v[116:119], v[36:39], v[36:39], v[116:119]
    v_mfma_f32_16x16x32_bf16 v[112:115], v[168:171], v[40:43], v[112:115]
    v_mfma_f32_16x16x32_bf16 v[116:119], v[40:43], v[40:43], v[116:119]
    v_mfma_f32_16x16x32_bf16 v[192:195], v[44:47], v[168:171], v[192:195]
    v_mfma_f32_16x16x32_bf16 v[196:199], v[48:51], v[168:171], v[196:199]
    v_mfma_f32_16x16x32_bf16 v[200:203], v[52:55], v[168:171], v[200:203]
    s_add_u32 s62, s49, s61
    s_add_u32 s65, s50, s61
    s_add_u32 s64, s62, 36864
    s_mov_b32 m0, s51
    s_add_u32 s51, s51, 6144
    buffer_load_dwordx4 v3, s[20:23], s62 offen lds
    s_mov_b32 m0, s52
    s_add_u32 s52, s52, 12288
    buffer_load_dwordx4 v6, s[20:23], s65 offen lds
    s_mov_b32 m0, s51
    s_add_u32 s51, s51, 6144
    buffer_load_dwordx4 v3, s[20:23], s64 offen lds
    s_mul_i32 s61, s71, 73728
    s_waitcnt vmcnt(3) lgkmcnt(0)
    s_barrier
    ds_read_b128 v[36:39], v8 offset:24576
    ds_read_b128 v[40:43], v9 offset:24576
    ds_read_b64_tr_b16 v[44:45], v172 offset:36864
    ds_read_b64_tr_b16 v[46:47], v175 offset:36864
    ds_read_b64_tr_b16 v[48:49], v173 offset:36864
    ds_read_b64_tr_b16 v[50:51], v176 offset:36864
    ds_read_b64_tr_b16 v[52:53], v174 offset:36864
    ds_read_b64_tr_b16 v[54:55], v177 offset:36864
    v_mfma_f32_16x16x32_bf16 v[112:115], v[168:171], v[16:19], v[112:115]
    v_mfma_f32_16x16x32_bf16 v[116:119], v[16:19], v[16:19], v[116:119]
    v_mfma_f32_16x16x32_bf16 v[112:115], v[168:171], v[20:23], v[112:115]
    v_mfma_f32_16x16x32_bf16 v[116:119], v[20:23], v[20:23], v[116:119]
    v_mfma_f32_16x16x32_bf16 v[192:195], v[24:27], v[168:171], v[192:195]
    v_mfma_f32_16x16x32_bf16 v[196:199], v[28:31], v[168:171], v[196:199]
    v_mfma_f32_16x16x32_bf16 v[200:203], v[32:35], v[168:171], v[200:203]
    s_add_u32 s62, s49, s61
    s_add_u32 s65, s50, s61
    s_add_u32 s64, s62, 36864
    s_mov_b32 m0, s51
    s_add_u32 s51, s51, 6144
    buffer_load_dwordx4 v3, s[20:23], s62 offen lds
    s_mov_b32 m0, s52
    s_add_u32 s52, s52, 12288
    buffer_load_dwordx4 v6, s[20:23], s65 offen lds
    s_mov_b32 m0, s51
    s_add_u32 s51, s51, 6144
    buffer_load_dwordx4 v3, s[20:23], s64 offen lds
    s_add_u32 s61, s61, 73728
    s_cmp_eq_u32 s61, 663552
    s_cselect_b32 s61, 368640, s61
    s_waitcnt vmcnt(3) lgkmcnt(0)
    s_barrier
    ds_read_b128 v[16:19], v190 offset:0
    ds_read_b128 v[20:23], v191 offset:0
    ds_read_b64_tr_b16 v[24:25], v172 offset:49152
    ds_read_b64_tr_b16 v[26:27], v175 offset:49152
    ds_read_b64_tr_b16 v[28:29], v173 offset:49152
    ds_read_b64_tr_b16 v[30:31], v176 offset:49152
    ds_read_b64_tr_b16 v[32:33], v174 offset:49152
    ds_read_b64_tr_b16 v[34:35], v177 offset:49152
    v_mfma_f32_16x16x32_bf16 v[112:115], v[168:171], v[36:39], v[112:115]
    v_mfma_f32_16x16x32_bf16 v[116:119], v[36:39], v[36:39], v[116:119]
    v_mfma_f32_16x16x32_bf16 v[112:115], v[168:171], v[40:43], v[112:115]
    v_mfma_f32_16x16x32_bf16 v[116:119], v[40:43], v[40:43], v[116:119]
    v_mfma_f32_16x16x32_bf16 v[192:195], v[44:47], v[168:171], v[192:195]
    v_mfma_f32_16x16x32_bf16 v[196:199], v[48:51], v[168:171], v[196:199]
    v_mfma_f32_16x16x32_bf16 v[200:203], v[52:55], v[168:171], v[200:203]
    s_add_u32 s62, s49, s61
    s_add_u32 s65, s50, s61
    s_add_u32 s64, s62, 36864
    s_mov_b32 m0, s51
    s_add_u32 s51, s51, 6144
    buffer_load_dwordx4 v3, s[20:23], s62 offen lds
    s_mov_b32 m0, s52
    s_add_u32 s52, s52, 12288
    buffer_load_dwordx4 v6, s[20:23], s65 offen lds
    s_mov_b32 m0, s51
    s_add_u32 s51, s51, 6144
    buffer_load_dwordx4 v3, s[20:23], s64 offen lds
    s_add_u32 s61, s61, 73728
    s_cmp_eq_u32 s61, 663552
    s_cselect_b32 s61, 368640, s61
    s_waitcnt vmcnt(3) lgkmcnt(0)
    s_barrier
    ds_read_b128 v[36:39], v190 offset:8192
    ds_read_b128 v[40:43], v191 offset:8192
    ds_read_b64_tr_b16 v[44:45], v178 offset:6144
    ds_read_b64_tr_b16 v[46:47], v181 offset:6144
    ds_read_b64_tr_b16 v[48:49], v179 offset:6144
    ds_read_b64_tr_b16 v[50:51], v182 offset:6144
    ds_read_b64_tr_b16 v[52:53], v180 offset:6144
    ds_read_b64_tr_b16 v[54:55], v183 offset:6144
    v_mfma_f32_16x16x32_bf16 v[112:115], v[168:171], v[16:19], v[112:115]
    v_mfma_f32_16x16x32_bf16 v[116:119], v[16:19], v[16:19], v[116:119]
    v_mfma_f32_16x16x32_bf16 v[112:115], v[168:171], v[20:23], v[112:115]
    v_mfma_f32_16x16x32_bf16 v[116:119], v[20:23], v[20:23], v[116:119]
    v_mfma_f32_16x16x32_bf16 v[192:195], v[24:27], v[168:171], v[192:195]
    v_mfma_f32_16x16x32_bf16 v[196:199], v[28:31], v[168:171], v[196:199]
    v_mfma_f32_16x16x32_bf16 v[200:203], v[32:35], v[168:171], v[200:203]
    s_add_u32 s62, s49, s61
    s_add_u32 s65, s50, s61
    s_add_u32 s64, s62, 36864
    s_mov_b32 m0, s51
    s_add_u32 s51, s51, 6144
    buffer_load_dwordx4 v3, s[20:23], s62 offen lds
    s_mov_b32 m0, s52
    s_add_u32 s52, s52, 12288
    buffer_load_dwordx4 v6, s[20:23], s65 offen lds
    s_mov_b32 m0, s51
    s_add_u32 s51, s51, 6144
    buffer_load_dwordx4 v3, s[20:23], s64 offen lds
    s_add_u32 s61, s61, 73728
    s_cmp_eq_u32 s61, 663552
    s_cselect_b32 s61, 368640, s61
    s_waitcnt vmcnt(3) lgkmcnt(0)
    s_barrier
    ds_read_b128 v[16:19], v190 offset:16384
    ds_read_b128 v[20:23], v191 offset:16384
    ds_read_b64_tr_b16 v[24:25], v178 offset:18432
    ds_read_b64_tr_b16 v[26:27], v181 offset:18432
    ds_read_b64_tr_b16 v[28:29], v179 offset:18432
    ds_read_b64_tr_b16 v[30:31], v182 offset:18432
    ds_read_b64_tr_b16 v[32:33], v180 offset:18432
    ds_read_b64_tr_b16 v[34:35], v183 offset:18432
    v_mfma_f32_16x16x32_bf16 v[112:115], v[168:171], v[36:39], v[112:115]
    v_mfma_f32_16x16x32_bf16 v[116:119], v[36:39], v[36:39], v[116:119]
    v_mfma_f32_16x16x32_bf16 v[112:115], v[168:171], v[40:43], v[112:115]
    v_mfma_f32_16x16x32_bf16 v[116:119], v[40:43], v[40:43], v[116:119]
    v_mfma_f32_16x16x32_bf16 v[192:195], v[44:47], v[168:171], v[192:195]
    v_mfma_f32_16x16x32_bf16 v[196:199], v[48:51], v[168:171], v[196:199]
    v_mfma_f32_16x16x32_bf16 v[200:203], v[52:55], v[168:171], v[200:203]
    s_add_u32 s62, s49, s61
    s_add_u32 s65, s50, s61
    s_add_u32 s64, s62, 36864
    s_mov_b32 m0, s51
    s_add_u32 s51, s51, 6144
    buffer_load_dwordx4 v3, s[20:23], s62 offen lds
    s_mov_b32 m0, s52
    s_add_u32 s52, s52, 12288
    buffer_load_dwordx4 v6, s[20:23], s65 offen lds
    s_mov_b32 m0, s51
    s_add_u32 s51, s51, 6144
    buffer_load_dwordx4 v3, s[20:23], s64 offen lds
    s_add_u32 s61, s61, 73728
    s_cmp_eq_u32 s61, 663552
    s_cselect_b32 s61, 368640, s61
    s_waitcnt vmcnt(3) lgkmcnt(0)
    s_barrier
    ds_read_b128 v[36:39], v190 offset:24576
    ds_read_b128 v[40:43], v191 offset:24576
    ds_read_b128 v[56:59], v190 offset:32768
    ds_read_b128 v[60:63], v191 offset:32768
    ds_read_b64_tr_b16 v[44:45], v178 offset:30720
    ds_read_b64_tr_b16 v[46:47], v181 offset:30720
    ds_read_b64_tr_b16 v[48:49], v179 offset:30720
    ds_read_b64_tr_b16 v[50:51], v182 offset:30720
    ds_read_b64_tr_b16 v[52:53], v180 offset:30720
    ds_read_b64_tr_b16 v[54:55], v183 offset:30720
    v_mfma_f32_16x16x32_bf16 v[112:115], v[168:171], v[16:19], v[112:115]
    v_mfma_f32_16x16x32_bf16 v[116:119], v[16:19], v[16:19], v[116:119]
    v_mfma_f32_16x16x32_bf16 v[112:115], v[168:171], v[20:23], v[112:115]
    v_mfma_f32_16x16x32_bf16 v[116:119], v[20:23], v[20:23], v[116:119]
    v_mfma_f32_16x16x32_bf16 v[192:195], v[24:27], v[168:171], v[192:195]
    v_mfma_f32_16x16x32_bf16 v[196:199], v[28:31], v[168:171], v[196:199]
    v_mfma_f32_16x16x32_bf16 v[200:203], v[32:35], v[168:171], v[200:203]
    s_waitcnt vmcnt(0) lgkmcnt(0)
    s_barrier
    ds_read_b64_tr_b16 v[24:25], v178 offset:43008
    ds_read_b64_tr_b16 v[26:27], v181 offset:43008
    ds_read_b64_tr_b16 v[28:29], v179 offset:43008
    ds_read_b64_tr_b16 v[30:31], v182 offset:43008
    ds_read_b64_tr_b16 v[32:33], v180 offset:43008
    ds_read_b64_tr_b16 v[34:35], v183 offset:43008
    v_mfma_f32_16x16x32_bf16 v[112:115], v[168:171], v[36:39], v[112:115]
    v_mfma_f32_16x16x32_bf16 v[116:119], v[36:39], v[36:39], v[116:119]
    v_mfma_f32_16x16x32_bf16 v[112:115], v[168:171], v[40:43], v[112:115]
    v_mfma_f32_16x16x32_bf16 v[116:119], v[40:43], v[40:43], v[116:119]
    v_mfma_f32_16x16x32_bf16 v[112:115], v[168:171], v[56:59], v[112:115]
    v_mfma_f32_16x16x32_bf16 v[116:119], v[56:59], v[56:59], v[116:119]
    v_mfma_f32_16x16x32_bf16 v[112:115], v[168:171], v[60:63], v[112:115]
    v_mfma_f32_16x16x32_bf16 v[116:119], v[60:63], v[60:63], v[116:119]
    v_mfma_f32_16x16x32_bf16 v[192:195], v[44:47], v[168:171], v[192:195]
    v_mfma_f32_16x16x32_bf16 v[196:199], v[48:51], v[168:171], v[196:199]
    v_mfma_f32_16x16x32_bf16 v[200:203], v[52:55], v[168:171], v[200:203]
    v_cmp_eq_u32 vcc, 1, v11
    v_cmp_eq_u32 s[54:55], 2, v11
    v_cmp_eq_u32 s[56:57], 3, v11
    v_cmp_eq_u32 s[58:59], v10, v2
    s_nop 3
    v_mul_f32 v4, 3135475257, v112
    v_cndmask_b32 v5, v116, v117, vcc
    v_cndmask_b32 v5, v5, v118, s[54:55]
    v_cndmask_b32 v5, v5, v119, s[56:57]
    v_cndmask_b32 v5, 0, v5, s[58:59]
    v_mov_b32 v7, v5
    s_nop 1
    v_permlane32_swap_b32 v5, v7
    s_nop 1
    v_add_f32 v5, v5, v7
    v_mov_b32 v7, v5
    s_nop 1
    v_permlane16_swap_b32 v5, v7
    s_nop 1
    v_add_f32 v5, v5, v7
    v_mul_f32 v5, 987991609, v5
    v_fma_f32 v5, -v4, v4, v5
    v_max_f32 v5, 0, v5
    v_add_f32 v5, 925353388, v5
    v_rsq_f32 v5, v5
    s_lshl_b32 s54, s3, 7
    s_add_u32 s54, s54, 160512
    v_lshlrev_b32 v7, 3, v1
    v_add_u32 v7, s54, v7
    ds_write_b64 v7, v[4:5]
    s_waitcnt lgkmcnt(0)
    v_mfma_f32_16x16x32_bf16 v[192:195], v[24:27], v[168:171], v[192:195]
    v_mfma_f32_16x16x32_bf16 v[196:199], v[28:31], v[168:171], v[196:199]
    v_mfma_f32_16x16x32_bf16 v[200:203], v[32:35], v[168:171], v[200:203]
    s_mul_i32 s54, s3, 192
    s_add_u32 s54, s54, 159744
    v_lshlrev_b32 v7, 4, v2
    v_add_u32 v7, s54, v7
    s_nop 3
    ds_write_b128 v7, v[192:195] offset:0
    ds_write_b128 v7, v[196:199] offset:64
    ds_write_b128 v7, v[200:203] offset:128
    s_waitcnt lgkmcnt(0)
    s_barrier
    s_branch K1_fin
K1_comp:
    v_lshrrev_b32 v10, 2, v1
    v_and_b32 v11, 3, v1
    v_lshl_add_u32 v12, v2, 3, v10
    s_cmp_ge_u32 s45, 6
    s_cbranch_scc1 K1_kvgemm
    s_and_b32 s68, s3, 1
    s_lshl_b32 s66, s68, 12
    s_add_u32 s66, s66, s63
    s_lshr_b32 s67, s3, 1
    v_and_b32 v7, 7, v1
    v_xor_b32 v8, v2, v7
    v_lshlrev_b32 v8, 4, v8
    v_lshl_add_u32 v8, v1, 7, v8
    v_add_u32 v8, s66, v8
    v_xor_b32 v9, 64, v8
    v_add_u32 v190, 0x8000, v8
    v_add_u32 v191, 0x8000, v9
    v_lshrrev_b32 v13, 1, v10
    v_and_b32 v14, 1, v2
    v_lshl_add_u32 v13, v14, 1, v13
    v_lshlrev_b32 v15, 7, v12
    v_lshl_add_u32 v15, v11, 3, v15
    v_lshlrev_b32 v7, 6, v12
    v_lshl_add_u32 v7, v11, 3, v7
    v_add_u32 v7, 4096, v7
    s_cmp_eq_u32 s67, 1
    s_cselect_b64 vcc, -1, 0
    s_mul_i32 s55, s67, 3
    v_xor_b32 v184, s55, v13
    v_lshl_add_u32 v172, v184, 5, v15
    v_add_u32 v175, 512, v172
    v_xor_b32 v184, 1, v13
    v_lshl_add_u32 v184, v184, 5, v15
    v_xor_b32 v185, 0, v14
    v_lshl_add_u32 v185, v185, 5, v7
    v_cndmask_b32 v173, v184, v185, vcc
    v_add_u32 v184, 512, v184
    v_add_u32 v185, 256, v185
    v_cndmask_b32 v176, v184, v185, vcc
    v_xor_b32 v184, 2, v13
    v_lshl_add_u32 v184, v184, 5, v15
    v_xor_b32 v185, 1, v14
    v_lshl_add_u32 v185, v185, 5, v7
    v_cndmask_b32 v174, v184, v185, vcc
    v_add_u32 v184, 512, v184
    v_add_u32 v185, 256, v185
    v_cndmask_b32 v177, v184, v185, vcc
    v_add_u32 v178, 55296, v172
    v_add_u32 v179, 55296, v173
    v_add_u32 v180, 55296, v174
    v_add_u32 v181, 55296, v175
    v_add_u32 v182, 55296, v176
    v_add_u32 v183, 55296, v177
    s_add_u32 s32, s14, 4096
    s_addc_u32 s33, s15, 0
    s_mov_b32 s34, 2359296
    s_mov_b32 s35, 0x00020000
    s_waitcnt vmcnt(4)
    s_barrier
    ds_read_b128 v[16:19], v8 offset:0
    ds_read_b128 v[20:23], v8 offset:2048
    ds_read_b64_tr_b16 v[24:25], v172 offset:0
    ds_read_b64_tr_b16 v[26:27], v175 offset:0
    ds_read_b64_tr_b16 v[28:29], v173 offset:0
    ds_read_b64_tr_b16 v[30:31], v176 offset:0
    ds_read_b64_tr_b16 v[32:33], v174 offset:0
    ds_read_b64_tr_b16 v[34:35], v177 offset:0
    s_waitcnt lgkmcnt(4)
    v_mfma_f32_16x16x32_bf16 v[88:91], v[24:27], v[16:19], 0
    ds_read_b128 v[36:39], v9 offset:0
    ds_read_b128 v[40:43], v9 offset:2048
    v_mfma_f32_16x16x32_bf16 v[92:95], v[24:27], v[20:23], 0
    ds_read_b64_tr_b16 v[44:45], v172 offset:6144
    ds_read_b64_tr_b16 v[46:47], v175 offset:6144
    s_waitcnt lgkmcnt(6)
    v_mfma_f32_16x16x32_bf16 v[96:99], v[28:31], v[16:19], 0
    ds_read_b64_tr_b16 v[48:49], v173 offset:6144
    ds_read_b64_tr_b16 v[50:51], v176 offset:6144
    v_mfma_f32_16x16x32_bf16 v[100:103], v[28:31], v[20:23], 0
    ds_read_b64_tr_b16 v[52:53], v174 offset:6144
    ds_read_b64_tr_b16 v[54:55], v177 offset:6144
    s_waitcnt lgkmcnt(8)
    v_mfma_f32_16x16x32_bf16 v[104:107], v[32:35], v[16:19], 0
    v_mfma_f32_16x16x32_bf16 v[108:111], v[32:35], v[20:23], 0
    s_mov_b32 m0, s64
    s_add_u32 s62, s47, s61
    s_add_u32 s64, s64, 8192
    buffer_load_dwordx4 v3, s[16:19], s62 offen lds
    buffer_load_dwordx4 v6, s[16:19], s62 offen offset:1024 lds
    s_add_u32 s61, s61, 128
    s_cmp_eq_u32 s61, 640
    s_cselect_b32 s61, 0, s61
    s_waitcnt vmcnt(4)
    s_barrier
    s_waitcnt lgkmcnt(4)
    v_mfma_f32_16x16x32_bf16 v[88:91], v[44:47], v[36:39], v[88:91]
    ds_read_b128 v[16:19], v8 offset:8192
    ds_read_b128 v[20:23], v8 offset:10240
    v_mfma_f32_16x16x32_bf16 v[92:95], v[44:47], v[40:43], v[92:95]
    ds_read_b64_tr_b16 v[24:25], v172 offset:12288
    ds_read_b64_tr_b16 v[26:27], v175 offset:12288
    s_waitcnt lgkmcnt(6)
    v_mfma_f32_16x16x32_bf16 v[96:99], v[48:51], v[36:39], v[96:99]
    ds_read_b64_tr_b16 v[28:29], v173 offset:12288
    ds_read_b64_tr_b16 v[30:31], v176 offset:12288
    v_mfma_f32_16x16x32_bf16 v[100:103], v[48:51], v[40:43], v[100:103]
    ds_read_b64_tr_b16 v[32:33], v174 offset:12288
    ds_read_b64_tr_b16 v[34:35], v177 offset:12288
    s_waitcnt lgkmcnt(8)
    v_mfma_f32_16x16x32_bf16 v[104:107], v[52:55], v[36:39], v[104:107]
    v_mfma_f32_16x16x32_bf16 v[108:111], v[52:55], v[40:43], v[108:111]
    s_waitcnt lgkmcnt(4)
    v_mfma_f32_16x16x32_bf16 v[88:91], v[24:27], v[16:19], v[88:91]
    ds_read_b128 v[36:39], v9 offset:8192
    ds_read_b128 v[40:43], v9 offset:10240
    v_mfma_f32_16x16x32_bf16 v[92:95], v[24:27], v[20:23], v[92:95]
    ds_read_b64_tr_b16 v[44:45], v172 offset:18432
    ds_read_b64_tr_b16 v[46:47], v175 offset:18432
    s_waitcnt lgkmcnt(6)
    v_mfma_f32_16x16x32_bf16 v[96:99], v[28:31], v[16:19], v[96:99]
    ds_read_b64_tr_b16 v[48:49], v173 offset:18432
    ds_read_b64_tr_b16 v[50:51], v176 offset:18432
    v_mfma_f32_16x16x32_bf16 v[100:103], v[28:31], v[20:23], v[100:103]
    ds_read_b64_tr_b16 v[52:53], v174 offset:18432
    ds_read_b64_tr_b16 v[54:55], v177 offset:18432
    s_waitcnt lgkmcnt(8)
    v_mfma_f32_16x16x32_bf16 v[104:107], v[32:35], v[16:19], v[104:107]
    v_mfma_f32_16x16x32_bf16 v[108:111], v[32:35], v[20:23], v[108:111]
    s_mov_b32 m0, s64
    s_add_u32 s62, s47, s61
    s_add_u32 s64, s64, 8192
    buffer_load_dwordx4 v3, s[16:19], s62 offen lds
    buffer_load_dwordx4 v6, s[16:19], s62 offen offset:1024 lds
    s_mul_i32 s61, s71, 128
    s_waitcnt vmcnt(4)
    s_barrier
    s_waitcnt lgkmcnt(4)
    v_mfma_f32_16x16x32_bf16 v[88:91], v[44:47], v[36:39], v[88:91]
    ds_read_b128 v[16:19], v8 offset:16384
    ds_read_b128 v[20:23], v8 offset:18432
    v_mfma_f32_16x16x32_bf16 v[92:95], v[44:47], v[40:43], v[92:95]
    ds_read_b64_tr_b16 v[24:25], v172 offset:24576
    ds_read_b64_tr_b16 v[26:27], v175 offset:24576
    s_waitcnt lgkmcnt(6)
    v_mfma_f32_16x16x32_bf16 v[96:99], v[48:51], v[36:39], v[96:99]
    ds_read_b64_tr_b16 v[28:29], v173 offset:24576
    ds_read_b64_tr_b16 v[30:31], v176 offset:24576
    v_mfma_f32_16x16x32_bf16 v[100:103], v[48:51], v[40:43], v[100:103]
    ds_read_b64_tr_b16 v[32:33], v174 offset:24576
    ds_read_b64_tr_b16 v[34:35], v177 offset:24576
    s_waitcnt lgkmcnt(8)
    v_mfma_f32_16x16x32_bf16 v[104:107], v[52:55], v[36:39], v[104:107]
    v_mfma_f32_16x16x32_bf16 v[108:111], v[52:55], v[40:43], v[108:111]
    s_waitcnt lgkmcnt(4)
    v_mfma_f32_16x16x32_bf16 v[88:91], v[24:27], v[16:19], v[88:91]
    ds_read_b128 v[36:39], v9 offset:16384
    ds_read_b128 v[40:43], v9 offset:18432
    v_mfma_f32_16x16x32_bf16 v[92:95], v[24:27], v[20:23], v[92:95]
    ds_read_b64_tr_b16 v[44:45], v172 offset:30720
    ds_read_b64_tr_b16 v[46:47], v175 offset:30720
    s_waitcnt lgkmcnt(6)
    v_mfma_f32_16x16x32_bf16 v[96:99], v[28:31], v[16:19], v[96:99]
    ds_read_b64_tr_b16 v[48:49], v173 offset:30720
    ds_read_b64_tr_b16 v[50:51], v176 offset:30720
    v_mfma_f32_16x16x32_bf16 v[100:103], v[28:31], v[20:23], v[100:103]
    ds_read_b64_tr_b16 v[52:53], v174 offset:30720
    ds_read_b64_tr_b16 v[54:55], v177 offset:30720
    s_waitcnt lgkmcnt(8)
    v_mfma_f32_16x16x32_bf16 v[104:107], v[32:35], v[16:19], v[104:107]
    v_mfma_f32_16x16x32_bf16 v[108:111], v[32:35], v[20:23], v[108:111]
    s_mov_b32 m0, s64
    s_add_u32 s62, s47, s61
    s_add_u32 s64, s64, 8192
    buffer_load_dwordx4 v3, s[16:19], s62 offen lds
    buffer_load_dwordx4 v6, s[16:19], s62 offen offset:1024 lds
    s_add_u32 s61, s61, 128
    s_cmp_eq_u32 s61, 1152
    s_cselect_b32 s61, 640, s61
    s_waitcnt vmcnt(4)
    s_barrier
    s_waitcnt lgkmcnt(4)
    v_mfma_f32_16x16x32_bf16 v[88:91], v[44:47], v[36:39], v[88:91]
    ds_read_b128 v[16:19], v8 offset:24576
    ds_read_b128 v[20:23], v8 offset:26624
    v_mfma_f32_16x16x32_bf16 v[92:95], v[44:47], v[40:43], v[92:95]
    ds_read_b64_tr_b16 v[24:25], v172 offset:36864
    ds_read_b64_tr_b16 v[26:27], v175 offset:36864
    s_waitcnt lgkmcnt(6)
    v_mfma_f32_16x16x32_bf16 v[96:99], v[48:51], v[36:39], v[96:99]
    ds_read_b64_tr_b16 v[28:29], v173 offset:36864
    ds_read_b64_tr_b16 v[30:31], v176 offset:36864
    v_mfma_f32_16x16x32_bf16 v[100:103], v[48:51], v[40:43], v[100:103]
    ds_read_b64_tr_b16 v[32:33], v174 offset:36864
    ds_read_b64_tr_b16 v[34:35], v177 offset:36864
    s_waitcnt lgkmcnt(8)
    v_mfma_f32_16x16x32_bf16 v[104:107], v[52:55], v[36:39], v[104:107]
    v_mfma_f32_16x16x32_bf16 v[108:111], v[52:55], v[40:43], v[108:111]
    s_waitcnt lgkmcnt(4)
    v_mfma_f32_16x16x32_bf16 v[88:91], v[24:27], v[16:19], v[88:91]
    ds_read_b128 v[36:39], v9 offset:24576
    ds_read_b128 v[40:43], v9 offset:26624
    v_mfma_f32_16x16x32_bf16 v[92:95], v[24:27], v[20:23], v[92:95]
    ds_read_b64_tr_b16 v[44:45], v172 offset:43008
    ds_read_b64_tr_b16 v[46:47], v175 offset:43008
    s_waitcnt lgkmcnt(6)
    v_mfma_f32_16x16x32_bf16 v[96:99], v[28:31], v[16:19], v[96:99]
    ds_read_b64_tr_b16 v[48:49], v173 offset:43008
    ds_read_b64_tr_b16 v[50:51], v176 offset:43008
    v_mfma_f32_16x16x32_bf16 v[100:103], v[28:31], v[20:23], v[100:103]
    ds_read_b64_tr_b16 v[52:53], v174 offset:43008
    ds_read_b64_tr_b16 v[54:55], v177 offset:43008
    s_waitcnt lgkmcnt(8)
    v_mfma_f32_16x16x32_bf16 v[104:107], v[32:35], v[16:19], v[104:107]
    v_mfma_f32_16x16x32_bf16 v[108:111], v[32:35], v[20:23], v[108:111]
    s_mov_b32 m0, s64
    s_add_u32 s62, s47, s61
    s_add_u32 s64, s64, 8192
    buffer_load_dwordx4 v3, s[16:19], s62 offen lds
    buffer_load_dwordx4 v6, s[16:19], s62 offen offset:1024 lds
    s_add_u32 s61, s61, 128
    s_cmp_eq_u32 s61, 1152
    s_cselect_b32 s61, 640, s61
    s_waitcnt vmcnt(4)
    s_barrier
    s_waitcnt lgkmcnt(4)
    v_mfma_f32_16x16x32_bf16 v[88:91], v[44:47], v[36:39], v[88:91]
    ds_read_b128 v[16:19], v190 offset:0
    ds_read_b128 v[20:23], v190 offset:2048
    v_mfma_f32_16x16x32_bf16 v[92:95], v[44:47], v[40:43], v[92:95]
    ds_read_b64_tr_b16 v[24:25], v172 offset:49152
    ds_read_b64_tr_b16 v[26:27], v175 offset:49152
    s_waitcnt lgkmcnt(6)
    v_mfma_f32_16x16x32_bf16 v[96:99], v[48:51], v[36:39], v[96:99]
    ds_read_b64_tr_b16 v[28:29], v173 offset:49152
    ds_read_b64_tr_b16 v[30:31], v176 offset:49152
    v_mfma_f32_16x16x32_bf16 v[100:103], v[48:51], v[40:43], v[100:103]
    ds_read_b64_tr_b16 v[32:33], v174 offset:49152
    ds_read_b64_tr_b16 v[34:35], v177 offset:49152
    s_waitcnt lgkmcnt(8)
    v_mfma_f32_16x16x32_bf16 v[104:107], v[52:55], v[36:39], v[104:107]
    v_mfma_f32_16x16x32_bf16 v[108:111], v[52:55], v[40:43], v[108:111]
    s_waitcnt lgkmcnt(4)
    v_mfma_f32_16x16x32_bf16 v[88:91], v[24:27], v[16:19], v[88:91]
    ds_read_b128 v[36:39], v191 offset:0
    ds_read_b128 v[40:43], v191 offset:2048
    v_mfma_f32_16x16x32_bf16 v[92:95], v[24:27], v[20:23], v[92:95]
    ds_read_b64_tr_b16 v[44:45], v178 offset:0
    ds_read_b64_tr_b16 v[46:47], v181 offset:0
    s_waitcnt lgkmcnt(6)
    v_mfma_f32_16x16x32_bf16 v[96:99], v[28:31], v[16:19], v[96:99]
    ds_read_b64_tr_b16 v[48:49], v179 offset:0
    ds_read_b64_tr_b16 v[50:51], v182 offset:0
    v_mfma_f32_16x16x32_bf16 v[100:103], v[28:31], v[20:23], v[100:103]
    ds_read_b64_tr_b16 v[52:53], v180 offset:0
    ds_read_b64_tr_b16 v[54:55], v183 offset:0
    s_waitcnt lgkmcnt(8)
    v_mfma_f32_16x16x32_bf16 v[104:107], v[32:35], v[16:19], v[104:107]
    v_mfma_f32_16x16x32_bf16 v[108:111], v[32:35], v[20:23], v[108:111]
    s_mov_b32 m0, s64
    s_add_u32 s62, s47, s61
    s_add_u32 s64, s64, 8192
    buffer_load_dwordx4 v3, s[16:19], s62 offen lds
    buffer_load_dwordx4 v6, s[16:19], s62 offen offset:1024 lds
    s_add_u32 s61, s61, 128
    s_cmp_eq_u32 s61, 1152
    s_cselect_b32 s61, 640, s61
    s_waitcnt vmcnt(4) lgkmcnt(6)
    s_barrier
    s_waitcnt lgkmcnt(4)
    v_mfma_f32_16x16x32_bf16 v[88:91], v[44:47], v[36:39], v[88:91]
    ds_read_b128 v[16:19], v190 offset:8192
    ds_read_b128 v[20:23], v190 offset:10240
    v_mfma_f32_16x16x32_bf16 v[92:95], v[44:47], v[40:43], v[92:95]
    ds_read_b64_tr_b16 v[24:25], v178 offset:6144
    ds_read_b64_tr_b16 v[26:27], v181 offset:6144
    s_waitcnt lgkmcnt(6)
    v_mfma_f32_16x16x32_bf16 v[96:99], v[48:51], v[36:39], v[96:99]
    ds_read_b64_tr_b16 v[28:29], v179 offset:6144
    ds_read_b64_tr_b16 v[30:31], v182 offset:6144
    v_mfma_f32_16x16x32_bf16 v[100:103], v[48:51], v[40:43], v[100:103]
    ds_read_b64_tr_b16 v[32:33], v180 offset:6144
    ds_read_b64_tr_b16 v[34:35], v183 offset:6144
    s_waitcnt lgkmcnt(8)
    v_mfma_f32_16x16x32_bf16 v[104:107], v[52:55], v[36:39], v[104:107]
    v_mfma_f32_16x16x32_bf16 v[108:111], v[52:55], v[40:43], v[108:111]
    s_waitcnt lgkmcnt(4)
    v_mfma_f32_16x16x32_bf16 v[88:91], v[24:27], v[16:19], v[88:91]
    ds_read_b128 v[36:39], v191 offset:8192
    ds_read_b128 v[40:43], v191 offset:10240
    v_mfma_f32_16x16x32_bf16 v[92:95], v[24:27], v[20:23], v[92:95]
    ds_read_b64_tr_b16 v[44:45], v178 offset:12288
    ds_read_b64_tr_b16 v[46:47], v181 offset:12288
    s_waitcnt lgkmcnt(6)
    v_mfma_f32_16x16x32_bf16 v[96:99], v[28:31], v[16:19], v[96:99]
    ds_read_b64_tr_b16 v[48:49], v179 offset:12288
    ds_read_b64_tr_b16 v[50:51], v182 offset:12288
    v_mfma_f32_16x16x32_bf16 v[100:103], v[28:31], v[20:23], v[100:103]
    ds_read_b64_tr_b16 v[52:53], v180 offset:12288
    ds_read_b64_tr_b16 v[54:55], v183 offset:12288
    s_waitcnt lgkmcnt(8)
    v_mfma_f32_16x16x32_bf16 v[104:107], v[32:35], v[16:19], v[104:107]
    v_mfma_f32_16x16x32_bf16 v[108:111], v[32:35], v[20:23], v[108:111]
    s_mov_b32 m0, s64
    s_add_u32 s62, s47, s61
    s_add_u32 s64, s64, 8192
    buffer_load_dwordx4 v3, s[16:19], s62 offen lds
    buffer_load_dwordx4 v6, s[16:19], s62 offen offset:1024 lds
    s_add_u32 s61, s61, 128
    s_cmp_eq_u32 s61, 1152
    s_cselect_b32 s61, 640, s61
    s_waitcnt vmcnt(4)
    s_barrier
    s_waitcnt lgkmcnt(4)
    v_mfma_f32_16x16x32_bf16 v[88:91], v[44:47], v[36:39], v[88:91]
    ds_read_b128 v[16:19], v190 offset:16384
    ds_read_b128 v[20:23], v190 offset:18432
    v_mfma_f32_16x16x32_bf16 v[92:95], v[44:47], v[40:43], v[92:95]
    ds_read_b64_tr_b16 v[24:25], v178 offset:18432
    ds_read_b64_tr_b16 v[26:27], v181 offset:18432
    s_waitcnt lgkmcnt(6)
    v_mfma_f32_16x16x32_bf16 v[96:99], v[48:51], v[36:39], v[96:99]
    ds_read_b64_tr_b16 v[28:29], v179 offset:18432
    ds_read_b64_tr_b16 v[30:31], v182 offset:18432
    v_mfma_f32_16x16x32_bf16 v[100:103], v[48:51], v[40:43], v[100:103]
    ds_read_b64_tr_b16 v[32:33], v180 offset:18432
    ds_read_b64_tr_b16 v[34:35], v183 offset:18432
    s_waitcnt lgkmcnt(8)
    v_mfma_f32_16x16x32_bf16 v[104:107], v[52:55], v[36:39], v[104:107]
    v_mfma_f32_16x16x32_bf16 v[108:111], v[52:55], v[40:43], v[108:111]
    s_waitcnt lgkmcnt(4)
    v_mfma_f32_16x16x32_bf16 v[88:91], v[24:27], v[16:19], v[88:91]
    ds_read_b128 v[36:39], v191 offset:16384
    ds_read_b128 v[40:43], v191 offset:18432
    v_mfma_f32_16x16x32_bf16 v[92:95], v[24:27], v[20:23], v[92:95]
    ds_read_b64_tr_b16 v[44:45], v178 offset:24576
    ds_read_b64_tr_b16 v[46:47], v181 offset:24576
    s_waitcnt lgkmcnt(6)
    v_mfma_f32_16x16x32_bf16 v[96:99], v[28:31], v[16:19], v[96:99]
    ds_read_b64_tr_b16 v[48:49], v179 offset:24576
    ds_read_b64_tr_b16 v[50:51], v182 offset:24576
    v_mfma_f32_16x16x32_bf16 v[100:103], v[28:31], v[20:23], v[100:103]
    ds_read_b64_tr_b16 v[52:53], v180 offset:24576
    ds_read_b64_tr_b16 v[54:55], v183 offset:24576
    s_waitcnt lgkmcnt(8)
    v_mfma_f32_16x16x32_bf16 v[104:107], v[32:35], v[16:19], v[104:107]
    v_mfma_f32_16x16x32_bf16 v[108:111], v[32:35], v[20:23], v[108:111]
    s_waitcnt vmcnt(0)
    s_barrier
    s_waitcnt lgkmcnt(4)
    v_mfma_f32_16x16x32_bf16 v[88:91], v[44:47], v[36:39], v[88:91]
    ds_read_b128 v[16:19], v190 offset:24576
    ds_read_b128 v[20:23], v190 offset:26624
    v_mfma_f32_16x16x32_bf16 v[92:95], v[44:47], v[40:43], v[92:95]
    ds_read_b64_tr_b16 v[24:25], v178 offset:30720
    ds_read_b64_tr_b16 v[26:27], v181 offset:30720
    s_waitcnt lgkmcnt(6)
    v_mfma_f32_16x16x32_bf16 v[96:99], v[48:51], v[36:39], v[96:99]
    ds_read_b64_tr_b16 v[28:29], v179 offset:30720
    ds_read_b64_tr_b16 v[30:31], v182 offset:30720
    v_mfma_f32_16x16x32_bf16 v[100:103], v[48:51], v[40:43], v[100:103]
    ds_read_b64_tr_b16 v[32:33], v180 offset:30720
    ds_read_b64_tr_b16 v[34:35], v183 offset:30720
    s_waitcnt lgkmcnt(8)
    v_mfma_f32_16x16x32_bf16 v[104:107], v[52:55], v[36:39], v[104:107]
    v_mfma_f32_16x16x32_bf16 v[108:111], v[52:55], v[40:43], v[108:111]
    s_waitcnt lgkmcnt(4)
    v_mfma_f32_16x16x32_bf16 v[88:91], v[24:27], v[16:19], v[88:91]
    ds_read_b128 v[36:39], v191 offset:24576
    ds_read_b128 v[40:43], v191 offset:26624
    v_mfma_f32_16x16x32_bf16 v[92:95], v[24:27], v[20:23], v[92:95]
    ds_read_b64_tr_b16 v[44:45], v178 offset:36864
    ds_read_b64_tr_b16 v[46:47], v181 offset:36864
    s_waitcnt lgkmcnt(6)
    v_mfma_f32_16x16x32_bf16 v[96:99], v[28:31], v[16:19], v[96:99]
    ds_read_b64_tr_b16 v[48:49], v179 offset:36864
    ds_read_b64_tr_b16 v[50:51], v182 offset:36864
    v_mfma_f32_16x16x32_bf16 v[100:103], v[28:31], v[20:23], v[100:103]
    ds_read_b64_tr_b16 v[52:53], v180 offset:36864
    ds_read_b64_tr_b16 v[54:55], v183 offset:36864
    s_waitcnt lgkmcnt(8)
    v_mfma_f32_16x16x32_bf16 v[104:107], v[32:35], v[16:19], v[104:107]
    v_mfma_f32_16x16x32_bf16 v[108:111], v[32:35], v[20:23], v[108:111]
    s_waitcnt vmcnt(0)
    s_barrier
    s_waitcnt lgkmcnt(4)
    v_mfma_f32_16x16x32_bf16 v[88:91], v[44:47], v[36:39], v[88:91]
    ds_read_b128 v[16:19], v190 offset:32768
    ds_read_b128 v[20:23], v190 offset:34816
    v_mfma_f32_16x16x32_bf16 v[92:95], v[44:47], v[40:43], v[92:95]
    ds_read_b64_tr_b16 v[24:25], v178 offset:43008
    ds_read_b64_tr_b16 v[26:27], v181 offset:43008
    s_waitcnt lgkmcnt(6)
    v_mfma_f32_16x16x32_bf16 v[96:99], v[48:51], v[36:39], v[96:99]
    ds_read_b64_tr_b16 v[28:29], v179 offset:43008
    ds_read_b64_tr_b16 v[30:31], v182 offset:43008
    v_mfma_f32_16x16x32_bf16 v[100:103], v[48:51], v[40:43], v[100:103]
    ds_read_b64_tr_b16 v[32:33], v180 offset:43008
    ds_read_b64_tr_b16 v[34:35], v183 offset:43008
    s_waitcnt lgkmcnt(8)
    v_mfma_f32_16x16x32_bf16 v[104:107], v[52:55], v[36:39], v[104:107]
    v_mfma_f32_16x16x32_bf16 v[108:111], v[52:55], v[40:43], v[108:111]
    s_waitcnt lgkmcnt(4)
    v_mfma_f32_16x16x32_bf16 v[88:91], v[24:27], v[16:19], v[88:91]
    ds_read_b128 v[36:39], v191 offset:32768
    ds_read_b128 v[40:43], v191 offset:34816
    v_mfma_f32_16x16x32_bf16 v[92:95], v[24:27], v[20:23], v[92:95]
    ds_read_b64_tr_b16 v[44:45], v178 offset:49152
    ds_read_b64_tr_b16 v[46:47], v181 offset:49152
    s_waitcnt lgkmcnt(6)
    v_mfma_f32_16x16x32_bf16 v[96:99], v[28:31], v[16:19], v[96:99]
    ds_read_b64_tr_b16 v[48:49], v179 offset:49152
    ds_read_b64_tr_b16 v[50:51], v182 offset:49152
    v_mfma_f32_16x16x32_bf16 v[100:103], v[28:31], v[20:23], v[100:103]
    ds_read_b64_tr_b16 v[52:53], v180 offset:49152
    ds_read_b64_tr_b16 v[54:55], v183 offset:49152
    s_waitcnt lgkmcnt(8)
    v_mfma_f32_16x16x32_bf16 v[104:107], v[32:35], v[16:19], v[104:107]
    v_mfma_f32_16x16x32_bf16 v[108:111], v[32:35], v[20:23], v[108:111]
    s_waitcnt lgkmcnt(4)
    v_mfma_f32_16x16x32_bf16 v[88:91], v[44:47], v[36:39], v[88:91]
    v_mfma_f32_16x16x32_bf16 v[92:95], v[44:47], v[40:43], v[92:95]
    s_waitcnt lgkmcnt(2)
    v_mfma_f32_16x16x32_bf16 v[96:99], v[48:51], v[36:39], v[96:99]
    v_mfma_f32_16x16x32_bf16 v[100:103], v[48:51], v[40:43], v[100:103]
    s_waitcnt lgkmcnt(0)
    v_mfma_f32_16x16x32_bf16 v[104:107], v[52:55], v[36:39], v[104:107]
    v_mfma_f32_16x16x32_bf16 v[108:111], v[52:55], v[40:43], v[108:111]
    v_lshlrev_b32 v3, 3, v0
    s_lshl_b32 s48, s44, 1
    s_add_u32 s48, s48, s68
    s_mul_i32 s48, s48, 36864
    s_mul_i32 s49, s45, 6
    s_and_b32 s50, s45, 1
    s_lshl_b32 s51, s50, 1
    s_add_u32 s51, s51, s49
    s_lshl_b32 s50, s50, 2
    s_sub_u32 s52, s49, s50
    s_mul_i32 s69, s67, 3
    s_mul_i32 s54, s67, 384
    s_add_u32 s54, s54, 159744
    v_lshlrev_b32 v7, 4, v2
    v_add_u32 v7, s54, v7
    s_lshl_b32 s54, s68, 8
    s_add_u32 s54, s54, 160512
    v_lshlrev_b32 v8, 3, v1
    v_add_u32 v8, s54, v8
    s_barrier
    ds_read_b64 v[12:13], v8
    ds_read_b64 v[14:15], v8 offset:128
    ds_read_b128 v[192:195], v7 offset:0
    ds_read_b128 v[196:199], v7 offset:64
    ds_read_b128 v[200:203], v7 offset:128
    ds_read_b128 v[204:207], v7 offset:192
    ds_read_b128 v[208:211], v7 offset:256
    ds_read_b128 v[212:215], v7 offset:320
    s_waitcnt lgkmcnt(0)
    v_mul_f32 v13, 1051597459, v13
    v_mul_f32 v15, 1051597459, v15
    s_add_u32 s53, s69, 0
    s_cmp_lt_u32 s53, 4
    s_cselect_b32 s54, s51, s52
    s_add_u32 s53, s53, s54
    s_mul_i32 s54, s53, 57
    s_lshr_b32 s54, s54, 9
    s_mul_i32 s54, s54, 4608
    s_lshl_b32 s53, s53, 9
    s_add_u32 s53, s53, s54
    s_add_u32 s53, s53, s48
    s_add_u32 s55, s53, 4608
    v_add_f32 v192, v192, v204
    v_add_f32 v193, v193, v205
    v_add_f32 v194, v194, v206
    v_add_f32 v195, v195, v207
    v_fmac_f32 v88, v192, v12
    v_mul_f32 v88, v88, v13
    v_fmac_f32 v89, v193, v12
    v_mul_f32 v89, v89, v13
    v_fmac_f32 v90, v194, v12
    v_mul_f32 v90, v90, v13
    v_fmac_f32 v91, v195, v12
    v_mul_f32 v91, v91, v13
    v_cvt_pk_bf16_f32 v88, v88, v89
    v_cvt_pk_bf16_f32 v89, v90, v91
    buffer_store_dwordx2 v[88:89], v3, s[32:35], s53 offen sc1
    v_fmac_f32 v92, v192, v14
    v_mul_f32 v92, v92, v15
    v_fmac_f32 v93, v193, v14
    v_mul_f32 v93, v93, v15
    v_fmac_f32 v94, v194, v14
    v_mul_f32 v94, v94, v15
    v_fmac_f32 v95, v195, v14
    v_mul_f32 v95, v95, v15
    v_cvt_pk_bf16_f32 v92, v92, v93
    v_cvt_pk_bf16_f32 v93, v94, v95
    buffer_store_dwordx2 v[92:93], v3, s[32:35], s55 offen sc1
    s_add_u32 s53, s69, 1
    s_cmp_lt_u32 s53, 4
    s_cselect_b32 s54, s51, s52
    s_add_u32 s53, s53, s54
    s_mul_i32 s54, s53, 57
    s_lshr_b32 s54, s54, 9
    s_mul_i32 s54, s54, 4608
    s_lshl_b32 s53, s53, 9
    s_add_u32 s53, s53, s54
    s_add_u32 s53, s53, s48
    s_add_u32 s55, s53, 4608
    v_add_f32 v196, v196, v208
    v_add_f32 v197, v197, v209
    v_add_f32 v198, v198, v210
    v_add_f32 v199, v199, v211
    v_fmac_f32 v96, v196, v12
    v_mul_f32 v96, v96, v13
    v_fmac_f32 v97, v197, v12
    v_mul_f32 v97, v97, v13
    v_fmac_f32 v98, v198, v12
    v_mul_f32 v98, v98, v13
    v_fmac_f32 v99, v199, v12
    v_mul_f32 v99, v99, v13
    v_cvt_pk_bf16_f32 v96, v96, v97
    v_cvt_pk_bf16_f32 v97, v98, v99
    buffer_store_dwordx2 v[96:97], v3, s[32:35], s53 offen sc1
    v_fmac_f32 v100, v196, v14
    v_mul_f32 v100, v100, v15
    v_fmac_f32 v101, v197, v14
    v_mul_f32 v101, v101, v15
    v_fmac_f32 v102, v198, v14
    v_mul_f32 v102, v102, v15
    v_fmac_f32 v103, v199, v14
    v_mul_f32 v103, v103, v15
    v_cvt_pk_bf16_f32 v100, v100, v101
    v_cvt_pk_bf16_f32 v101, v102, v103
    buffer_store_dwordx2 v[100:101], v3, s[32:35], s55 offen sc1
    s_add_u32 s53, s69, 2
    s_cmp_lt_u32 s53, 4
    s_cselect_b32 s54, s51, s52
    s_add_u32 s53, s53, s54
    s_mul_i32 s54, s53, 57
    s_lshr_b32 s54, s54, 9
    s_mul_i32 s54, s54, 4608
    s_lshl_b32 s53, s53, 9
    s_add_u32 s53, s53, s54
    s_add_u32 s53, s53, s48
    s_add_u32 s55, s53, 4608
    v_add_f32 v200, v200, v212
    v_add_f32 v201, v201, v213
    v_add_f32 v202, v202, v214
    v_add_f32 v203, v203, v215
    v_fmac_f32 v104, v200, v12
    v_mul_f32 v104, v104, v13
    v_fmac_f32 v105, v201, v12
    v_mul_f32 v105, v105, v13
    v_fmac_f32 v106, v202, v12
    v_mul_f32 v106, v106, v13
    v_fmac_f32 v107, v203, v12
    v_mul_f32 v107, v107, v13
    v_cvt_pk_bf16_f32 v104, v104, v105
    v_cvt_pk_bf16_f32 v105, v106, v107
    buffer_store_dwordx2 v[104:105], v3, s[32:35], s53 offen sc1
    v_fmac_f32 v108, v200, v14
    v_mul_f32 v108, v108, v15
    v_fmac_f32 v109, v201, v14
    v_mul_f32 v109, v109, v15
    v_fmac_f32 v110, v202, v14
    v_mul_f32 v110, v110, v15
    v_fmac_f32 v111, v203, v14
    v_mul_f32 v111, v111, v15
    v_cvt_pk_bf16_f32 v108, v108, v109
    v_cvt_pk_bf16_f32 v109, v110, v111
    buffer_store_dwordx2 v[108:109], v3, s[32:35], s55 offen sc1
    s_branch K1_fin
K1_kvload:
    v_lshrrev_b32 v10, 2, v1
    v_and_b32 v11, 3, v1
    v_lshl_add_u32 v12, v2, 3, v10
    s_lshl_b32 s66, s3, 11
    s_add_u32 s66, s66, s63
    v_and_b32 v7, 7, v1
    v_xor_b32 v8, v2, v7
    v_lshlrev_b32 v8, 4, v8
    v_lshl_add_u32 v8, v1, 7, v8
    v_add_u32 v8, s66, v8
    v_xor_b32 v9, 64, v8
    v_add_u32 v190, 0x8000, v8
    v_add_u32 v191, 0x8000, v9
    v_mov_b32 v168, 1065369472
    v_mov_b32 v169, 1065369472
    v_mov_b32 v170, 1065369472
    v_mov_b32 v171, 1065369472
    s_add_u32 s40, s14, 2514944
    s_addc_u32 s41, s15, 0
    s_mov_b32 s42, 16384
    s_mov_b32 s43, 0x00020000
    s_lshl_b32 s46, s44, 2
    s_add_u32 s46, s46, s3
    s_waitcnt vmcnt(0)
    s_barrier
    ds_read_b128 v[16:19], v8 offset:0
    ds_read_b128 v[20:23], v9 offset:0
    ds_read_b128 v[24:27], v8 offset:8192
    ds_read_b128 v[28:31], v9 offset:8192
    ds_read_b128 v[32:35], v8 offset:16384
    ds_read_b128 v[36:39], v9 offset:16384
    ds_read_b128 v[40:43], v8 offset:24576
    ds_read_b128 v[44:47], v9 offset:24576
    s_waitcnt lgkmcnt(7)
    v_mfma_f32_16x16x32_bf16 v[112:115], v[168:171], v[16:19], 0
    v_mfma_f32_16x16x32_bf16 v[116:119], v[16:19], v[16:19], 0
    ds_read_b128 v[48:51], v190 offset:0
    s_waitcnt lgkmcnt(7)
    v_mfma_f32_16x16x32_bf16 v[112:115], v[168:171], v[20:23], v[112:115]
    v_mfma_f32_16x16x32_bf16 v[116:119], v[20:23], v[20:23], v[116:119]
    ds_read_b128 v[52:55], v191 offset:0
    s_waitcnt lgkmcnt(7)
    v_mfma_f32_16x16x32_bf16 v[112:115], v[168:171], v[24:27], v[112:115]
    v_mfma_f32_16x16x32_bf16 v[116:119], v[24:27], v[24:27], v[116:119]
    ds_read_b128 v[56:59], v190 offset:8192
    s_waitcnt lgkmcnt(7)
    v_mfma_f32_16x16x32_bf16 v[112:115], v[168:171], v[28:31], v[112:115]
    v_mfma_f32_16x16x32_bf16 v[116:119], v[28:31], v[28:31], v[116:119]
    ds_read_b128 v[60:63], v191 offset:8192
    s_waitcnt lgkmcnt(7)
    v_mfma_f32_16x16x32_bf16 v[112:115], v[168:171], v[32:35], v[112:115]
    v_mfma_f32_16x16x32_bf16 v[116:119], v[32:35], v[32:35], v[116:119]
    ds_read_b128 v[64:67], v190 offset:16384
    s_waitcnt lgkmcnt(7)
    v_mfma_f32_16x16x32_bf16 v[112:115], v[168:171], v[36:39], v[112:115]
    v_mfma_f32_16x16x32_bf16 v[116:119], v[36:39], v[36:39], v[116:119]
    ds_read_b128 v[68:71], v191 offset:16384
    s_waitcnt lgkmcnt(7)
    v_mfma_f32_16x16x32_bf16 v[112:115], v[168:171], v[40:43], v[112:115]
    v_mfma_f32_16x16x32_bf16 v[116:119], v[40:43], v[40:43], v[116:119]
    ds_read_b128 v[72:75], v190 offset:24576
    s_waitcnt lgkmcnt(7)
    v_mfma_f32_16x16x32_bf16 v[112:115], v[168:171], v[44:47], v[112:115]
    v_mfma_f32_16x16x32_bf16 v[116:119], v[44:47], v[44:47], v[116:119]
    ds_read_b128 v[76:79], v191 offset:24576
    s_waitcnt lgkmcnt(7)
    v_mfma_f32_16x16x32_bf16 v[112:115], v[168:171], v[48:51], v[112:115]
    v_mfma_f32_16x16x32_bf16 v[116:119], v[48:51], v[48:51], v[116:119]
    ds_read_b128 v[80:83], v190 offset:32768
    s_waitcnt lgkmcnt(7)
    v_mfma_f32_16x16x32_bf16 v[112:115], v[168:171], v[52:55], v[112:115]
    v_mfma_f32_16x16x32_bf16 v[116:119], v[52:55], v[52:55], v[116:119]
    ds_read_b128 v[84:87], v191 offset:32768
    s_waitcnt lgkmcnt(7)
    v_mfma_f32_16x16x32_bf16 v[112:115], v[168:171], v[56:59], v[112:115]
    v_mfma_f32_16x16x32_bf16 v[116:119], v[56:59], v[56:59], v[116:119]
    s_waitcnt lgkmcnt(6)
    v_mfma_f32_16x16x32_bf16 v[112:115], v[168:171], v[60:63], v[112:115]
    v_mfma_f32_16x16x32_bf16 v[116:119], v[60:63], v[60:63], v[116:119]
    s_waitcnt lgkmcnt(5)
    v_mfma_f32_16x16x32_bf16 v[112:115], v[168:171], v[64:67], v[112:115]
    v_mfma_f32_16x16x32_bf16 v[116:119], v[64:67], v[64:67], v[116:119]
    s_waitcnt lgkmcnt(4)
    v_mfma_f32_16x16x32_bf16 v[112:115], v[168:171], v[68:71], v[112:115]
    v_mfma_f32_16x16x32_bf16 v[116:119], v[68:71], v[68:71], v[116:119]
    s_waitcnt lgkmcnt(3)
    v_mfma_f32_16x16x32_bf16 v[112:115], v[168:171], v[72:75], v[112:115]
    v_mfma_f32_16x16x32_bf16 v[116:119], v[72:75], v[72:75], v[116:119]
    s_waitcnt lgkmcnt(2)
    v_mfma_f32_16x16x32_bf16 v[112:115], v[168:171], v[76:79], v[112:115]
    v_mfma_f32_16x16x32_bf16 v[116:119], v[76:79], v[76:79], v[116:119]
    s_waitcnt lgkmcnt(1)
    v_mfma_f32_16x16x32_bf16 v[112:115], v[168:171], v[80:83], v[112:115]
    v_mfma_f32_16x16x32_bf16 v[116:119], v[80:83], v[80:83], v[116:119]
    s_waitcnt lgkmcnt(0)
    v_mfma_f32_16x16x32_bf16 v[112:115], v[168:171], v[84:87], v[112:115]
    v_mfma_f32_16x16x32_bf16 v[116:119], v[84:87], v[84:87], v[116:119]
    s_nop 3
    v_cmp_eq_u32 vcc, 1, v11
    v_cmp_eq_u32 s[54:55], 2, v11
    v_cmp_eq_u32 s[56:57], 3, v11
    v_cmp_eq_u32 s[58:59], v10, v2
    s_nop 3
    v_mul_f32 v4, 3135475257, v112
    v_cndmask_b32 v5, v116, v117, vcc
    v_cndmask_b32 v5, v5, v118, s[54:55]
    v_cndmask_b32 v5, v5, v119, s[56:57]
    v_cndmask_b32 v5, 0, v5, s[58:59]
    v_mov_b32 v7, v5
    s_nop 1
    v_permlane32_swap_b32 v5, v7
    s_nop 1
    v_add_f32 v5, v5, v7
    v_mov_b32 v7, v5
    s_nop 1
    v_permlane16_swap_b32 v5, v7
    s_nop 1
    v_add_f32 v5, v5, v7
    v_mul_f32 v5, 987991609, v5
    v_fma_f32 v5, -v4, v4, v5
    v_max_f32 v5, 0, v5
    v_add_f32 v5, 925353388, v5
    v_rsq_f32 v5, v5
    s_lshl_b32 s54, s3, 7
    s_add_u32 s54, s54, 160512
    v_lshlrev_b32 v7, 3, v1
    v_add_u32 v7, s54, v7
    ds_write_b64 v7, v[4:5]
    s_waitcnt lgkmcnt(0)
    s_barrier
    v_sub_f32 v9, 0, v4
    v_lshlrev_b32 v7, 2, v0
    s_lshl_b32 s49, s46, 7
    s_mov_b32 exec_lo, -1
    s_mov_b32 exec_hi, 0
    buffer_store_dword v9, v7, s[40:43], s49 offen sc1
    s_mov_b64 exec, -1
    s_barrier
    s_branch K1_fin
K1_worp:
    s_waitcnt lgkmcnt(0)
    s_load_dword s101, s[14:15], 0
    v_lshlrev_b32 v3, 4, v0
    s_add_u32 s60, s14, 9777152
    s_addc_u32 s61, s15, 0
    s_mov_b32 s62, 11542528
    s_mov_b32 s63, 0x00020000
    v_and_b32 v6, 15, v0
    v_lshrrev_b32 v7, 4, v0
    s_mov_b32 s80, 0x05040100
    s_mov_b32 s81, 0x07060302
    s_barrier
    s_lshl_b32 s47, s44, 2
    s_add_u32 s47, s47, s3
    s_add_u32 s47, s47, 4294967292
    s_lshl_b32 s59, s3, 13
    s_sub_u32 s59, s59, 28672
    v_add_u32 v16, s59, v3
    s_mul_hi_u32 s49, s47, 477218589
    s_mul_i32 s50, s49, 9
    s_sub_u32 s50, s47, s50
    s_mov_b32 s67, 0x00020000
    s_lshl_b32 s54, s50, 7
    s_mov_b32 s64, s12
    s_mov_b32 s65, s13
    s_cmp_lt_u32 s47, 162
    s_cselect_b32 s66, 663552, 0
    s_cselect_b32 s56, 0, 0x40000000
    s_lshl_b32 s55, s50, 1
    s_add_u32 s55, s55, 0
    s_mul_i32 s57, s55, 86
    s_lshr_b32 s57, s57, 8
    s_mul_i32 s58, s57, 3
    s_cmp_lt_u32 s49, s58
    s_cselect_b32 s58, 54, 0
    s_mul_i32 s57, s57, 42
    s_add_u32 s55, s55, s57
    s_add_u32 s55, s55, s58
    s_mul_i32 s57, s49, 3
    s_add_u32 s55, s55, s57
    s_lshl_b32 s55, s55, 11
    s_add_u32 s82, s55, s56
    s_lshl_b32 s55, s50, 1
    s_add_u32 s55, s55, 1
    s_mul_i32 s57, s55, 86
    s_lshr_b32 s57, s57, 8
    s_mul_i32 s58, s57, 3
    s_cmp_lt_u32 s49, s58
    s_cselect_b32 s58, 54, 0
    s_mul_i32 s57, s57, 42
    s_add_u32 s55, s55, s57
    s_add_u32 s55, s55, s58
    s_mul_i32 s57, s49, 3
    s_add_u32 s55, s55, s57
    s_lshl_b32 s55, s55, 11
    s_add_u32 s83, s55, s56
    v_lshrrev_b32 v245, 3, v6
    v_lshlrev_b32 v245, 11, v245
    v_and_b32 v246, 7, v6
    v_lshl_add_u32 v245, v246, 5, v245
    v_lshl_add_u32 v245, v7, 8, v245
    v_add_u32 v240, s59, v245
    s_mov_b32 s75, 1152
    s_cmp_ge_u32 s49, 16
    s_cbranch_scc1 L_rp_1_wo2
    s_mul_i32 s53, s49, 41472
    s_mov_b32 s73, 9216
    s_mov_b32 s74, 2304
    v_lshrrev_b32 v246, 1, v7
    v_mul_u32_u24 v246, 18, v246
    v_and_b32 v247, 1, v7
    v_lshl_add_u32 v246, v247, 2, v246
    s_branch L_rp_1_wo3
L_rp_1_wo2:
    s_sub_u32 s53, s49, 16
    s_mul_i32 s53, s53, 331776
    s_add_u32 s53, s53, 18432
    s_mov_b32 s73, 41472
    s_mov_b32 s74, 20736
    v_mul_u32_u24 v246, 72, v7
L_rp_1_wo3:
    s_add_u32 s72, s53, s54
    v_mul_u32_u24 v242, 1152, v246
    v_lshl_add_u32 v242, v6, 3, v242
    s_mov_b32 s55, s72
    buffer_load_dwordx2 v[208:209], v242, s[64:67], s55 offen
    s_mov_b32 s55, s72
    s_add_u32 s55, s55, s75
    buffer_load_dwordx2 v[210:211], v242, s[64:67], s55 offen
    s_mov_b32 s55, s72
    s_add_u32 s55, s55, s74
    buffer_load_dwordx2 v[212:213], v242, s[64:67], s55 offen
    s_mov_b32 s55, s72
    s_add_u32 s55, s55, s74
    s_add_u32 s55, s55, s75
    buffer_load_dwordx2 v[214:215], v242, s[64:67], s55 offen
    s_mov_b32 s55, s72
    s_add_u32 s55, s55, s73
    buffer_load_dwordx2 v[216:217], v242, s[64:67], s55 offen
    s_mov_b32 s55, s72
    s_add_u32 s55, s55, s73
    s_add_u32 s55, s55, s75
    buffer_load_dwordx2 v[218:219], v242, s[64:67], s55 offen
    s_mov_b32 s55, s72
    s_add_u32 s55, s55, s73
    s_add_u32 s55, s55, s74
    buffer_load_dwordx2 v[220:221], v242, s[64:67], s55 offen
    s_mov_b32 s55, s72
    s_add_u32 s55, s55, s73
    s_add_u32 s55, s55, s74
    s_add_u32 s55, s55, s75
    buffer_load_dwordx2 v[222:223], v242, s[64:67], s55 offen
    s_lshl_b32 s47, s44, 2
    s_add_u32 s47, s47, s3
    s_add_u32 s47, s47, 124
    s_lshl_b32 s59, s3, 13
    s_sub_u32 s59, s59, 24576
    v_add_u32 v17, s59, v3
    s_mul_hi_u32 s49, s47, 477218589
    s_mul_i32 s50, s49, 9
    s_sub_u32 s50, s47, s50
    s_mov_b32 s71, 0x00020000
    s_lshl_b32 s54, s50, 7
    s_mov_b32 s68, s12
    s_mov_b32 s69, s13
    s_cmp_lt_u32 s47, 162
    s_cselect_b32 s70, 663552, 0
    s_cselect_b32 s56, 0, 0x40000000
    s_lshl_b32 s55, s50, 1
    s_add_u32 s55, s55, 0
    s_mul_i32 s57, s55, 86
    s_lshr_b32 s57, s57, 8
    s_mul_i32 s58, s57, 3
    s_cmp_lt_u32 s49, s58
    s_cselect_b32 s58, 54, 0
    s_mul_i32 s57, s57, 42
    s_add_u32 s55, s55, s57
    s_add_u32 s55, s55, s58
    s_mul_i32 s57, s49, 3
    s_add_u32 s55, s55, s57
    s_lshl_b32 s55, s55, 11
    s_add_u32 s86, s55, s56
    s_lshl_b32 s55, s50, 1
    s_add_u32 s55, s55, 1
    s_mul_i32 s57, s55, 86
    s_lshr_b32 s57, s57, 8
    s_mul_i32 s58, s57, 3
    s_cmp_lt_u32 s49, s58
    s_cselect_b32 s58, 54, 0
    s_mul_i32 s57, s57, 42
    s_add_u32 s55, s55, s57
    s_add_u32 s55, s55, s58
    s_mul_i32 s57, s49, 3
    s_add_u32 s55, s55, s57
    s_lshl_b32 s55, s55, 11
    s_add_u32 s87, s55, s56
    v_lshrrev_b32 v245, 3, v6
    v_lshlrev_b32 v245, 11, v245
    v_and_b32 v246, 7, v6
    v_lshl_add_u32 v245, v246, 5, v245
    v_lshl_add_u32 v245, v7, 8, v245
    v_add_u32 v241, s59, v245
    s_mov_b32 s79, 1152
    s_cmp_ge_u32 s49, 16
    s_cbranch_scc1 L_rp_2_wo2
    s_mul_i32 s53, s49, 41472
    s_mov_b32 s77, 9216
    s_mov_b32 s78, 2304
    v_lshrrev_b32 v246, 1, v7
    v_mul_u32_u24 v246, 18, v246
    v_and_b32 v247, 1, v7
    v_lshl_add_u32 v246, v247, 2, v246
    s_branch L_rp_2_wo3
L_rp_2_wo2:
    s_sub_u32 s53, s49, 16
    s_mul_i32 s53, s53, 331776
    s_add_u32 s53, s53, 18432
    s_mov_b32 s77, 41472
    s_mov_b32 s78, 20736
    v_mul_u32_u24 v246, 72, v7
L_rp_2_wo3:
    s_add_u32 s76, s53, s54
    v_mul_u32_u24 v243, 1152, v246
    v_lshl_add_u32 v243, v6, 3, v243
    s_mov_b32 s55, s76
    buffer_load_dwordx2 v[224:225], v243, s[68:71], s55 offen
    s_mov_b32 s55, s76
    s_add_u32 s55, s55, s79
    buffer_load_dwordx2 v[226:227], v243, s[68:71], s55 offen
    s_mov_b32 s55, s76
    s_add_u32 s55, s55, s78
    buffer_load_dwordx2 v[228:229], v243, s[68:71], s55 offen
    s_mov_b32 s55, s76
    s_add_u32 s55, s55, s78
    s_add_u32 s55, s55, s79
    buffer_load_dwordx2 v[230:231], v243, s[68:71], s55 offen
    s_mov_b32 s55, s76
    s_add_u32 s55, s55, s77
    buffer_load_dwordx2 v[232:233], v243, s[68:71], s55 offen
    s_mov_b32 s55, s76
    s_add_u32 s55, s55, s77
    s_add_u32 s55, s55, s79
    buffer_load_dwordx2 v[234:235], v243, s[68:71], s55 offen
    s_mov_b32 s55, s76
    s_add_u32 s55, s55, s77
    s_add_u32 s55, s55, s78
    buffer_load_dwordx2 v[236:237], v243, s[68:71], s55 offen
    s_mov_b32 s55, s76
    s_add_u32 s55, s55, s77
    s_add_u32 s55, s55, s78
    s_add_u32 s55, s55, s79
    buffer_load_dwordx2 v[238:239], v243, s[68:71], s55 offen
    s_waitcnt vmcnt(8)
    v_perm_b32 v196, v210, v208, s80
    v_perm_b32 v197, v214, v212, s80
    v_perm_b32 v198, v218, v216, s80
    v_perm_b32 v199, v222, v220, s80
    ds_write_b128 v240, v[196:199] offset:0
    v_perm_b32 v200, v210, v208, s81
    v_perm_b32 v201, v214, v212, s81
    v_perm_b32 v202, v218, v216, s81
    v_perm_b32 v203, v222, v220, s81
    ds_write_b128 v240, v[200:203] offset:1024
    v_perm_b32 v196, v211, v209, s80
    v_perm_b32 v197, v215, v213, s80
    v_perm_b32 v198, v219, v217, s80
    v_perm_b32 v199, v223, v221, s80
    ds_write_b128 v240, v[196:199] offset:16
    v_perm_b32 v200, v211, v209, s81
    v_perm_b32 v201, v215, v213, s81
    v_perm_b32 v202, v219, v217, s81
    v_perm_b32 v203, v223, v221, s81
    ds_write_b128 v240, v[200:203] offset:1040
    ds_read_b128 v[32:35], v16 offset:0
    ds_read_b128 v[36:39], v16 offset:1024
    ds_read_b128 v[40:43], v16 offset:2048
    ds_read_b128 v[44:47], v16 offset:3072
    s_waitcnt lgkmcnt(3)
    buffer_store_dwordx4 v[32:35], v3, s[60:63], s82 offen offset:0 sc1
    s_waitcnt lgkmcnt(2)
    buffer_store_dwordx4 v[36:39], v3, s[60:63], s82 offen offset:1024 sc1
    s_waitcnt lgkmcnt(1)
    buffer_store_dwordx4 v[40:43], v3, s[60:63], s83 offen offset:0 sc1
    s_waitcnt lgkmcnt(0)
    buffer_store_dwordx4 v[44:47], v3, s[60:63], s83 offen offset:1024 sc1
    s_waitcnt vmcnt(4)
    v_perm_b32 v196, v226, v224, s80
    v_perm_b32 v197, v230, v228, s80
    v_perm_b32 v198, v234, v232, s80
    v_perm_b32 v199, v238, v236, s80
    ds_write_b128 v241, v[196:199] offset:0
    v_perm_b32 v200, v226, v224, s81
    v_perm_b32 v201, v230, v228, s81
    v_perm_b32 v202, v234, v232, s81
    v_perm_b32 v203, v238, v236, s81
    ds_write_b128 v241, v[200:203] offset:1024
    v_perm_b32 v196, v227, v225, s80
    v_perm_b32 v197, v231, v229, s80
    v_perm_b32 v198, v235, v233, s80
    v_perm_b32 v199, v239, v237, s80
    ds_write_b128 v241, v[196:199] offset:16
    v_perm_b32 v200, v227, v225, s81
    v_perm_b32 v201, v231, v229, s81
    v_perm_b32 v202, v235, v233, s81
    v_perm_b32 v203, v239, v237, s81
    ds_write_b128 v241, v[200:203] offset:1040
    ds_read_b128 v[48:51], v17 offset:0
    ds_read_b128 v[52:55], v17 offset:1024
    ds_read_b128 v[56:59], v17 offset:2048
    ds_read_b128 v[60:63], v17 offset:3072
    s_waitcnt lgkmcnt(3)
    buffer_store_dwordx4 v[48:51], v3, s[60:63], s86 offen offset:0 sc1
    s_waitcnt lgkmcnt(2)
    buffer_store_dwordx4 v[52:55], v3, s[60:63], s86 offen offset:1024 sc1
    s_waitcnt lgkmcnt(1)
    buffer_store_dwordx4 v[56:59], v3, s[60:63], s87 offen offset:0 sc1
    s_waitcnt lgkmcnt(0)
    buffer_store_dwordx4 v[60:63], v3, s[60:63], s87 offen offset:1024 sc1
    s_branch K1_fin
K1_kvgemm:
    s_cmp_eq_u32 s45, 7
    s_cbranch_scc1 K1_wbar
    s_mov_b32 m0, s64
    s_add_u32 s62, s47, s61
    s_add_u32 s64, s64, 8192
    buffer_load_dwordx4 v3, s[16:19], s62 offen lds
    buffer_load_dwordx4 v6, s[16:19], s62 offen offset:1024 lds
    s_add_u32 s61, s61, 128
    s_cmp_eq_u32 s61, 640
    s_cselect_b32 s61, 0, s61
    s_mov_b32 m0, s64
    s_add_u32 s62, s47, s61
    s_add_u32 s64, s64, 8192
    buffer_load_dwordx4 v3, s[16:19], s62 offen lds
    buffer_load_dwordx4 v6, s[16:19], s62 offen offset:1024 lds
    s_mul_i32 s61, s71, 128
    s_mov_b32 m0, s64
    s_add_u32 s62, s47, s61
    s_add_u32 s64, s64, 8192
    buffer_load_dwordx4 v3, s[16:19], s62 offen lds
    buffer_load_dwordx4 v6, s[16:19], s62 offen offset:1024 lds
    s_add_u32 s61, s61, 128
    s_cmp_eq_u32 s61, 1152
    s_cselect_b32 s61, 640, s61
    s_mov_b32 m0, s64
    s_add_u32 s62, s47, s61
    s_add_u32 s64, s64, 8192
    buffer_load_dwordx4 v3, s[16:19], s62 offen lds
    buffer_load_dwordx4 v6, s[16:19], s62 offen offset:1024 lds
    s_add_u32 s61, s61, 128
    s_cmp_eq_u32 s61, 1152
    s_cselect_b32 s61, 640, s61
    s_mov_b32 m0, s64
    s_add_u32 s62, s47, s61
    s_add_u32 s64, s64, 8192
    buffer_load_dwordx4 v3, s[16:19], s62 offen lds
    buffer_load_dwordx4 v6, s[16:19], s62 offen offset:1024 lds
    s_add_u32 s61, s61, 128
    s_cmp_eq_u32 s61, 1152
    s_cselect_b32 s61, 640, s61
    s_mov_b32 m0, s64
    s_add_u32 s62, s47, s61
    s_add_u32 s64, s64, 8192
    buffer_load_dwordx4 v3, s[16:19], s62 offen lds
    buffer_load_dwordx4 v6, s[16:19], s62 offen offset:1024 lds
    s_add_u32 s61, s61, 128
    s_cmp_eq_u32 s61, 1152
    s_cselect_b32 s61, 640, s61
    v_and_b32 v7, 7, v1
    v_xor_b32 v8, v2, v7
    v_lshlrev_b32 v8, 4, v8
    v_lshl_add_u32 v8, v1, 7, v8
    v_add_u32 v8, s63, v8
    v_xor_b32 v9, 64, v8
    v_add_u32 v190, 0x8000, v8
    v_add_u32 v191, 0x8000, v9
    v_mul_u32_u24 v13, 36, v12
    v_lshl_add_u32 v13, v11, 3, v13
    v_and_b32 v14, 1, v10
    v_mul_u32_u24 v14, 21500, v14
    v_add_u32 v172, v13, v14
    v_mul_u32_u24 v13, 36, v12
    v_add_u32 v173, v13, v14
    s_cmp_ge_u32 s3, 2
    s_cselect_b64 vcc, -1, 0
    s_and_b32 s55, s3, 1
    s_mul_i32 s55, s55, 43008
    s_lshr_b32 s56, s3, 1
    s_lshl_b32 s56, s56, 5
    s_add_u32 s55, s55, s56
    v_cndmask_b32 v172, v172, v173, vcc
    v_add_u32 v172, s55, v172
    v_mov_b32 v168, 1065369472
    v_mov_b32 v169, 1065369472
    v_mov_b32 v170, 1065369472
    v_mov_b32 v171, 1065369472
    s_add_u32 s36, s14, 2363392
    s_addc_u32 s37, s15, 0
    s_mov_b32 s38, 151552
    s_mov_b32 s39, 0x00020000
    s_mul_i32 s48, s44, 4736
    s_waitcnt vmcnt(0)
    s_barrier
    ds_read_b64_tr_b16 v[16:17], v172 offset:0
    ds_read_b64_tr_b16 v[18:19], v172 offset:144
    ds_read_b128 v[20:23], v8 offset:0
    ds_read_b128 v[24:27], v8 offset:2048
    ds_read_b128 v[28:31], v8 offset:4096
    ds_read_b128 v[32:35], v8 offset:6144
    ds_read_b64_tr_b16 v[36:37], v172 offset:1152
    ds_read_b64_tr_b16 v[38:39], v172 offset:1296
    ds_read_b128 v[40:43], v9 offset:0
    ds_read_b128 v[44:47], v9 offset:2048
    ds_read_b128 v[48:51], v9 offset:4096
    ds_read_b128 v[52:55], v9 offset:6144
    s_bitcmp1_b32 s3, 0
    s_cbranch_scc1 K1_vform
    s_waitcnt lgkmcnt(6)
    v_mfma_f32_16x16x32_bf16 v[88:91], v[16:19], v[20:23], 0
    ds_read_b64_tr_b16 v[56:57], v172 offset:2304
    ds_read_b64_tr_b16 v[58:59], v172 offset:2448
    v_mfma_f32_16x16x32_bf16 v[92:95], v[16:19], v[24:27], 0
    ds_read_b128 v[60:63], v8 offset:8192
    v_mfma_f32_16x16x32_bf16 v[96:99], v[16:19], v[28:31], 0
    ds_read_b128 v[64:67], v8 offset:10240
    v_mfma_f32_16x16x32_bf16 v[100:103], v[16:19], v[32:35], 0
    ds_read_b128 v[68:71], v8 offset:12288
    v_mfma_f32_16x16x32_bf16 v[192:195], v[16:19], v[168:171], 0
    ds_read_b128 v[72:75], v8 offset:14336
    s_waitcnt lgkmcnt(6)
    v_mfma_f32_16x16x32_bf16 v[88:91], v[36:39], v[40:43], v[88:91]
    ds_read_b64_tr_b16 v[16:17], v172 offset:3456
    ds_read_b64_tr_b16 v[18:19], v172 offset:3600
    v_mfma_f32_16x16x32_bf16 v[92:95], v[36:39], v[44:47], v[92:95]
    ds_read_b128 v[20:23], v9 offset:8192
    v_mfma_f32_16x16x32_bf16 v[96:99], v[36:39], v[48:51], v[96:99]
    ds_read_b128 v[24:27], v9 offset:10240
    v_mfma_f32_16x16x32_bf16 v[100:103], v[36:39], v[52:55], v[100:103]
    ds_read_b128 v[28:31], v9 offset:12288
    v_mfma_f32_16x16x32_bf16 v[192:195], v[36:39], v[168:171], v[192:195]
    ds_read_b128 v[32:35], v9 offset:14336
    s_waitcnt lgkmcnt(6)
    v_mfma_f32_16x16x32_bf16 v[88:91], v[56:59], v[60:63], v[88:91]
    ds_read_b64_tr_b16 v[36:37], v172 offset:4608
    ds_read_b64_tr_b16 v[38:39], v172 offset:4752
    v_mfma_f32_16x16x32_bf16 v[92:95], v[56:59], v[64:67], v[92:95]
    ds_read_b128 v[40:43], v8 offset:16384
    v_mfma_f32_16x16x32_bf16 v[96:99], v[56:59], v[68:71], v[96:99]
    ds_read_b128 v[44:47], v8 offset:18432
    v_mfma_f32_16x16x32_bf16 v[100:103], v[56:59], v[72:75], v[100:103]
    ds_read_b128 v[48:51], v8 offset:20480
    v_mfma_f32_16x16x32_bf16 v[192:195], v[56:59], v[168:171], v[192:195]
    ds_read_b128 v[52:55], v8 offset:22528
    s_waitcnt lgkmcnt(6)
    v_mfma_f32_16x16x32_bf16 v[88:91], v[16:19], v[20:23], v[88:91]
    ds_read_b64_tr_b16 v[56:57], v172 offset:5760
    ds_read_b64_tr_b16 v[58:59], v172 offset:5904
    v_mfma_f32_16x16x32_bf16 v[92:95], v[16:19], v[24:27], v[92:95]
    ds_read_b128 v[60:63], v9 offset:16384
    v_mfma_f32_16x16x32_bf16 v[96:99], v[16:19], v[28:31], v[96:99]
    ds_read_b128 v[64:67], v9 offset:18432
    v_mfma_f32_16x16x32_bf16 v[100:103], v[16:19], v[32:35], v[100:103]
    ds_read_b128 v[68:71], v9 offset:20480
    v_mfma_f32_16x16x32_bf16 v[192:195], v[16:19], v[168:171], v[192:195]
    ds_read_b128 v[72:75], v9 offset:22528
    s_waitcnt lgkmcnt(6)
    v_mfma_f32_16x16x32_bf16 v[88:91], v[36:39], v[40:43], v[88:91]
    ds_read_b64_tr_b16 v[16:17], v172 offset:6912
    ds_read_b64_tr_b16 v[18:19], v172 offset:7056
    v_mfma_f32_16x16x32_bf16 v[92:95], v[36:39], v[44:47], v[92:95]
    ds_read_b128 v[20:23], v8 offset:24576
    v_mfma_f32_16x16x32_bf16 v[96:99], v[36:39], v[48:51], v[96:99]
    ds_read_b128 v[24:27], v8 offset:26624
    v_mfma_f32_16x16x32_bf16 v[100:103], v[36:39], v[52:55], v[100:103]
    ds_read_b128 v[28:31], v8 offset:28672
    v_mfma_f32_16x16x32_bf16 v[192:195], v[36:39], v[168:171], v[192:195]
    ds_read_b128 v[32:35], v8 offset:30720
    s_waitcnt lgkmcnt(6)
    v_mfma_f32_16x16x32_bf16 v[88:91], v[56:59], v[60:63], v[88:91]
    ds_read_b64_tr_b16 v[36:37], v172 offset:8064
    ds_read_b64_tr_b16 v[38:39], v172 offset:8208
    v_mfma_f32_16x16x32_bf16 v[92:95], v[56:59], v[64:67], v[92:95]
    ds_read_b128 v[40:43], v9 offset:24576
    v_mfma_f32_16x16x32_bf16 v[96:99], v[56:59], v[68:71], v[96:99]
    ds_read_b128 v[44:47], v9 offset:26624
    v_mfma_f32_16x16x32_bf16 v[100:103], v[56:59], v[72:75], v[100:103]
    ds_read_b128 v[48:51], v9 offset:28672
    v_mfma_f32_16x16x32_bf16 v[192:195], v[56:59], v[168:171], v[192:195]
    ds_read_b128 v[52:55], v9 offset:30720
    s_waitcnt lgkmcnt(6)
    v_mfma_f32_16x16x32_bf16 v[88:91], v[16:19], v[20:23], v[88:91]
    ds_read_b64_tr_b16 v[56:57], v172 offset:9216
    ds_read_b64_tr_b16 v[58:59], v172 offset:9360
    v_mfma_f32_16x16x32_bf16 v[92:95], v[16:19], v[24:27], v[92:95]
    ds_read_b128 v[60:63], v190 offset:0
    v_mfma_f32_16x16x32_bf16 v[96:99], v[16:19], v[28:31], v[96:99]
    ds_read_b128 v[64:67], v190 offset:2048
    v_mfma_f32_16x16x32_bf16 v[100:103], v[16:19], v[32:35], v[100:103]
    ds_read_b128 v[68:71], v190 offset:4096
    v_mfma_f32_16x16x32_bf16 v[192:195], v[16:19], v[168:171], v[192:195]
    ds_read_b128 v[72:75], v190 offset:6144
    s_waitcnt lgkmcnt(6)
    v_mfma_f32_16x16x32_bf16 v[88:91], v[36:39], v[40:43], v[88:91]
    ds_read_b64_tr_b16 v[16:17], v172 offset:10368
    ds_read_b64_tr_b16 v[18:19], v172 offset:10512
    v_mfma_f32_16x16x32_bf16 v[92:95], v[36:39], v[44:47], v[92:95]
    ds_read_b128 v[20:23], v191 offset:0
    v_mfma_f32_16x16x32_bf16 v[96:99], v[36:39], v[48:51], v[96:99]
    ds_read_b128 v[24:27], v191 offset:2048
    v_mfma_f32_16x16x32_bf16 v[100:103], v[36:39], v[52:55], v[100:103]
    ds_read_b128 v[28:31], v191 offset:4096
    v_mfma_f32_16x16x32_bf16 v[192:195], v[36:39], v[168:171], v[192:195]
    ds_read_b128 v[32:35], v191 offset:6144
    s_waitcnt lgkmcnt(6)
    v_mfma_f32_16x16x32_bf16 v[88:91], v[56:59], v[60:63], v[88:91]
    ds_read_b64_tr_b16 v[36:37], v172 offset:11520
    ds_read_b64_tr_b16 v[38:39], v172 offset:11664
    v_mfma_f32_16x16x32_bf16 v[92:95], v[56:59], v[64:67], v[92:95]
    ds_read_b128 v[40:43], v190 offset:8192
    v_mfma_f32_16x16x32_bf16 v[96:99], v[56:59], v[68:71], v[96:99]
    ds_read_b128 v[44:47], v190 offset:10240
    v_mfma_f32_16x16x32_bf16 v[100:103], v[56:59], v[72:75], v[100:103]
    ds_read_b128 v[48:51], v190 offset:12288
    v_mfma_f32_16x16x32_bf16 v[192:195], v[56:59], v[168:171], v[192:195]
    ds_read_b128 v[52:55], v190 offset:14336
    s_waitcnt lgkmcnt(6)
    v_mfma_f32_16x16x32_bf16 v[88:91], v[16:19], v[20:23], v[88:91]
    ds_read_b64_tr_b16 v[56:57], v172 offset:12672
    ds_read_b64_tr_b16 v[58:59], v172 offset:12816
    v_mfma_f32_16x16x32_bf16 v[92:95], v[16:19], v[24:27], v[92:95]
    ds_read_b128 v[60:63], v191 offset:8192
    v_mfma_f32_16x16x32_bf16 v[96:99], v[16:19], v[28:31], v[96:99]
    ds_read_b128 v[64:67], v191 offset:10240
    v_mfma_f32_16x16x32_bf16 v[100:103], v[16:19], v[32:35], v[100:103]
    ds_read_b128 v[68:71], v191 offset:12288
    v_mfma_f32_16x16x32_bf16 v[192:195], v[16:19], v[168:171], v[192:195]
    ds_read_b128 v[72:75], v191 offset:14336
    s_waitcnt lgkmcnt(6)
    v_mfma_f32_16x16x32_bf16 v[88:91], v[36:39], v[40:43], v[88:91]
    ds_read_b64_tr_b16 v[16:17], v172 offset:13824
    ds_read_b64_tr_b16 v[18:19], v172 offset:13968
    v_mfma_f32_16x16x32_bf16 v[92:95], v[36:39], v[44:47], v[92:95]
    ds_read_b128 v[20:23], v190 offset:16384
    v_mfma_f32_16x16x32_bf16 v[96:99], v[36:39], v[48:51], v[96:99]
    ds_read_b128 v[24:27], v190 offset:18432
    v_mfma_f32_16x16x32_bf16 v[100:103], v[36:39], v[52:55], v[100:103]
    ds_read_b128 v[28:31], v190 offset:20480
    v_mfma_f32_16x16x32_bf16 v[192:195], v[36:39], v[168:171], v[192:195]
    ds_read_b128 v[32:35], v190 offset:22528
    s_waitcnt lgkmcnt(6)
    v_mfma_f32_16x16x32_bf16 v[88:91], v[56:59], v[60:63], v[88:91]
    ds_read_b64_tr_b16 v[36:37], v172 offset:14976
    ds_read_b64_tr_b16 v[38:39], v172 offset:15120
    v_mfma_f32_16x16x32_bf16 v[92:95], v[56:59], v[64:67], v[92:95]
    ds_read_b128 v[40:43], v191 offset:16384
    v_mfma_f32_16x16x32_bf16 v[96:99], v[56:59], v[68:71], v[96:99]
    ds_read_b128 v[44:47], v191 offset:18432
    v_mfma_f32_16x16x32_bf16 v[100:103], v[56:59], v[72:75], v[100:103]
    ds_read_b128 v[48:51], v191 offset:20480
    v_mfma_f32_16x16x32_bf16 v[192:195], v[56:59], v[168:171], v[192:195]
    ds_read_b128 v[52:55], v191 offset:22528
    s_waitcnt lgkmcnt(6)
    v_mfma_f32_16x16x32_bf16 v[88:91], v[16:19], v[20:23], v[88:91]
    ds_read_b64_tr_b16 v[56:57], v172 offset:16128
    ds_read_b64_tr_b16 v[58:59], v172 offset:16272
    v_mfma_f32_16x16x32_bf16 v[92:95], v[16:19], v[24:27], v[92:95]
    ds_read_b128 v[60:63], v190 offset:24576
    v_mfma_f32_16x16x32_bf16 v[96:99], v[16:19], v[28:31], v[96:99]
    ds_read_b128 v[64:67], v190 offset:26624
    v_mfma_f32_16x16x32_bf16 v[100:103], v[16:19], v[32:35], v[100:103]
    ds_read_b128 v[68:71], v190 offset:28672
    v_mfma_f32_16x16x32_bf16 v[192:195], v[16:19], v[168:171], v[192:195]
    ds_read_b128 v[72:75], v190 offset:30720
    s_waitcnt lgkmcnt(6)
    v_mfma_f32_16x16x32_bf16 v[88:91], v[36:39], v[40:43], v[88:91]
    ds_read_b64_tr_b16 v[16:17], v172 offset:17280
    ds_read_b64_tr_b16 v[18:19], v172 offset:17424
    v_mfma_f32_16x16x32_bf16 v[92:95], v[36:39], v[44:47], v[92:95]
    ds_read_b128 v[20:23], v191 offset:24576
    v_mfma_f32_16x16x32_bf16 v[96:99], v[36:39], v[48:51], v[96:99]
    ds_read_b128 v[24:27], v191 offset:26624
    v_mfma_f32_16x16x32_bf16 v[100:103], v[36:39], v[52:55], v[100:103]
    ds_read_b128 v[28:31], v191 offset:28672
    v_mfma_f32_16x16x32_bf16 v[192:195], v[36:39], v[168:171], v[192:195]
    ds_read_b128 v[32:35], v191 offset:30720
    s_waitcnt lgkmcnt(6)
    v_mfma_f32_16x16x32_bf16 v[88:91], v[56:59], v[60:63], v[88:91]
    ds_read_b64_tr_b16 v[36:37], v172 offset:18432
    ds_read_b64_tr_b16 v[38:39], v172 offset:18576
    v_mfma_f32_16x16x32_bf16 v[92:95], v[56:59], v[64:67], v[92:95]
    ds_read_b128 v[40:43], v190 offset:32768
    v_mfma_f32_16x16x32_bf16 v[96:99], v[56:59], v[68:71], v[96:99]
    ds_read_b128 v[44:47], v190 offset:34816
    v_mfma_f32_16x16x32_bf16 v[100:103], v[56:59], v[72:75], v[100:103]
    ds_read_b128 v[48:51], v190 offset:36864
    v_mfma_f32_16x16x32_bf16 v[192:195], v[56:59], v[168:171], v[192:195]
    ds_read_b128 v[52:55], v190 offset:38912
    s_waitcnt lgkmcnt(6)
    v_mfma_f32_16x16x32_bf16 v[88:91], v[16:19], v[20:23], v[88:91]
    ds_read_b64_tr_b16 v[56:57], v172 offset:19584
    ds_read_b64_tr_b16 v[58:59], v172 offset:19728
    v_mfma_f32_16x16x32_bf16 v[92:95], v[16:19], v[24:27], v[92:95]
    ds_read_b128 v[60:63], v191 offset:32768
    v_mfma_f32_16x16x32_bf16 v[96:99], v[16:19], v[28:31], v[96:99]
    ds_read_b128 v[64:67], v191 offset:34816
    v_mfma_f32_16x16x32_bf16 v[100:103], v[16:19], v[32:35], v[100:103]
    ds_read_b128 v[68:71], v191 offset:36864
    v_mfma_f32_16x16x32_bf16 v[192:195], v[16:19], v[168:171], v[192:195]
    ds_read_b128 v[72:75], v191 offset:38912
    s_waitcnt lgkmcnt(6)
    v_mfma_f32_16x16x32_bf16 v[88:91], v[36:39], v[40:43], v[88:91]
    v_mfma_f32_16x16x32_bf16 v[92:95], v[36:39], v[44:47], v[92:95]
    v_mfma_f32_16x16x32_bf16 v[96:99], v[36:39], v[48:51], v[96:99]
    v_mfma_f32_16x16x32_bf16 v[100:103], v[36:39], v[52:55], v[100:103]
    v_mfma_f32_16x16x32_bf16 v[192:195], v[36:39], v[168:171], v[192:195]
    s_waitcnt lgkmcnt(0)
    v_mfma_f32_16x16x32_bf16 v[88:91], v[56:59], v[60:63], v[88:91]
    v_mfma_f32_16x16x32_bf16 v[92:95], v[56:59], v[64:67], v[92:95]
    v_mfma_f32_16x16x32_bf16 v[96:99], v[56:59], v[68:71], v[96:99]
    v_mfma_f32_16x16x32_bf16 v[100:103], v[56:59], v[72:75], v[100:103]
    v_mfma_f32_16x16x32_bf16 v[192:195], v[56:59], v[168:171], v[192:195]
    v_lshlrev_b32 v7, 3, v1
    v_add_u32 v7, 160512, v7
    v_lshrrev_b32 v8, 1, v2
    v_lshlrev_b32 v8, 9, v8
    v_lshl_add_u32 v8, v1, 4, v8
    v_and_b32 v9, 1, v2
    v_lshl_add_u32 v8, v9, 3, v8
    v_lshlrev_b32 v9, 2, v1
    s_barrier
    ds_read_b64 v[216:217], v7 offset:0
    ds_read_b64 v[218:219], v7 offset:128
    ds_read_b64 v[220:221], v7 offset:256
    ds_read_b64 v[222:223], v7 offset:384
    s_waitcnt lgkmcnt(0)
    v_fmac_f32 v88, v192, v216
    v_mul_f32 v88, v88, v217
    v_fmac_f32 v89, v193, v216
    v_mul_f32 v89, v89, v217
    v_fmac_f32 v90, v194, v216
    v_mul_f32 v90, v90, v217
    v_fmac_f32 v91, v195, v216
    v_mul_f32 v91, v91, v217
    v_cvt_pk_bf16_f32 v88, v88, v89
    v_cvt_pk_bf16_f32 v89, v90, v91
    v_fmac_f32 v92, v192, v218
    v_mul_f32 v92, v92, v219
    v_fmac_f32 v93, v193, v218
    v_mul_f32 v93, v93, v219
    v_fmac_f32 v94, v194, v218
    v_mul_f32 v94, v94, v219
    v_fmac_f32 v95, v195, v218
    v_mul_f32 v95, v95, v219
    v_cvt_pk_bf16_f32 v92, v92, v93
    v_cvt_pk_bf16_f32 v93, v94, v95
    v_fmac_f32 v96, v192, v220
    v_mul_f32 v96, v96, v221
    v_fmac_f32 v97, v193, v220
    v_mul_f32 v97, v97, v221
    v_fmac_f32 v98, v194, v220
    v_mul_f32 v98, v98, v221
    v_fmac_f32 v99, v195, v220
    v_mul_f32 v99, v99, v221
    v_cvt_pk_bf16_f32 v96, v96, v97
    v_cvt_pk_bf16_f32 v97, v98, v99
    v_fmac_f32 v100, v192, v222
    v_mul_f32 v100, v100, v223
    v_fmac_f32 v101, v193, v222
    v_mul_f32 v101, v101, v223
    v_fmac_f32 v102, v194, v222
    v_mul_f32 v102, v102, v223
    v_fmac_f32 v103, v195, v222
    v_mul_f32 v103, v103, v223
    v_cvt_pk_bf16_f32 v100, v100, v101
    v_cvt_pk_bf16_f32 v101, v102, v103
    s_cmp_lg_u32 s3, 0
    s_cbranch_scc1 K1_k2p
    ds_write_b64 v8, v[88:89] offset:0
    ds_write_b64 v8, v[92:93] offset:256
    ds_write_b64 v8, v[96:97] offset:1024
    ds_write_b64 v8, v[100:101] offset:1280
    s_branch K1_kvst
K1_k2p:
    s_mov_b64 exec, 0xffff
    ds_write_b32 v9, v88 offset:2048
    ds_write_b32 v9, v92 offset:2112
    ds_write_b32 v9, v96 offset:2176
    ds_write_b32 v9, v100 offset:2240
    s_mov_b64 exec, -1
    s_branch K1_kvst
K1_vform:
    s_waitcnt lgkmcnt(6)
    v_mfma_f32_16x16x32_bf16 v[88:91], v[20:23], v[16:19], 0
    ds_read_b64_tr_b16 v[56:57], v172 offset:2304
    ds_read_b64_tr_b16 v[58:59], v172 offset:2448
    v_mfma_f32_16x16x32_bf16 v[92:95], v[24:27], v[16:19], 0
    ds_read_b128 v[60:63], v8 offset:8192
    v_mfma_f32_16x16x32_bf16 v[96:99], v[28:31], v[16:19], 0
    ds_read_b128 v[64:67], v8 offset:10240
    v_mfma_f32_16x16x32_bf16 v[100:103], v[32:35], v[16:19], 0
    ds_read_b128 v[68:71], v8 offset:12288
    v_mfma_f32_16x16x32_bf16 v[192:195], v[168:171], v[16:19], 0
    ds_read_b128 v[72:75], v8 offset:14336
    s_waitcnt lgkmcnt(6)
    v_mfma_f32_16x16x32_bf16 v[88:91], v[40:43], v[36:39], v[88:91]
    ds_read_b64_tr_b16 v[16:17], v172 offset:3456
    ds_read_b64_tr_b16 v[18:19], v172 offset:3600
    v_mfma_f32_16x16x32_bf16 v[92:95], v[44:47], v[36:39], v[92:95]
    ds_read_b128 v[20:23], v9 offset:8192
    v_mfma_f32_16x16x32_bf16 v[96:99], v[48:51], v[36:39], v[96:99]
    ds_read_b128 v[24:27], v9 offset:10240
    v_mfma_f32_16x16x32_bf16 v[100:103], v[52:55], v[36:39], v[100:103]
    ds_read_b128 v[28:31], v9 offset:12288
    v_mfma_f32_16x16x32_bf16 v[192:195], v[168:171], v[36:39], v[192:195]
    ds_read_b128 v[32:35], v9 offset:14336
    s_waitcnt lgkmcnt(6)
    v_mfma_f32_16x16x32_bf16 v[88:91], v[60:63], v[56:59], v[88:91]
    ds_read_b64_tr_b16 v[36:37], v172 offset:4608
    ds_read_b64_tr_b16 v[38:39], v172 offset:4752
    v_mfma_f32_16x16x32_bf16 v[92:95], v[64:67], v[56:59], v[92:95]
    ds_read_b128 v[40:43], v8 offset:16384
    v_mfma_f32_16x16x32_bf16 v[96:99], v[68:71], v[56:59], v[96:99]
    ds_read_b128 v[44:47], v8 offset:18432
    v_mfma_f32_16x16x32_bf16 v[100:103], v[72:75], v[56:59], v[100:103]
    ds_read_b128 v[48:51], v8 offset:20480
    v_mfma_f32_16x16x32_bf16 v[192:195], v[168:171], v[56:59], v[192:195]
    ds_read_b128 v[52:55], v8 offset:22528
    s_waitcnt lgkmcnt(6)
    v_mfma_f32_16x16x32_bf16 v[88:91], v[20:23], v[16:19], v[88:91]
    ds_read_b64_tr_b16 v[56:57], v172 offset:5760
    ds_read_b64_tr_b16 v[58:59], v172 offset:5904
    v_mfma_f32_16x16x32_bf16 v[92:95], v[24:27], v[16:19], v[92:95]
    ds_read_b128 v[60:63], v9 offset:16384
    v_mfma_f32_16x16x32_bf16 v[96:99], v[28:31], v[16:19], v[96:99]
    ds_read_b128 v[64:67], v9 offset:18432
    v_mfma_f32_16x16x32_bf16 v[100:103], v[32:35], v[16:19], v[100:103]
    ds_read_b128 v[68:71], v9 offset:20480
    v_mfma_f32_16x16x32_bf16 v[192:195], v[168:171], v[16:19], v[192:195]
    ds_read_b128 v[72:75], v9 offset:22528
    s_waitcnt lgkmcnt(6)
    v_mfma_f32_16x16x32_bf16 v[88:91], v[40:43], v[36:39], v[88:91]
    ds_read_b64_tr_b16 v[16:17], v172 offset:6912
    ds_read_b64_tr_b16 v[18:19], v172 offset:7056
    v_mfma_f32_16x16x32_bf16 v[92:95], v[44:47], v[36:39], v[92:95]
    ds_read_b128 v[20:23], v8 offset:24576
    v_mfma_f32_16x16x32_bf16 v[96:99], v[48:51], v[36:39], v[96:99]
    ds_read_b128 v[24:27], v8 offset:26624
    v_mfma_f32_16x16x32_bf16 v[100:103], v[52:55], v[36:39], v[100:103]
    ds_read_b128 v[28:31], v8 offset:28672
    v_mfma_f32_16x16x32_bf16 v[192:195], v[168:171], v[36:39], v[192:195]
    ds_read_b128 v[32:35], v8 offset:30720
    s_waitcnt lgkmcnt(6)
    v_mfma_f32_16x16x32_bf16 v[88:91], v[60:63], v[56:59], v[88:91]
    ds_read_b64_tr_b16 v[36:37], v172 offset:8064
    ds_read_b64_tr_b16 v[38:39], v172 offset:8208
    v_mfma_f32_16x16x32_bf16 v[92:95], v[64:67], v[56:59], v[92:95]
    ds_read_b128 v[40:43], v9 offset:24576
    v_mfma_f32_16x16x32_bf16 v[96:99], v[68:71], v[56:59], v[96:99]
    ds_read_b128 v[44:47], v9 offset:26624
    v_mfma_f32_16x16x32_bf16 v[100:103], v[72:75], v[56:59], v[100:103]
    ds_read_b128 v[48:51], v9 offset:28672
    v_mfma_f32_16x16x32_bf16 v[192:195], v[168:171], v[56:59], v[192:195]
    ds_read_b128 v[52:55], v9 offset:30720
    s_waitcnt lgkmcnt(6)
    v_mfma_f32_16x16x32_bf16 v[88:91], v[20:23], v[16:19], v[88:91]
    ds_read_b64_tr_b16 v[56:57], v172 offset:9216
    ds_read_b64_tr_b16 v[58:59], v172 offset:9360
    v_mfma_f32_16x16x32_bf16 v[92:95], v[24:27], v[16:19], v[92:95]
    ds_read_b128 v[60:63], v190 offset:0
    v_mfma_f32_16x16x32_bf16 v[96:99], v[28:31], v[16:19], v[96:99]
    ds_read_b128 v[64:67], v190 offset:2048
    v_mfma_f32_16x16x32_bf16 v[100:103], v[32:35], v[16:19], v[100:103]
    ds_read_b128 v[68:71], v190 offset:4096
    v_mfma_f32_16x16x32_bf16 v[192:195], v[168:171], v[16:19], v[192:195]
    ds_read_b128 v[72:75], v190 offset:6144
    s_waitcnt lgkmcnt(6)
    v_mfma_f32_16x16x32_bf16 v[88:91], v[40:43], v[36:39], v[88:91]
    ds_read_b64_tr_b16 v[16:17], v172 offset:10368
    ds_read_b64_tr_b16 v[18:19], v172 offset:10512
    v_mfma_f32_16x16x32_bf16 v[92:95], v[44:47], v[36:39], v[92:95]
    ds_read_b128 v[20:23], v191 offset:0
    v_mfma_f32_16x16x32_bf16 v[96:99], v[48:51], v[36:39], v[96:99]
    ds_read_b128 v[24:27], v191 offset:2048
    v_mfma_f32_16x16x32_bf16 v[100:103], v[52:55], v[36:39], v[100:103]
    ds_read_b128 v[28:31], v191 offset:4096
    v_mfma_f32_16x16x32_bf16 v[192:195], v[168:171], v[36:39], v[192:195]
    ds_read_b128 v[32:35], v191 offset:6144
    s_waitcnt lgkmcnt(6)
    v_mfma_f32_16x16x32_bf16 v[88:91], v[60:63], v[56:59], v[88:91]
    ds_read_b64_tr_b16 v[36:37], v172 offset:11520
    ds_read_b64_tr_b16 v[38:39], v172 offset:11664
    v_mfma_f32_16x16x32_bf16 v[92:95], v[64:67], v[56:59], v[92:95]
    ds_read_b128 v[40:43], v190 offset:8192
    v_mfma_f32_16x16x32_bf16 v[96:99], v[68:71], v[56:59], v[96:99]
    ds_read_b128 v[44:47], v190 offset:10240
    v_mfma_f32_16x16x32_bf16 v[100:103], v[72:75], v[56:59], v[100:103]
    ds_read_b128 v[48:51], v190 offset:12288
    v_mfma_f32_16x16x32_bf16 v[192:195], v[168:171], v[56:59], v[192:195]
    ds_read_b128 v[52:55], v190 offset:14336
    s_waitcnt lgkmcnt(6)
    v_mfma_f32_16x16x32_bf16 v[88:91], v[20:23], v[16:19], v[88:91]
    ds_read_b64_tr_b16 v[56:57], v172 offset:12672
    ds_read_b64_tr_b16 v[58:59], v172 offset:12816
    v_mfma_f32_16x16x32_bf16 v[92:95], v[24:27], v[16:19], v[92:95]
    ds_read_b128 v[60:63], v191 offset:8192
    v_mfma_f32_16x16x32_bf16 v[96:99], v[28:31], v[16:19], v[96:99]
    ds_read_b128 v[64:67], v191 offset:10240
    v_mfma_f32_16x16x32_bf16 v[100:103], v[32:35], v[16:19], v[100:103]
    ds_read_b128 v[68:71], v191 offset:12288
    v_mfma_f32_16x16x32_bf16 v[192:195], v[168:171], v[16:19], v[192:195]
    ds_read_b128 v[72:75], v191 offset:14336
    s_waitcnt lgkmcnt(6)
    v_mfma_f32_16x16x32_bf16 v[88:91], v[40:43], v[36:39], v[88:91]
    ds_read_b64_tr_b16 v[16:17], v172 offset:13824
    ds_read_b64_tr_b16 v[18:19], v172 offset:13968
    v_mfma_f32_16x16x32_bf16 v[92:95], v[44:47], v[36:39], v[92:95]
    ds_read_b128 v[20:23], v190 offset:16384
    v_mfma_f32_16x16x32_bf16 v[96:99], v[48:51], v[36:39], v[96:99]
    ds_read_b128 v[24:27], v190 offset:18432
    v_mfma_f32_16x16x32_bf16 v[100:103], v[52:55], v[36:39], v[100:103]
    ds_read_b128 v[28:31], v190 offset:20480
    v_mfma_f32_16x16x32_bf16 v[192:195], v[168:171], v[36:39], v[192:195]
    ds_read_b128 v[32:35], v190 offset:22528
    s_waitcnt lgkmcnt(6)
    v_mfma_f32_16x16x32_bf16 v[88:91], v[60:63], v[56:59], v[88:91]
    ds_read_b64_tr_b16 v[36:37], v172 offset:14976
    ds_read_b64_tr_b16 v[38:39], v172 offset:15120
    v_mfma_f32_16x16x32_bf16 v[92:95], v[64:67], v[56:59], v[92:95]
    ds_read_b128 v[40:43], v191 offset:16384
    v_mfma_f32_16x16x32_bf16 v[96:99], v[68:71], v[56:59], v[96:99]
    ds_read_b128 v[44:47], v191 offset:18432
    v_mfma_f32_16x16x32_bf16 v[100:103], v[72:75], v[56:59], v[100:103]
    ds_read_b128 v[48:51], v191 offset:20480
    v_mfma_f32_16x16x32_bf16 v[192:195], v[168:171], v[56:59], v[192:195]
    ds_read_b128 v[52:55], v191 offset:22528
    s_waitcnt lgkmcnt(6)
    v_mfma_f32_16x16x32_bf16 v[88:91], v[20:23], v[16:19], v[88:91]
    ds_read_b64_tr_b16 v[56:57], v172 offset:16128
    ds_read_b64_tr_b16 v[58:59], v172 offset:16272
    v_mfma_f32_16x16x32_bf16 v[92:95], v[24:27], v[16:19], v[92:95]
    ds_read_b128 v[60:63], v190 offset:24576
    v_mfma_f32_16x16x32_bf16 v[96:99], v[28:31], v[16:19], v[96:99]
    ds_read_b128 v[64:67], v190 offset:26624
    v_mfma_f32_16x16x32_bf16 v[100:103], v[32:35], v[16:19], v[100:103]
    ds_read_b128 v[68:71], v190 offset:28672
    v_mfma_f32_16x16x32_bf16 v[192:195], v[168:171], v[16:19], v[192:195]
    ds_read_b128 v[72:75], v190 offset:30720
    s_waitcnt lgkmcnt(6)
    v_mfma_f32_16x16x32_bf16 v[88:91], v[40:43], v[36:39], v[88:91]
    ds_read_b64_tr_b16 v[16:17], v172 offset:17280
    ds_read_b64_tr_b16 v[18:19], v172 offset:17424
    v_mfma_f32_16x16x32_bf16 v[92:95], v[44:47], v[36:39], v[92:95]
    ds_read_b128 v[20:23], v191 offset:24576
    v_mfma_f32_16x16x32_bf16 v[96:99], v[48:51], v[36:39], v[96:99]
    ds_read_b128 v[24:27], v191 offset:26624
    v_mfma_f32_16x16x32_bf16 v[100:103], v[52:55], v[36:39], v[100:103]
    ds_read_b128 v[28:31], v191 offset:28672
    v_mfma_f32_16x16x32_bf16 v[192:195], v[168:171], v[36:39], v[192:195]
    ds_read_b128 v[32:35], v191 offset:30720
    s_waitcnt lgkmcnt(6)
    v_mfma_f32_16x16x32_bf16 v[88:91], v[60:63], v[56:59], v[88:91]
    ds_read_b64_tr_b16 v[36:37], v172 offset:18432
    ds_read_b64_tr_b16 v[38:39], v172 offset:18576
    v_mfma_f32_16x16x32_bf16 v[92:95], v[64:67], v[56:59], v[92:95]
    ds_read_b128 v[40:43], v190 offset:32768
    v_mfma_f32_16x16x32_bf16 v[96:99], v[68:71], v[56:59], v[96:99]
    ds_read_b128 v[44:47], v190 offset:34816
    v_mfma_f32_16x16x32_bf16 v[100:103], v[72:75], v[56:59], v[100:103]
    ds_read_b128 v[48:51], v190 offset:36864
    v_mfma_f32_16x16x32_bf16 v[192:195], v[168:171], v[56:59], v[192:195]
    ds_read_b128 v[52:55], v190 offset:38912
    s_waitcnt lgkmcnt(6)
    v_mfma_f32_16x16x32_bf16 v[88:91], v[20:23], v[16:19], v[88:91]
    ds_read_b64_tr_b16 v[56:57], v172 offset:19584
    ds_read_b64_tr_b16 v[58:59], v172 offset:19728
    v_mfma_f32_16x16x32_bf16 v[92:95], v[24:27], v[16:19], v[92:95]
    ds_read_b128 v[60:63], v191 offset:32768
    v_mfma_f32_16x16x32_bf16 v[96:99], v[28:31], v[16:19], v[96:99]
    ds_read_b128 v[64:67], v191 offset:34816
    v_mfma_f32_16x16x32_bf16 v[100:103], v[32:35], v[16:19], v[100:103]
    ds_read_b128 v[68:71], v191 offset:36864
    v_mfma_f32_16x16x32_bf16 v[192:195], v[168:171], v[16:19], v[192:195]
    ds_read_b128 v[72:75], v191 offset:38912
    s_waitcnt lgkmcnt(6)
    v_mfma_f32_16x16x32_bf16 v[88:91], v[40:43], v[36:39], v[88:91]
    v_mfma_f32_16x16x32_bf16 v[92:95], v[44:47], v[36:39], v[92:95]
    v_mfma_f32_16x16x32_bf16 v[96:99], v[48:51], v[36:39], v[96:99]
    v_mfma_f32_16x16x32_bf16 v[100:103], v[52:55], v[36:39], v[100:103]
    v_mfma_f32_16x16x32_bf16 v[192:195], v[168:171], v[36:39], v[192:195]
    s_waitcnt lgkmcnt(0)
    v_mfma_f32_16x16x32_bf16 v[88:91], v[60:63], v[56:59], v[88:91]
    v_mfma_f32_16x16x32_bf16 v[92:95], v[64:67], v[56:59], v[92:95]
    v_mfma_f32_16x16x32_bf16 v[96:99], v[68:71], v[56:59], v[96:99]
    v_mfma_f32_16x16x32_bf16 v[100:103], v[72:75], v[56:59], v[100:103]
    v_mfma_f32_16x16x32_bf16 v[192:195], v[168:171], v[56:59], v[192:195]
    v_lshlrev_b32 v7, 5, v2
    v_add_u32 v7, 160512, v7
    v_and_b32 v8, 1, v2
    v_mul_u32_u24 v8, 19, v8
    v_add_u32 v8, v8, v1
    v_lshlrev_b32 v8, 4, v8
    v_lshrrev_b32 v10, 1, v2
    v_lshl_add_u32 v8, v10, 3, v8
    s_lshr_b32 s56, s3, 1
    s_lshl_b32 s56, s56, 8
    v_add_u32 v8, s56, v8
    v_cmp_eq_u32 s[54:55], 2, v1
    v_cmp_gt_u32 s[58:59], 3, v1
    s_nop 1
    s_cmp_eq_u32 s3, 3
    s_cselect_b64 s[54:55], s[54:55], 0
    s_cselect_b64 s[58:59], s[58:59], -1
    s_barrier
    ds_read_b128 v[216:219], v7 offset:0
    ds_read_b128 v[220:223], v7 offset:16
    ds_read_b128 v[224:227], v7 offset:128
    ds_read_b128 v[228:231], v7 offset:144
    ds_read_b128 v[232:235], v7 offset:256
    ds_read_b128 v[236:239], v7 offset:272
    ds_read_b128 v[240:243], v7 offset:384
    ds_read_b128 v[244:247], v7 offset:400
    s_waitcnt lgkmcnt(0)
    v_fmac_f32 v88, v192, v216
    v_mul_f32 v88, v88, v217
    v_fmac_f32 v89, v192, v218
    v_mul_f32 v89, v89, v219
    v_fmac_f32 v90, v192, v220
    v_mul_f32 v90, v90, v221
    v_fmac_f32 v91, v192, v222
    v_mul_f32 v91, v91, v223
    v_cvt_pk_bf16_f32 v88, v88, v89
    v_cvt_pk_bf16_f32 v89, v90, v91
    v_cndmask_b32 v88, v88, v168, s[54:55]
    v_cndmask_b32 v89, v89, v168, s[54:55]
    v_fmac_f32 v92, v192, v224
    v_mul_f32 v92, v92, v225
    v_fmac_f32 v93, v192, v226
    v_mul_f32 v93, v93, v227
    v_fmac_f32 v94, v192, v228
    v_mul_f32 v94, v94, v229
    v_fmac_f32 v95, v192, v230
    v_mul_f32 v95, v95, v231
    v_cvt_pk_bf16_f32 v92, v92, v93
    v_cvt_pk_bf16_f32 v93, v94, v95
    v_cndmask_b32 v92, v92, v168, s[54:55]
    v_cndmask_b32 v93, v93, v168, s[54:55]
    v_fmac_f32 v96, v192, v232
    v_mul_f32 v96, v96, v233
    v_fmac_f32 v97, v192, v234
    v_mul_f32 v97, v97, v235
    v_fmac_f32 v98, v192, v236
    v_mul_f32 v98, v98, v237
    v_fmac_f32 v99, v192, v238
    v_mul_f32 v99, v99, v239
    v_cvt_pk_bf16_f32 v96, v96, v97
    v_cvt_pk_bf16_f32 v97, v98, v99
    v_cndmask_b32 v96, v96, v168, s[54:55]
    v_cndmask_b32 v97, v97, v168, s[54:55]
    v_fmac_f32 v100, v192, v240
    v_mul_f32 v100, v100, v241
    v_fmac_f32 v101, v192, v242
    v_mul_f32 v101, v101, v243
    v_fmac_f32 v102, v192, v244
    v_mul_f32 v102, v102, v245
    v_fmac_f32 v103, v192, v246
    v_mul_f32 v103, v103, v247
    v_cvt_pk_bf16_f32 v100, v100, v101
    v_cvt_pk_bf16_f32 v101, v102, v103
    v_cndmask_b32 v100, v100, v168, s[54:55]
    v_cndmask_b32 v101, v101, v168, s[54:55]
    s_mov_b64 exec, s[58:59]
    ds_write_b64 v8, v[88:89] offset:2304
    ds_write_b64 v8, v[92:93] offset:2912
    ds_write_b64 v8, v[96:97] offset:3520
    ds_write_b64 v8, v[100:101] offset:4128
    s_mov_b64 exec, -1
K1_kvst:
    s_lshl_b32 s49, s3, 10
    v_lshlrev_b32 v3, 4, v0
    v_add_u32 v3, s49, v3
    s_waitcnt lgkmcnt(0)
    s_barrier
    ds_read_b128 v[16:19], v3
    ds_read_b128 v[20:23], v3 offset:1024
    s_waitcnt lgkmcnt(1)
    buffer_store_dwordx4 v[16:19], v3, s[36:39], s48 offen sc1
    s_waitcnt lgkmcnt(0)
    s_cmp_lg_u32 s3, 3
    s_cbranch_scc1 K1_fin
    s_mov_b32 exec_hi, 0xff
    buffer_store_dwordx4 v[20:23], v3, s[36:39], s48 offen offset:1024 sc1
    s_mov_b64 exec, -1
    s_branch K1_fin
K1_wbar:
    s_mov_b32 m0, s64
    s_add_u32 s62, s47, s61
    s_add_u32 s64, s64, 8192
    buffer_load_dwordx4 v3, s[16:19], s62 offen lds
    buffer_load_dwordx4 v6, s[16:19], s62 offen offset:1024 lds
    s_add_u32 s61, s61, 128
    s_cmp_eq_u32 s61, 640
    s_cselect_b32 s61, 0, s61
    s_mov_b32 m0, s64
    s_add_u32 s62, s47, s61
    s_add_u32 s64, s64, 8192
    buffer_load_dwordx4 v3, s[16:19], s62 offen lds
    buffer_load_dwordx4 v6, s[16:19], s62 offen offset:1024 lds
    s_mul_i32 s61, s71, 128
    s_mov_b32 m0, s64
    s_add_u32 s62, s47, s61
    s_add_u32 s64, s64, 8192
    buffer_load_dwordx4 v3, s[16:19], s62 offen lds
    buffer_load_dwordx4 v6, s[16:19], s62 offen offset:1024 lds
    s_add_u32 s61, s61, 128
    s_cmp_eq_u32 s61, 1152
    s_cselect_b32 s61, 640, s61
    s_mov_b32 m0, s64
    s_add_u32 s62, s47, s61
    s_add_u32 s64, s64, 8192
    buffer_load_dwordx4 v3, s[16:19], s62 offen lds
    buffer_load_dwordx4 v6, s[16:19], s62 offen offset:1024 lds
    s_add_u32 s61, s61, 128
    s_cmp_eq_u32 s61, 1152
    s_cselect_b32 s61, 640, s61
    s_mov_b32 m0, s64
    s_add_u32 s62, s47, s61
    s_add_u32 s64, s64, 8192
    buffer_load_dwordx4 v3, s[16:19], s62 offen lds
    buffer_load_dwordx4 v6, s[16:19], s62 offen offset:1024 lds
    s_add_u32 s61, s61, 128
    s_cmp_eq_u32 s61, 1152
    s_cselect_b32 s61, 640, s61
    s_mov_b32 m0, s64
    s_add_u32 s62, s47, s61
    s_add_u32 s64, s64, 8192
    buffer_load_dwordx4 v3, s[16:19], s62 offen lds
    buffer_load_dwordx4 v6, s[16:19], s62 offen offset:1024 lds
    s_add_u32 s61, s61, 128
    s_cmp_eq_u32 s61, 1152
    s_cselect_b32 s61, 640, s61
    s_waitcnt vmcnt(12)
    s_barrier
    s_mov_b32 s24, s12
    s_mov_b32 s25, s13
    s_mov_b32 s26, 663552
    s_mov_b32 s27, 0x00020000
    s_cmp_lt_u32 s44, 18
    s_cselect_b32 s26, s26, 0
    s_cmp_ge_u32 s44, 16
    s_cbranch_scc1 K1_wb_hi
    s_mul_i32 s50, s44, 36
    s_lshr_b32 s51, s3, 1
    s_mul_i32 s51, s51, 18
    s_add_u32 s50, s50, s51
    s_and_b32 s51, s3, 1
    s_lshl_b32 s51, s51, 2
    s_add_u32 s50, s50, s51
    v_lshrrev_b32 v13, 2, v4
    v_lshlrev_b32 v13, 3, v13
    v_and_b32 v14, 3, v4
    v_add_u32 v13, v13, v14
    s_branch K1_wb_go
K1_wb_hi:
    s_sub_u32 s50, s44, 16
    s_mul_i32 s50, s50, 288
    s_mul_i32 s51, s3, 72
    s_add_u32 s50, s50, s51
    s_add_u32 s50, s50, 16
    v_lshrrev_b32 v13, 1, v4
    v_mul_u32_u24 v13, 18, v13
    v_and_b32 v14, 1, v4
    v_add_u32 v13, v13, v14
K1_wb_go:
    s_mul_i32 s50, s50, 1152
    v_mul_u32_u24 v13, 1152, v13
    v_lshl_add_u32 v13, v5, 4, v13
    buffer_load_dwordx4 v[100:103], v13, s[24:27], s50 offen offset:0
    buffer_load_dwordx4 v[104:107], v13, s[24:27], s50 offen offset:128
    buffer_load_dwordx4 v[108:111], v13, s[24:27], s50 offen offset:256
    buffer_load_dwordx4 v[112:115], v13, s[24:27], s50 offen offset:384
    buffer_load_dwordx4 v[116:119], v13, s[24:27], s50 offen offset:512
    buffer_load_dwordx4 v[120:123], v13, s[24:27], s50 offen offset:640
    buffer_load_dwordx4 v[124:127], v13, s[24:27], s50 offen offset:768
    buffer_load_dwordx4 v[128:131], v13, s[24:27], s50 offen offset:896
    buffer_load_dwordx4 v[132:135], v13, s[24:27], s50 offen offset:1024
    v_and_b32 v7, 7, v1
    v_xor_b32 v8, v2, v7
    v_lshlrev_b32 v8, 4, v8
    v_lshl_add_u32 v8, v1, 7, v8
    v_add_u32 v8, s66, v8
    v_xor_b32 v9, 64, v8
    v_add_u32 v190, 0x8000, v8
    v_add_u32 v191, 0x8000, v9
    s_add_u32 s68, s14, 7380992
    s_addc_u32 s69, s15, 0
    s_mov_b32 s70, 2359296
    s_mov_b32 s71, 0x00020000
    s_add_u32 s20, s14, 9740288
    s_addc_u32 s21, s15, 0
    s_mov_b32 s22, 36864
    s_mov_b32 s23, 0x00020000
    v_lshlrev_b32 v3, 4, v0
    s_lshr_b32 s48, s46, 4
    s_mul_i32 s48, s48, 18432
    s_waitcnt vmcnt(9)
    ds_read_b128 v[16:19], v8 offset:0
    ds_read_b128 v[20:23], v9 offset:0
    ds_read_b128 v[24:27], v8 offset:8192
    ds_read_b128 v[28:31], v9 offset:8192
    ds_read_b128 v[32:35], v8 offset:16384
    ds_read_b128 v[36:39], v9 offset:16384
    ds_read_b128 v[40:43], v8 offset:24576
    ds_read_b128 v[44:47], v9 offset:24576
    ds_read_b128 v[48:51], v190 offset:0
    ds_read_b128 v[52:55], v191 offset:0
    ds_read_b128 v[56:59], v190 offset:8192
    ds_read_b128 v[60:63], v191 offset:8192
    ds_read_b128 v[64:67], v190 offset:16384
    ds_read_b128 v[68:71], v191 offset:16384
    ds_read_b128 v[72:75], v190 offset:24576
    ds_read_b128 v[76:79], v191 offset:24576
    ds_read_b128 v[80:83], v190 offset:32768
    ds_read_b128 v[84:87], v191 offset:32768
    s_waitcnt vmcnt(0)
    s_cmp_ge_u32 s44, 18
    s_cbranch_scc1 K1_xc
    s_mov_b32 s56, 1065369472
    v_mov_b32 v6, 0
    v_mov_b32 v7, 0
    v_dot2_f32_bf16 v6, v100, s56, v6
    v_dot2_f32_bf16 v7, v101, s56, v7
    v_dot2_f32_bf16 v6, v102, s56, v6
    v_dot2_f32_bf16 v7, v103, s56, v7
    v_dot2_f32_bf16 v6, v104, s56, v6
    v_dot2_f32_bf16 v7, v105, s56, v7
    v_dot2_f32_bf16 v6, v106, s56, v6
    v_dot2_f32_bf16 v7, v107, s56, v7
    v_dot2_f32_bf16 v6, v108, s56, v6
    v_dot2_f32_bf16 v7, v109, s56, v7
    v_dot2_f32_bf16 v6, v110, s56, v6
    v_dot2_f32_bf16 v7, v111, s56, v7
    v_dot2_f32_bf16 v6, v112, s56, v6
    v_dot2_f32_bf16 v7, v113, s56, v7
    v_dot2_f32_bf16 v6, v114, s56, v6
    v_dot2_f32_bf16 v7, v115, s56, v7
    v_dot2_f32_bf16 v6, v116, s56, v6
    v_dot2_f32_bf16 v7, v117, s56, v7
    v_dot2_f32_bf16 v6, v118, s56, v6
    v_dot2_f32_bf16 v7, v119, s56, v7
    v_dot2_f32_bf16 v6, v120, s56, v6
    v_dot2_f32_bf16 v7, v121, s56, v7
    v_dot2_f32_bf16 v6, v122, s56, v6
    v_dot2_f32_bf16 v7, v123, s56, v7
    v_dot2_f32_bf16 v6, v124, s56, v6
    v_dot2_f32_bf16 v7, v125, s56, v7
    v_dot2_f32_bf16 v6, v126, s56, v6
    v_dot2_f32_bf16 v7, v127, s56, v7
    v_dot2_f32_bf16 v6, v128, s56, v6
    v_dot2_f32_bf16 v7, v129, s56, v7
    v_dot2_f32_bf16 v6, v130, s56, v6
    v_dot2_f32_bf16 v7, v131, s56, v7
    v_dot2_f32_bf16 v6, v132, s56, v6
    v_dot2_f32_bf16 v7, v133, s56, v7
    v_dot2_f32_bf16 v6, v134, s56, v6
    v_dot2_f32_bf16 v7, v135, s56, v7
    s_nop 2
    v_add_f32 v6, v6, v7
    s_nop 1
    ds_swizzle_b32 v7, v6 offset:1055
    s_waitcnt lgkmcnt(0)
    v_add_f32 v6, v6, v7
    ds_swizzle_b32 v7, v6 offset:2079
    s_waitcnt lgkmcnt(0)
    v_add_f32 v6, v6, v7
    ds_swizzle_b32 v7, v6 offset:4127
    s_waitcnt lgkmcnt(0)
    v_add_f32 v6, v6, v7
    v_mul_f32 v6, 987991609, v6
    v_cvt_pk_bf16_f32 v7, v6, v6
    v_lshlrev_b32 v8, 16, v7
    v_sub_f32 v8, v6, v8
    v_cvt_pk_bf16_f32 v8, v8, v8
    s_lshl_b32 s47, s3, 8
    v_lshlrev_b32 v9, 5, v5
    v_lshl_add_u32 v9, v4, 1, v9
    v_add_u32 v9, s47, v9
    ds_write_b16 v9, v7
    ds_write_b16 v9, v8 offset:16
    v_lshlrev_b32 v9, 2, v0
    v_add_u32 v10, s47, v9
    ds_read_b32 v7, v10
    s_lshl_b32 s50, s44, 10
    s_add_u32 s50, s50, s47
    s_add_u32 s51, s50, 18432
    s_waitcnt lgkmcnt(0)
    buffer_store_dword v7, v9, s[20:23], s50 offen sc1
    buffer_store_dword v7, v9, s[20:23], s51 offen sc1
K1_xc:
    s_waitcnt lgkmcnt(0)
    buffer_store_dwordx4 v[16:19], v3, s[68:71], s48 offen offset:0 sc1
    buffer_store_dwordx4 v[20:23], v3, s[68:71], s48 offen offset:1024 sc1
    buffer_store_dwordx4 v[24:27], v3, s[68:71], s48 offen offset:2048 sc1
    buffer_store_dwordx4 v[28:31], v3, s[68:71], s48 offen offset:3072 sc1
    s_add_u32 s48, s48, 4096
    buffer_store_dwordx4 v[32:35], v3, s[68:71], s48 offen offset:0 sc1
    buffer_store_dwordx4 v[36:39], v3, s[68:71], s48 offen offset:1024 sc1
    buffer_store_dwordx4 v[40:43], v3, s[68:71], s48 offen offset:2048 sc1
    buffer_store_dwordx4 v[44:47], v3, s[68:71], s48 offen offset:3072 sc1
    s_add_u32 s48, s48, 4096
    buffer_store_dwordx4 v[48:51], v3, s[68:71], s48 offen offset:0 sc1
    buffer_store_dwordx4 v[52:55], v3, s[68:71], s48 offen offset:1024 sc1
    buffer_store_dwordx4 v[56:59], v3, s[68:71], s48 offen offset:2048 sc1
    buffer_store_dwordx4 v[60:63], v3, s[68:71], s48 offen offset:3072 sc1
    s_add_u32 s48, s48, 4096
    buffer_store_dwordx4 v[64:67], v3, s[68:71], s48 offen offset:0 sc1
    buffer_store_dwordx4 v[68:71], v3, s[68:71], s48 offen offset:1024 sc1
    buffer_store_dwordx4 v[72:75], v3, s[68:71], s48 offen offset:2048 sc1
    buffer_store_dwordx4 v[76:79], v3, s[68:71], s48 offen offset:3072 sc1
    s_add_u32 s48, s48, 4096
    buffer_store_dwordx4 v[80:83], v3, s[68:71], s48 offen offset:0 sc1
    buffer_store_dwordx4 v[84:87], v3, s[68:71], s48 offen offset:1024 sc1
K1_fin:
    s_mov_b32 s3, s100
    s_waitcnt lgkmcnt(0)
    s_add_u32 s36, s14, 40194048
    s_addc_u32 s37, s15, 0
    s_mov_b32 s38, 524288
    s_mov_b32 s39, 0x00020000
    s_mul_i32 s101, s101, 0x9e3779b1
    s_add_u32 s101, s101, 0x7f4a7c15
    v_mov_b32 v4, s101
    v_lshlrev_b32 v5, 2, v0
    s_lshl_b32 s45, s90, 7
    s_add_u32 s45, s45, 491520
    s_waitcnt vmcnt(0)
    s_barrier
    s_cmp_lg_u32 s3, 0
    s_cbranch_scc1 K2_naf
    s_mov_b32 exec_lo, -1
    s_mov_b32 exec_hi, 0
    buffer_store_dword v4, v5, s[36:39], s45 offen sc1
    s_mov_b64 exec, -1
K2_naf:
    s_setprio 0
    s_load_dwordx2 s[4:5], s[0:1], 64
    s_load_dwordx4 s[8:11], s[0:1], 48
    v_and_b32 v1, 31, v0
    v_lshrrev_b32 v2, 5, v0
    v_lshlrev_b32 v3, 4, v0
    s_and_b32 s93, s2, 7
    s_lshl_b32 s93, s93, 5
    s_lshr_b32 s40, s2, 3
    s_add_u32 s93, s93, s40
    s_lshr_b32 s40, s93, 2
    s_and_b32 s41, s93, 3
    s_lshl_b32 s41, s41, 3
    s_add_u32 s41, s41, s3
    s_mul_i32 s42, s93, 9216
    s_lshl_b32 s43, s3, 10
    s_add_u32 s42, s42, s43
    s_add_u32 s43, s43, 151552
    s_lshl_b32 s44, s3, 10
    s_add_u32 s16, s14, 2363392
    s_addc_u32 s17, s15, 0
    s_mov_b32 s18, 151552
    s_mov_b32 s19, 0x00020000
    s_add_u32 s20, s14, 4096
    s_addc_u32 s21, s15, 0
    s_mov_b32 s22, 2359296
    s_mov_b32 s23, 0x00020000
    s_mov_b32 s60, s14
    s_mov_b32 s61, s15
    s_mov_b32 s62, 0
    s_mov_b32 s63, 0x00020000
    s_mov_b32 s64, s14
    s_mov_b32 s65, s15
    s_mov_b32 s66, 0
    s_mov_b32 s67, 0x00020000
    s_mov_b32 s68, s14
    s_mov_b32 s69, s15
    s_mov_b32 s70, 0
    s_mov_b32 s71, 0x00020000
    v_mov_b32 v240, 0
    v_mov_b32 v241, 0
    v_mov_b32 v242, 0
    v_mov_b32 v243, 0
    s_and_b32 s45, s93, 3
    s_mul_i32 s45, s45, 3
    s_lshr_b32 s45, s45, 1
    s_lshl_b32 s45, s45, 5
    s_lshr_b32 s46, s93, 3
    s_add_u32 s45, s45, s46
    v_add_u32 v30, 192, v0
    v_lshlrev_b32 v31, 5, v1
    v_add_u32 v31, s45, v31
    v_cmp_gt_u32 vcc, 32, v0
    s_nop 1
    v_cndmask_b32 v30, v31, v30, vcc
    v_lshlrev_b32 v30, 7, v30
    s_mov_b32 s45, 491520
    s_cmp_lg_u32 s3, 1
    s_cbranch_scc1 K2_np
    s_mov_b32 s91, 0x10000
    s_mov_b32 exec_lo, 4294967295
    s_mov_b32 exec_hi, 3
L_poll_3:
    buffer_load_dword v31, v30, s[36:39], s45 offen sc1
    s_waitcnt vmcnt(0)
L_poll_3_1:
    v_cmp_eq_u32 vcc, s101, v31
    s_nop 1
    s_cmp_eq_u64 vcc, exec
    s_cbranch_scc1 L_poll_3_ok
    s_sleep 2
    s_sub_u32 s91, s91, 1
    s_cbranch_scc0 L_poll_3
L_poll_3_ok:
    s_mov_b64 exec, -1
    s_branch K2_nb
K2_np:
    s_waitcnt lgkmcnt(0)
    s_add_u32 s60, s14, 9777152
    s_addc_u32 s61, s15, 0
    s_mov_b32 s62, 11542528
    s_mov_b32 s63, 0x00020000
    v_and_b32 v6, 15, v0
    v_lshrrev_b32 v7, 4, v0
    s_mov_b32 s80, 0x05040100
    s_mov_b32 s81, 0x07060302
    s_and_b32 s46, s2, 7
    s_lshr_b32 s47, s2, 3
    s_and_b32 s34, s46, 7
    s_lshl_b32 s34, s34, 0
    s_and_b32 s48, s47, 0
    s_add_u32 s34, s34, s48
    s_lshr_b32 s35, s46, 3
    s_lshl_b32 s35, s35, 5
    s_lshr_b32 s48, s47, 0
    s_add_u32 s35, s35, s48
    s_mov_b32 s45, s34
    s_mul_i32 s47, s35, 11
    s_add_u32 s47, s47, s3
    s_mul_hi_u32 s46, s47, 26512144
    s_mul_i32 s49, s46, 162
    s_sub_u32 s47, s47, s49
    s_mul_hi_u32 s49, s47, 477218589
    s_mul_i32 s50, s49, 9
    s_sub_u32 s50, s47, s50
    s_mov_b32 s67, 0x00020000
    s_lshl_b32 s54, s50, 7
    v_mov_b32 v240, v3
    s_cmp_lt_u32 s46, 2
    s_cselect_b32 s66, 5308416, 0
    s_cselect_b32 s57, 0, 0x100000
    s_mul_i32 s53, s45, 1304
    s_mul_i32 s55, s46, 162
    s_add_u32 s53, s53, s55
    s_add_u32 s53, s53, 648
    s_add_u32 s53, s53, s57
    s_cmp_eq_u32 s46, 1
    s_cbranch_scc1 L_rp_4_w2
    s_mul_i32 s55, s49, 3
    s_add_u32 s53, s53, s55
    s_lshl_b32 s55, s50, 2
    s_add_u32 s55, s55, 0
    s_mul_i32 s56, s55, 86
    s_lshr_b32 s56, s56, 8
    s_lshr_b32 s58, s56, 2
    s_mul_i32 s58, s58, 1250
    s_mul_i32 s56, s56, 323
    s_sub_u32 s56, s56, s58
    s_add_u32 s55, s55, s56
    s_add_u32 s55, s55, s53
    s_lshl_b32 s82, s55, 10
    s_lshl_b32 s55, s50, 2
    s_add_u32 s55, s55, 1
    s_mul_i32 s56, s55, 86
    s_lshr_b32 s56, s56, 8
    s_lshr_b32 s58, s56, 2
    s_mul_i32 s58, s58, 1250
    s_mul_i32 s56, s56, 323
    s_sub_u32 s56, s56, s58
    s_add_u32 s55, s55, s56
    s_add_u32 s55, s55, s53
    s_lshl_b32 s83, s55, 10
    s_lshl_b32 s55, s50, 2
    s_add_u32 s55, s55, 2
    s_mul_i32 s56, s55, 86
    s_lshr_b32 s56, s56, 8
    s_lshr_b32 s58, s56, 2
    s_mul_i32 s58, s58, 1250
    s_mul_i32 s56, s56, 323
    s_sub_u32 s56, s56, s58
    s_add_u32 s55, s55, s56
    s_add_u32 s55, s55, s53
    s_lshl_b32 s84, s55, 10
    s_lshl_b32 s55, s50, 2
    s_add_u32 s55, s55, 3
    s_mul_i32 s56, s55, 86
    s_lshr_b32 s56, s56, 8
    s_lshr_b32 s58, s56, 2
    s_mul_i32 s58, s58, 1250
    s_mul_i32 s56, s56, 323
    s_sub_u32 s56, s56, s58
    s_add_u32 s55, s55, s56
    s_add_u32 s55, s55, s53
    s_lshl_b32 s85, s55, 10
    s_mov_b32 s64, s8
    s_mov_b32 s65, s9
    s_mul_i32 s53, s49, 294912
    s_mul_i32 s55, s45, 1152
    s_add_u32 s53, s53, s55
    s_add_u32 s72, s53, s54
    s_mov_b32 s73, 36864
    s_mov_b32 s74, 18432
    s_mov_b32 s75, 9216
    v_mul_u32_u24 v242, 73728, v7
    v_lshl_add_u32 v242, v6, 3, v242
    s_branch L_rp_4_done
L_rp_4_w2:
    s_sub_u32 s55, s50, s45
    s_sub_u32 s55, s55, 1
    s_and_b32 s55, s55, 7
    s_add_u32 s55, s55, 1
    s_cmp_eq_u32 s50, 8
    s_cselect_b32 s50, 0, s55
    s_lshl_b32 s55, s50, 1
    s_lshr_b32 s56, 1092, s55
    s_and_b32 s56, s56, 3
    s_lshr_b32 s58, 88746, s55
    s_and_b32 s58, s58, 3
    s_mul_i32 s58, s58, s49
    s_add_u32 s53, s53, s58
    s_mul_i32 s58, s50, 18
    s_add_u32 s53, s53, s58
    s_mul_i32 s56, s56, 17
    s_sub_u32 s53, s53, s56
    s_lshl_b32 s82, s53, 10
    s_add_u32 s83, s82, 333824
    s_add_u32 s84, s82, 667648
    s_add_u32 s85, s82, 1001472
    s_mov_b32 s64, s10
    s_mov_b32 s65, s11
    s_lshr_b32 s53, s49, 1
    s_lshl_b32 s53, s53, 6
    s_and_b32 s55, s49, 1
    s_lshl_b32 s55, s55, 1
    s_add_u32 s53, s53, s55
    s_mul_i32 s55, s45, 576
    s_add_u32 s53, s53, s55
    s_mul_i32 s53, s53, 1152
    s_add_u32 s72, s53, s54
    s_mov_b32 s73, 1152
    s_mov_b32 s74, 9216
    s_mov_b32 s75, 4608
    v_mul_u32_u24 v242, 18432, v7
    v_lshl_add_u32 v242, v6, 3, v242
L_rp_4_done:
    s_cmp_lt_u32 s3, 5
    s_cbranch_scc1 K2_nb
    s_mov_b32 s45, s34
    s_mul_i32 s47, s35, 11
    s_add_u32 s47, s47, s3
    s_add_u32 s47, s47, 3
    s_cmp_lt_u32 s3, 5
    s_cselect_b32 s47, 400, s47
    s_mul_hi_u32 s46, s47, 26512144
    s_mul_i32 s49, s46, 162
    s_sub_u32 s47, s47, s49
    s_mul_hi_u32 s49, s47, 477218589
    s_mul_i32 s50, s49, 9
    s_sub_u32 s50, s47, s50
    s_mov_b32 s71, 0x00020000
    s_lshl_b32 s54, s50, 7
    v_mov_b32 v241, v3
    s_cmp_lt_u32 s46, 2
    s_cselect_b32 s70, 5308416, 0
    s_cselect_b32 s57, 0, 0x100000
    s_mul_i32 s53, s45, 1304
    s_mul_i32 s55, s46, 162
    s_add_u32 s53, s53, s55
    s_add_u32 s53, s53, 648
    s_add_u32 s53, s53, s57
    s_cmp_eq_u32 s46, 1
    s_cbranch_scc1 L_rp_5_w2
    s_mul_i32 s55, s49, 3
    s_add_u32 s53, s53, s55
    s_lshl_b32 s55, s50, 2
    s_add_u32 s55, s55, 0
    s_mul_i32 s56, s55, 86
    s_lshr_b32 s56, s56, 8
    s_lshr_b32 s58, s56, 2
    s_mul_i32 s58, s58, 1250
    s_mul_i32 s56, s56, 323
    s_sub_u32 s56, s56, s58
    s_add_u32 s55, s55, s56
    s_add_u32 s55, s55, s53
    s_lshl_b32 s86, s55, 10
    s_lshl_b32 s55, s50, 2
    s_add_u32 s55, s55, 1
    s_mul_i32 s56, s55, 86
    s_lshr_b32 s56, s56, 8
    s_lshr_b32 s58, s56, 2
    s_mul_i32 s58, s58, 1250
    s_mul_i32 s56, s56, 323
    s_sub_u32 s56, s56, s58
    s_add_u32 s55, s55, s56
    s_add_u32 s55, s55, s53
    s_lshl_b32 s87, s55, 10
    s_lshl_b32 s55, s50, 2
    s_add_u32 s55, s55, 2
    s_mul_i32 s56, s55, 86
    s_lshr_b32 s56, s56, 8
    s_lshr_b32 s58, s56, 2
    s_mul_i32 s58, s58, 1250
    s_mul_i32 s56, s56, 323
    s_sub_u32 s56, s56, s58
    s_add_u32 s55, s55, s56
    s_add_u32 s55, s55, s53
    s_lshl_b32 s88, s55, 10
    s_lshl_b32 s55, s50, 2
    s_add_u32 s55, s55, 3
    s_mul_i32 s56, s55, 86
    s_lshr_b32 s56, s56, 8
    s_lshr_b32 s58, s56, 2
    s_mul_i32 s58, s58, 1250
    s_mul_i32 s56, s56, 323
    s_sub_u32 s56, s56, s58
    s_add_u32 s55, s55, s56
    s_add_u32 s55, s55, s53
    s_lshl_b32 s89, s55, 10
    s_mov_b32 s68, s8
    s_mov_b32 s69, s9
    s_mul_i32 s53, s49, 294912
    s_mul_i32 s55, s45, 1152
    s_add_u32 s53, s53, s55
    s_add_u32 s76, s53, s54
    s_mov_b32 s77, 36864
    s_mov_b32 s78, 18432
    s_mov_b32 s79, 9216
    v_mul_u32_u24 v243, 73728, v7
    v_lshl_add_u32 v243, v6, 3, v243
    s_branch L_rp_5_done
L_rp_5_w2:
    s_sub_u32 s55, s50, s45
    s_sub_u32 s55, s55, 1
    s_and_b32 s55, s55, 7
    s_add_u32 s55, s55, 1
    s_cmp_eq_u32 s50, 8
    s_cselect_b32 s50, 0, s55
    s_lshl_b32 s55, s50, 1
    s_lshr_b32 s56, 1092, s55
    s_and_b32 s56, s56, 3
    s_lshr_b32 s58, 88746, s55
    s_and_b32 s58, s58, 3
    s_mul_i32 s58, s58, s49
    s_add_u32 s53, s53, s58
    s_mul_i32 s58, s50, 18
    s_add_u32 s53, s53, s58
    s_mul_i32 s56, s56, 17
    s_sub_u32 s53, s53, s56
    s_lshl_b32 s86, s53, 10
    s_add_u32 s87, s86, 333824
    s_add_u32 s88, s86, 667648
    s_add_u32 s89, s86, 1001472
    s_mov_b32 s68, s10
    s_mov_b32 s69, s11
    s_lshr_b32 s53, s49, 1
    s_lshl_b32 s53, s53, 6
    s_and_b32 s55, s49, 1
    s_lshl_b32 s55, s55, 1
    s_add_u32 s53, s53, s55
    s_mul_i32 s55, s45, 576
    s_add_u32 s53, s53, s55
    s_mul_i32 s53, s53, 1152
    s_add_u32 s76, s53, s54
    s_mov_b32 s77, 1152
    s_mov_b32 s78, 9216
    s_mov_b32 s79, 4608
    v_mul_u32_u24 v243, 18432, v7
    v_lshl_add_u32 v243, v6, 3, v243
L_rp_5_done:
K2_nb:
    s_barrier
    s_cmp_lg_u32 s3, 0
    s_cbranch_scc1 K2_q1
    s_mov_b32 m0, 159744
    s_add_u32 s45, s42, 8192
    buffer_load_dwordx4 v3, s[20:23], s45 offen sc1 lds
K2_q1:
    s_mov_b32 m0, s43
    s_nop 0
    buffer_load_dwordx4 v3, s[20:23], s42 offen sc1 lds
    s_mov_b32 m0, s44
    s_nop 0
    buffer_load_dwordx4 v3, s[16:19], s44 offen sc1 lds
    s_add_u32 s44, s44, 8192
    s_mov_b32 m0, s44
    s_nop 0
    buffer_load_dwordx4 v3, s[16:19], s44 offen sc1 lds
    s_add_u32 s44, s44, 8192
    s_mov_b32 m0, s44
    s_nop 0
    buffer_load_dwordx4 v3, s[16:19], s44 offen sc1 lds
    s_add_u32 s44, s44, 8192
    s_mov_b32 m0, s44
    s_nop 0
    buffer_load_dwordx4 v3, s[16:19], s44 offen sc1 lds
    s_add_u32 s44, s44, 8192
    v_mov_b32 v13, 0
    s_add_u32 s24, s14, 2531328
    s_addc_u32 s25, s15, 0
    s_mov_b32 s26, 2359296
    s_mov_b32 s27, 0x00020000
    v_lshrrev_b32 v4, 4, v1
    v_mul_u32_u24 v4, 4608, v4
    v_and_b32 v5, 15, v1
    v_lshl_add_u32 v4, v5, 3, v4
    v_add_u32 v4, 151552, v4
    s_mul_i32 s45, s3, 9
    v_lshlrev_b32 v5, 2, v2
    v_add_u32 v5, s45, v5
    v_add_u32 v30, 0, v5
    v_lshrrev_b32 v31, 1, v30
    v_lshl_add_u32 v31, v31, 7, v4
    v_and_b32 v30, 1, v30
    v_lshl_add_u32 v25, v30, 2, v31
    v_add_u32 v30, 1, v5
    v_lshrrev_b32 v31, 1, v30
    v_lshl_add_u32 v31, v31, 7, v4
    v_and_b32 v30, 1, v30
    v_lshl_add_u32 v26, v30, 2, v31
    v_add_u32 v30, 2, v5
    v_lshrrev_b32 v31, 1, v30
    v_lshl_add_u32 v31, v31, 7, v4
    v_and_b32 v30, 1, v30
    v_lshl_add_u32 v27, v30, 2, v31
    v_add_u32 v30, 3, v5
    v_lshrrev_b32 v31, 1, v30
    v_lshl_add_u32 v31, v31, 7, v4
    v_and_b32 v30, 1, v30
    v_lshl_add_u32 v28, v30, 2, v31
    s_add_u32 s45, s45, 8
    v_mov_b32 v30, s45
    v_lshrrev_b32 v31, 1, v30
    v_lshl_add_u32 v31, v31, 7, v4
    v_and_b32 v30, 1, v30
    v_lshl_add_u32 v29, v30, 2, v31
    v_mul_u32_u24 v23, 19, v2
    v_add_u32 v23, v23, v1
    v_lshlrev_b32 v23, 4, v23
    v_mov_b32 v24, 0x40000
    v_cmp_gt_u32 vcc, 19, v1
    s_nop 1
    v_cndmask_b32 v20, v24, v23, vcc
    v_mov_b32 v14, v3
    v_lshlrev_b32 v17, 2, v0
    v_add_u32 v15, 61568, v14
    v_add_u32 v16, 123136, v14
    v_add_u32 v18, 61568, v17
    v_add_u32 v19, 123136, v17
    v_add_u32 v21, 61568, v20
    v_add_u32 v22, 123136, v20
    v_mov_b32 v161, 1065369472
    v_mov_b32 v163, 1065369472
    v_mov_b32 v112, 0
    v_mov_b32 v113, 0
    v_mov_b32 v114, 0
    v_mov_b32 v115, 0
    v_mov_b32 v116, 0
    v_mov_b32 v117, 0
    v_mov_b32 v118, 0
    v_mov_b32 v119, 0
    v_mov_b32 v120, 0
    v_mov_b32 v121, 0
    v_mov_b32 v122, 0
    v_mov_b32 v123, 0
    v_mov_b32 v124, 0
    v_mov_b32 v125, 0
    v_mov_b32 v126, 0
    v_mov_b32 v127, 0
    s_waitcnt lgkmcnt(0)
    s_setprio 1
    s_waitcnt vmcnt(3)
    s_barrier
    ds_read_b32 v8, v25
    ds_read_b32 v9, v26
    ds_read_b32 v10, v27
    ds_read_b32 v11, v28
    ds_read_b32 v12, v29
    ds_read_b128 v[144:147], v14 offset:0
    ds_read_b128 v[148:151], v14 offset:1024
    ds_read_b32 v160, v17 offset:2048
    ds_read_b128 v[152:155], v14 offset:4736
    ds_read_b128 v[156:159], v14 offset:5760
    ds_read_b32 v162, v17 offset:6784
    ds_read_b128 v[164:167], v20 offset:2304
    ds_read_b128 v[168:171], v20 offset:2912
    ds_read_b128 v[172:175], v20 offset:3520
    ds_read_b128 v[176:179], v20 offset:4128
    s_waitcnt lgkmcnt(7)
    v_mfma_f32_32x32x16_bf16 v[32:47], v[144:147], v[8:11], 0
    v_mfma_f32_32x32x16_bf16 v[48:63], v[148:151], v[8:11], 0
    s_nop 9
    v_mfma_f32_32x32x4_2b_bf16 v[32:63], v[160:161], v[12:13], v[32:63]
    s_nop 15
    s_nop 3
    v_max_f32 v24, v32, v33
    v_max3_f32 v24, v34, v35, v24
    v_max3_f32 v24, v36, v37, v24
    v_max3_f32 v24, v38, v39, v24
    v_max3_f32 v24, v40, v41, v24
    v_max3_f32 v24, v42, v43, v24
    v_max3_f32 v24, v44, v45, v24
    v_max3_f32 v24, v46, v47, v24
    v_max3_f32 v24, v48, v49, v24
    v_max3_f32 v24, v50, v51, v24
    v_max3_f32 v24, v52, v53, v24
    v_max3_f32 v24, v54, v55, v24
    v_max3_f32 v24, v56, v57, v24
    v_max3_f32 v24, v58, v59, v24
    v_max3_f32 v24, v60, v61, v24
    v_max3_f32 v24, v62, v63, v24
    v_mov_b32 v25, v24
    s_nop 1
    v_permlane32_swap_b32 v24, v25
    s_nop 1
    v_max_f32 v24, v24, v25
    v_cvt_pk_bf16_f32 v25, -v24, -v24
    v_mov_b32 v128, 0
    v_lshlrev_b32 v26, 16, v25
    v_sub_f32 v26, -v24, v26
    v_cvt_pk_bf16_f32 v13, -v24, v26
    v_cvt_pk_bf16_f32 v129, -v24, v26
    s_nop 1
    v_mfma_f32_32x32x4_2b_bf16 v[32:63], v[160:161], v[128:129], v[32:63]
    s_nop 15
    s_nop 1
    s_waitcnt vmcnt(0)
    s_barrier
    s_cmp_lt_u32 s3, 4
    s_cbranch_scc1 L_pr_23
    s_setprio 2
L_pr_23:
    s_waitcnt lgkmcnt(0)
    v_mfma_f32_32x32x16_bf16 v[64:79], v[152:155], v[8:11], 0
    ds_read_b128 v[144:147], v14 offset:9472
    ds_read_b128 v[148:151], v14 offset:10496
    v_exp_f32 v32, v32
    v_exp_f32 v33, v33
    v_exp_f32 v34, v34
    v_exp_f32 v35, v35
    v_cvt_pk_bf16_f32 v96, v32, v33
    v_cvt_pk_bf16_f32 v97, v34, v35
    ds_read_b32 v160, v17 offset:11520
    ds_read_b128 v[180:183], v20 offset:7040
    v_exp_f32 v36, v36
    v_exp_f32 v37, v37
    v_exp_f32 v38, v38
    v_exp_f32 v39, v39
    v_cvt_pk_bf16_f32 v98, v36, v37
    v_cvt_pk_bf16_f32 v99, v38, v39
    v_mfma_f32_32x32x16_bf16 v[80:95], v[156:159], v[8:11], 0
    ds_read_b128 v[184:187], v20 offset:7648
    ds_read_b128 v[188:191], v20 offset:8256
    v_exp_f32 v40, v40
    v_exp_f32 v41, v41
    v_exp_f32 v42, v42
    v_exp_f32 v43, v43
    v_cvt_pk_bf16_f32 v100, v40, v41
    v_cvt_pk_bf16_f32 v101, v42, v43
    v_mfma_f32_32x32x16_bf16 v[112:127], v[164:167], v[96:99], v[112:127]
    ds_read_b128 v[192:195], v20 offset:8864
    v_exp_f32 v44, v44
    v_exp_f32 v45, v45
    v_exp_f32 v46, v46
    v_exp_f32 v47, v47
    v_cvt_pk_bf16_f32 v102, v44, v45
    v_cvt_pk_bf16_f32 v103, v46, v47
    v_mfma_f32_32x32x4_2b_bf16 v[64:95], v[162:163], v[12:13], v[64:95]
    s_mov_b32 m0, s44
    s_nop 0
    buffer_load_dwordx4 v3, s[16:19], s44 offen sc1 lds
    s_add_u32 s44, s44, 8192
    v_exp_f32 v48, v48
    v_exp_f32 v49, v49
    v_exp_f32 v50, v50
    v_exp_f32 v51, v51
    v_cvt_pk_bf16_f32 v104, v48, v49
    v_cvt_pk_bf16_f32 v105, v50, v51
    v_exp_f32 v52, v52
    v_exp_f32 v53, v53
    v_exp_f32 v54, v54
    v_mfma_f32_32x32x16_bf16 v[112:127], v[168:171], v[100:103], v[112:127]
    s_mov_b32 m0, s44
    s_nop 0
    buffer_load_dwordx4 v3, s[16:19], s44 offen sc1 lds
    s_add_u32 s44, s44, 8192
    v_exp_f32 v55, v55
    v_cvt_pk_bf16_f32 v106, v52, v53
    v_cvt_pk_bf16_f32 v107, v54, v55
    v_exp_f32 v56, v56
    v_exp_f32 v57, v57
    v_mfma_f32_32x32x16_bf16 v[112:127], v[172:175], v[104:107], v[112:127]
    s_mov_b32 m0, s44
    s_nop 0
    buffer_load_dwordx4 v3, s[16:19], s44 offen sc1 lds
    s_add_u32 s44, s44, 8192
    v_exp_f32 v58, v58
    v_exp_f32 v59, v59
    v_cvt_pk_bf16_f32 v108, v56, v57
    v_cvt_pk_bf16_f32 v109, v58, v59
    v_exp_f32 v60, v60
    v_exp_f32 v61, v61
    v_exp_f32 v62, v62
    v_exp_f32 v63, v63
    v_cvt_pk_bf16_f32 v110, v60, v61
    v_cvt_pk_bf16_f32 v111, v62, v63
    s_waitcnt lgkmcnt(0)
    v_mfma_f32_32x32x16_bf16 v[32:47], v[144:147], v[8:11], 0
    ds_read_b128 v[152:155], v14 offset:14208
    ds_read_b128 v[156:159], v14 offset:15232
    v_exp_f32 v64, v64
    v_exp_f32 v65, v65
    v_exp_f32 v66, v66
    v_exp_f32 v67, v67
    v_cvt_pk_bf16_f32 v96, v64, v65
    v_cvt_pk_bf16_f32 v97, v66, v67
    v_mfma_f32_32x32x16_bf16 v[112:127], v[176:179], v[108:111], v[112:127]
    ds_read_b32 v162, v17 offset:16256
    ds_read_b128 v[164:167], v20 offset:11776
    v_exp_f32 v68, v68
    v_exp_f32 v69, v69
    v_exp_f32 v70, v70
    v_exp_f32 v71, v71
    v_cvt_pk_bf16_f32 v98, v68, v69
    v_cvt_pk_bf16_f32 v99, v70, v71
    v_mfma_f32_32x32x16_bf16 v[48:63], v[148:151], v[8:11], 0
    ds_read_b128 v[168:171], v20 offset:12384
    ds_read_b128 v[172:175], v20 offset:12992
    v_exp_f32 v72, v72
    v_exp_f32 v73, v73
    v_exp_f32 v74, v74
    v_exp_f32 v75, v75
    v_cvt_pk_bf16_f32 v100, v72, v73
    v_cvt_pk_bf16_f32 v101, v74, v75
    v_mfma_f32_32x32x16_bf16 v[112:127], v[180:183], v[96:99], v[112:127]
    ds_read_b128 v[176:179], v20 offset:13600
    v_exp_f32 v76, v76
    v_exp_f32 v77, v77
    v_exp_f32 v78, v78
    v_exp_f32 v79, v79
    v_cvt_pk_bf16_f32 v102, v76, v77
    v_cvt_pk_bf16_f32 v103, v78, v79
    v_mfma_f32_32x32x4_2b_bf16 v[32:63], v[160:161], v[12:13], v[32:63]
    s_mov_b32 m0, s44
    s_nop 0
    buffer_load_dwordx4 v3, s[16:19], s44 offen sc1 lds
    s_add_u32 s44, s44, 8192
    v_exp_f32 v80, v80
    v_exp_f32 v81, v81
    v_exp_f32 v82, v82
    v_exp_f32 v83, v83
    v_cvt_pk_bf16_f32 v104, v80, v81
    v_cvt_pk_bf16_f32 v105, v82, v83
    v_exp_f32 v84, v84
    v_exp_f32 v85, v85
    v_exp_f32 v86, v86
    v_mfma_f32_32x32x16_bf16 v[112:127], v[184:187], v[100:103], v[112:127]
    s_mov_b32 m0, s44
    s_nop 0
    buffer_load_dwordx4 v3, s[16:19], s44 offen sc1 lds
    s_add_u32 s44, s44, 8192
    v_exp_f32 v87, v87
    v_cvt_pk_bf16_f32 v106, v84, v85
    v_cvt_pk_bf16_f32 v107, v86, v87
    v_exp_f32 v88, v88
    v_exp_f32 v89, v89
    v_mfma_f32_32x32x16_bf16 v[112:127], v[188:191], v[104:107], v[112:127]
    s_mov_b32 m0, s44
    s_nop 0
    buffer_load_dwordx4 v3, s[16:19], s44 offen sc1 lds
    s_add_u32 s44, s44, 8192
    v_exp_f32 v90, v90
    v_exp_f32 v91, v91
    v_cvt_pk_bf16_f32 v108, v88, v89
    v_cvt_pk_bf16_f32 v109, v90, v91
    v_exp_f32 v92, v92
    v_exp_f32 v93, v93
    v_exp_f32 v94, v94
    v_exp_f32 v95, v95
    v_cvt_pk_bf16_f32 v110, v92, v93
    v_cvt_pk_bf16_f32 v111, v94, v95
    s_waitcnt lgkmcnt(0)
    v_mfma_f32_32x32x16_bf16 v[64:79], v[152:155], v[8:11], 0
    ds_read_b128 v[144:147], v14 offset:18944
    ds_read_b128 v[148:151], v14 offset:19968
    v_exp_f32 v32, v32
    v_exp_f32 v33, v33
    v_exp_f32 v34, v34
    v_exp_f32 v35, v35
    v_cvt_pk_bf16_f32 v96, v32, v33
    v_cvt_pk_bf16_f32 v97, v34, v35
    v_mfma_f32_32x32x16_bf16 v[112:127], v[192:195], v[108:111], v[112:127]
    ds_read_b32 v160, v17 offset:20992
    ds_read_b128 v[180:183], v20 offset:16512
    v_exp_f32 v36, v36
    v_exp_f32 v37, v37
    v_exp_f32 v38, v38
    v_exp_f32 v39, v39
    v_cvt_pk_bf16_f32 v98, v36, v37
    v_cvt_pk_bf16_f32 v99, v38, v39
    v_mfma_f32_32x32x16_bf16 v[80:95], v[156:159], v[8:11], 0
    ds_read_b128 v[184:187], v20 offset:17120
    ds_read_b128 v[188:191], v20 offset:17728
    v_exp_f32 v40, v40
    v_exp_f32 v41, v41
    v_exp_f32 v42, v42
    v_exp_f32 v43, v43
    v_cvt_pk_bf16_f32 v100, v40, v41
    v_cvt_pk_bf16_f32 v101, v42, v43
    v_mfma_f32_32x32x16_bf16 v[112:127], v[164:167], v[96:99], v[112:127]
    ds_read_b128 v[192:195], v20 offset:18336
    v_exp_f32 v44, v44
    v_exp_f32 v45, v45
    v_exp_f32 v46, v46
    v_exp_f32 v47, v47
    v_cvt_pk_bf16_f32 v102, v44, v45
    v_cvt_pk_bf16_f32 v103, v46, v47
    v_mfma_f32_32x32x4_2b_bf16 v[64:95], v[162:163], v[12:13], v[64:95]
    s_mov_b32 m0, s44
    s_nop 0
    buffer_load_dwordx4 v3, s[16:19], s44 offen sc1 lds
    s_add_u32 s44, s44, 8192
    v_exp_f32 v48, v48
    v_exp_f32 v49, v49
    v_exp_f32 v50, v50
    v_exp_f32 v51, v51
    v_cvt_pk_bf16_f32 v104, v48, v49
    v_cvt_pk_bf16_f32 v105, v50, v51
    v_exp_f32 v52, v52
    v_exp_f32 v53, v53
    v_exp_f32 v54, v54
    v_mfma_f32_32x32x16_bf16 v[112:127], v[168:171], v[100:103], v[112:127]
    s_mov_b32 m0, s44
    s_nop 0
    buffer_load_dwordx4 v3, s[16:19], s44 offen sc1 lds
    s_add_u32 s44, s44, 8192
    v_exp_f32 v55, v55
    v_cvt_pk_bf16_f32 v106, v52, v53
    v_cvt_pk_bf16_f32 v107, v54, v55
    v_exp_f32 v56, v56
    v_exp_f32 v57, v57
    v_mfma_f32_32x32x16_bf16 v[112:127], v[172:175], v[104:107], v[112:127]
    s_mov_b32 m0, s44
    s_nop 0
    buffer_load_dwordx4 v3, s[16:19], s44 offen sc1 lds
    s_add_u32 s44, s44, 8192
    v_exp_f32 v58, v58
    v_exp_f32 v59, v59
    v_cvt_pk_bf16_f32 v108, v56, v57
    v_cvt_pk_bf16_f32 v109, v58, v59
    v_exp_f32 v60, v60
    v_exp_f32 v61, v61
    v_exp_f32 v62, v62
    v_exp_f32 v63, v63
    v_cvt_pk_bf16_f32 v110, v60, v61
    v_cvt_pk_bf16_f32 v111, v62, v63
    s_cmp_lt_u32 s3, 4
    s_cbranch_scc1 L_pr_24
    s_setprio 0
L_pr_24:
    s_waitcnt lgkmcnt(0)
    v_mfma_f32_32x32x16_bf16 v[32:47], v[144:147], v[8:11], 0
    ds_read_b128 v[152:155], v14 offset:23680
    ds_read_b128 v[156:159], v14 offset:24704
    v_exp_f32 v64, v64
    v_exp_f32 v65, v65
    v_exp_f32 v66, v66
    v_exp_f32 v67, v67
    v_cvt_pk_bf16_f32 v96, v64, v65
    v_cvt_pk_bf16_f32 v97, v66, v67
    v_mfma_f32_32x32x16_bf16 v[112:127], v[176:179], v[108:111], v[112:127]
    ds_read_b32 v162, v17 offset:25728
    ds_read_b128 v[164:167], v20 offset:21248
    v_exp_f32 v68, v68
    v_exp_f32 v69, v69
    v_exp_f32 v70, v70
    v_exp_f32 v71, v71
    v_cvt_pk_bf16_f32 v98, v68, v69
    v_cvt_pk_bf16_f32 v99, v70, v71
    v_mfma_f32_32x32x16_bf16 v[48:63], v[148:151], v[8:11], 0
    ds_read_b128 v[168:171], v20 offset:21856
    ds_read_b128 v[172:175], v20 offset:22464
    v_exp_f32 v72, v72
    v_exp_f32 v73, v73
    v_exp_f32 v74, v74
    v_exp_f32 v75, v75
    v_cvt_pk_bf16_f32 v100, v72, v73
    v_cvt_pk_bf16_f32 v101, v74, v75
    v_mfma_f32_32x32x16_bf16 v[112:127], v[180:183], v[96:99], v[112:127]
    ds_read_b128 v[176:179], v20 offset:23072
    v_exp_f32 v76, v76
    v_exp_f32 v77, v77
    v_exp_f32 v78, v78
    v_exp_f32 v79, v79
    v_cvt_pk_bf16_f32 v102, v76, v77
    v_cvt_pk_bf16_f32 v103, v78, v79
    v_mfma_f32_32x32x4_2b_bf16 v[32:63], v[160:161], v[12:13], v[32:63]
    s_mov_b32 m0, s44
    s_nop 0
    buffer_load_dwordx4 v3, s[16:19], s44 offen sc1 lds
    s_add_u32 s44, s44, 8192
    v_exp_f32 v80, v80
    v_exp_f32 v81, v81
    v_exp_f32 v82, v82
    v_exp_f32 v83, v83
    v_cvt_pk_bf16_f32 v104, v80, v81
    v_cvt_pk_bf16_f32 v105, v82, v83
    v_exp_f32 v84, v84
    v_exp_f32 v85, v85
    v_exp_f32 v86, v86
    v_mfma_f32_32x32x16_bf16 v[112:127], v[184:187], v[100:103], v[112:127]
    s_mov_b32 m0, s44
    s_nop 0
    buffer_load_dwordx4 v3, s[16:19], s44 offen sc1 lds
    s_add_u32 s44, s44, 8192
    v_exp_f32 v87, v87
    v_cvt_pk_bf16_f32 v106, v84, v85
    v_cvt_pk_bf16_f32 v107, v86, v87
    v_exp_f32 v88, v88
    v_exp_f32 v89, v89
    v_mfma_f32_32x32x16_bf16 v[112:127], v[188:191], v[104:107], v[112:127]
    s_mov_b32 m0, s44
    s_nop 0
    buffer_load_dwordx4 v3, s[16:19], s44 offen sc1 lds
    s_add_u32 s44, s44, 8192
    v_exp_f32 v90, v90
    v_exp_f32 v91, v91
    v_cvt_pk_bf16_f32 v108, v88, v89
    v_cvt_pk_bf16_f32 v109, v90, v91
    v_exp_f32 v92, v92
    v_exp_f32 v93, v93
    v_exp_f32 v94, v94
    v_exp_f32 v95, v95
    v_cvt_pk_bf16_f32 v110, v92, v93
    v_cvt_pk_bf16_f32 v111, v94, v95
    s_waitcnt vmcnt(3)
    s_barrier
    s_cmp_lt_u32 s3, 4
    s_cbranch_scc1 L_pr_25
    s_setprio 2
L_pr_25:
    s_waitcnt lgkmcnt(0)
    v_mfma_f32_32x32x16_bf16 v[64:79], v[152:155], v[8:11], 0
    ds_read_b128 v[144:147], v14 offset:28416
    ds_read_b128 v[148:151], v14 offset:29440
    v_exp_f32 v32, v32
    v_exp_f32 v33, v33
    v_exp_f32 v34, v34
    v_exp_f32 v35, v35
    v_cvt_pk_bf16_f32 v96, v32, v33
    v_cvt_pk_bf16_f32 v97, v34, v35
    v_mfma_f32_32x32x16_bf16 v[112:127], v[192:195], v[108:111], v[112:127]
    ds_read_b32 v160, v17 offset:30464
    ds_read_b128 v[180:183], v20 offset:25984
    v_exp_f32 v36, v36
    v_exp_f32 v37, v37
    v_exp_f32 v38, v38
    v_exp_f32 v39, v39
    v_cvt_pk_bf16_f32 v98, v36, v37
    v_cvt_pk_bf16_f32 v99, v38, v39
    v_mfma_f32_32x32x16_bf16 v[80:95], v[156:159], v[8:11], 0
    ds_read_b128 v[184:187], v20 offset:26592
    ds_read_b128 v[188:191], v20 offset:27200
    v_exp_f32 v40, v40
    v_exp_f32 v41, v41
    v_exp_f32 v42, v42
    v_exp_f32 v43, v43
    v_cvt_pk_bf16_f32 v100, v40, v41
    v_cvt_pk_bf16_f32 v101, v42, v43
    v_mfma_f32_32x32x16_bf16 v[112:127], v[164:167], v[96:99], v[112:127]
    ds_read_b128 v[192:195], v20 offset:27808
    v_exp_f32 v44, v44
    v_exp_f32 v45, v45
    v_exp_f32 v46, v46
    v_exp_f32 v47, v47
    v_cvt_pk_bf16_f32 v102, v44, v45
    v_cvt_pk_bf16_f32 v103, v46, v47
    v_mfma_f32_32x32x4_2b_bf16 v[64:95], v[162:163], v[12:13], v[64:95]
    s_mov_b32 m0, s44
    s_nop 0
    buffer_load_dwordx4 v3, s[16:19], s44 offen sc1 lds
    s_add_u32 s44, s44, 8192
    v_exp_f32 v48, v48
    v_exp_f32 v49, v49
    v_exp_f32 v50, v50
    v_exp_f32 v51, v51
    v_cvt_pk_bf16_f32 v104, v48, v49
    v_cvt_pk_bf16_f32 v105, v50, v51
    v_exp_f32 v52, v52
    v_exp_f32 v53, v53
    v_exp_f32 v54, v54
    v_mfma_f32_32x32x16_bf16 v[112:127], v[168:171], v[100:103], v[112:127]
    s_mov_b32 m0, s44
    s_nop 0
    buffer_load_dwordx4 v3, s[16:19], s44 offen sc1 lds
    s_add_u32 s44, s44, 8192
    v_exp_f32 v55, v55
    v_cvt_pk_bf16_f32 v106, v52, v53
    v_cvt_pk_bf16_f32 v107, v54, v55
    v_exp_f32 v56, v56
    v_exp_f32 v57, v57
    v_mfma_f32_32x32x16_bf16 v[112:127], v[172:175], v[104:107], v[112:127]
    s_cmp_ge_u32 s3, 4
    s_cbranch_scc1 L_dm_6
    s_mov_b32 m0, s44
    s_nop 0
    buffer_load_dwordx4 v3, s[16:19], s44 offen sc1 lds
    s_add_u32 s44, s44, 8192
L_dm_6:
    v_exp_f32 v58, v58
    v_exp_f32 v59, v59
    v_cvt_pk_bf16_f32 v108, v56, v57
    v_cvt_pk_bf16_f32 v109, v58, v59
    v_exp_f32 v60, v60
    v_exp_f32 v61, v61
    v_exp_f32 v62, v62
    v_exp_f32 v63, v63
    v_cvt_pk_bf16_f32 v110, v60, v61
    v_cvt_pk_bf16_f32 v111, v62, v63
    s_cmp_lg_u32 s3, 1
    s_cbranch_scc1 K2_s1
    s_add_u32 s60, s14, 9777152
    s_addc_u32 s61, s15, 0
    s_mov_b32 s62, 11542528
    s_mov_b32 s63, 0x00020000
    v_and_b32 v6, 15, v0
    v_lshrrev_b32 v7, 4, v0
    s_mov_b32 s80, 0x05040100
    s_mov_b32 s81, 0x07060302
    s_and_b32 s46, s2, 7
    s_lshr_b32 s47, s2, 3
    s_and_b32 s34, s46, 7
    s_lshl_b32 s34, s34, 0
    s_and_b32 s48, s47, 0
    s_add_u32 s34, s34, s48
    s_lshr_b32 s35, s46, 3
    s_lshl_b32 s35, s35, 5
    s_lshr_b32 s48, s47, 0
    s_add_u32 s35, s35, s48
    s_mov_b32 s45, s34
    s_mul_i32 s47, s35, 11
    s_add_u32 s47, s47, s3
    s_mul_hi_u32 s46, s47, 26512144
    s_mul_i32 s49, s46, 162
    s_sub_u32 s47, s47, s49
    s_mul_hi_u32 s49, s47, 477218589
    s_mul_i32 s50, s49, 9
    s_sub_u32 s50, s47, s50
    s_mov_b32 s67, 0x00020000
    s_lshl_b32 s54, s50, 7
    v_mov_b32 v240, v3
    s_cmp_lt_u32 s46, 2
    s_cselect_b32 s66, 5308416, 0
    s_cselect_b32 s57, 0, 0x100000
    s_mul_i32 s53, s45, 1304
    s_mul_i32 s55, s46, 162
    s_add_u32 s53, s53, s55
    s_add_u32 s53, s53, 648
    s_add_u32 s53, s53, s57
    s_cmp_eq_u32 s46, 1
    s_cbranch_scc1 L_rp_15_w2
    s_mul_i32 s55, s49, 3
    s_add_u32 s53, s53, s55
    s_lshl_b32 s55, s50, 2
    s_add_u32 s55, s55, 0
    s_mul_i32 s56, s55, 86
    s_lshr_b32 s56, s56, 8
    s_lshr_b32 s58, s56, 2
    s_mul_i32 s58, s58, 1250
    s_mul_i32 s56, s56, 323
    s_sub_u32 s56, s56, s58
    s_add_u32 s55, s55, s56
    s_add_u32 s55, s55, s53
    s_lshl_b32 s82, s55, 10
    s_lshl_b32 s55, s50, 2
    s_add_u32 s55, s55, 1
    s_mul_i32 s56, s55, 86
    s_lshr_b32 s56, s56, 8
    s_lshr_b32 s58, s56, 2
    s_mul_i32 s58, s58, 1250
    s_mul_i32 s56, s56, 323
    s_sub_u32 s56, s56, s58
    s_add_u32 s55, s55, s56
    s_add_u32 s55, s55, s53
    s_lshl_b32 s83, s55, 10
    s_lshl_b32 s55, s50, 2
    s_add_u32 s55, s55, 2
    s_mul_i32 s56, s55, 86
    s_lshr_b32 s56, s56, 8
    s_lshr_b32 s58, s56, 2
    s_mul_i32 s58, s58, 1250
    s_mul_i32 s56, s56, 323
    s_sub_u32 s56, s56, s58
    s_add_u32 s55, s55, s56
    s_add_u32 s55, s55, s53
    s_lshl_b32 s84, s55, 10
    s_lshl_b32 s55, s50, 2
    s_add_u32 s55, s55, 3
    s_mul_i32 s56, s55, 86
    s_lshr_b32 s56, s56, 8
    s_lshr_b32 s58, s56, 2
    s_mul_i32 s58, s58, 1250
    s_mul_i32 s56, s56, 323
    s_sub_u32 s56, s56, s58
    s_add_u32 s55, s55, s56
    s_add_u32 s55, s55, s53
    s_lshl_b32 s85, s55, 10
    s_mov_b32 s64, s8
    s_mov_b32 s65, s9
    s_mul_i32 s53, s49, 294912
    s_mul_i32 s55, s45, 1152
    s_add_u32 s53, s53, s55
    s_add_u32 s72, s53, s54
    s_mov_b32 s73, 36864
    s_mov_b32 s74, 18432
    s_mov_b32 s75, 9216
    v_mul_u32_u24 v242, 73728, v7
    v_lshl_add_u32 v242, v6, 3, v242
    s_branch L_rp_15_done
L_rp_15_w2:
    s_sub_u32 s55, s50, s45
    s_sub_u32 s55, s55, 1
    s_and_b32 s55, s55, 7
    s_add_u32 s55, s55, 1
    s_cmp_eq_u32 s50, 8
    s_cselect_b32 s50, 0, s55
    s_lshl_b32 s55, s50, 1
    s_lshr_b32 s56, 1092, s55
    s_and_b32 s56, s56, 3
    s_lshr_b32 s58, 88746, s55
    s_and_b32 s58, s58, 3
    s_mul_i32 s58, s58, s49
    s_add_u32 s53, s53, s58
    s_mul_i32 s58, s50, 18
    s_add_u32 s53, s53, s58
    s_mul_i32 s56, s56, 17
    s_sub_u32 s53, s53, s56
    s_lshl_b32 s82, s53, 10
    s_add_u32 s83, s82, 333824
    s_add_u32 s84, s82, 667648
    s_add_u32 s85, s82, 1001472
    s_mov_b32 s64, s10
    s_mov_b32 s65, s11
    s_lshr_b32 s53, s49, 1
    s_lshl_b32 s53, s53, 6
    s_and_b32 s55, s49, 1
    s_lshl_b32 s55, s55, 1
    s_add_u32 s53, s53, s55
    s_mul_i32 s55, s45, 576
    s_add_u32 s53, s53, s55
    s_mul_i32 s53, s53, 1152
    s_add_u32 s72, s53, s54
    s_mov_b32 s73, 1152
    s_mov_b32 s74, 9216
    s_mov_b32 s75, 4608
    v_mul_u32_u24 v242, 18432, v7
    v_lshl_add_u32 v242, v6, 3, v242
L_rp_15_done:
K2_s1:
    s_waitcnt lgkmcnt(0)
    v_mfma_f32_32x32x16_bf16 v[32:47], v[144:147], v[8:11], 0
    ds_read_b128 v[152:155], v14 offset:33152
    ds_read_b128 v[156:159], v14 offset:34176
    v_exp_f32 v64, v64
    v_exp_f32 v65, v65
    v_exp_f32 v66, v66
    v_exp_f32 v67, v67
    v_cvt_pk_bf16_f32 v96, v64, v65
    v_cvt_pk_bf16_f32 v97, v66, v67
    v_mfma_f32_32x32x16_bf16 v[112:127], v[176:179], v[108:111], v[112:127]
    ds_read_b32 v162, v17 offset:35200
    ds_read_b128 v[164:167], v20 offset:30720
    v_exp_f32 v68, v68
    v_exp_f32 v69, v69
    v_exp_f32 v70, v70
    v_exp_f32 v71, v71
    v_cvt_pk_bf16_f32 v98, v68, v69
    v_cvt_pk_bf16_f32 v99, v70, v71
    v_mfma_f32_32x32x16_bf16 v[48:63], v[148:151], v[8:11], 0
    ds_read_b128 v[168:171], v20 offset:31328
    ds_read_b128 v[172:175], v20 offset:31936
    v_exp_f32 v72, v72
    v_exp_f32 v73, v73
    v_exp_f32 v74, v74
    v_exp_f32 v75, v75
    v_cvt_pk_bf16_f32 v100, v72, v73
    v_cvt_pk_bf16_f32 v101, v74, v75
    v_mfma_f32_32x32x16_bf16 v[112:127], v[180:183], v[96:99], v[112:127]
    ds_read_b128 v[176:179], v20 offset:32544
    v_exp_f32 v76, v76
    v_exp_f32 v77, v77
    v_exp_f32 v78, v78
    v_exp_f32 v79, v79
    v_cvt_pk_bf16_f32 v102, v76, v77
    v_cvt_pk_bf16_f32 v103, v78, v79
    v_mfma_f32_32x32x4_2b_bf16 v[32:63], v[160:161], v[12:13], v[32:63]
    v_exp_f32 v80, v80
    v_exp_f32 v81, v81
    v_exp_f32 v82, v82
    v_exp_f32 v83, v83
    v_cvt_pk_bf16_f32 v104, v80, v81
    v_cvt_pk_bf16_f32 v105, v82, v83
    v_exp_f32 v84, v84
    v_exp_f32 v85, v85
    v_exp_f32 v86, v86
    v_mfma_f32_32x32x16_bf16 v[112:127], v[184:187], v[100:103], v[112:127]
    v_exp_f32 v87, v87
    v_cvt_pk_bf16_f32 v106, v84, v85
    v_cvt_pk_bf16_f32 v107, v86, v87
    v_exp_f32 v88, v88
    v_exp_f32 v89, v89
    v_mfma_f32_32x32x16_bf16 v[112:127], v[188:191], v[104:107], v[112:127]
    v_exp_f32 v90, v90
    v_exp_f32 v91, v91
    v_cvt_pk_bf16_f32 v108, v88, v89
    v_cvt_pk_bf16_f32 v109, v90, v91
    v_exp_f32 v92, v92
    v_exp_f32 v93, v93
    v_exp_f32 v94, v94
    v_exp_f32 v95, v95
    v_cvt_pk_bf16_f32 v110, v92, v93
    v_cvt_pk_bf16_f32 v111, v94, v95
    s_waitcnt lgkmcnt(0)
    v_mfma_f32_32x32x16_bf16 v[64:79], v[152:155], v[8:11], 0
    ds_read_b128 v[144:147], v14 offset:37888
    ds_read_b128 v[148:151], v14 offset:38912
    v_exp_f32 v32, v32
    v_exp_f32 v33, v33
    v_exp_f32 v34, v34
    v_exp_f32 v35, v35
    v_cvt_pk_bf16_f32 v96, v32, v33
    v_cvt_pk_bf16_f32 v97, v34, v35
    v_mfma_f32_32x32x16_bf16 v[112:127], v[192:195], v[108:111], v[112:127]
    ds_read_b32 v160, v17 offset:39936
    ds_read_b128 v[180:183], v20 offset:35456
    v_exp_f32 v36, v36
    v_exp_f32 v37, v37
    v_exp_f32 v38, v38
    v_exp_f32 v39, v39
    v_cvt_pk_bf16_f32 v98, v36, v37
    v_cvt_pk_bf16_f32 v99, v38, v39
    v_mfma_f32_32x32x16_bf16 v[80:95], v[156:159], v[8:11], 0
    ds_read_b128 v[184:187], v20 offset:36064
    ds_read_b128 v[188:191], v20 offset:36672
    v_exp_f32 v40, v40
    v_exp_f32 v41, v41
    v_exp_f32 v42, v42
    v_exp_f32 v43, v43
    v_cvt_pk_bf16_f32 v100, v40, v41
    v_cvt_pk_bf16_f32 v101, v42, v43
    v_mfma_f32_32x32x16_bf16 v[112:127], v[164:167], v[96:99], v[112:127]
    ds_read_b128 v[192:195], v20 offset:37280
    v_exp_f32 v44, v44
    v_exp_f32 v45, v45
    v_exp_f32 v46, v46
    v_exp_f32 v47, v47
    v_cvt_pk_bf16_f32 v102, v44, v45
    v_cvt_pk_bf16_f32 v103, v46, v47
    v_mfma_f32_32x32x4_2b_bf16 v[64:95], v[162:163], v[12:13], v[64:95]
    v_exp_f32 v48, v48
    v_exp_f32 v49, v49
    v_exp_f32 v50, v50
    v_exp_f32 v51, v51
    v_cvt_pk_bf16_f32 v104, v48, v49
    v_cvt_pk_bf16_f32 v105, v50, v51
    v_exp_f32 v52, v52
    v_exp_f32 v53, v53
    v_exp_f32 v54, v54
    v_mfma_f32_32x32x16_bf16 v[112:127], v[168:171], v[100:103], v[112:127]
    v_exp_f32 v55, v55
    v_cvt_pk_bf16_f32 v106, v52, v53
    v_cvt_pk_bf16_f32 v107, v54, v55
    v_exp_f32 v56, v56
    v_exp_f32 v57, v57
    v_mfma_f32_32x32x16_bf16 v[112:127], v[172:175], v[104:107], v[112:127]
    v_exp_f32 v58, v58
    v_exp_f32 v59, v59
    v_cvt_pk_bf16_f32 v108, v56, v57
    v_cvt_pk_bf16_f32 v109, v58, v59
    v_exp_f32 v60, v60
    v_exp_f32 v61, v61
    v_exp_f32 v62, v62
    v_exp_f32 v63, v63
    v_cvt_pk_bf16_f32 v110, v60, v61
    v_cvt_pk_bf16_f32 v111, v62, v63
    s_cmp_lt_u32 s3, 4
    s_cbranch_scc1 L_pr_26
    s_setprio 0
L_pr_26:
    s_waitcnt lgkmcnt(0)
    v_mfma_f32_32x32x16_bf16 v[32:47], v[144:147], v[8:11], 0
    ds_read_b128 v[152:155], v14 offset:42624
    ds_read_b128 v[156:159], v14 offset:43648
    v_exp_f32 v64, v64
    v_exp_f32 v65, v65
    v_exp_f32 v66, v66
    v_exp_f32 v67, v67
    v_cvt_pk_bf16_f32 v96, v64, v65
    v_cvt_pk_bf16_f32 v97, v66, v67
    v_mfma_f32_32x32x16_bf16 v[112:127], v[176:179], v[108:111], v[112:127]
    ds_read_b32 v162, v17 offset:44672
    ds_read_b128 v[164:167], v20 offset:40192
    v_exp_f32 v68, v68
    v_exp_f32 v69, v69
    v_exp_f32 v70, v70
    v_exp_f32 v71, v71
    v_cvt_pk_bf16_f32 v98, v68, v69
    v_cvt_pk_bf16_f32 v99, v70, v71
    v_mfma_f32_32x32x16_bf16 v[48:63], v[148:151], v[8:11], 0
    ds_read_b128 v[168:171], v20 offset:40800
    ds_read_b128 v[172:175], v20 offset:41408
    v_exp_f32 v72, v72
    v_exp_f32 v73, v73
    v_exp_f32 v74, v74
    v_exp_f32 v75, v75
    v_cvt_pk_bf16_f32 v100, v72, v73
    v_cvt_pk_bf16_f32 v101, v74, v75
    v_mfma_f32_32x32x16_bf16 v[112:127], v[180:183], v[96:99], v[112:127]
    ds_read_b128 v[176:179], v20 offset:42016
    v_exp_f32 v76, v76
    v_exp_f32 v77, v77
    v_exp_f32 v78, v78
    v_exp_f32 v79, v79
    v_cvt_pk_bf16_f32 v102, v76, v77
    v_cvt_pk_bf16_f32 v103, v78, v79
    v_mfma_f32_32x32x4_2b_bf16 v[32:63], v[160:161], v[12:13], v[32:63]
    s_mov_b32 s45, 520192
    v_lshlrev_b32 v206, 7, v1
    buffer_load_dword v205, v206, s[36:39], s45 offen sc1
    v_exp_f32 v80, v80
    v_exp_f32 v81, v81
    v_exp_f32 v82, v82
    v_exp_f32 v83, v83
    v_cvt_pk_bf16_f32 v104, v80, v81
    v_cvt_pk_bf16_f32 v105, v82, v83
    v_exp_f32 v84, v84
    v_exp_f32 v85, v85
    v_exp_f32 v86, v86
    v_mfma_f32_32x32x16_bf16 v[112:127], v[184:187], v[100:103], v[112:127]
    v_exp_f32 v87, v87
    v_cvt_pk_bf16_f32 v106, v84, v85
    v_cvt_pk_bf16_f32 v107, v86, v87
    v_exp_f32 v88, v88
    v_exp_f32 v89, v89
    v_mfma_f32_32x32x16_bf16 v[112:127], v[188:191], v[104:107], v[112:127]
    v_exp_f32 v90, v90
    v_exp_f32 v91, v91
    v_cvt_pk_bf16_f32 v108, v88, v89
    v_cvt_pk_bf16_f32 v109, v90, v91
    v_exp_f32 v92, v92
    v_exp_f32 v93, v93
    v_exp_f32 v94, v94
    v_exp_f32 v95, v95
    v_cvt_pk_bf16_f32 v110, v92, v93
    v_cvt_pk_bf16_f32 v111, v94, v95
    v_mov_b32 v196, 0
    v_mov_b32 v197, 0
    v_mov_b32 v198, 0
    v_mov_b32 v199, 0
    v_mov_b32 v200, 151552
    ds_write_b128 v200, v[196:199]
    ds_write_b128 v200, v[196:199] offset:16
    ds_write_b128 v200, v[196:199] offset:32
    ds_write_b128 v200, v[196:199] offset:48
    s_waitcnt vmcnt(0) lgkmcnt(0)
    s_barrier
    s_mov_b32 s91, 0x10000
    s_mov_b32 exec_lo, 4294967295
    s_mov_b32 exec_hi, 0
    s_branch L_poll_9001_1
L_poll_9001:
    buffer_load_dword v205, v206, s[36:39], s45 offen sc1
    s_waitcnt vmcnt(0)
L_poll_9001_1:
    v_cmp_eq_u32 vcc, s101, v205
    s_nop 1
    s_cmp_eq_u64 vcc, exec
    s_cbranch_scc1 L_poll_9001_ok
    s_sleep 2
    s_sub_u32 s91, s91, 1
    s_cbranch_scc0 L_poll_9001
L_poll_9001_ok:
    s_mov_b64 exec, -1
    s_cmp_lt_u32 s3, 4
    s_cbranch_scc1 L_pr_27
    s_setprio 2
L_pr_27:
    s_waitcnt lgkmcnt(0)
    v_mfma_f32_32x32x16_bf16 v[64:79], v[152:155], v[8:11], 0
    ds_read_b128 v[144:147], v14 offset:47360
    ds_read_b128 v[148:151], v14 offset:48384
    v_exp_f32 v32, v32
    v_exp_f32 v33, v33
    v_exp_f32 v34, v34
    v_exp_f32 v35, v35
    v_cvt_pk_bf16_f32 v96, v32, v33
    v_cvt_pk_bf16_f32 v97, v34, v35
    v_mfma_f32_32x32x16_bf16 v[112:127], v[192:195], v[108:111], v[112:127]
    ds_read_b32 v160, v17 offset:49408
    ds_read_b128 v[180:183], v20 offset:44928
    v_exp_f32 v36, v36
    v_exp_f32 v37, v37
    v_exp_f32 v38, v38
    v_exp_f32 v39, v39
    v_cvt_pk_bf16_f32 v98, v36, v37
    v_cvt_pk_bf16_f32 v99, v38, v39
    v_mfma_f32_32x32x16_bf16 v[80:95], v[156:159], v[8:11], 0
    ds_read_b128 v[184:187], v20 offset:45536
    ds_read_b128 v[188:191], v20 offset:46144
    v_exp_f32 v40, v40
    v_exp_f32 v41, v41
    v_exp_f32 v42, v42
    v_exp_f32 v43, v43
    v_cvt_pk_bf16_f32 v100, v40, v41
    v_cvt_pk_bf16_f32 v101, v42, v43
    v_mfma_f32_32x32x16_bf16 v[112:127], v[164:167], v[96:99], v[112:127]
    ds_read_b128 v[192:195], v20 offset:46752
    v_exp_f32 v44, v44
    v_exp_f32 v45, v45
    v_exp_f32 v46, v46
    v_exp_f32 v47, v47
    v_cvt_pk_bf16_f32 v102, v44, v45
    v_cvt_pk_bf16_f32 v103, v46, v47
    v_mfma_f32_32x32x4_2b_bf16 v[64:95], v[162:163], v[12:13], v[64:95]
    v_exp_f32 v48, v48
    v_exp_f32 v49, v49
    v_exp_f32 v50, v50
    v_exp_f32 v51, v51
    v_cvt_pk_bf16_f32 v104, v48, v49
    v_cvt_pk_bf16_f32 v105, v50, v51
    v_exp_f32 v52, v52
    v_exp_f32 v53, v53
    v_exp_f32 v54, v54
    v_mfma_f32_32x32x16_bf16 v[112:127], v[168:171], v[100:103], v[112:127]
    v_exp_f32 v55, v55
    v_cvt_pk_bf16_f32 v106, v52, v53
    v_cvt_pk_bf16_f32 v107, v54, v55
    v_exp_f32 v56, v56
    v_exp_f32 v57, v57
    v_mfma_f32_32x32x16_bf16 v[112:127], v[172:175], v[104:107], v[112:127]
    v_exp_f32 v58, v58
    v_exp_f32 v59, v59
    v_cvt_pk_bf16_f32 v108, v56, v57
    v_cvt_pk_bf16_f32 v109, v58, v59
    v_exp_f32 v60, v60
    v_exp_f32 v61, v61
    v_exp_f32 v62, v62
    v_exp_f32 v63, v63
    v_cvt_pk_bf16_f32 v110, v60, v61
    v_cvt_pk_bf16_f32 v111, v62, v63
    s_waitcnt lgkmcnt(0)
    v_mfma_f32_32x32x16_bf16 v[32:47], v[144:147], v[8:11], 0
    ds_read_b128 v[152:155], v14 offset:52096
    ds_read_b128 v[156:159], v14 offset:53120
    v_exp_f32 v64, v64
    v_exp_f32 v65, v65
    v_exp_f32 v66, v66
    v_exp_f32 v67, v67
    v_cvt_pk_bf16_f32 v96, v64, v65
    v_cvt_pk_bf16_f32 v97, v66, v67
    v_mfma_f32_32x32x16_bf16 v[112:127], v[176:179], v[108:111], v[112:127]
    ds_read_b32 v162, v17 offset:54144
    ds_read_b128 v[164:167], v20 offset:49664
    v_exp_f32 v68, v68
    v_exp_f32 v69, v69
    v_exp_f32 v70, v70
    v_exp_f32 v71, v71
    v_cvt_pk_bf16_f32 v98, v68, v69
    v_cvt_pk_bf16_f32 v99, v70, v71
    v_mfma_f32_32x32x16_bf16 v[48:63], v[148:151], v[8:11], 0
    ds_read_b128 v[168:171], v20 offset:50272
    ds_read_b128 v[172:175], v20 offset:50880
    v_exp_f32 v72, v72
    v_exp_f32 v73, v73
    v_exp_f32 v74, v74
    v_exp_f32 v75, v75
    v_cvt_pk_bf16_f32 v100, v72, v73
    v_cvt_pk_bf16_f32 v101, v74, v75
    v_mfma_f32_32x32x16_bf16 v[112:127], v[180:183], v[96:99], v[112:127]
    ds_read_b128 v[176:179], v20 offset:51488
    v_exp_f32 v76, v76
    v_exp_f32 v77, v77
    v_exp_f32 v78, v78
    v_exp_f32 v79, v79
    v_cvt_pk_bf16_f32 v102, v76, v77
    v_cvt_pk_bf16_f32 v103, v78, v79
    v_mfma_f32_32x32x4_2b_bf16 v[32:63], v[160:161], v[12:13], v[32:63]
    s_mov_b32 s55, s72
    buffer_load_dwordx2 v[208:209], v242, s[64:67], s55 offen nt
    v_exp_f32 v80, v80
    v_exp_f32 v81, v81
    v_exp_f32 v82, v82
    v_exp_f32 v83, v83
    v_cvt_pk_bf16_f32 v104, v80, v81
    v_cvt_pk_bf16_f32 v105, v82, v83
    v_exp_f32 v84, v84
    v_exp_f32 v85, v85
    v_exp_f32 v86, v86
    v_mfma_f32_32x32x16_bf16 v[112:127], v[184:187], v[100:103], v[112:127]
    s_mov_b32 s55, s72
    s_add_u32 s55, s55, s75
    buffer_load_dwordx2 v[210:211], v242, s[64:67], s55 offen nt
    v_exp_f32 v87, v87
    v_cvt_pk_bf16_f32 v106, v84, v85
    v_cvt_pk_bf16_f32 v107, v86, v87
    v_exp_f32 v88, v88
    v_exp_f32 v89, v89
    v_mfma_f32_32x32x16_bf16 v[112:127], v[188:191], v[104:107], v[112:127]
    v_exp_f32 v90, v90
    v_exp_f32 v91, v91
    v_cvt_pk_bf16_f32 v108, v88, v89
    v_cvt_pk_bf16_f32 v109, v90, v91
    v_exp_f32 v92, v92
    v_exp_f32 v93, v93
    v_exp_f32 v94, v94
    v_exp_f32 v95, v95
    v_cvt_pk_bf16_f32 v110, v92, v93
    v_cvt_pk_bf16_f32 v111, v94, v95
    s_waitcnt lgkmcnt(0)
    v_mfma_f32_32x32x16_bf16 v[64:79], v[152:155], v[8:11], 0
    ds_read_b128 v[144:147], v14 offset:56832
    ds_read_b128 v[148:151], v14 offset:57856
    v_exp_f32 v32, v32
    v_exp_f32 v33, v33
    v_exp_f32 v34, v34
    v_exp_f32 v35, v35
    v_cvt_pk_bf16_f32 v96, v32, v33
    v_cvt_pk_bf16_f32 v97, v34, v35
    v_mfma_f32_32x32x16_bf16 v[112:127], v[192:195], v[108:111], v[112:127]
    ds_read_b32 v160, v17 offset:58880
    ds_read_b128 v[180:183], v20 offset:54400
    v_exp_f32 v36, v36
    v_exp_f32 v37, v37
    v_exp_f32 v38, v38
    v_exp_f32 v39, v39
    v_cvt_pk_bf16_f32 v98, v36, v37
    v_cvt_pk_bf16_f32 v99, v38, v39
    v_mfma_f32_32x32x16_bf16 v[80:95], v[156:159], v[8:11], 0
    ds_read_b128 v[184:187], v20 offset:55008
    ds_read_b128 v[188:191], v20 offset:55616
    v_exp_f32 v40, v40
    v_exp_f32 v41, v41
    v_exp_f32 v42, v42
    v_exp_f32 v43, v43
    v_cvt_pk_bf16_f32 v100, v40, v41
    v_cvt_pk_bf16_f32 v101, v42, v43
    v_mfma_f32_32x32x16_bf16 v[112:127], v[164:167], v[96:99], v[112:127]
    ds_read_b128 v[192:195], v20 offset:56224
    v_exp_f32 v44, v44
    v_exp_f32 v45, v45
    v_exp_f32 v46, v46
    v_exp_f32 v47, v47
    v_cvt_pk_bf16_f32 v102, v44, v45
    v_cvt_pk_bf16_f32 v103, v46, v47
    v_mfma_f32_32x32x4_2b_bf16 v[64:95], v[162:163], v[12:13], v[64:95]
    s_mov_b32 s55, s72
    s_add_u32 s55, s55, s74
    buffer_load_dwordx2 v[212:213], v242, s[64:67], s55 offen nt
    v_exp_f32 v48, v48
    v_exp_f32 v49, v49
    v_exp_f32 v50, v50
    v_exp_f32 v51, v51
    v_cvt_pk_bf16_f32 v104, v48, v49
    v_cvt_pk_bf16_f32 v105, v50, v51
    v_exp_f32 v52, v52
    v_exp_f32 v53, v53
    v_exp_f32 v54, v54
    v_mfma_f32_32x32x16_bf16 v[112:127], v[168:171], v[100:103], v[112:127]
    s_mov_b32 s55, s72
    s_add_u32 s55, s55, s74
    s_add_u32 s55, s55, s75
    buffer_load_dwordx2 v[214:215], v242, s[64:67], s55 offen nt
    v_exp_f32 v55, v55
    v_cvt_pk_bf16_f32 v106, v52, v53
    v_cvt_pk_bf16_f32 v107, v54, v55
    v_exp_f32 v56, v56
    v_exp_f32 v57, v57
    v_mfma_f32_32x32x16_bf16 v[112:127], v[172:175], v[104:107], v[112:127]
    v_exp_f32 v58, v58
    v_exp_f32 v59, v59
    v_cvt_pk_bf16_f32 v108, v56, v57
    v_cvt_pk_bf16_f32 v109, v58, v59
    v_exp_f32 v60, v60
    v_exp_f32 v61, v61
    v_exp_f32 v62, v62
    v_exp_f32 v63, v63
    v_cvt_pk_bf16_f32 v110, v60, v61
    v_cvt_pk_bf16_f32 v111, v62, v63
    s_cmp_lt_u32 s3, 4
    s_cbranch_scc1 L_pr_28
    s_setprio 0
L_pr_28:
    s_waitcnt lgkmcnt(0)
    v_mfma_f32_32x32x16_bf16 v[32:47], v[144:147], v[8:11], 0
    ds_read_b128 v[152:155], v15 offset:0
    ds_read_b128 v[156:159], v15 offset:1024
    v_exp_f32 v64, v64
    v_exp_f32 v65, v65
    v_exp_f32 v66, v66
    v_exp_f32 v67, v67
    v_cvt_pk_bf16_f32 v96, v64, v65
    v_cvt_pk_bf16_f32 v97, v66, v67
    v_mfma_f32_32x32x16_bf16 v[112:127], v[176:179], v[108:111], v[112:127]
    ds_read_b32 v162, v18 offset:2048
    ds_read_b128 v[164:167], v20 offset:59136
    v_exp_f32 v68, v68
    v_exp_f32 v69, v69
    v_exp_f32 v70, v70
    v_exp_f32 v71, v71
    v_cvt_pk_bf16_f32 v98, v68, v69
    v_cvt_pk_bf16_f32 v99, v70, v71
    v_mfma_f32_32x32x16_bf16 v[48:63], v[148:151], v[8:11], 0
    ds_read_b128 v[168:171], v20 offset:59744
    ds_read_b128 v[172:175], v20 offset:60352
    v_exp_f32 v72, v72
    v_exp_f32 v73, v73
    v_exp_f32 v74, v74
    v_exp_f32 v75, v75
    v_cvt_pk_bf16_f32 v100, v72, v73
    v_cvt_pk_bf16_f32 v101, v74, v75
    v_mfma_f32_32x32x16_bf16 v[112:127], v[180:183], v[96:99], v[112:127]
    ds_read_b128 v[176:179], v20 offset:60960
    v_exp_f32 v76, v76
    v_exp_f32 v77, v77
    v_exp_f32 v78, v78
    v_exp_f32 v79, v79
    v_cvt_pk_bf16_f32 v102, v76, v77
    v_cvt_pk_bf16_f32 v103, v78, v79
    v_mfma_f32_32x32x4_2b_bf16 v[32:63], v[160:161], v[12:13], v[32:63]
    s_mov_b32 s55, s72
    s_add_u32 s55, s55, s73
    buffer_load_dwordx2 v[216:217], v242, s[64:67], s55 offen nt
    v_exp_f32 v80, v80
    v_exp_f32 v81, v81
    v_exp_f32 v82, v82
    v_exp_f32 v83, v83
    v_cvt_pk_bf16_f32 v104, v80, v81
    v_cvt_pk_bf16_f32 v105, v82, v83
    v_exp_f32 v84, v84
    v_exp_f32 v85, v85
    v_exp_f32 v86, v86
    v_mfma_f32_32x32x16_bf16 v[112:127], v[184:187], v[100:103], v[112:127]
    s_mov_b32 s55, s72
    s_add_u32 s55, s55, s73
    s_add_u32 s55, s55, s75
    buffer_load_dwordx2 v[218:219], v242, s[64:67], s55 offen nt
    v_exp_f32 v87, v87
    v_cvt_pk_bf16_f32 v106, v84, v85
    v_cvt_pk_bf16_f32 v107, v86, v87
    v_exp_f32 v88, v88
    v_exp_f32 v89, v89
    v_mfma_f32_32x32x16_bf16 v[112:127], v[188:191], v[104:107], v[112:127]
    v_exp_f32 v90, v90
    v_exp_f32 v91, v91
    v_cvt_pk_bf16_f32 v108, v88, v89
    v_cvt_pk_bf16_f32 v109, v90, v91
    v_exp_f32 v92, v92
    v_exp_f32 v93, v93
    v_exp_f32 v94, v94
    v_exp_f32 v95, v95
    v_cvt_pk_bf16_f32 v110, v92, v93
    v_cvt_pk_bf16_f32 v111, v94, v95
    s_cmp_lt_u32 s3, 4
    s_cbranch_scc1 L_pr_29
    s_setprio 2
L_pr_29:
    s_waitcnt lgkmcnt(0)
    v_mfma_f32_32x32x16_bf16 v[64:79], v[152:155], v[8:11], 0
    ds_read_b128 v[144:147], v15 offset:4736
    ds_read_b128 v[148:151], v15 offset:5760
    v_exp_f32 v32, v32
    v_exp_f32 v33, v33
    v_exp_f32 v34, v34
    v_exp_f32 v35, v35
    v_cvt_pk_bf16_f32 v96, v32, v33
    v_cvt_pk_bf16_f32 v97, v34, v35
    v_mfma_f32_32x32x16_bf16 v[112:127], v[192:195], v[108:111], v[112:127]
    ds_read_b32 v160, v18 offset:6784
    ds_read_b128 v[180:183], v21 offset:2304
    v_exp_f32 v36, v36
    v_exp_f32 v37, v37
    v_exp_f32 v38, v38
    v_exp_f32 v39, v39
    v_cvt_pk_bf16_f32 v98, v36, v37
    v_cvt_pk_bf16_f32 v99, v38, v39
    v_mfma_f32_32x32x16_bf16 v[80:95], v[156:159], v[8:11], 0
    ds_read_b128 v[184:187], v21 offset:2912
    ds_read_b128 v[188:191], v21 offset:3520
    v_exp_f32 v40, v40
    v_exp_f32 v41, v41
    v_exp_f32 v42, v42
    v_exp_f32 v43, v43
    v_cvt_pk_bf16_f32 v100, v40, v41
    v_cvt_pk_bf16_f32 v101, v42, v43
    v_mfma_f32_32x32x16_bf16 v[112:127], v[164:167], v[96:99], v[112:127]
    ds_read_b128 v[192:195], v21 offset:4128
    v_exp_f32 v44, v44
    v_exp_f32 v45, v45
    v_exp_f32 v46, v46
    v_exp_f32 v47, v47
    v_cvt_pk_bf16_f32 v102, v44, v45
    v_cvt_pk_bf16_f32 v103, v46, v47
    v_mfma_f32_32x32x4_2b_bf16 v[64:95], v[162:163], v[12:13], v[64:95]
    s_mov_b32 s55, s72
    s_add_u32 s55, s55, s73
    s_add_u32 s55, s55, s74
    buffer_load_dwordx2 v[220:221], v242, s[64:67], s55 offen nt
    v_exp_f32 v48, v48
    v_exp_f32 v49, v49
    v_exp_f32 v50, v50
    v_exp_f32 v51, v51
    v_cvt_pk_bf16_f32 v104, v48, v49
    v_cvt_pk_bf16_f32 v105, v50, v51
    v_exp_f32 v52, v52
    v_exp_f32 v53, v53
    v_exp_f32 v54, v54
    v_mfma_f32_32x32x16_bf16 v[112:127], v[168:171], v[100:103], v[112:127]
    s_mov_b32 s55, s72
    s_add_u32 s55, s55, s73
    s_add_u32 s55, s55, s74
    s_add_u32 s55, s55, s75
    buffer_load_dwordx2 v[222:223], v242, s[64:67], s55 offen nt
    v_exp_f32 v55, v55
    v_cvt_pk_bf16_f32 v106, v52, v53
    v_cvt_pk_bf16_f32 v107, v54, v55
    v_exp_f32 v56, v56
    v_exp_f32 v57, v57
    v_mfma_f32_32x32x16_bf16 v[112:127], v[172:175], v[104:107], v[112:127]
    v_exp_f32 v58, v58
    v_exp_f32 v59, v59
    v_cvt_pk_bf16_f32 v108, v56, v57
    v_cvt_pk_bf16_f32 v109, v58, v59
    v_exp_f32 v60, v60
    v_exp_f32 v61, v61
    v_exp_f32 v62, v62
    v_exp_f32 v63, v63
    v_cvt_pk_bf16_f32 v110, v60, v61
    v_cvt_pk_bf16_f32 v111, v62, v63
    s_waitcnt lgkmcnt(0)
    v_mfma_f32_32x32x16_bf16 v[32:47], v[144:147], v[8:11], 0
    ds_read_b128 v[152:155], v15 offset:9472
    ds_read_b128 v[156:159], v15 offset:10496
    v_exp_f32 v64, v64
    v_exp_f32 v65, v65
    v_exp_f32 v66, v66
    v_exp_f32 v67, v67
    v_cvt_pk_bf16_f32 v96, v64, v65
    v_cvt_pk_bf16_f32 v97, v66, v67
    v_mfma_f32_32x32x16_bf16 v[112:127], v[176:179], v[108:111], v[112:127]
    ds_read_b32 v162, v18 offset:11520
    ds_read_b128 v[164:167], v21 offset:7040
    v_exp_f32 v68, v68
    v_exp_f32 v69, v69
    v_exp_f32 v70, v70
    v_exp_f32 v71, v71
    v_cvt_pk_bf16_f32 v98, v68, v69
    v_cvt_pk_bf16_f32 v99, v70, v71
    v_mfma_f32_32x32x16_bf16 v[48:63], v[148:151], v[8:11], 0
    ds_read_b128 v[168:171], v21 offset:7648
    ds_read_b128 v[172:175], v21 offset:8256
    v_exp_f32 v72, v72
    v_exp_f32 v73, v73
    v_exp_f32 v74, v74
    v_exp_f32 v75, v75
    v_cvt_pk_bf16_f32 v100, v72, v73
    v_cvt_pk_bf16_f32 v101, v74, v75
    v_mfma_f32_32x32x16_bf16 v[112:127], v[180:183], v[96:99], v[112:127]
    ds_read_b128 v[176:179], v21 offset:8864
    v_exp_f32 v76, v76
    v_exp_f32 v77, v77
    v_exp_f32 v78, v78
    v_exp_f32 v79, v79
    v_cvt_pk_bf16_f32 v102, v76, v77
    v_cvt_pk_bf16_f32 v103, v78, v79
    v_mfma_f32_32x32x4_2b_bf16 v[32:63], v[160:161], v[12:13], v[32:63]
    s_cmp_lt_u32 s3, 5
    s_cbranch_scc1 L_w3_7
    s_mov_b32 s55, s76
    buffer_load_dwordx2 v[224:225], v243, s[68:71], s55 offen nt
L_w3_7:
    v_exp_f32 v80, v80
    v_exp_f32 v81, v81
    v_exp_f32 v82, v82
    v_exp_f32 v83, v83
    v_cvt_pk_bf16_f32 v104, v80, v81
    v_cvt_pk_bf16_f32 v105, v82, v83
    v_exp_f32 v84, v84
    v_exp_f32 v85, v85
    v_exp_f32 v86, v86
    v_mfma_f32_32x32x16_bf16 v[112:127], v[184:187], v[100:103], v[112:127]
    s_cmp_lt_u32 s3, 5
    s_cbranch_scc1 L_w3_8
    s_mov_b32 s55, s76
    s_add_u32 s55, s55, s79
    buffer_load_dwordx2 v[226:227], v243, s[68:71], s55 offen nt
L_w3_8:
    v_exp_f32 v87, v87
    v_cvt_pk_bf16_f32 v106, v84, v85
    v_cvt_pk_bf16_f32 v107, v86, v87
    v_exp_f32 v88, v88
    v_exp_f32 v89, v89
    v_mfma_f32_32x32x16_bf16 v[112:127], v[188:191], v[104:107], v[112:127]
    v_exp_f32 v90, v90
    v_exp_f32 v91, v91
    v_cvt_pk_bf16_f32 v108, v88, v89
    v_cvt_pk_bf16_f32 v109, v90, v91
    v_exp_f32 v92, v92
    v_exp_f32 v93, v93
    v_exp_f32 v94, v94
    v_exp_f32 v95, v95
    v_cvt_pk_bf16_f32 v110, v92, v93
    v_cvt_pk_bf16_f32 v111, v94, v95
    s_waitcnt lgkmcnt(0)
    v_mfma_f32_32x32x16_bf16 v[64:79], v[152:155], v[8:11], 0
    ds_read_b128 v[144:147], v15 offset:14208
    ds_read_b128 v[148:151], v15 offset:15232
    v_exp_f32 v32, v32
    v_exp_f32 v33, v33
    v_exp_f32 v34, v34
    v_exp_f32 v35, v35
    v_cvt_pk_bf16_f32 v96, v32, v33
    v_cvt_pk_bf16_f32 v97, v34, v35
    v_mfma_f32_32x32x16_bf16 v[112:127], v[192:195], v[108:111], v[112:127]
    ds_read_b32 v160, v18 offset:16256
    ds_read_b128 v[180:183], v21 offset:11776
    v_exp_f32 v36, v36
    v_exp_f32 v37, v37
    v_exp_f32 v38, v38
    v_exp_f32 v39, v39
    v_cvt_pk_bf16_f32 v98, v36, v37
    v_cvt_pk_bf16_f32 v99, v38, v39
    v_mfma_f32_32x32x16_bf16 v[80:95], v[156:159], v[8:11], 0
    ds_read_b128 v[184:187], v21 offset:12384
    ds_read_b128 v[188:191], v21 offset:12992
    v_exp_f32 v40, v40
    v_exp_f32 v41, v41
    v_exp_f32 v42, v42
    v_exp_f32 v43, v43
    v_cvt_pk_bf16_f32 v100, v40, v41
    v_cvt_pk_bf16_f32 v101, v42, v43
    v_mfma_f32_32x32x16_bf16 v[112:127], v[164:167], v[96:99], v[112:127]
    ds_read_b128 v[192:195], v21 offset:13600
    v_exp_f32 v44, v44
    v_exp_f32 v45, v45
    v_exp_f32 v46, v46
    v_exp_f32 v47, v47
    v_cvt_pk_bf16_f32 v102, v44, v45
    v_cvt_pk_bf16_f32 v103, v46, v47
    v_mfma_f32_32x32x4_2b_bf16 v[64:95], v[162:163], v[12:13], v[64:95]
    s_cmp_lt_u32 s3, 5
    s_cbranch_scc1 L_w3_9
    s_mov_b32 s55, s76
    s_add_u32 s55, s55, s78
    buffer_load_dwordx2 v[228:229], v243, s[68:71], s55 offen nt
L_w3_9:
    v_exp_f32 v48, v48
    v_exp_f32 v49, v49
    v_exp_f32 v50, v50
    v_exp_f32 v51, v51
    v_cvt_pk_bf16_f32 v104, v48, v49
    v_cvt_pk_bf16_f32 v105, v50, v51
    v_exp_f32 v52, v52
    v_exp_f32 v53, v53
    v_exp_f32 v54, v54
    v_mfma_f32_32x32x16_bf16 v[112:127], v[168:171], v[100:103], v[112:127]
    s_cmp_lt_u32 s3, 5
    s_cbranch_scc1 L_w3_10
    s_mov_b32 s55, s76
    s_add_u32 s55, s55, s78
    s_add_u32 s55, s55, s79
    buffer_load_dwordx2 v[230:231], v243, s[68:71], s55 offen nt
L_w3_10:
    v_exp_f32 v55, v55
    v_cvt_pk_bf16_f32 v106, v52, v53
    v_cvt_pk_bf16_f32 v107, v54, v55
    v_exp_f32 v56, v56
    v_exp_f32 v57, v57
    v_mfma_f32_32x32x16_bf16 v[112:127], v[172:175], v[104:107], v[112:127]
    v_exp_f32 v58, v58
    v_exp_f32 v59, v59
    v_cvt_pk_bf16_f32 v108, v56, v57
    v_cvt_pk_bf16_f32 v109, v58, v59
    v_exp_f32 v60, v60
    v_exp_f32 v61, v61
    v_exp_f32 v62, v62
    v_exp_f32 v63, v63
    v_cvt_pk_bf16_f32 v110, v60, v61
    v_cvt_pk_bf16_f32 v111, v62, v63
    s_cmp_lt_u32 s3, 4
    s_cbranch_scc1 L_pr_30
    s_setprio 0
L_pr_30:
    s_waitcnt lgkmcnt(0)
    v_mfma_f32_32x32x16_bf16 v[32:47], v[144:147], v[8:11], 0
    ds_read_b128 v[152:155], v15 offset:18944
    ds_read_b128 v[156:159], v15 offset:19968
    v_exp_f32 v64, v64
    v_exp_f32 v65, v65
    v_exp_f32 v66, v66
    v_exp_f32 v67, v67
    v_cvt_pk_bf16_f32 v96, v64, v65
    v_cvt_pk_bf16_f32 v97, v66, v67
    v_mfma_f32_32x32x16_bf16 v[112:127], v[176:179], v[108:111], v[112:127]
    ds_read_b32 v162, v18 offset:20992
    ds_read_b128 v[164:167], v21 offset:16512
    v_exp_f32 v68, v68
    v_exp_f32 v69, v69
    v_exp_f32 v70, v70
    v_exp_f32 v71, v71
    v_cvt_pk_bf16_f32 v98, v68, v69
    v_cvt_pk_bf16_f32 v99, v70, v71
    v_mfma_f32_32x32x16_bf16 v[48:63], v[148:151], v[8:11], 0
    ds_read_b128 v[168:171], v21 offset:17120
    ds_read_b128 v[172:175], v21 offset:17728
    v_exp_f32 v72, v72
    v_exp_f32 v73, v73
    v_exp_f32 v74, v74
    v_exp_f32 v75, v75
    v_cvt_pk_bf16_f32 v100, v72, v73
    v_cvt_pk_bf16_f32 v101, v74, v75
    v_mfma_f32_32x32x16_bf16 v[112:127], v[180:183], v[96:99], v[112:127]
    ds_read_b128 v[176:179], v21 offset:18336
    v_exp_f32 v76, v76
    v_exp_f32 v77, v77
    v_exp_f32 v78, v78
    v_exp_f32 v79, v79
    v_cvt_pk_bf16_f32 v102, v76, v77
    v_cvt_pk_bf16_f32 v103, v78, v79
    v_mfma_f32_32x32x4_2b_bf16 v[32:63], v[160:161], v[12:13], v[32:63]
    s_cmp_lt_u32 s3, 5
    s_cbranch_scc1 L_w3_11
    s_mov_b32 s55, s76
    s_add_u32 s55, s55, s77
    buffer_load_dwordx2 v[232:233], v243, s[68:71], s55 offen nt
L_w3_11:
    v_exp_f32 v80, v80
    v_exp_f32 v81, v81
    v_exp_f32 v82, v82
    v_exp_f32 v83, v83
    v_cvt_pk_bf16_f32 v104, v80, v81
    v_cvt_pk_bf16_f32 v105, v82, v83
    v_exp_f32 v84, v84
    v_exp_f32 v85, v85
    v_exp_f32 v86, v86
    v_mfma_f32_32x32x16_bf16 v[112:127], v[184:187], v[100:103], v[112:127]
    s_cmp_lt_u32 s3, 5
    s_cbranch_scc1 L_w3_12
    s_mov_b32 s55, s76
    s_add_u32 s55, s55, s77
    s_add_u32 s55, s55, s79
    buffer_load_dwordx2 v[234:235], v243, s[68:71], s55 offen nt
L_w3_12:
    v_exp_f32 v87, v87
    v_cvt_pk_bf16_f32 v106, v84, v85
    v_cvt_pk_bf16_f32 v107, v86, v87
    v_exp_f32 v88, v88
    v_exp_f32 v89, v89
    v_mfma_f32_32x32x16_bf16 v[112:127], v[188:191], v[104:107], v[112:127]
    v_exp_f32 v90, v90
    v_exp_f32 v91, v91
    v_cvt_pk_bf16_f32 v108, v88, v89
    v_cvt_pk_bf16_f32 v109, v90, v91
    v_exp_f32 v92, v92
    v_exp_f32 v93, v93
    v_exp_f32 v94, v94
    v_exp_f32 v95, v95
    v_cvt_pk_bf16_f32 v110, v92, v93
    v_cvt_pk_bf16_f32 v111, v94, v95
    s_cmp_lt_u32 s3, 4
    s_cbranch_scc1 L_pr_31
    s_setprio 2
L_pr_31:
    s_waitcnt lgkmcnt(0)
    v_mfma_f32_32x32x16_bf16 v[64:79], v[152:155], v[8:11], 0
    ds_read_b128 v[144:147], v15 offset:23680
    ds_read_b128 v[148:151], v15 offset:24704
    v_exp_f32 v32, v32
    v_exp_f32 v33, v33
    v_exp_f32 v34, v34
    v_exp_f32 v35, v35
    v_cvt_pk_bf16_f32 v96, v32, v33
    v_cvt_pk_bf16_f32 v97, v34, v35
    v_mfma_f32_32x32x16_bf16 v[112:127], v[192:195], v[108:111], v[112:127]
    ds_read_b32 v160, v18 offset:25728
    ds_read_b128 v[180:183], v21 offset:21248
    v_exp_f32 v36, v36
    v_exp_f32 v37, v37
    v_exp_f32 v38, v38
    v_exp_f32 v39, v39
    v_cvt_pk_bf16_f32 v98, v36, v37
    v_cvt_pk_bf16_f32 v99, v38, v39
    v_mfma_f32_32x32x16_bf16 v[80:95], v[156:159], v[8:11], 0
    ds_read_b128 v[184:187], v21 offset:21856
    ds_read_b128 v[188:191], v21 offset:22464
    v_exp_f32 v40, v40
    v_exp_f32 v41, v41
    v_exp_f32 v42, v42
    v_exp_f32 v43, v43
    v_cvt_pk_bf16_f32 v100, v40, v41
    v_cvt_pk_bf16_f32 v101, v42, v43
    v_mfma_f32_32x32x16_bf16 v[112:127], v[164:167], v[96:99], v[112:127]
    ds_read_b128 v[192:195], v21 offset:23072
    v_exp_f32 v44, v44
    v_exp_f32 v45, v45
    v_exp_f32 v46, v46
    v_exp_f32 v47, v47
    v_cvt_pk_bf16_f32 v102, v44, v45
    v_cvt_pk_bf16_f32 v103, v46, v47
    v_mfma_f32_32x32x4_2b_bf16 v[64:95], v[162:163], v[12:13], v[64:95]
    s_cmp_lt_u32 s3, 5
    s_cbranch_scc1 L_w3_13
    s_mov_b32 s55, s76
    s_add_u32 s55, s55, s77
    s_add_u32 s55, s55, s78
    buffer_load_dwordx2 v[236:237], v243, s[68:71], s55 offen nt
L_w3_13:
    v_exp_f32 v48, v48
    v_exp_f32 v49, v49
    v_exp_f32 v50, v50
    v_exp_f32 v51, v51
    v_cvt_pk_bf16_f32 v104, v48, v49
    v_cvt_pk_bf16_f32 v105, v50, v51
    v_exp_f32 v52, v52
    v_exp_f32 v53, v53
    v_exp_f32 v54, v54
    v_mfma_f32_32x32x16_bf16 v[112:127], v[168:171], v[100:103], v[112:127]
    s_cmp_lt_u32 s3, 5
    s_cbranch_scc1 L_w3_14
    s_mov_b32 s55, s76
    s_add_u32 s55, s55, s77
    s_add_u32 s55, s55, s78
    s_add_u32 s55, s55, s79
    buffer_load_dwordx2 v[238:239], v243, s[68:71], s55 offen nt
L_w3_14:
    v_exp_f32 v55, v55
    v_cvt_pk_bf16_f32 v106, v52, v53
    v_cvt_pk_bf16_f32 v107, v54, v55
    v_exp_f32 v56, v56
    v_exp_f32 v57, v57
    v_mfma_f32_32x32x16_bf16 v[112:127], v[172:175], v[104:107], v[112:127]
    v_exp_f32 v58, v58
    v_exp_f32 v59, v59
    v_cvt_pk_bf16_f32 v108, v56, v57
    v_cvt_pk_bf16_f32 v109, v58, v59
    v_exp_f32 v60, v60
    v_exp_f32 v61, v61
    v_exp_f32 v62, v62
    v_exp_f32 v63, v63
    v_cvt_pk_bf16_f32 v110, v60, v61
    v_cvt_pk_bf16_f32 v111, v62, v63
    s_waitcnt lgkmcnt(0)
    v_mfma_f32_32x32x16_bf16 v[32:47], v[144:147], v[8:11], 0
    ds_read_b128 v[152:155], v15 offset:28416
    ds_read_b128 v[156:159], v15 offset:29440
    v_exp_f32 v64, v64
    v_exp_f32 v65, v65
    v_exp_f32 v66, v66
    v_exp_f32 v67, v67
    v_cvt_pk_bf16_f32 v96, v64, v65
    v_cvt_pk_bf16_f32 v97, v66, v67
    v_mfma_f32_32x32x16_bf16 v[112:127], v[176:179], v[108:111], v[112:127]
    ds_read_b32 v162, v18 offset:30464
    ds_read_b128 v[164:167], v21 offset:25984
    v_exp_f32 v68, v68
    v_exp_f32 v69, v69
    v_exp_f32 v70, v70
    v_exp_f32 v71, v71
    v_cvt_pk_bf16_f32 v98, v68, v69
    v_cvt_pk_bf16_f32 v99, v70, v71
    v_mfma_f32_32x32x16_bf16 v[48:63], v[148:151], v[8:11], 0
    ds_read_b128 v[168:171], v21 offset:26592
    ds_read_b128 v[172:175], v21 offset:27200
    v_exp_f32 v72, v72
    v_exp_f32 v73, v73
    v_exp_f32 v74, v74
    v_exp_f32 v75, v75
    v_cvt_pk_bf16_f32 v100, v72, v73
    v_cvt_pk_bf16_f32 v101, v74, v75
    v_mfma_f32_32x32x16_bf16 v[112:127], v[180:183], v[96:99], v[112:127]
    ds_read_b128 v[176:179], v21 offset:27808
    v_exp_f32 v76, v76
    v_exp_f32 v77, v77
    v_exp_f32 v78, v78
    v_exp_f32 v79, v79
    v_cvt_pk_bf16_f32 v102, v76, v77
    v_cvt_pk_bf16_f32 v103, v78, v79
    v_mfma_f32_32x32x4_2b_bf16 v[32:63], v[160:161], v[12:13], v[32:63]
    v_exp_f32 v80, v80
    v_exp_f32 v81, v81
    v_exp_f32 v82, v82
    v_exp_f32 v83, v83
    v_cvt_pk_bf16_f32 v104, v80, v81
    v_cvt_pk_bf16_f32 v105, v82, v83
    v_exp_f32 v84, v84
    v_exp_f32 v85, v85
    v_exp_f32 v86, v86
    v_mfma_f32_32x32x16_bf16 v[112:127], v[184:187], v[100:103], v[112:127]
    v_exp_f32 v87, v87
    v_cvt_pk_bf16_f32 v106, v84, v85
    v_cvt_pk_bf16_f32 v107, v86, v87
    v_exp_f32 v88, v88
    v_exp_f32 v89, v89
    v_mfma_f32_32x32x16_bf16 v[112:127], v[188:191], v[104:107], v[112:127]
    v_exp_f32 v90, v90
    v_exp_f32 v91, v91
    v_cvt_pk_bf16_f32 v108, v88, v89
    v_cvt_pk_bf16_f32 v109, v90, v91
    v_exp_f32 v92, v92
    v_exp_f32 v93, v93
    v_exp_f32 v94, v94
    v_exp_f32 v95, v95
    v_cvt_pk_bf16_f32 v110, v92, v93
    v_cvt_pk_bf16_f32 v111, v94, v95
    s_waitcnt lgkmcnt(0)
    v_mfma_f32_32x32x16_bf16 v[64:79], v[152:155], v[8:11], 0
    ds_read_b128 v[144:147], v15 offset:33152
    ds_read_b128 v[148:151], v15 offset:34176
    v_exp_f32 v32, v32
    v_exp_f32 v33, v33
    v_exp_f32 v34, v34
    v_exp_f32 v35, v35
    v_cvt_pk_bf16_f32 v96, v32, v33
    v_cvt_pk_bf16_f32 v97, v34, v35
    v_mfma_f32_32x32x16_bf16 v[112:127], v[192:195], v[108:111], v[112:127]
    ds_read_b32 v160, v18 offset:35200
    ds_read_b128 v[180:183], v21 offset:30720
    v_exp_f32 v36, v36
    v_exp_f32 v37, v37
    v_exp_f32 v38, v38
    v_exp_f32 v39, v39
    v_cvt_pk_bf16_f32 v98, v36, v37
    v_cvt_pk_bf16_f32 v99, v38, v39
    v_mfma_f32_32x32x16_bf16 v[80:95], v[156:159], v[8:11], 0
    ds_read_b128 v[184:187], v21 offset:31328
    ds_read_b128 v[188:191], v21 offset:31936
    v_exp_f32 v40, v40
    v_exp_f32 v41, v41
    v_exp_f32 v42, v42
    v_exp_f32 v43, v43
    v_cvt_pk_bf16_f32 v100, v40, v41
    v_cvt_pk_bf16_f32 v101, v42, v43
    v_mfma_f32_32x32x16_bf16 v[112:127], v[164:167], v[96:99], v[112:127]
    ds_read_b128 v[192:195], v21 offset:32544
    v_exp_f32 v44, v44
    v_exp_f32 v45, v45
    v_exp_f32 v46, v46
    v_exp_f32 v47, v47
    v_cvt_pk_bf16_f32 v102, v44, v45
    v_cvt_pk_bf16_f32 v103, v46, v47
    v_mfma_f32_32x32x4_2b_bf16 v[64:95], v[162:163], v[12:13], v[64:95]
    s_lshr_b32 s56, s2, 3
    s_cmp_ge_u32 s56, CODE_PF_N
    s_cbranch_scc1 L_cp_22
    s_cmp_lg_u32 s3, 0
    s_cbranch_scc1 L_cp_22
    s_getpc_b64 s[58:59]
L_cp_22_pc:
    s_add_u32 s58, s58, K2_out-L_cp_22_pc
    s_addc_u32 s59, s59, 0
    s_lshl_b32 s56, s56, 13
    v_lshlrev_b32 v206, 7, v0
    v_add_u32 v206, s56, v206
    v_min_u32 v206, CODE_END-K2_out-4, v206
    global_load_dword v205, v206, s[58:59]
L_cp_22:
    v_exp_f32 v48, v48
    v_exp_f32 v49, v49
    v_exp_f32 v50, v50
    v_exp_f32 v51, v51
    v_cvt_pk_bf16_f32 v104, v48, v49
    v_cvt_pk_bf16_f32 v105, v50, v51
    v_exp_f32 v52, v52
    v_exp_f32 v53, v53
    v_exp_f32 v54, v54
    v_mfma_f32_32x32x16_bf16 v[112:127], v[168:171], v[100:103], v[112:127]
    v_exp_f32 v55, v55
    v_cvt_pk_bf16_f32 v106, v52, v53
    v_cvt_pk_bf16_f32 v107, v54, v55
    v_exp_f32 v56, v56
    v_exp_f32 v57, v57
    v_mfma_f32_32x32x16_bf16 v[112:127], v[172:175], v[104:107], v[112:127]
    v_exp_f32 v58, v58
    v_exp_f32 v59, v59
    v_cvt_pk_bf16_f32 v108, v56, v57
    v_cvt_pk_bf16_f32 v109, v58, v59
    v_exp_f32 v60, v60
    v_exp_f32 v61, v61
    v_exp_f32 v62, v62
    v_exp_f32 v63, v63
    v_cvt_pk_bf16_f32 v110, v60, v61
    v_cvt_pk_bf16_f32 v111, v62, v63
    s_cmp_lt_u32 s3, 4
    s_cbranch_scc1 L_pr_32
    s_setprio 0
L_pr_32:
    s_waitcnt lgkmcnt(0)
    v_mfma_f32_32x32x16_bf16 v[32:47], v[144:147], v[8:11], 0
    ds_read_b128 v[152:155], v15 offset:37888
    ds_read_b128 v[156:159], v15 offset:38912
    v_exp_f32 v64, v64
    v_exp_f32 v65, v65
    v_exp_f32 v66, v66
    v_exp_f32 v67, v67
    v_cvt_pk_bf16_f32 v96, v64, v65
    v_cvt_pk_bf16_f32 v97, v66, v67
    v_mfma_f32_32x32x16_bf16 v[112:127], v[176:179], v[108:111], v[112:127]
    ds_read_b32 v162, v18 offset:39936
    ds_read_b128 v[164:167], v21 offset:35456
    v_exp_f32 v68, v68
    v_exp_f32 v69, v69
    v_exp_f32 v70, v70
    v_exp_f32 v71, v71
    v_cvt_pk_bf16_f32 v98, v68, v69
    v_cvt_pk_bf16_f32 v99, v70, v71
    v_mfma_f32_32x32x16_bf16 v[48:63], v[148:151], v[8:11], 0
    ds_read_b128 v[168:171], v21 offset:36064
    ds_read_b128 v[172:175], v21 offset:36672
    v_exp_f32 v72, v72
    v_exp_f32 v73, v73
    v_exp_f32 v74, v74
    v_exp_f32 v75, v75
    v_cvt_pk_bf16_f32 v100, v72, v73
    v_cvt_pk_bf16_f32 v101, v74, v75
    v_mfma_f32_32x32x16_bf16 v[112:127], v[180:183], v[96:99], v[112:127]
    ds_read_b128 v[176:179], v21 offset:37280
    v_exp_f32 v76, v76
    v_exp_f32 v77, v77
    v_exp_f32 v78, v78
    v_exp_f32 v79, v79
    v_cvt_pk_bf16_f32 v102, v76, v77
    v_cvt_pk_bf16_f32 v103, v78, v79
    v_mfma_f32_32x32x4_2b_bf16 v[32:63], v[160:161], v[12:13], v[32:63]
    s_sub_u32 s56, s3, 3
    s_cmp_ge_u32 s56, 3
    s_cbranch_scc1 L_wt_21
    s_lshr_b32 s57, s2, 3
    s_mul_i32 s57, s57, 3
    s_add_u32 s56, s56, s57
    s_lshl_b32 s56, s56, 13
    s_add_u32 s28, s14, 9740288
    s_addc_u32 s29, s15, 0
    s_mov_b32 s30, 700416
    s_mov_b32 s31, 0x00020000
    v_lshlrev_b32 v206, 7, v0
    buffer_load_dword v205, v206, s[28:31], s56 offen sc1
L_wt_21:
    v_exp_f32 v80, v80
    v_exp_f32 v81, v81
    v_exp_f32 v82, v82
    v_exp_f32 v83, v83
    v_cvt_pk_bf16_f32 v104, v80, v81
    v_cvt_pk_bf16_f32 v105, v82, v83
    v_exp_f32 v84, v84
    v_exp_f32 v85, v85
    v_exp_f32 v86, v86
    v_mfma_f32_32x32x16_bf16 v[112:127], v[184:187], v[100:103], v[112:127]
    v_exp_f32 v87, v87
    v_cvt_pk_bf16_f32 v106, v84, v85
    v_cvt_pk_bf16_f32 v107, v86, v87
    v_exp_f32 v88, v88
    v_exp_f32 v89, v89
    v_mfma_f32_32x32x16_bf16 v[112:127], v[188:191], v[104:107], v[112:127]
    v_exp_f32 v90, v90
    v_exp_f32 v91, v91
    v_cvt_pk_bf16_f32 v108, v88, v89
    v_cvt_pk_bf16_f32 v109, v90, v91
    v_exp_f32 v92, v92
    v_exp_f32 v93, v93
    v_exp_f32 v94, v94
    v_exp_f32 v95, v95
    v_cvt_pk_bf16_f32 v110, v92, v93
    v_cvt_pk_bf16_f32 v111, v94, v95
    s_cmp_lt_u32 s3, 4
    s_cbranch_scc1 L_pr_33
    s_setprio 2
L_pr_33:
    s_waitcnt lgkmcnt(0)
    v_mfma_f32_32x32x16_bf16 v[64:79], v[152:155], v[8:11], 0
    ds_read_b128 v[144:147], v15 offset:42624
    ds_read_b128 v[148:151], v15 offset:43648
    v_exp_f32 v32, v32
    v_exp_f32 v33, v33
    v_exp_f32 v34, v34
    v_exp_f32 v35, v35
    v_cvt_pk_bf16_f32 v96, v32, v33
    v_cvt_pk_bf16_f32 v97, v34, v35
    v_mfma_f32_32x32x16_bf16 v[112:127], v[192:195], v[108:111], v[112:127]
    ds_read_b32 v160, v18 offset:44672
    ds_read_b128 v[180:183], v21 offset:40192
    v_exp_f32 v36, v36
    v_exp_f32 v37, v37
    v_exp_f32 v38, v38
    v_exp_f32 v39, v39
    v_cvt_pk_bf16_f32 v98, v36, v37
    v_cvt_pk_bf16_f32 v99, v38, v39
    v_mfma_f32_32x32x16_bf16 v[80:95], v[156:159], v[8:11], 0
    ds_read_b128 v[184:187], v21 offset:40800
    ds_read_b128 v[188:191], v21 offset:41408
    v_exp_f32 v40, v40
    v_exp_f32 v41, v41
    v_exp_f32 v42, v42
    v_exp_f32 v43, v43
    v_cvt_pk_bf16_f32 v100, v40, v41
    v_cvt_pk_bf16_f32 v101, v42, v43
    v_mfma_f32_32x32x16_bf16 v[112:127], v[164:167], v[96:99], v[112:127]
    ds_read_b128 v[192:195], v21 offset:42016
    v_exp_f32 v44, v44
    v_exp_f32 v45, v45
    v_exp_f32 v46, v46
    v_exp_f32 v47, v47
    v_cvt_pk_bf16_f32 v102, v44, v45
    v_cvt_pk_bf16_f32 v103, v46, v47
    v_mfma_f32_32x32x4_2b_bf16 v[64:95], v[162:163], v[12:13], v[64:95]
    v_exp_f32 v48, v48
    v_exp_f32 v49, v49
    v_exp_f32 v50, v50
    v_exp_f32 v51, v51
    v_cvt_pk_bf16_f32 v104, v48, v49
    v_cvt_pk_bf16_f32 v105, v50, v51
    v_exp_f32 v52, v52
    v_exp_f32 v53, v53
    v_exp_f32 v54, v54
    v_mfma_f32_32x32x16_bf16 v[112:127], v[168:171], v[100:103], v[112:127]
    v_exp_f32 v55, v55
    v_cvt_pk_bf16_f32 v106, v52, v53
    v_cvt_pk_bf16_f32 v107, v54, v55
    v_exp_f32 v56, v56
    v_exp_f32 v57, v57
    v_mfma_f32_32x32x16_bf16 v[112:127], v[172:175], v[104:107], v[112:127]
    v_exp_f32 v58, v58
    v_exp_f32 v59, v59
    v_cvt_pk_bf16_f32 v108, v56, v57
    v_cvt_pk_bf16_f32 v109, v58, v59
    v_exp_f32 v60, v60
    v_exp_f32 v61, v61
    v_exp_f32 v62, v62
    v_exp_f32 v63, v63
    v_cvt_pk_bf16_f32 v110, v60, v61
    v_cvt_pk_bf16_f32 v111, v62, v63
    s_waitcnt vmcnt(0)
    s_waitcnt lgkmcnt(0)
    v_mfma_f32_32x32x16_bf16 v[32:47], v[144:147], v[8:11], 0
    ds_read_b128 v[152:155], v15 offset:47360
    ds_read_b128 v[156:159], v15 offset:48384
    v_exp_f32 v64, v64
    v_exp_f32 v65, v65
    v_exp_f32 v66, v66
    v_exp_f32 v67, v67
    v_cvt_pk_bf16_f32 v96, v64, v65
    v_cvt_pk_bf16_f32 v97, v66, v67
    v_mfma_f32_32x32x16_bf16 v[112:127], v[176:179], v[108:111], v[112:127]
    ds_read_b32 v162, v18 offset:49408
    ds_read_b128 v[164:167], v21 offset:44928
    v_exp_f32 v68, v68
    v_exp_f32 v69, v69
    v_exp_f32 v70, v70
    v_exp_f32 v71, v71
    v_cvt_pk_bf16_f32 v98, v68, v69
    v_cvt_pk_bf16_f32 v99, v70, v71
    v_mfma_f32_32x32x16_bf16 v[48:63], v[148:151], v[8:11], 0
    ds_read_b128 v[168:171], v21 offset:45536
    ds_read_b128 v[172:175], v21 offset:46144
    v_exp_f32 v72, v72
    v_exp_f32 v73, v73
    v_exp_f32 v74, v74
    v_exp_f32 v75, v75
    v_cvt_pk_bf16_f32 v100, v72, v73
    v_cvt_pk_bf16_f32 v101, v74, v75
    v_mfma_f32_32x32x16_bf16 v[112:127], v[180:183], v[96:99], v[112:127]
    ds_read_b128 v[176:179], v21 offset:46752
    v_exp_f32 v76, v76
    v_exp_f32 v77, v77
    v_exp_f32 v78, v78
    v_exp_f32 v79, v79
    v_cvt_pk_bf16_f32 v102, v76, v77
    v_cvt_pk_bf16_f32 v103, v78, v79
    v_mfma_f32_32x32x4_2b_bf16 v[32:63], v[160:161], v[12:13], v[32:63]
    v_perm_b32 v196, v210, v208, s80
    v_perm_b32 v197, v214, v212, s80
    v_perm_b32 v198, v218, v216, s80
    v_perm_b32 v199, v222, v220, s80
    buffer_store_dwordx4 v[196:199], v240, s[60:63], s82 offen sc1
    v_exp_f32 v80, v80
    v_exp_f32 v81, v81
    v_exp_f32 v82, v82
    v_exp_f32 v83, v83
    v_cvt_pk_bf16_f32 v104, v80, v81
    v_cvt_pk_bf16_f32 v105, v82, v83
    v_exp_f32 v84, v84
    v_exp_f32 v85, v85
    v_exp_f32 v86, v86
    v_mfma_f32_32x32x16_bf16 v[112:127], v[184:187], v[100:103], v[112:127]
    v_perm_b32 v200, v210, v208, s81
    v_perm_b32 v201, v214, v212, s81
    v_perm_b32 v202, v218, v216, s81
    v_perm_b32 v203, v222, v220, s81
    buffer_store_dwordx4 v[200:203], v240, s[60:63], s83 offen sc1
    v_exp_f32 v87, v87
    v_cvt_pk_bf16_f32 v106, v84, v85
    v_cvt_pk_bf16_f32 v107, v86, v87
    v_exp_f32 v88, v88
    v_exp_f32 v89, v89
    v_mfma_f32_32x32x16_bf16 v[112:127], v[188:191], v[104:107], v[112:127]
    v_exp_f32 v90, v90
    v_exp_f32 v91, v91
    v_cvt_pk_bf16_f32 v108, v88, v89
    v_cvt_pk_bf16_f32 v109, v90, v91
    v_exp_f32 v92, v92
    v_exp_f32 v93, v93
    v_exp_f32 v94, v94
    v_exp_f32 v95, v95
    v_cvt_pk_bf16_f32 v110, v92, v93
    v_cvt_pk_bf16_f32 v111, v94, v95
    s_waitcnt lgkmcnt(0)
    v_mfma_f32_32x32x16_bf16 v[64:79], v[152:155], v[8:11], 0
    ds_read_b128 v[144:147], v15 offset:52096
    ds_read_b128 v[148:151], v15 offset:53120
    v_exp_f32 v32, v32
    v_exp_f32 v33, v33
    v_exp_f32 v34, v34
    v_exp_f32 v35, v35
    v_cvt_pk_bf16_f32 v96, v32, v33
    v_cvt_pk_bf16_f32 v97, v34, v35
    v_mfma_f32_32x32x16_bf16 v[112:127], v[192:195], v[108:111], v[112:127]
    ds_read_b32 v160, v18 offset:54144
    ds_read_b128 v[180:183], v21 offset:49664
    v_exp_f32 v36, v36
    v_exp_f32 v37, v37
    v_exp_f32 v38, v38
    v_exp_f32 v39, v39
    v_cvt_pk_bf16_f32 v98, v36, v37
    v_cvt_pk_bf16_f32 v99, v38, v39
    v_mfma_f32_32x32x16_bf16 v[80:95], v[156:159], v[8:11], 0
    ds_read_b128 v[184:187], v21 offset:50272
    ds_read_b128 v[188:191], v21 offset:50880
    v_exp_f32 v40, v40
    v_exp_f32 v41, v41
    v_exp_f32 v42, v42
    v_exp_f32 v43, v43
    v_cvt_pk_bf16_f32 v100, v40, v41
    v_cvt_pk_bf16_f32 v101, v42, v43
    v_mfma_f32_32x32x16_bf16 v[112:127], v[164:167], v[96:99], v[112:127]
    ds_read_b128 v[192:195], v21 offset:51488
    v_exp_f32 v44, v44
    v_exp_f32 v45, v45
    v_exp_f32 v46, v46
    v_exp_f32 v47, v47
    v_cvt_pk_bf16_f32 v102, v44, v45
    v_cvt_pk_bf16_f32 v103, v46, v47
    v_mfma_f32_32x32x4_2b_bf16 v[64:95], v[162:163], v[12:13], v[64:95]
    v_perm_b32 v196, v211, v209, s80
    v_perm_b32 v197, v215, v213, s80
    v_perm_b32 v198, v219, v217, s80
    v_perm_b32 v199, v223, v221, s80
    buffer_store_dwordx4 v[196:199], v240, s[60:63], s84 offen sc1
    v_exp_f32 v48, v48
    v_exp_f32 v49, v49
    v_exp_f32 v50, v50
    v_exp_f32 v51, v51
    v_cvt_pk_bf16_f32 v104, v48, v49
    v_cvt_pk_bf16_f32 v105, v50, v51
    v_exp_f32 v52, v52
    v_exp_f32 v53, v53
    v_exp_f32 v54, v54
    v_mfma_f32_32x32x16_bf16 v[112:127], v[168:171], v[100:103], v[112:127]
    v_perm_b32 v200, v211, v209, s81
    v_perm_b32 v201, v215, v213, s81
    v_perm_b32 v202, v219, v217, s81
    v_perm_b32 v203, v223, v221, s81
    buffer_store_dwordx4 v[200:203], v240, s[60:63], s85 offen sc1
    v_exp_f32 v55, v55
    v_cvt_pk_bf16_f32 v106, v52, v53
    v_cvt_pk_bf16_f32 v107, v54, v55
    v_exp_f32 v56, v56
    v_exp_f32 v57, v57
    v_mfma_f32_32x32x16_bf16 v[112:127], v[172:175], v[104:107], v[112:127]
    v_exp_f32 v58, v58
    v_exp_f32 v59, v59
    v_cvt_pk_bf16_f32 v108, v56, v57
    v_cvt_pk_bf16_f32 v109, v58, v59
    v_exp_f32 v60, v60
    v_exp_f32 v61, v61
    v_exp_f32 v62, v62
    v_exp_f32 v63, v63
    v_cvt_pk_bf16_f32 v110, v60, v61
    v_cvt_pk_bf16_f32 v111, v62, v63
    s_cmp_lt_u32 s3, 4
    s_cbranch_scc1 L_pr_34
    s_setprio 0
L_pr_34:
    s_waitcnt lgkmcnt(0)
    v_mfma_f32_32x32x16_bf16 v[32:47], v[144:147], v[8:11], 0
    ds_read_b128 v[152:155], v15 offset:56832
    ds_read_b128 v[156:159], v15 offset:57856
    v_exp_f32 v64, v64
    v_exp_f32 v65, v65
    v_exp_f32 v66, v66
    v_exp_f32 v67, v67
    v_cvt_pk_bf16_f32 v96, v64, v65
    v_cvt_pk_bf16_f32 v97, v66, v67
    v_mfma_f32_32x32x16_bf16 v[112:127], v[176:179], v[108:111], v[112:127]
    ds_read_b32 v162, v18 offset:58880
    ds_read_b128 v[164:167], v21 offset:54400
    v_exp_f32 v68, v68
    v_exp_f32 v69, v69
    v_exp_f32 v70, v70
    v_exp_f32 v71, v71
    v_cvt_pk_bf16_f32 v98, v68, v69
    v_cvt_pk_bf16_f32 v99, v70, v71
    v_mfma_f32_32x32x16_bf16 v[48:63], v[148:151], v[8:11], 0
    ds_read_b128 v[168:171], v21 offset:55008
    ds_read_b128 v[172:175], v21 offset:55616
    v_exp_f32 v72, v72
    v_exp_f32 v73, v73
    v_exp_f32 v74, v74
    v_exp_f32 v75, v75
    v_cvt_pk_bf16_f32 v100, v72, v73
    v_cvt_pk_bf16_f32 v101, v74, v75
    v_mfma_f32_32x32x16_bf16 v[112:127], v[180:183], v[96:99], v[112:127]
    ds_read_b128 v[176:179], v21 offset:56224
    v_exp_f32 v76, v76
    v_exp_f32 v77, v77
    v_exp_f32 v78, v78
    v_exp_f32 v79, v79
    v_cvt_pk_bf16_f32 v102, v76, v77
    v_cvt_pk_bf16_f32 v103, v78, v79
    v_mfma_f32_32x32x4_2b_bf16 v[32:63], v[160:161], v[12:13], v[32:63]
    s_cmp_lt_u32 s3, 5
    s_cbranch_scc1 L_w3_17
    v_perm_b32 v196, v226, v224, s80
    v_perm_b32 v197, v230, v228, s80
    v_perm_b32 v198, v234, v232, s80
    v_perm_b32 v199, v238, v236, s80
    buffer_store_dwordx4 v[196:199], v241, s[60:63], s86 offen sc1
L_w3_17:
    v_exp_f32 v80, v80
    v_exp_f32 v81, v81
    v_exp_f32 v82, v82
    v_exp_f32 v83, v83
    v_cvt_pk_bf16_f32 v104, v80, v81
    v_cvt_pk_bf16_f32 v105, v82, v83
    v_exp_f32 v84, v84
    v_exp_f32 v85, v85
    v_exp_f32 v86, v86
    v_mfma_f32_32x32x16_bf16 v[112:127], v[184:187], v[100:103], v[112:127]
    s_cmp_lt_u32 s3, 5
    s_cbranch_scc1 L_w3_18
    v_perm_b32 v200, v226, v224, s81
    v_perm_b32 v201, v230, v228, s81
    v_perm_b32 v202, v234, v232, s81
    v_perm_b32 v203, v238, v236, s81
    buffer_store_dwordx4 v[200:203], v241, s[60:63], s87 offen sc1
L_w3_18:
    v_exp_f32 v87, v87
    v_cvt_pk_bf16_f32 v106, v84, v85
    v_cvt_pk_bf16_f32 v107, v86, v87
    v_exp_f32 v88, v88
    v_exp_f32 v89, v89
    v_mfma_f32_32x32x16_bf16 v[112:127], v[188:191], v[104:107], v[112:127]
    v_exp_f32 v90, v90
    v_exp_f32 v91, v91
    v_cvt_pk_bf16_f32 v108, v88, v89
    v_cvt_pk_bf16_f32 v109, v90, v91
    v_exp_f32 v92, v92
    v_exp_f32 v93, v93
    v_exp_f32 v94, v94
    v_exp_f32 v95, v95
    v_cvt_pk_bf16_f32 v110, v92, v93
    v_cvt_pk_bf16_f32 v111, v94, v95
    s_lshr_b32 s77, s2, 5
    s_add_u32 s20, s14, 9777152
    s_addc_u32 s21, s15, 0
    s_mov_b32 s22, 663552
    s_mov_b32 s23, 0x00020000
    s_lshl_b32 s32, s3, 10
    s_mul_i32 s33, s77, 110592
    s_add_u32 s33, s33, s32
    s_waitcnt lgkmcnt(0)
    s_barrier
    s_cmp_lt_u32 s3, 4
    s_cbranch_scc1 L_pr_35
    s_setprio 2
L_pr_35:
    s_waitcnt lgkmcnt(0)
    v_mfma_f32_32x32x16_bf16 v[64:79], v[152:155], v[8:11], 0
    ds_read_b128 v[144:147], v16 offset:0
    ds_read_b128 v[148:151], v16 offset:1024
    v_exp_f32 v32, v32
    v_exp_f32 v33, v33
    v_exp_f32 v34, v34
    v_exp_f32 v35, v35
    v_cvt_pk_bf16_f32 v96, v32, v33
    v_cvt_pk_bf16_f32 v97, v34, v35
    v_mfma_f32_32x32x16_bf16 v[112:127], v[192:195], v[108:111], v[112:127]
    ds_read_b32 v160, v19 offset:2048
    ds_read_b128 v[180:183], v21 offset:59136
    v_exp_f32 v36, v36
    v_exp_f32 v37, v37
    v_exp_f32 v38, v38
    v_exp_f32 v39, v39
    v_cvt_pk_bf16_f32 v98, v36, v37
    v_cvt_pk_bf16_f32 v99, v38, v39
    v_mfma_f32_32x32x16_bf16 v[80:95], v[156:159], v[8:11], 0
    ds_read_b128 v[184:187], v21 offset:59744
    ds_read_b128 v[188:191], v21 offset:60352
    v_exp_f32 v40, v40
    v_exp_f32 v41, v41
    v_exp_f32 v42, v42
    v_exp_f32 v43, v43
    v_cvt_pk_bf16_f32 v100, v40, v41
    v_cvt_pk_bf16_f32 v101, v42, v43
    v_mfma_f32_32x32x16_bf16 v[112:127], v[164:167], v[96:99], v[112:127]
    ds_read_b128 v[192:195], v21 offset:60960
    v_exp_f32 v44, v44
    v_exp_f32 v45, v45
    v_exp_f32 v46, v46
    v_exp_f32 v47, v47
    v_cvt_pk_bf16_f32 v102, v44, v45
    v_cvt_pk_bf16_f32 v103, v46, v47
    v_mfma_f32_32x32x4_2b_bf16 v[64:95], v[162:163], v[12:13], v[64:95]
    s_cmp_lt_u32 s3, 5
    s_cbranch_scc1 L_w3_19
    v_perm_b32 v196, v227, v225, s80
    v_perm_b32 v197, v231, v229, s80
    v_perm_b32 v198, v235, v233, s80
    v_perm_b32 v199, v239, v237, s80
    buffer_store_dwordx4 v[196:199], v241, s[60:63], s88 offen sc1
L_w3_19:
    v_exp_f32 v48, v48
    v_exp_f32 v49, v49
    v_exp_f32 v50, v50
    v_exp_f32 v51, v51
    v_cvt_pk_bf16_f32 v104, v48, v49
    v_cvt_pk_bf16_f32 v105, v50, v51
    v_exp_f32 v52, v52
    v_exp_f32 v53, v53
    v_exp_f32 v54, v54
    v_mfma_f32_32x32x16_bf16 v[112:127], v[168:171], v[100:103], v[112:127]
    s_cmp_lt_u32 s3, 5
    s_cbranch_scc1 L_w3_20
    v_perm_b32 v200, v227, v225, s81
    v_perm_b32 v201, v231, v229, s81
    v_perm_b32 v202, v235, v233, s81
    v_perm_b32 v203, v239, v237, s81
    buffer_store_dwordx4 v[200:203], v241, s[60:63], s89 offen sc1
L_w3_20:
    v_exp_f32 v55, v55
    v_cvt_pk_bf16_f32 v106, v52, v53
    v_cvt_pk_bf16_f32 v107, v54, v55
    v_exp_f32 v56, v56
    v_exp_f32 v57, v57
    v_mfma_f32_32x32x16_bf16 v[112:127], v[172:175], v[104:107], v[112:127]
    v_exp_f32 v58, v58
    v_exp_f32 v59, v59
    v_cvt_pk_bf16_f32 v108, v56, v57
    v_cvt_pk_bf16_f32 v109, v58, v59
    v_exp_f32 v60, v60
    v_exp_f32 v61, v61
    v_exp_f32 v62, v62
    v_exp_f32 v63, v63
    v_cvt_pk_bf16_f32 v110, v60, v61
    v_cvt_pk_bf16_f32 v111, v62, v63
    s_waitcnt lgkmcnt(0)
    v_mfma_f32_32x32x16_bf16 v[32:47], v[144:147], v[8:11], 0
    ds_read_b128 v[152:155], v16 offset:4736
    ds_read_b128 v[156:159], v16 offset:5760
    v_exp_f32 v64, v64
    v_exp_f32 v65, v65
    v_exp_f32 v66, v66
    v_exp_f32 v67, v67
    v_cvt_pk_bf16_f32 v96, v64, v65
    v_cvt_pk_bf16_f32 v97, v66, v67
    v_mfma_f32_32x32x16_bf16 v[112:127], v[176:179], v[108:111], v[112:127]
    ds_read_b32 v162, v19 offset:6784
    ds_read_b128 v[164:167], v22 offset:2304
    v_exp_f32 v68, v68
    v_exp_f32 v69, v69
    v_exp_f32 v70, v70
    v_exp_f32 v71, v71
    v_cvt_pk_bf16_f32 v98, v68, v69
    v_cvt_pk_bf16_f32 v99, v70, v71
    v_mfma_f32_32x32x16_bf16 v[48:63], v[148:151], v[8:11], 0
    ds_read_b128 v[168:171], v22 offset:2912
    ds_read_b128 v[172:175], v22 offset:3520
    v_exp_f32 v72, v72
    v_exp_f32 v73, v73
    v_exp_f32 v74, v74
    v_exp_f32 v75, v75
    v_cvt_pk_bf16_f32 v100, v72, v73
    v_cvt_pk_bf16_f32 v101, v74, v75
    v_mfma_f32_32x32x16_bf16 v[112:127], v[180:183], v[96:99], v[112:127]
    ds_read_b128 v[176:179], v22 offset:4128
    v_exp_f32 v76, v76
    v_exp_f32 v77, v77
    v_exp_f32 v78, v78
    v_exp_f32 v79, v79
    v_cvt_pk_bf16_f32 v102, v76, v77
    v_cvt_pk_bf16_f32 v103, v78, v79
    v_mfma_f32_32x32x4_2b_bf16 v[32:63], v[160:161], v[12:13], v[32:63]
    s_mov_b32 m0, s32
    s_add_u32 s32, s32, 8192
    buffer_load_dwordx4 v3, s[20:23], s33 offen sc1 lds
    s_add_u32 s33, s33, 8192
    v_exp_f32 v80, v80
    v_exp_f32 v81, v81
    v_exp_f32 v82, v82
    v_exp_f32 v83, v83
    v_cvt_pk_bf16_f32 v104, v80, v81
    v_cvt_pk_bf16_f32 v105, v82, v83
    v_exp_f32 v84, v84
    v_exp_f32 v85, v85
    v_exp_f32 v86, v86
    v_mfma_f32_32x32x16_bf16 v[112:127], v[184:187], v[100:103], v[112:127]
    s_mov_b32 m0, s32
    s_add_u32 s32, s32, 8192
    buffer_load_dwordx4 v3, s[20:23], s33 offen sc1 lds
    s_add_u32 s33, s33, 8192
    v_exp_f32 v87, v87
    v_cvt_pk_bf16_f32 v106, v84, v85
    v_cvt_pk_bf16_f32 v107, v86, v87
    v_exp_f32 v88, v88
    v_exp_f32 v89, v89
    v_mfma_f32_32x32x16_bf16 v[112:127], v[188:191], v[104:107], v[112:127]
    v_exp_f32 v90, v90
    v_exp_f32 v91, v91
    v_cvt_pk_bf16_f32 v108, v88, v89
    v_cvt_pk_bf16_f32 v109, v90, v91
    v_exp_f32 v92, v92
    v_exp_f32 v93, v93
    v_exp_f32 v94, v94
    v_exp_f32 v95, v95
    v_cvt_pk_bf16_f32 v110, v92, v93
    v_cvt_pk_bf16_f32 v111, v94, v95
    s_waitcnt lgkmcnt(0)
    v_mfma_f32_32x32x16_bf16 v[64:79], v[152:155], v[8:11], 0
    ds_read_b128 v[144:147], v16 offset:9472
    ds_read_b128 v[148:151], v16 offset:10496
    v_exp_f32 v32, v32
    v_exp_f32 v33, v33
    v_exp_f32 v34, v34
    v_exp_f32 v35, v35
    v_cvt_pk_bf16_f32 v96, v32, v33
    v_cvt_pk_bf16_f32 v97, v34, v35
    v_mfma_f32_32x32x16_bf16 v[112:127], v[192:195], v[108:111], v[112:127]
    ds_read_b32 v160, v19 offset:11520
    ds_read_b128 v[180:183], v22 offset:7040
    v_exp_f32 v36, v36
    v_exp_f32 v37, v37
    v_exp_f32 v38, v38
    v_exp_f32 v39, v39
    v_cvt_pk_bf16_f32 v98, v36, v37
    v_cvt_pk_bf16_f32 v99, v38, v39
    v_mfma_f32_32x32x16_bf16 v[80:95], v[156:159], v[8:11], 0
    ds_read_b128 v[184:187], v22 offset:7648
    ds_read_b128 v[188:191], v22 offset:8256
    v_exp_f32 v40, v40
    v_exp_f32 v41, v41
    v_exp_f32 v42, v42
    v_exp_f32 v43, v43
    v_cvt_pk_bf16_f32 v100, v40, v41
    v_cvt_pk_bf16_f32 v101, v42, v43
    v_mfma_f32_32x32x16_bf16 v[112:127], v[164:167], v[96:99], v[112:127]
    ds_read_b128 v[192:195], v22 offset:8864
    v_exp_f32 v44, v44
    v_exp_f32 v45, v45
    v_exp_f32 v46, v46
    v_exp_f32 v47, v47
    v_cvt_pk_bf16_f32 v102, v44, v45
    v_cvt_pk_bf16_f32 v103, v46, v47
    v_mfma_f32_32x32x4_2b_bf16 v[64:95], v[162:163], v[12:13], v[64:95]
    s_mov_b32 m0, s32
    s_add_u32 s32, s32, 8192
    buffer_load_dwordx4 v3, s[20:23], s33 offen sc1 lds
    s_add_u32 s33, s33, 8192
    v_exp_f32 v48, v48
    v_exp_f32 v49, v49
    v_exp_f32 v50, v50
    v_exp_f32 v51, v51
    v_cvt_pk_bf16_f32 v104, v48, v49
    v_cvt_pk_bf16_f32 v105, v50, v51
    v_exp_f32 v52, v52
    v_exp_f32 v53, v53
    v_exp_f32 v54, v54
    v_mfma_f32_32x32x16_bf16 v[112:127], v[168:171], v[100:103], v[112:127]
    s_mov_b32 m0, s32
    s_add_u32 s32, s32, 8192
    buffer_load_dwordx4 v3, s[20:23], s33 offen sc1 lds
    s_add_u32 s33, s33, 8192
    v_exp_f32 v55, v55
    v_cvt_pk_bf16_f32 v106, v52, v53
    v_cvt_pk_bf16_f32 v107, v54, v55
    v_exp_f32 v56, v56
    v_exp_f32 v57, v57
    v_mfma_f32_32x32x16_bf16 v[112:127], v[172:175], v[104:107], v[112:127]
    v_exp_f32 v58, v58
    v_exp_f32 v59, v59
    v_cvt_pk_bf16_f32 v108, v56, v57
    v_cvt_pk_bf16_f32 v109, v58, v59
    v_exp_f32 v60, v60
    v_exp_f32 v61, v61
    v_exp_f32 v62, v62
    v_exp_f32 v63, v63
    v_cvt_pk_bf16_f32 v110, v60, v61
    v_cvt_pk_bf16_f32 v111, v62, v63
    s_cmp_lt_u32 s3, 4
    s_cbranch_scc1 L_pr_36
    s_setprio 0
L_pr_36:
    s_waitcnt lgkmcnt(0)
    v_mfma_f32_32x32x16_bf16 v[32:47], v[144:147], v[8:11], 0
    ds_read_b128 v[152:155], v16 offset:14208
    ds_read_b128 v[156:159], v16 offset:15232
    v_exp_f32 v64, v64
    v_exp_f32 v65, v65
    v_exp_f32 v66, v66
    v_exp_f32 v67, v67
    v_cvt_pk_bf16_f32 v96, v64, v65
    v_cvt_pk_bf16_f32 v97, v66, v67
    v_mfma_f32_32x32x16_bf16 v[112:127], v[176:179], v[108:111], v[112:127]
    ds_read_b32 v162, v19 offset:16256
    ds_read_b128 v[164:167], v22 offset:11776
    v_exp_f32 v68, v68
    v_exp_f32 v69, v69
    v_exp_f32 v70, v70
    v_exp_f32 v71, v71
    v_cvt_pk_bf16_f32 v98, v68, v69
    v_cvt_pk_bf16_f32 v99, v70, v71
    v_mfma_f32_32x32x16_bf16 v[48:63], v[148:151], v[8:11], 0
    ds_read_b128 v[168:171], v22 offset:12384
    ds_read_b128 v[172:175], v22 offset:12992
    v_exp_f32 v72, v72
    v_exp_f32 v73, v73
    v_exp_f32 v74, v74
    v_exp_f32 v75, v75
    v_cvt_pk_bf16_f32 v100, v72, v73
    v_cvt_pk_bf16_f32 v101, v74, v75
    v_mfma_f32_32x32x16_bf16 v[112:127], v[180:183], v[96:99], v[112:127]
    ds_read_b128 v[176:179], v22 offset:13600
    v_exp_f32 v76, v76
    v_exp_f32 v77, v77
    v_exp_f32 v78, v78
    v_exp_f32 v79, v79
    v_cvt_pk_bf16_f32 v102, v76, v77
    v_cvt_pk_bf16_f32 v103, v78, v79
    v_mfma_f32_32x32x4_2b_bf16 v[32:63], v[160:161], v[12:13], v[32:63]
    s_mov_b32 m0, s32
    s_add_u32 s32, s32, 8192
    buffer_load_dwordx4 v3, s[20:23], s33 offen sc1 lds
    s_add_u32 s33, s33, 8192
    v_exp_f32 v80, v80
    v_exp_f32 v81, v81
    v_exp_f32 v82, v82
    v_exp_f32 v83, v83
    v_cvt_pk_bf16_f32 v104, v80, v81
    v_cvt_pk_bf16_f32 v105, v82, v83
    v_exp_f32 v84, v84
    v_exp_f32 v85, v85
    v_exp_f32 v86, v86
    v_mfma_f32_32x32x16_bf16 v[112:127], v[184:187], v[100:103], v[112:127]
    s_mov_b32 m0, s32
    s_add_u32 s32, s32, 8192
    buffer_load_dwordx4 v3, s[20:23], s33 offen sc1 lds
    s_add_u32 s33, s33, 8192
    v_exp_f32 v87, v87
    v_cvt_pk_bf16_f32 v106, v84, v85
    v_cvt_pk_bf16_f32 v107, v86, v87
    v_exp_f32 v88, v88
    v_exp_f32 v89, v89
    v_mfma_f32_32x32x16_bf16 v[112:127], v[188:191], v[104:107], v[112:127]
    v_exp_f32 v90, v90
    v_exp_f32 v91, v91
    v_cvt_pk_bf16_f32 v108, v88, v89
    v_cvt_pk_bf16_f32 v109, v90, v91
    v_exp_f32 v92, v92
    v_exp_f32 v93, v93
    v_exp_f32 v94, v94
    v_exp_f32 v95, v95
    v_cvt_pk_bf16_f32 v110, v92, v93
    v_cvt_pk_bf16_f32 v111, v94, v95
    s_waitcnt vmcnt(0)
    s_cmp_lt_u32 s3, 4
    s_cbranch_scc1 L_pr_37
    s_setprio 2
L_pr_37:
    s_waitcnt lgkmcnt(0)
    v_mfma_f32_32x32x16_bf16 v[64:79], v[152:155], v[8:11], 0
    ds_read_b128 v[144:147], v16 offset:18944
    ds_read_b128 v[148:151], v16 offset:19968
    v_exp_f32 v32, v32
    v_exp_f32 v33, v33
    v_exp_f32 v34, v34
    v_exp_f32 v35, v35
    v_cvt_pk_bf16_f32 v96, v32, v33
    v_cvt_pk_bf16_f32 v97, v34, v35
    v_mfma_f32_32x32x16_bf16 v[112:127], v[192:195], v[108:111], v[112:127]
    ds_read_b32 v160, v19 offset:20992
    ds_read_b128 v[180:183], v22 offset:16512
    v_exp_f32 v36, v36
    v_exp_f32 v37, v37
    v_exp_f32 v38, v38
    v_exp_f32 v39, v39
    v_cvt_pk_bf16_f32 v98, v36, v37
    v_cvt_pk_bf16_f32 v99, v38, v39
    v_mfma_f32_32x32x16_bf16 v[80:95], v[156:159], v[8:11], 0
    ds_read_b128 v[184:187], v22 offset:17120
    ds_read_b128 v[188:191], v22 offset:17728
    v_exp_f32 v40, v40
    v_exp_f32 v41, v41
    v_exp_f32 v42, v42
    v_exp_f32 v43, v43
    v_cvt_pk_bf16_f32 v100, v40, v41
    v_cvt_pk_bf16_f32 v101, v42, v43
    v_mfma_f32_32x32x16_bf16 v[112:127], v[164:167], v[96:99], v[112:127]
    ds_read_b128 v[192:195], v22 offset:18336
    v_exp_f32 v44, v44
    v_exp_f32 v45, v45
    v_exp_f32 v46, v46
    v_exp_f32 v47, v47
    v_cvt_pk_bf16_f32 v102, v44, v45
    v_cvt_pk_bf16_f32 v103, v46, v47
    v_mfma_f32_32x32x4_2b_bf16 v[64:95], v[162:163], v[12:13], v[64:95]
    v_mov_b32 v206, 151552
    v_mov_b32 v207, 1
    s_mov_b64 exec, 1
    ds_add_rtn_u32 v205, v206, v207 offset:44
    s_mov_b64 exec, -1
    v_exp_f32 v48, v48
    v_exp_f32 v49, v49
    v_exp_f32 v50, v50
    v_exp_f32 v51, v51
    v_cvt_pk_bf16_f32 v104, v48, v49
    v_cvt_pk_bf16_f32 v105, v50, v51
    v_exp_f32 v52, v52
    v_exp_f32 v53, v53
    v_exp_f32 v54, v54
    v_mfma_f32_32x32x16_bf16 v[112:127], v[168:171], v[100:103], v[112:127]
    s_mov_b32 m0, s32
    s_add_u32 s32, s32, 8192
    buffer_load_dwordx4 v3, s[20:23], s33 offen sc1 lds
    s_add_u32 s33, s33, 8192
    v_exp_f32 v55, v55
    v_cvt_pk_bf16_f32 v106, v52, v53
    v_cvt_pk_bf16_f32 v107, v54, v55
    v_exp_f32 v56, v56
    v_exp_f32 v57, v57
    v_mfma_f32_32x32x16_bf16 v[112:127], v[172:175], v[104:107], v[112:127]
    v_exp_f32 v58, v58
    v_exp_f32 v59, v59
    v_cvt_pk_bf16_f32 v108, v56, v57
    v_cvt_pk_bf16_f32 v109, v58, v59
    v_exp_f32 v60, v60
    v_exp_f32 v61, v61
    v_exp_f32 v62, v62
    v_exp_f32 v63, v63
    v_cvt_pk_bf16_f32 v110, v60, v61
    v_cvt_pk_bf16_f32 v111, v62, v63
    s_waitcnt lgkmcnt(0)
    v_mfma_f32_32x32x16_bf16 v[32:47], v[144:147], v[8:11], 0
    ds_read_b128 v[152:155], v16 offset:23680
    ds_read_b128 v[156:159], v16 offset:24704
    v_exp_f32 v64, v64
    v_exp_f32 v65, v65
    v_exp_f32 v66, v66
    v_exp_f32 v67, v67
    v_cvt_pk_bf16_f32 v96, v64, v65
    v_cvt_pk_bf16_f32 v97, v66, v67
    v_mfma_f32_32x32x16_bf16 v[112:127], v[176:179], v[108:111], v[112:127]
    ds_read_b32 v162, v19 offset:25728
    ds_read_b128 v[164:167], v22 offset:21248
    v_exp_f32 v68, v68
    v_exp_f32 v69, v69
    v_exp_f32 v70, v70
    v_exp_f32 v71, v71
    v_cvt_pk_bf16_f32 v98, v68, v69
    v_cvt_pk_bf16_f32 v99, v70, v71
    v_mfma_f32_32x32x16_bf16 v[48:63], v[148:151], v[8:11], 0
    ds_read_b128 v[168:171], v22 offset:21856
    ds_read_b128 v[172:175], v22 offset:22464
    v_exp_f32 v72, v72
    v_exp_f32 v73, v73
    v_exp_f32 v74, v74
    v_exp_f32 v75, v75
    v_cvt_pk_bf16_f32 v100, v72, v73
    v_cvt_pk_bf16_f32 v101, v74, v75
    v_mfma_f32_32x32x16_bf16 v[112:127], v[180:183], v[96:99], v[112:127]
    ds_read_b128 v[176:179], v22 offset:23072
    v_exp_f32 v76, v76
    v_exp_f32 v77, v77
    v_exp_f32 v78, v78
    v_exp_f32 v79, v79
    v_cvt_pk_bf16_f32 v102, v76, v77
    v_cvt_pk_bf16_f32 v103, v78, v79
    v_mfma_f32_32x32x4_2b_bf16 v[32:63], v[160:161], v[12:13], v[32:63]
    v_readfirstlane_b32 s45, v205
    s_cmp_lg_u32 s45, 7
    s_cbranch_scc1 K2_nrf
    s_lshl_b32 s45, s34, 5
    s_add_u32 s45, s45, s35
    s_lshl_b32 s45, s45, 7
    s_add_u32 s45, s45, 458752
    v_mov_b32 v206, s101
    v_lshlrev_b32 v207, 2, v0
    s_mov_b32 exec_lo, -1
    s_mov_b32 exec_hi, 0
    buffer_store_dword v206, v207, s[36:39], s45 offen sc1
    s_mov_b64 exec, -1
K2_nrf:
    v_exp_f32 v80, v80
    v_exp_f32 v81, v81
    v_exp_f32 v82, v82
    v_exp_f32 v83, v83
    v_cvt_pk_bf16_f32 v104, v80, v81
    v_cvt_pk_bf16_f32 v105, v82, v83
    v_exp_f32 v84, v84
    v_exp_f32 v85, v85
    v_exp_f32 v86, v86
    v_mfma_f32_32x32x16_bf16 v[112:127], v[184:187], v[100:103], v[112:127]
    s_mov_b32 m0, s32
    s_add_u32 s32, s32, 8192
    buffer_load_dwordx4 v3, s[20:23], s33 offen sc1 lds
    s_add_u32 s33, s33, 8192
    v_exp_f32 v87, v87
    v_cvt_pk_bf16_f32 v106, v84, v85
    v_cvt_pk_bf16_f32 v107, v86, v87
    v_exp_f32 v88, v88
    v_exp_f32 v89, v89
    v_mfma_f32_32x32x16_bf16 v[112:127], v[188:191], v[104:107], v[112:127]
    v_exp_f32 v90, v90
    v_exp_f32 v91, v91
    v_cvt_pk_bf16_f32 v108, v88, v89
    v_cvt_pk_bf16_f32 v109, v90, v91
    v_exp_f32 v92, v92
    v_exp_f32 v93, v93
    v_exp_f32 v94, v94
    v_exp_f32 v95, v95
    v_cvt_pk_bf16_f32 v110, v92, v93
    v_cvt_pk_bf16_f32 v111, v94, v95
    s_waitcnt lgkmcnt(0)
    v_mfma_f32_32x32x16_bf16 v[64:79], v[152:155], v[8:11], 0
    v_exp_f32 v32, v32
    v_exp_f32 v33, v33
    v_exp_f32 v34, v34
    v_exp_f32 v35, v35
    v_cvt_pk_bf16_f32 v96, v32, v33
    v_cvt_pk_bf16_f32 v97, v34, v35
    v_mfma_f32_32x32x16_bf16 v[112:127], v[192:195], v[108:111], v[112:127]
    ds_read_b128 v[180:183], v22 offset:25984
    v_exp_f32 v36, v36
    v_exp_f32 v37, v37
    v_exp_f32 v38, v38
    v_exp_f32 v39, v39
    v_cvt_pk_bf16_f32 v98, v36, v37
    v_cvt_pk_bf16_f32 v99, v38, v39
    v_mfma_f32_32x32x16_bf16 v[80:95], v[156:159], v[8:11], 0
    ds_read_b128 v[184:187], v22 offset:26592
    ds_read_b128 v[188:191], v22 offset:27200
    v_exp_f32 v40, v40
    v_exp_f32 v41, v41
    v_exp_f32 v42, v42
    v_exp_f32 v43, v43
    v_cvt_pk_bf16_f32 v100, v40, v41
    v_cvt_pk_bf16_f32 v101, v42, v43
    v_mfma_f32_32x32x16_bf16 v[112:127], v[164:167], v[96:99], v[112:127]
    ds_read_b128 v[192:195], v22 offset:27808
    v_exp_f32 v44, v44
    v_exp_f32 v45, v45
    v_exp_f32 v46, v46
    v_exp_f32 v47, v47
    v_cvt_pk_bf16_f32 v102, v44, v45
    v_cvt_pk_bf16_f32 v103, v46, v47
    v_mfma_f32_32x32x4_2b_bf16 v[64:95], v[162:163], v[12:13], v[64:95]
    s_mov_b32 m0, s32
    s_add_u32 s32, s32, 8192
    buffer_load_dwordx4 v3, s[20:23], s33 offen sc1 lds
    s_add_u32 s33, s33, 8192
    v_exp_f32 v48, v48
    v_exp_f32 v49, v49
    v_exp_f32 v50, v50
    v_exp_f32 v51, v51
    v_cvt_pk_bf16_f32 v104, v48, v49
    v_cvt_pk_bf16_f32 v105, v50, v51
    v_exp_f32 v52, v52
    v_exp_f32 v53, v53
    v_exp_f32 v54, v54
    v_mfma_f32_32x32x16_bf16 v[112:127], v[168:171], v[100:103], v[112:127]
    v_exp_f32 v55, v55
    v_cvt_pk_bf16_f32 v106, v52, v53
    v_cvt_pk_bf16_f32 v107, v54, v55
    v_exp_f32 v56, v56
    v_exp_f32 v57, v57
    v_mfma_f32_32x32x16_bf16 v[112:127], v[172:175], v[104:107], v[112:127]
    v_exp_f32 v58, v58
    v_exp_f32 v59, v59
    v_cvt_pk_bf16_f32 v108, v56, v57
    v_cvt_pk_bf16_f32 v109, v58, v59
    v_exp_f32 v60, v60
    v_exp_f32 v61, v61
    v_exp_f32 v62, v62
    v_exp_f32 v63, v63
    v_cvt_pk_bf16_f32 v110, v60, v61
    v_cvt_pk_bf16_f32 v111, v62, v63
    s_cmp_lt_u32 s3, 4
    s_cbranch_scc1 L_pr_38
    s_setprio 0
L_pr_38:
    s_waitcnt lgkmcnt(0)
    v_exp_f32 v64, v64
    v_exp_f32 v65, v65
    v_exp_f32 v66, v66
    v_exp_f32 v67, v67
    v_cvt_pk_bf16_f32 v96, v64, v65
    v_cvt_pk_bf16_f32 v97, v66, v67
    v_mfma_f32_32x32x16_bf16 v[112:127], v[176:179], v[108:111], v[112:127]
    v_exp_f32 v68, v68
    v_exp_f32 v69, v69
    v_exp_f32 v70, v70
    v_exp_f32 v71, v71
    v_cvt_pk_bf16_f32 v98, v68, v69
    v_cvt_pk_bf16_f32 v99, v70, v71
    v_exp_f32 v72, v72
    v_exp_f32 v73, v73
    v_exp_f32 v74, v74
    v_exp_f32 v75, v75
    v_cvt_pk_bf16_f32 v100, v72, v73
    v_cvt_pk_bf16_f32 v101, v74, v75
    v_mfma_f32_32x32x16_bf16 v[112:127], v[180:183], v[96:99], v[112:127]
    v_exp_f32 v76, v76
    v_exp_f32 v77, v77
    v_exp_f32 v78, v78
    v_exp_f32 v79, v79
    v_cvt_pk_bf16_f32 v102, v76, v77
    v_cvt_pk_bf16_f32 v103, v78, v79
    s_mov_b32 m0, s32
    s_add_u32 s32, s32, 8192
    buffer_load_dwordx4 v3, s[20:23], s33 offen sc1 lds
    s_add_u32 s33, s33, 8192
    v_exp_f32 v80, v80
    v_exp_f32 v81, v81
    v_exp_f32 v82, v82
    v_exp_f32 v83, v83
    v_cvt_pk_bf16_f32 v104, v80, v81
    v_cvt_pk_bf16_f32 v105, v82, v83
    v_exp_f32 v84, v84
    v_exp_f32 v85, v85
    v_exp_f32 v86, v86
    v_mfma_f32_32x32x16_bf16 v[112:127], v[184:187], v[100:103], v[112:127]
    v_exp_f32 v87, v87
    v_cvt_pk_bf16_f32 v106, v84, v85
    v_cvt_pk_bf16_f32 v107, v86, v87
    v_exp_f32 v88, v88
    v_exp_f32 v89, v89
    v_mfma_f32_32x32x16_bf16 v[112:127], v[188:191], v[104:107], v[112:127]
    v_exp_f32 v90, v90
    v_exp_f32 v91, v91
    v_cvt_pk_bf16_f32 v108, v88, v89
    v_cvt_pk_bf16_f32 v109, v90, v91
    v_exp_f32 v92, v92
    v_exp_f32 v93, v93
    v_exp_f32 v94, v94
    v_exp_f32 v95, v95
    v_cvt_pk_bf16_f32 v110, v92, v93
    v_cvt_pk_bf16_f32 v111, v94, v95
    s_nop 1
    v_mfma_f32_32x32x16_bf16 v[112:127], v[192:195], v[108:111], v[112:127]
    s_setprio 0
    s_nop 15
    v_mov_b32 v25, v122
    v_mov_b32 v26, v122
    s_nop 1
    v_permlane32_swap_b32 v25, v26
    s_nop 1
    v_mov_b32 v26, 1568669696
    v_cmp_nle_f32 vcc, v25, v26
    v_mov_b32 v26, 562036736
    v_cmp_lt_f32 s[52:53], v25, v26
    s_nop 4
    s_or_b64 vcc, vcc, s[52:53]
    s_cbranch_scc0 K2_out
    v_mov_b32 v24, 0xff800000
    v_mov_b32 v13, 0
    s_mov_b32 s52, 0
    v_mov_b32 v27, v14
    v_mov_b32 v28, v17
    v_mov_b32 v29, v20
K2_fb0:
    buffer_load_dwordx4 v[144:147], v27, s[16:19], 0 offen sc1
    buffer_load_dwordx4 v[148:151], v27, s[16:19], 0 offen offset:1024 sc1
    buffer_load_dword v160, v28, s[16:19], 0 offen offset:2048 sc1
    s_waitcnt vmcnt(0)
    v_mfma_f32_32x32x16_bf16 v[32:47], v[144:147], v[8:11], 0
    v_mfma_f32_32x32x16_bf16 v[48:63], v[148:151], v[8:11], 0
    s_nop 9
    v_mfma_f32_32x32x4_2b_bf16 v[32:63], v[160:161], v[12:13], v[32:63]
    s_nop 15
    s_nop 3
    v_max3_f32 v24, v32, v33, v24
    v_max3_f32 v24, v34, v35, v24
    v_max3_f32 v24, v36, v37, v24
    v_max3_f32 v24, v38, v39, v24
    v_max3_f32 v24, v40, v41, v24
    v_max3_f32 v24, v42, v43, v24
    v_max3_f32 v24, v44, v45, v24
    v_max3_f32 v24, v46, v47, v24
    v_max3_f32 v24, v48, v49, v24
    v_max3_f32 v24, v50, v51, v24
    v_max3_f32 v24, v52, v53, v24
    v_max3_f32 v24, v54, v55, v24
    v_max3_f32 v24, v56, v57, v24
    v_max3_f32 v24, v58, v59, v24
    v_max3_f32 v24, v60, v61, v24
    v_max3_f32 v24, v62, v63, v24
    v_add_u32 v27, 4736, v27
    v_add_u32 v28, 4736, v28
    v_add_u32 v29, 4736, v29
    s_add_u32 s52, s52, 1
    s_cmp_lt_u32 s52, 32
    s_cbranch_scc1 K2_fb0
    v_mov_b32 v25, v24
    s_nop 1
    v_permlane32_swap_b32 v24, v25
    s_nop 1
    v_max_f32 v24, v24, v25
    v_sub_f32 v128, 0, v24
    v_sub_f32 v129, 0, v24
    v_sub_f32 v130, 0, v24
    v_sub_f32 v131, 0, v24
    v_sub_f32 v132, 0, v24
    v_sub_f32 v133, 0, v24
    v_sub_f32 v134, 0, v24
    v_sub_f32 v135, 0, v24
    v_sub_f32 v136, 0, v24
    v_sub_f32 v137, 0, v24
    v_sub_f32 v138, 0, v24
    v_sub_f32 v139, 0, v24
    v_sub_f32 v140, 0, v24
    v_sub_f32 v141, 0, v24
    v_sub_f32 v142, 0, v24
    v_sub_f32 v143, 0, v24
    v_mov_b32 v112, 0
    v_mov_b32 v113, 0
    v_mov_b32 v114, 0
    v_mov_b32 v115, 0
    v_mov_b32 v116, 0
    v_mov_b32 v117, 0
    v_mov_b32 v118, 0
    v_mov_b32 v119, 0
    v_mov_b32 v120, 0
    v_mov_b32 v121, 0
    v_mov_b32 v122, 0
    v_mov_b32 v123, 0
    v_mov_b32 v124, 0
    v_mov_b32 v125, 0
    v_mov_b32 v126, 0
    v_mov_b32 v127, 0
    s_mov_b32 s52, 0
    v_mov_b32 v27, v14
    v_mov_b32 v28, v17
    v_mov_b32 v29, v20
K2_fb1:
    buffer_load_dwordx4 v[144:147], v27, s[16:19], 0 offen sc1
    buffer_load_dwordx4 v[148:151], v27, s[16:19], 0 offen offset:1024 sc1
    buffer_load_dword v160, v28, s[16:19], 0 offen offset:2048 sc1
    s_movk_i32 s53, 2304
    buffer_load_dwordx4 v[164:167], v29, s[16:19], s53 offen offset:0 sc1
    buffer_load_dwordx4 v[168:171], v29, s[16:19], s53 offen offset:608 sc1
    buffer_load_dwordx4 v[172:175], v29, s[16:19], s53 offen offset:1216 sc1
    buffer_load_dwordx4 v[176:179], v29, s[16:19], s53 offen offset:1824 sc1
    s_waitcnt vmcnt(0)
    v_mfma_f32_32x32x16_bf16 v[32:47], v[144:147], v[8:11], v[128:143]
    v_mfma_f32_32x32x16_bf16 v[48:63], v[148:151], v[8:11], v[128:143]
    s_nop 9
    v_mfma_f32_32x32x4_2b_bf16 v[32:63], v[160:161], v[12:13], v[32:63]
    s_nop 15
    s_nop 3
    v_exp_f32 v32, v32
    v_exp_f32 v33, v33
    v_exp_f32 v34, v34
    v_exp_f32 v35, v35
    v_cvt_pk_bf16_f32 v96, v32, v33
    v_cvt_pk_bf16_f32 v97, v34, v35
    v_exp_f32 v36, v36
    v_exp_f32 v37, v37
    v_exp_f32 v38, v38
    v_exp_f32 v39, v39
    v_cvt_pk_bf16_f32 v98, v36, v37
    v_cvt_pk_bf16_f32 v99, v38, v39
    v_exp_f32 v40, v40
    v_exp_f32 v41, v41
    v_exp_f32 v42, v42
    v_exp_f32 v43, v43
    v_cvt_pk_bf16_f32 v100, v40, v41
    v_cvt_pk_bf16_f32 v101, v42, v43
    v_exp_f32 v44, v44
    v_exp_f32 v45, v45
    v_exp_f32 v46, v46
    v_exp_f32 v47, v47
    v_cvt_pk_bf16_f32 v102, v44, v45
    v_cvt_pk_bf16_f32 v103, v46, v47
    v_exp_f32 v48, v48
    v_exp_f32 v49, v49
    v_exp_f32 v50, v50
    v_exp_f32 v51, v51
    v_cvt_pk_bf16_f32 v104, v48, v49
    v_cvt_pk_bf16_f32 v105, v50, v51
    v_exp_f32 v52, v52
    v_exp_f32 v53, v53
    v_exp_f32 v54, v54
    v_exp_f32 v55, v55
    v_cvt_pk_bf16_f32 v106, v52, v53
    v_cvt_pk_bf16_f32 v107, v54, v55
    v_exp_f32 v56, v56
    v_exp_f32 v57, v57
    v_exp_f32 v58, v58
    v_exp_f32 v59, v59
    v_cvt_pk_bf16_f32 v108, v56, v57
    v_cvt_pk_bf16_f32 v109, v58, v59
    v_exp_f32 v60, v60
    v_exp_f32 v61, v61
    v_exp_f32 v62, v62
    v_exp_f32 v63, v63
    v_cvt_pk_bf16_f32 v110, v60, v61
    v_cvt_pk_bf16_f32 v111, v62, v63
    s_nop 1
    v_mfma_f32_32x32x16_bf16 v[112:127], v[164:167], v[96:99], v[112:127]
    v_mfma_f32_32x32x16_bf16 v[112:127], v[168:171], v[100:103], v[112:127]
    v_mfma_f32_32x32x16_bf16 v[112:127], v[172:175], v[104:107], v[112:127]
    v_mfma_f32_32x32x16_bf16 v[112:127], v[176:179], v[108:111], v[112:127]
    v_add_u32 v27, 4736, v27
    v_add_u32 v28, 4736, v28
    v_add_u32 v29, 4736, v29
    s_add_u32 s52, s52, 1
    s_cmp_lt_u32 s52, 32
    s_cbranch_scc1 K2_fb1
    s_nop 15
    v_mov_b32 v25, v122
    v_mov_b32 v26, v122
    s_nop 1
    v_permlane32_swap_b32 v25, v26
    s_nop 1
K2_out:
    s_lshr_b32 s77, s2, 5
    s_and_b32 s78, s2, 7
    s_lshl_b32 s78, s78, 2
    s_bfe_u32 s43, s2, 0x20003
    s_add_u32 s78, s78, s43
    s_cmp_ge_u32 s3, 4
    s_cbranch_scc1 K2_noearly
    s_lshl_b32 s46, s78, 2
    s_add_u32 s46, s46, s3
    s_add_u32 s48, s14, 2514944
    s_addc_u32 s49, s15, 0
    s_mov_b32 s50, 16384
    s_mov_b32 s51, 0x00020000
    s_add_u32 s52, s14, 7380992
    s_addc_u32 s53, s15, 0
    s_mov_b32 s54, 2359296
    s_mov_b32 s55, 0x00020000
    s_mul_i32 s47, s77, 3072
    s_mul_i32 s30, s46, 18432
    s_add_u32 s47, s47, s30
    buffer_load_dwordx4 v[140:143], v3, s[52:55], s47 offen offset:0 sc1
    buffer_load_dwordx4 v[144:147], v3, s[52:55], s47 offen offset:1024 sc1
    buffer_load_dwordx4 v[148:151], v3, s[52:55], s47 offen offset:2048 sc1
    v_and_b32 v166, 15, v0
    v_lshlrev_b32 v166, 2, v166
    s_lshl_b32 s65, s46, 7
    buffer_load_dword v165, v166, s[48:51], s65 offen sc1
K2_noearly:
    s_lshl_b32 s43, s34, 12
    s_add_u32 s43, s43, 458752
    v_lshlrev_b32 v161, 7, v1
    buffer_load_dword v160, v161, s[36:39], s43 offen sc1
    v_rcp_f32 v25, v25
    s_nop 0
    v_mul_f32 v112, v112, v25
    v_mul_f32 v113, v113, v25
    v_mul_f32 v114, v114, v25
    v_mul_f32 v115, v115, v25
    v_mul_f32 v116, v116, v25
    v_mul_f32 v117, v117, v25
    v_mul_f32 v118, v118, v25
    v_mul_f32 v119, v119, v25
    v_mul_f32 v120, v120, v25
    v_mul_f32 v121, v121, v25
    v_cvt_pk_bf16_f32 v96, v112, v113
    v_cvt_pk_bf16_f32 v97, v114, v115
    v_cvt_pk_bf16_f32 v98, v116, v117
    v_cvt_pk_bf16_f32 v99, v118, v119
    v_cvt_pk_bf16_f32 v100, v120, v121
    v_lshrrev_b32 v26, 4, v1
    v_mul_u32_u24 v27, 18432, v26
    v_and_b32 v28, 15, v1
    v_lshl_add_u32 v27, v28, 4, v27
    v_lshl_add_u32 v27, v2, 8, v27
    s_mul_i32 s42, s40, 36864
    s_lshl_b32 s43, s41, 9
    s_add_u32 s43, s43, s42
    buffer_store_dwordx4 v[96:99], v27, s[24:27], s43 offen sc1
    s_lshr_b32 s43, s3, 2
    s_lshl_b32 s43, s43, 8
    s_and_b32 s44, s3, 3
    s_lshl_b32 s44, s44, 2
    s_add_u32 s43, s43, s44
    s_add_u32 s43, s43, 152576
    v_lshlrev_b32 v26, 9, v26
    v_lshl_add_u32 v26, v28, 4, v26
    v_add_u32 v26, s43, v26
    s_mov_b32 exec_lo, -1
    s_mov_b32 exec_hi, 0
    ds_write_b32 v26, v100
    s_mov_b64 exec, -1
    v_mov_b32 v172, 151552
    v_mov_b32 v8, 1
    v_lshlrev_b32 v9, 2, v0
    v_mov_b32 v174, s101
    s_lshl_b32 s79, s93, 7
    s_add_u32 s79, s79, 294912
    v_add_u32 v4, 152576, v3
    v_mul_u32_u24 v5, 18432, v2
    v_lshl_add_u32 v5, v1, 4, v5
    s_and_b32 s43, s93, 3
    s_lshl_b32 s43, s43, 9
    s_add_u32 s43, s43, s42
    s_add_u32 s43, s43, 16384
    s_waitcnt lgkmcnt(0)
    s_barrier
    s_cmp_lg_u32 s3, 0
    s_cbranch_scc1 K3_norem
    ds_read_b128 v[12:15], v4
    s_waitcnt lgkmcnt(0)
    buffer_store_dwordx4 v[12:15], v5, s[24:27], s43 offen sc1
K3_norem:
    v_lshlrev_b32 v2, 4, v0
    s_mov_b32 s40, s77
    s_mov_b32 s41, s78
    s_waitcnt vmcnt(0)
    s_mov_b64 exec, 1
    ds_add_rtn_u32 v168, v172, v8 offset:36
    s_waitcnt lgkmcnt(0)
    v_readfirstlane_b32 s70, v168
    s_cmp_lg_u32 s70, 7
    s_cbranch_scc1 K3_nofl
    s_mov_b32 exec_lo, -1
    s_mov_b32 exec_hi, 0
    buffer_store_dword v174, v9, s[36:39], s79 offen sc1
K3_nofl:
    s_mov_b64 exec, -1
    s_cmp_ge_u32 s3, 4
    s_cbranch_scc1 K3_loader
    v_add_u32 v3, 0x10000, v2
    v_add_u32 v4, 0x20000, v2
    v_and_b32 v5, 15, v0
    v_lshrrev_b32 v6, 4, v0
    v_lshlrev_b32 v7, 7, v0
    v_lshlrev_b32 v11, 2, v5
    v_mov_b32 v10, v165
    s_cmp_ge_u32 s40, 6
    s_cbranch_scc1 K4_compute
    s_lshl_b32 s43, s41, 3
    s_lshr_b32 s44, s3, 1
    s_lshl_b32 s44, s44, 2
    s_add_u32 s43, s43, s44
    s_lshl_b32 s43, s43, 7
    s_add_u32 s43, s43, 294912
    s_add_u32 s52, s14, 4890624
    s_addc_u32 s53, s15, 0
    s_mov_b32 s54, 2359296
    s_mov_b32 s55, 0x00020000
    s_add_u32 s60, s14, 7249920
    s_addc_u32 s61, s15, 0
    s_mov_b32 s62, 131072
    s_mov_b32 s63, 0x00020000
    s_barrier
    ds_read_b128 v[12:15], v2 offset:0
    ds_read_b128 v[16:19], v2 offset:1024
    ds_read_b128 v[20:23], v2 offset:2048
    ds_read_b128 v[24:27], v2 offset:3072
    ds_read_b128 v[28:31], v2 offset:4096
    ds_read_b128 v[32:35], v2 offset:5120
    ds_read_b128 v[36:39], v3 offset:45056
    s_mov_b32 s91, 0x10000
    s_mov_b32 exec_lo, 15
    s_mov_b32 exec_hi, 0
L_poll_39:
    buffer_load_dword v164, v7, s[36:39], s43 offen sc1
    s_waitcnt vmcnt(0)
L_poll_39_1:
    v_cmp_eq_u32 vcc, s101, v164
    s_nop 1
    s_cmp_eq_u64 vcc, exec
    s_cbranch_scc1 L_poll_39_ok
    s_sleep 1
    s_sub_u32 s91, s91, 1
    s_cbranch_scc0 L_poll_39
L_poll_39_ok:
    s_mov_b64 exec, -1
    s_mul_i32 s44, s40, 3072
    s_add_u32 s45, s30, s44
    s_add_u32 s44, s44, 3072
    s_cmp_eq_u32 s44, 18432
    s_cselect_b32 s44, 0, s44
    buffer_load_dwordx4 v[40:43], v2, s[24:27], s45 offen offset:0 sc1
    buffer_load_dwordx4 v[44:47], v2, s[24:27], s45 offen offset:1024 sc1
    buffer_load_dwordx4 v[48:51], v2, s[24:27], s45 offen offset:2048 sc1
    s_add_u32 s45, s30, s44
    s_add_u32 s44, s44, 3072
    s_cmp_eq_u32 s44, 18432
    s_cselect_b32 s44, 0, s44
    buffer_load_dwordx4 v[52:55], v2, s[24:27], s45 offen offset:0 sc1
    buffer_load_dwordx4 v[56:59], v2, s[24:27], s45 offen offset:1024 sc1
    buffer_load_dwordx4 v[60:63], v2, s[24:27], s45 offen offset:2048 sc1
    s_waitcnt vmcnt(5) lgkmcnt(6)
    v_mfma_f32_16x16x32_bf16 v[112:115], v[12:15], v[40:43], 0
    ds_read_b128 v[12:15], v2 offset:6144
    s_waitcnt lgkmcnt(6)
    v_mfma_f32_16x16x32_bf16 v[116:119], v[16:19], v[40:43], 0
    ds_read_b128 v[16:19], v2 offset:7168
    s_add_u32 s45, s30, s44
    s_add_u32 s44, s44, 3072
    s_cmp_eq_u32 s44, 18432
    s_cselect_b32 s44, 0, s44
    buffer_load_dwordx4 v[64:67], v2, s[24:27], s45 offen offset:0 sc1
    s_waitcnt lgkmcnt(6)
    v_mfma_f32_16x16x32_bf16 v[120:123], v[20:23], v[40:43], 0
    ds_read_b128 v[20:23], v2 offset:8192
    s_waitcnt lgkmcnt(6)
    v_mfma_f32_16x16x32_bf16 v[124:127], v[24:27], v[40:43], 0
    ds_read_b128 v[24:27], v2 offset:9216
    s_waitcnt lgkmcnt(6)
    v_mfma_f32_16x16x32_bf16 v[128:131], v[28:31], v[40:43], 0
    ds_read_b128 v[28:31], v2 offset:10240
    buffer_load_dwordx4 v[68:71], v2, s[24:27], s45 offen offset:1024 sc1
    s_waitcnt lgkmcnt(6)
    v_mfma_f32_16x16x32_bf16 v[132:135], v[32:35], v[40:43], 0
    ds_read_b128 v[32:35], v2 offset:11264
    s_waitcnt lgkmcnt(6)
    v_mfma_f32_16x16x32_bf16 v[136:139], v[36:39], v[40:43], 0
    ds_read_b128 v[36:39], v3 offset:46080
    s_waitcnt vmcnt(6) lgkmcnt(6)
    v_mfma_f32_16x16x32_bf16 v[112:115], v[12:15], v[44:47], v[112:115]
    ds_read_b128 v[12:15], v2 offset:12288
    s_waitcnt lgkmcnt(6)
    v_mfma_f32_16x16x32_bf16 v[116:119], v[16:19], v[44:47], v[116:119]
    ds_read_b128 v[16:19], v2 offset:13312
    buffer_load_dwordx4 v[72:75], v2, s[24:27], s45 offen offset:2048 sc1
    s_waitcnt lgkmcnt(6)
    v_mfma_f32_16x16x32_bf16 v[120:123], v[20:23], v[44:47], v[120:123]
    ds_read_b128 v[20:23], v2 offset:14336
    s_waitcnt lgkmcnt(6)
    v_mfma_f32_16x16x32_bf16 v[124:127], v[24:27], v[44:47], v[124:127]
    ds_read_b128 v[24:27], v2 offset:15360
    s_waitcnt lgkmcnt(6)
    v_mfma_f32_16x16x32_bf16 v[128:131], v[28:31], v[44:47], v[128:131]
    ds_read_b128 v[28:31], v2 offset:16384
    s_add_u32 s45, s30, s44
    s_add_u32 s44, s44, 3072
    s_cmp_eq_u32 s44, 18432
    s_cselect_b32 s44, 0, s44
    buffer_load_dwordx4 v[76:79], v2, s[24:27], s45 offen offset:0 sc1
    s_waitcnt lgkmcnt(6)
    v_mfma_f32_16x16x32_bf16 v[132:135], v[32:35], v[44:47], v[132:135]
    ds_read_b128 v[32:35], v2 offset:17408
    s_waitcnt lgkmcnt(6)
    v_mfma_f32_16x16x32_bf16 v[136:139], v[36:39], v[44:47], v[136:139]
    ds_read_b128 v[36:39], v3 offset:47104
    s_waitcnt vmcnt(7) lgkmcnt(6)
    v_mfma_f32_16x16x32_bf16 v[112:115], v[12:15], v[48:51], v[112:115]
    ds_read_b128 v[12:15], v2 offset:18432
    s_waitcnt lgkmcnt(6)
    v_mfma_f32_16x16x32_bf16 v[116:119], v[16:19], v[48:51], v[116:119]
    ds_read_b128 v[16:19], v2 offset:19456
    buffer_load_dwordx4 v[80:83], v2, s[24:27], s45 offen offset:1024 sc1
    s_waitcnt lgkmcnt(6)
    v_mfma_f32_16x16x32_bf16 v[120:123], v[20:23], v[48:51], v[120:123]
    ds_read_b128 v[20:23], v2 offset:20480
    s_waitcnt lgkmcnt(6)
    v_mfma_f32_16x16x32_bf16 v[124:127], v[24:27], v[48:51], v[124:127]
    ds_read_b128 v[24:27], v2 offset:21504
    s_waitcnt lgkmcnt(6)
    v_mfma_f32_16x16x32_bf16 v[128:131], v[28:31], v[48:51], v[128:131]
    ds_read_b128 v[28:31], v2 offset:22528
    buffer_load_dwordx4 v[84:87], v2, s[24:27], s45 offen offset:2048 sc1
    s_waitcnt lgkmcnt(6)
    v_mfma_f32_16x16x32_bf16 v[132:135], v[32:35], v[48:51], v[132:135]
    ds_read_b128 v[32:35], v2 offset:23552
    s_waitcnt lgkmcnt(6)
    v_mfma_f32_16x16x32_bf16 v[136:139], v[36:39], v[48:51], v[136:139]
    ds_read_b128 v[36:39], v3 offset:48128
    s_waitcnt vmcnt(8) lgkmcnt(6)
    v_mfma_f32_16x16x32_bf16 v[112:115], v[12:15], v[52:55], v[112:115]
    ds_read_b128 v[12:15], v2 offset:24576
    s_waitcnt lgkmcnt(6)
    v_mfma_f32_16x16x32_bf16 v[116:119], v[16:19], v[52:55], v[116:119]
    ds_read_b128 v[16:19], v2 offset:25600
    s_add_u32 s45, s30, s44
    s_add_u32 s44, s44, 3072
    s_cmp_eq_u32 s44, 18432
    s_cselect_b32 s44, 0, s44
    buffer_load_dwordx4 v[88:91], v2, s[24:27], s45 offen offset:0 sc1
    s_waitcnt lgkmcnt(6)
    v_mfma_f32_16x16x32_bf16 v[120:123], v[20:23], v[52:55], v[120:123]
    ds_read_b128 v[20:23], v2 offset:26624
    s_waitcnt lgkmcnt(6)
    v_mfma_f32_16x16x32_bf16 v[124:127], v[24:27], v[52:55], v[124:127]
    ds_read_b128 v[24:27], v2 offset:27648
    s_waitcnt lgkmcnt(6)
    v_mfma_f32_16x16x32_bf16 v[128:131], v[28:31], v[52:55], v[128:131]
    ds_read_b128 v[28:31], v2 offset:28672
    buffer_load_dwordx4 v[92:95], v2, s[24:27], s45 offen offset:1024 sc1
    s_waitcnt lgkmcnt(6)
    v_mfma_f32_16x16x32_bf16 v[132:135], v[32:35], v[52:55], v[132:135]
    ds_read_b128 v[32:35], v2 offset:29696
    s_waitcnt lgkmcnt(6)
    v_mfma_f32_16x16x32_bf16 v[136:139], v[36:39], v[52:55], v[136:139]
    ds_read_b128 v[36:39], v3 offset:49152
    s_waitcnt vmcnt(9) lgkmcnt(6)
    v_mfma_f32_16x16x32_bf16 v[112:115], v[12:15], v[56:59], v[112:115]
    ds_read_b128 v[12:15], v2 offset:30720
    s_waitcnt lgkmcnt(6)
    v_mfma_f32_16x16x32_bf16 v[116:119], v[16:19], v[56:59], v[116:119]
    ds_read_b128 v[16:19], v2 offset:31744
    buffer_load_dwordx4 v[96:99], v2, s[24:27], s45 offen offset:2048 sc1
    s_waitcnt lgkmcnt(6)
    v_mfma_f32_16x16x32_bf16 v[120:123], v[20:23], v[56:59], v[120:123]
    ds_read_b128 v[20:23], v2 offset:32768
    s_waitcnt lgkmcnt(6)
    v_mfma_f32_16x16x32_bf16 v[124:127], v[24:27], v[56:59], v[124:127]
    ds_read_b128 v[24:27], v2 offset:33792
    s_waitcnt lgkmcnt(6)
    v_mfma_f32_16x16x32_bf16 v[128:131], v[28:31], v[56:59], v[128:131]
    ds_read_b128 v[28:31], v2 offset:34816
    s_add_u32 s45, s30, s44
    s_add_u32 s44, s44, 3072
    s_cmp_eq_u32 s44, 18432
    s_cselect_b32 s44, 0, s44
    buffer_load_dwordx4 v[100:103], v2, s[24:27], s45 offen offset:0 sc1
    s_waitcnt lgkmcnt(6)
    v_mfma_f32_16x16x32_bf16 v[132:135], v[32:35], v[56:59], v[132:135]
    ds_read_b128 v[32:35], v2 offset:35840
    s_waitcnt lgkmcnt(6)
    v_mfma_f32_16x16x32_bf16 v[136:139], v[36:39], v[56:59], v[136:139]
    ds_read_b128 v[36:39], v3 offset:50176
    s_waitcnt vmcnt(10) lgkmcnt(6)
    v_mfma_f32_16x16x32_bf16 v[112:115], v[12:15], v[60:63], v[112:115]
    ds_read_b128 v[12:15], v2 offset:36864
    s_waitcnt lgkmcnt(6)
    v_mfma_f32_16x16x32_bf16 v[116:119], v[16:19], v[60:63], v[116:119]
    ds_read_b128 v[16:19], v2 offset:37888
    buffer_load_dwordx4 v[104:107], v2, s[24:27], s45 offen offset:1024 sc1
    s_waitcnt lgkmcnt(6)
    v_mfma_f32_16x16x32_bf16 v[120:123], v[20:23], v[60:63], v[120:123]
    ds_read_b128 v[20:23], v2 offset:38912
    s_waitcnt lgkmcnt(6)
    v_mfma_f32_16x16x32_bf16 v[124:127], v[24:27], v[60:63], v[124:127]
    ds_read_b128 v[24:27], v2 offset:39936
    s_waitcnt lgkmcnt(6)
    v_mfma_f32_16x16x32_bf16 v[128:131], v[28:31], v[60:63], v[128:131]
    ds_read_b128 v[28:31], v2 offset:40960
    buffer_load_dwordx4 v[108:111], v2, s[24:27], s45 offen offset:2048 sc1
    s_waitcnt lgkmcnt(6)
    v_mfma_f32_16x16x32_bf16 v[132:135], v[32:35], v[60:63], v[132:135]
    ds_read_b128 v[32:35], v2 offset:41984
    s_waitcnt lgkmcnt(6)
    v_mfma_f32_16x16x32_bf16 v[136:139], v[36:39], v[60:63], v[136:139]
    ds_read_b128 v[36:39], v3 offset:51200
    s_waitcnt vmcnt(11) lgkmcnt(6)
    v_mfma_f32_16x16x32_bf16 v[112:115], v[12:15], v[64:67], v[112:115]
    ds_read_b128 v[12:15], v2 offset:43008
    s_waitcnt lgkmcnt(6)
    v_mfma_f32_16x16x32_bf16 v[116:119], v[16:19], v[64:67], v[116:119]
    ds_read_b128 v[16:19], v2 offset:44032
    s_waitcnt lgkmcnt(6)
    v_mfma_f32_16x16x32_bf16 v[120:123], v[20:23], v[64:67], v[120:123]
    ds_read_b128 v[20:23], v2 offset:45056
    s_waitcnt lgkmcnt(6)
    v_mfma_f32_16x16x32_bf16 v[124:127], v[24:27], v[64:67], v[124:127]
    ds_read_b128 v[24:27], v2 offset:46080
    s_waitcnt lgkmcnt(6)
    v_mfma_f32_16x16x32_bf16 v[128:131], v[28:31], v[64:67], v[128:131]
    ds_read_b128 v[28:31], v2 offset:47104
    s_waitcnt lgkmcnt(6)
    v_mfma_f32_16x16x32_bf16 v[132:135], v[32:35], v[64:67], v[132:135]
    ds_read_b128 v[32:35], v2 offset:48128
    s_waitcnt lgkmcnt(6)
    v_mfma_f32_16x16x32_bf16 v[136:139], v[36:39], v[64:67], v[136:139]
    ds_read_b128 v[36:39], v3 offset:52224
    s_waitcnt vmcnt(10) lgkmcnt(6)
    v_mfma_f32_16x16x32_bf16 v[112:115], v[12:15], v[68:71], v[112:115]
    ds_read_b128 v[12:15], v2 offset:49152
    s_waitcnt lgkmcnt(6)
    v_mfma_f32_16x16x32_bf16 v[116:119], v[16:19], v[68:71], v[116:119]
    ds_read_b128 v[16:19], v2 offset:50176
    s_waitcnt lgkmcnt(6)
    v_mfma_f32_16x16x32_bf16 v[120:123], v[20:23], v[68:71], v[120:123]
    ds_read_b128 v[20:23], v2 offset:51200
    s_waitcnt lgkmcnt(6)
    v_mfma_f32_16x16x32_bf16 v[124:127], v[24:27], v[68:71], v[124:127]
    ds_read_b128 v[24:27], v2 offset:52224
    s_waitcnt lgkmcnt(6)
    v_mfma_f32_16x16x32_bf16 v[128:131], v[28:31], v[68:71], v[128:131]
    ds_read_b128 v[28:31], v2 offset:53248
    s_waitcnt lgkmcnt(6)
    v_mfma_f32_16x16x32_bf16 v[132:135], v[32:35], v[68:71], v[132:135]
    ds_read_b128 v[32:35], v2 offset:54272
    s_waitcnt lgkmcnt(6)
    v_mfma_f32_16x16x32_bf16 v[136:139], v[36:39], v[68:71], v[136:139]
    ds_read_b128 v[36:39], v3 offset:53248
    s_waitcnt vmcnt(9) lgkmcnt(6)
    v_mfma_f32_16x16x32_bf16 v[112:115], v[12:15], v[72:75], v[112:115]
    ds_read_b128 v[12:15], v2 offset:55296
    s_waitcnt lgkmcnt(6)
    v_mfma_f32_16x16x32_bf16 v[116:119], v[16:19], v[72:75], v[116:119]
    ds_read_b128 v[16:19], v2 offset:56320
    s_waitcnt lgkmcnt(6)
    v_mfma_f32_16x16x32_bf16 v[120:123], v[20:23], v[72:75], v[120:123]
    ds_read_b128 v[20:23], v2 offset:57344
    s_waitcnt lgkmcnt(6)
    v_mfma_f32_16x16x32_bf16 v[124:127], v[24:27], v[72:75], v[124:127]
    ds_read_b128 v[24:27], v2 offset:58368
    s_waitcnt lgkmcnt(6)
    v_mfma_f32_16x16x32_bf16 v[128:131], v[28:31], v[72:75], v[128:131]
    ds_read_b128 v[28:31], v2 offset:59392
    s_waitcnt lgkmcnt(6)
    v_mfma_f32_16x16x32_bf16 v[132:135], v[32:35], v[72:75], v[132:135]
    ds_read_b128 v[32:35], v2 offset:60416
    s_waitcnt lgkmcnt(6)
    v_mfma_f32_16x16x32_bf16 v[136:139], v[36:39], v[72:75], v[136:139]
    ds_read_b128 v[36:39], v3 offset:54272
    s_waitcnt vmcnt(8) lgkmcnt(6)
    v_mfma_f32_16x16x32_bf16 v[112:115], v[12:15], v[76:79], v[112:115]
    ds_read_b128 v[12:15], v2 offset:61440
    s_waitcnt lgkmcnt(6)
    v_mfma_f32_16x16x32_bf16 v[116:119], v[16:19], v[76:79], v[116:119]
    ds_read_b128 v[16:19], v2 offset:62464
    s_waitcnt lgkmcnt(6)
    v_mfma_f32_16x16x32_bf16 v[120:123], v[20:23], v[76:79], v[120:123]
    ds_read_b128 v[20:23], v2 offset:63488
    s_waitcnt lgkmcnt(6)
    v_mfma_f32_16x16x32_bf16 v[124:127], v[24:27], v[76:79], v[124:127]
    ds_read_b128 v[24:27], v2 offset:64512
    s_waitcnt lgkmcnt(6)
    v_mfma_f32_16x16x32_bf16 v[128:131], v[28:31], v[76:79], v[128:131]
    ds_read_b128 v[28:31], v3 offset:0
    s_waitcnt lgkmcnt(6)
    v_mfma_f32_16x16x32_bf16 v[132:135], v[32:35], v[76:79], v[132:135]
    ds_read_b128 v[32:35], v3 offset:1024
    s_waitcnt lgkmcnt(6)
    v_mfma_f32_16x16x32_bf16 v[136:139], v[36:39], v[76:79], v[136:139]
    ds_read_b128 v[36:39], v3 offset:55296
    s_waitcnt vmcnt(7) lgkmcnt(6)
    v_mfma_f32_16x16x32_bf16 v[112:115], v[12:15], v[80:83], v[112:115]
    ds_read_b128 v[12:15], v3 offset:2048
    s_waitcnt lgkmcnt(6)
    v_mfma_f32_16x16x32_bf16 v[116:119], v[16:19], v[80:83], v[116:119]
    ds_read_b128 v[16:19], v3 offset:3072
    s_waitcnt lgkmcnt(6)
    v_mfma_f32_16x16x32_bf16 v[120:123], v[20:23], v[80:83], v[120:123]
    ds_read_b128 v[20:23], v3 offset:4096
    s_waitcnt lgkmcnt(6)
    v_mfma_f32_16x16x32_bf16 v[124:127], v[24:27], v[80:83], v[124:127]
    ds_read_b128 v[24:27], v3 offset:5120
    s_waitcnt lgkmcnt(6)
    v_mfma_f32_16x16x32_bf16 v[128:131], v[28:31], v[80:83], v[128:131]
    ds_read_b128 v[28:31], v3 offset:6144
    s_waitcnt lgkmcnt(6)
    v_mfma_f32_16x16x32_bf16 v[132:135], v[32:35], v[80:83], v[132:135]
    ds_read_b128 v[32:35], v3 offset:7168
    s_waitcnt lgkmcnt(6)
    v_mfma_f32_16x16x32_bf16 v[136:139], v[36:39], v[80:83], v[136:139]
    ds_read_b128 v[36:39], v3 offset:56320
    s_waitcnt vmcnt(6) lgkmcnt(6)
    v_mfma_f32_16x16x32_bf16 v[112:115], v[12:15], v[84:87], v[112:115]
    ds_read_b128 v[12:15], v3 offset:8192
    s_waitcnt lgkmcnt(6)
    v_mfma_f32_16x16x32_bf16 v[116:119], v[16:19], v[84:87], v[116:119]
    ds_read_b128 v[16:19], v3 offset:9216
    s_waitcnt lgkmcnt(6)
    v_mfma_f32_16x16x32_bf16 v[120:123], v[20:23], v[84:87], v[120:123]
    ds_read_b128 v[20:23], v3 offset:10240
    s_waitcnt lgkmcnt(6)
    v_mfma_f32_16x16x32_bf16 v[124:127], v[24:27], v[84:87], v[124:127]
    ds_read_b128 v[24:27], v3 offset:11264
    s_waitcnt lgkmcnt(6)
    v_mfma_f32_16x16x32_bf16 v[128:131], v[28:31], v[84:87], v[128:131]
    ds_read_b128 v[28:31], v3 offset:12288
    s_waitcnt lgkmcnt(6)
    v_mfma_f32_16x16x32_bf16 v[132:135], v[32:35], v[84:87], v[132:135]
    ds_read_b128 v[32:35], v3 offset:13312
    s_waitcnt lgkmcnt(6)
    v_mfma_f32_16x16x32_bf16 v[136:139], v[36:39], v[84:87], v[136:139]
    ds_read_b128 v[36:39], v3 offset:57344
    s_waitcnt vmcnt(5) lgkmcnt(6)
    v_mfma_f32_16x16x32_bf16 v[112:115], v[12:15], v[88:91], v[112:115]
    ds_read_b128 v[12:15], v3 offset:14336
    s_waitcnt lgkmcnt(6)
    v_mfma_f32_16x16x32_bf16 v[116:119], v[16:19], v[88:91], v[116:119]
    ds_read_b128 v[16:19], v3 offset:15360
    s_waitcnt lgkmcnt(6)
    v_mfma_f32_16x16x32_bf16 v[120:123], v[20:23], v[88:91], v[120:123]
    ds_read_b128 v[20:23], v3 offset:16384
    s_waitcnt lgkmcnt(6)
    v_mfma_f32_16x16x32_bf16 v[124:127], v[24:27], v[88:91], v[124:127]
    ds_read_b128 v[24:27], v3 offset:17408
    s_waitcnt lgkmcnt(6)
    v_mfma_f32_16x16x32_bf16 v[128:131], v[28:31], v[88:91], v[128:131]
    ds_read_b128 v[28:31], v3 offset:18432
    s_waitcnt lgkmcnt(6)
    v_mfma_f32_16x16x32_bf16 v[132:135], v[32:35], v[88:91], v[132:135]
    ds_read_b128 v[32:35], v3 offset:19456
    s_waitcnt lgkmcnt(6)
    v_mfma_f32_16x16x32_bf16 v[136:139], v[36:39], v[88:91], v[136:139]
    ds_read_b128 v[36:39], v3 offset:58368
    s_waitcnt vmcnt(4) lgkmcnt(6)
    v_mfma_f32_16x16x32_bf16 v[112:115], v[12:15], v[92:95], v[112:115]
    ds_read_b128 v[12:15], v3 offset:20480
    s_waitcnt lgkmcnt(6)
    v_mfma_f32_16x16x32_bf16 v[116:119], v[16:19], v[92:95], v[116:119]
    ds_read_b128 v[16:19], v3 offset:21504
    s_waitcnt lgkmcnt(6)
    v_mfma_f32_16x16x32_bf16 v[120:123], v[20:23], v[92:95], v[120:123]
    ds_read_b128 v[20:23], v3 offset:22528
    s_waitcnt lgkmcnt(6)
    v_mfma_f32_16x16x32_bf16 v[124:127], v[24:27], v[92:95], v[124:127]
    ds_read_b128 v[24:27], v3 offset:23552
    s_waitcnt lgkmcnt(6)
    v_mfma_f32_16x16x32_bf16 v[128:131], v[28:31], v[92:95], v[128:131]
    ds_read_b128 v[28:31], v3 offset:24576
    s_waitcnt lgkmcnt(6)
    v_mfma_f32_16x16x32_bf16 v[132:135], v[32:35], v[92:95], v[132:135]
    ds_read_b128 v[32:35], v3 offset:25600
    s_waitcnt lgkmcnt(6)
    v_mfma_f32_16x16x32_bf16 v[136:139], v[36:39], v[92:95], v[136:139]
    ds_read_b128 v[36:39], v3 offset:59392
    s_waitcnt vmcnt(3) lgkmcnt(6)
    v_mfma_f32_16x16x32_bf16 v[112:115], v[12:15], v[96:99], v[112:115]
    ds_read_b128 v[12:15], v3 offset:26624
    s_waitcnt lgkmcnt(6)
    v_mfma_f32_16x16x32_bf16 v[116:119], v[16:19], v[96:99], v[116:119]
    ds_read_b128 v[16:19], v3 offset:27648
    s_waitcnt lgkmcnt(6)
    v_mfma_f32_16x16x32_bf16 v[120:123], v[20:23], v[96:99], v[120:123]
    ds_read_b128 v[20:23], v3 offset:28672
    s_waitcnt lgkmcnt(6)
    v_mfma_f32_16x16x32_bf16 v[124:127], v[24:27], v[96:99], v[124:127]
    ds_read_b128 v[24:27], v3 offset:29696
    s_waitcnt lgkmcnt(6)
    v_mfma_f32_16x16x32_bf16 v[128:131], v[28:31], v[96:99], v[128:131]
    ds_read_b128 v[28:31], v3 offset:30720
    s_waitcnt lgkmcnt(6)
    v_mfma_f32_16x16x32_bf16 v[132:135], v[32:35], v[96:99], v[132:135]
    ds_read_b128 v[32:35], v3 offset:31744
    s_waitcnt lgkmcnt(6)
    v_mfma_f32_16x16x32_bf16 v[136:139], v[36:39], v[96:99], v[136:139]
    ds_read_b128 v[36:39], v3 offset:60416
    s_waitcnt vmcnt(2) lgkmcnt(6)
    v_mfma_f32_16x16x32_bf16 v[112:115], v[12:15], v[100:103], v[112:115]
    ds_read_b128 v[12:15], v3 offset:32768
    s_waitcnt lgkmcnt(6)
    v_mfma_f32_16x16x32_bf16 v[116:119], v[16:19], v[100:103], v[116:119]
    ds_read_b128 v[16:19], v3 offset:33792
    s_waitcnt lgkmcnt(6)
    v_mfma_f32_16x16x32_bf16 v[120:123], v[20:23], v[100:103], v[120:123]
    ds_read_b128 v[20:23], v3 offset:34816
    s_waitcnt lgkmcnt(6)
    v_mfma_f32_16x16x32_bf16 v[124:127], v[24:27], v[100:103], v[124:127]
    ds_read_b128 v[24:27], v3 offset:35840
    s_waitcnt lgkmcnt(6)
    v_mfma_f32_16x16x32_bf16 v[128:131], v[28:31], v[100:103], v[128:131]
    ds_read_b128 v[28:31], v3 offset:36864
    s_waitcnt lgkmcnt(6)
    v_mfma_f32_16x16x32_bf16 v[132:135], v[32:35], v[100:103], v[132:135]
    ds_read_b128 v[32:35], v3 offset:37888
    s_waitcnt lgkmcnt(6)
    v_mfma_f32_16x16x32_bf16 v[136:139], v[36:39], v[100:103], v[136:139]
    ds_read_b128 v[36:39], v3 offset:61440
    s_waitcnt vmcnt(1) lgkmcnt(6)
    v_mfma_f32_16x16x32_bf16 v[112:115], v[12:15], v[104:107], v[112:115]
    ds_read_b128 v[12:15], v3 offset:38912
    s_waitcnt lgkmcnt(6)
    v_mfma_f32_16x16x32_bf16 v[116:119], v[16:19], v[104:107], v[116:119]
    ds_read_b128 v[16:19], v3 offset:39936
    s_waitcnt lgkmcnt(6)
    v_mfma_f32_16x16x32_bf16 v[120:123], v[20:23], v[104:107], v[120:123]
    ds_read_b128 v[20:23], v3 offset:40960
    s_waitcnt lgkmcnt(6)
    v_mfma_f32_16x16x32_bf16 v[124:127], v[24:27], v[104:107], v[124:127]
    ds_read_b128 v[24:27], v3 offset:41984
    s_waitcnt lgkmcnt(6)
    v_mfma_f32_16x16x32_bf16 v[128:131], v[28:31], v[104:107], v[128:131]
    ds_read_b128 v[28:31], v3 offset:43008
    s_waitcnt lgkmcnt(6)
    v_mfma_f32_16x16x32_bf16 v[132:135], v[32:35], v[104:107], v[132:135]
    ds_read_b128 v[32:35], v3 offset:44032
    s_waitcnt lgkmcnt(6)
    v_mfma_f32_16x16x32_bf16 v[136:139], v[36:39], v[104:107], v[136:139]
    ds_read_b128 v[36:39], v3 offset:62464
    s_waitcnt vmcnt(0) lgkmcnt(6)
    v_mfma_f32_16x16x32_bf16 v[112:115], v[12:15], v[108:111], v[112:115]
    s_waitcnt lgkmcnt(5)
    v_mfma_f32_16x16x32_bf16 v[116:119], v[16:19], v[108:111], v[116:119]
    s_waitcnt lgkmcnt(4)
    v_mfma_f32_16x16x32_bf16 v[120:123], v[20:23], v[108:111], v[120:123]
    s_waitcnt lgkmcnt(3)
    v_mfma_f32_16x16x32_bf16 v[124:127], v[24:27], v[108:111], v[124:127]
    s_waitcnt lgkmcnt(2)
    v_mfma_f32_16x16x32_bf16 v[128:131], v[28:31], v[108:111], v[128:131]
    s_waitcnt lgkmcnt(1)
    v_mfma_f32_16x16x32_bf16 v[132:135], v[32:35], v[108:111], v[132:135]
    s_waitcnt lgkmcnt(0)
    v_mfma_f32_16x16x32_bf16 v[136:139], v[36:39], v[108:111], v[136:139]
    s_barrier
    s_nop 6
    v_add_f32 v10, v10, v136
    v_add_f32 v10, v10, v137
    v_mov_b32 v14, 0
    v_lshlrev_b32 v12, 16, v140
    v_and_b32 v13, 0xffff0000, v140
    v_add_f32 v112, v112, v12
    v_add_f32 v116, v116, v13
    v_sub_f32 v112, v112, v10
    v_sub_f32 v116, v116, v10
    v_cvt_pk_bf16_f32 v40, v112, v116
    v_lshlrev_b32 v12, 16, v141
    v_and_b32 v13, 0xffff0000, v141
    v_add_f32 v113, v113, v12
    v_add_f32 v117, v117, v13
    v_sub_f32 v113, v113, v10
    v_sub_f32 v117, v117, v10
    v_cvt_pk_bf16_f32 v41, v113, v117
    v_lshlrev_b32 v12, 16, v142
    v_and_b32 v13, 0xffff0000, v142
    v_add_f32 v114, v114, v12
    v_add_f32 v118, v118, v13
    v_sub_f32 v114, v114, v10
    v_sub_f32 v118, v118, v10
    v_cvt_pk_bf16_f32 v42, v114, v118
    v_lshlrev_b32 v12, 16, v143
    v_and_b32 v13, 0xffff0000, v143
    v_add_f32 v115, v115, v12
    v_add_f32 v119, v119, v13
    v_sub_f32 v115, v115, v10
    v_sub_f32 v119, v119, v10
    v_cvt_pk_bf16_f32 v43, v115, v119
    buffer_store_dwordx4 v[40:43], v2, s[52:55], s47 offen offset:0 sc1
    v_lshlrev_b32 v12, 16, v144
    v_and_b32 v13, 0xffff0000, v144
    v_add_f32 v120, v120, v12
    v_add_f32 v124, v124, v13
    v_sub_f32 v120, v120, v10
    v_sub_f32 v124, v124, v10
    v_cvt_pk_bf16_f32 v44, v120, v124
    v_lshlrev_b32 v12, 16, v145
    v_and_b32 v13, 0xffff0000, v145
    v_add_f32 v121, v121, v12
    v_add_f32 v125, v125, v13
    v_sub_f32 v121, v121, v10
    v_sub_f32 v125, v125, v10
    v_cvt_pk_bf16_f32 v45, v121, v125
    v_lshlrev_b32 v12, 16, v146
    v_and_b32 v13, 0xffff0000, v146
    v_add_f32 v122, v122, v12
    v_add_f32 v126, v126, v13
    v_sub_f32 v122, v122, v10
    v_sub_f32 v126, v126, v10
    v_cvt_pk_bf16_f32 v46, v122, v126
    v_lshlrev_b32 v12, 16, v147
    v_and_b32 v13, 0xffff0000, v147
    v_add_f32 v123, v123, v12
    v_add_f32 v127, v127, v13
    v_sub_f32 v123, v123, v10
    v_sub_f32 v127, v127, v10
    v_cvt_pk_bf16_f32 v47, v123, v127
    buffer_store_dwordx4 v[44:47], v2, s[52:55], s47 offen offset:1024 sc1
    v_lshlrev_b32 v12, 16, v148
    v_and_b32 v13, 0xffff0000, v148
    v_add_f32 v128, v128, v12
    v_add_f32 v132, v132, v13
    v_sub_f32 v128, v128, v10
    v_sub_f32 v132, v132, v10
    v_cvt_pk_bf16_f32 v48, v128, v132
    v_lshlrev_b32 v12, 16, v149
    v_and_b32 v13, 0xffff0000, v149
    v_add_f32 v129, v129, v12
    v_add_f32 v133, v133, v13
    v_sub_f32 v129, v129, v10
    v_sub_f32 v133, v133, v10
    v_cvt_pk_bf16_f32 v49, v129, v133
    v_lshlrev_b32 v12, 16, v150
    v_and_b32 v13, 0xffff0000, v150
    v_add_f32 v130, v130, v12
    v_add_f32 v134, v134, v13
    v_sub_f32 v130, v130, v10
    v_sub_f32 v134, v134, v10
    v_cvt_pk_bf16_f32 v50, v130, v134
    v_lshlrev_b32 v12, 16, v151
    v_and_b32 v13, 0xffff0000, v151
    v_add_f32 v131, v131, v12
    v_add_f32 v135, v135, v13
    v_sub_f32 v131, v131, v10
    v_sub_f32 v135, v135, v10
    v_cvt_pk_bf16_f32 v51, v131, v135
    buffer_store_dwordx4 v[48:51], v2, s[52:55], s47 offen offset:2048 sc1
    v_dot2_f32_bf16 v14, v40, v40, v14
    v_dot2_f32_bf16 v14, v41, v41, v14
    v_dot2_f32_bf16 v14, v42, v42, v14
    v_dot2_f32_bf16 v14, v43, v43, v14
    v_dot2_f32_bf16 v14, v44, v44, v14
    v_dot2_f32_bf16 v14, v45, v45, v14
    v_dot2_f32_bf16 v14, v46, v46, v14
    v_dot2_f32_bf16 v14, v47, v47, v14
    v_dot2_f32_bf16 v14, v48, v48, v14
    v_dot2_f32_bf16 v14, v49, v49, v14
    v_dot2_f32_bf16 v14, v50, v50, v14
    v_dot2_f32_bf16 v14, v51, v51, v14
    s_nop 2
    v_mov_b32 v12, v14
    s_nop 1
    v_permlane32_swap_b32 v14, v12
    s_nop 1
    v_add_f32 v14, v14, v12
    v_mov_b32 v12, v14
    s_nop 1
    v_permlane16_swap_b32 v14, v12
    s_nop 1
    v_add_f32 v14, v14, v12
    v_cmp_eq_u32 vcc, 1, v6
    s_lshl_b32 s43, s46, 3
    s_add_u32 s43, s43, s40
    s_lshl_b32 s43, s43, 7
    v_cndmask_b32 v14, v14, v10, vcc
    s_mov_b32 exec_lo, -1
    s_mov_b32 exec_hi, 0
    buffer_store_dword v14, v9, s[60:63], s43 offen sc1
    s_lshl_b32 s43, s46, 3
    s_add_u32 s43, s43, s40
    s_lshl_b32 s43, s43, 7
    s_add_u32 s43, s43, 327680
    s_waitcnt vmcnt(0)
    buffer_store_dword v174, v9, s[36:39], s43 offen sc1
    s_mov_b64 exec, -1
    s_branch K4_compute
K3_loader:
    v_mov_b32 v4, 151552
    s_sub_u32 s33, s3, 4
    s_cmp_ge_u32 s40, 6
    s_cbranch_scc1 K3_pf
    s_add_u32 s20, s14, 9777152
    s_addc_u32 s21, s15, 0
    s_mov_b32 s22, 663552
    s_mov_b32 s23, 0x00020000
    s_add_u32 s68, s14, 9740288
    s_addc_u32 s69, s15, 0
    s_mov_b32 s70, 36864
    s_mov_b32 s71, 0x00020000
    s_lshl_b32 s76, s33, 10
    s_mul_i32 s75, s40, 110592
    s_add_u32 s74, s76, 81920
    s_add_u32 s75, s75, s74
    s_mul_i32 s77, s40, 3072
    s_add_u32 s76, s76, s77
    s_mov_b32 m0, s74
    s_add_u32 s74, s74, 4096
    buffer_load_dwordx4 v2, s[20:23], s75 offen sc1 lds
    s_add_u32 s75, s75, 4096
    s_mov_b32 m0, s74
    s_add_u32 s74, s74, 4096
    buffer_load_dwordx4 v2, s[20:23], s75 offen sc1 lds
    s_add_u32 s75, s75, 4096
    s_mov_b32 m0, s74
    s_add_u32 s74, s74, 4096
    buffer_load_dwordx4 v2, s[20:23], s75 offen sc1 lds
    s_add_u32 s75, s75, 4096
    s_mov_b32 m0, s74
    s_add_u32 s74, s74, 4096
    buffer_load_dwordx4 v2, s[20:23], s75 offen sc1 lds
    s_add_u32 s75, s75, 4096
    s_mov_b32 m0, s74
    s_add_u32 s74, s74, 4096
    buffer_load_dwordx4 v2, s[20:23], s75 offen sc1 lds
    s_add_u32 s75, s75, 4096
    s_mov_b32 m0, s74
    s_add_u32 s74, s74, 4096
    buffer_load_dwordx4 v2, s[20:23], s75 offen sc1 lds
    s_add_u32 s75, s75, 4096
    s_mov_b32 m0, s74
    s_add_u32 s74, s74, 4096
    buffer_load_dwordx4 v2, s[20:23], s75 offen sc1 lds
    s_add_u32 s75, s75, 4096
    s_mov_b32 m0, s74
    s_add_u32 s74, s74, 4096
    buffer_load_dwordx4 v2, s[68:71], s76 offen sc1 lds
    s_add_u32 s76, s76, 4096
    s_mov_b32 m0, s74
    s_add_u32 s74, s74, 4096
    buffer_load_dwordx4 v2, s[68:71], s76 offen sc1 lds
    s_add_u32 s76, s76, 4096
    s_mov_b32 m0, s74
    s_add_u32 s74, s74, 4096
    buffer_load_dwordx4 v2, s[68:71], s76 offen sc1 lds
    s_add_u32 s76, s76, 4096
    s_mov_b32 m0, s74
    s_add_u32 s74, s74, 4096
    buffer_load_dwordx4 v2, s[68:71], s76 offen sc1 lds
    s_add_u32 s76, s76, 4096
    s_mov_b32 m0, s74
    s_add_u32 s74, s74, 4096
    buffer_load_dwordx4 v2, s[68:71], s76 offen sc1 lds
    s_add_u32 s76, s76, 4096
    s_waitcnt vmcnt(0)
    s_barrier
K3_pf:
    s_cmp_ge_u32 s40, 6
    s_cbranch_scc1 K4_helper
    s_barrier
    s_branch K4_helper
K4_compute:
    s_mov_b32 s40, s34
    s_mov_b32 s41, s35
    s_lshl_b32 s43, s34, 12
    s_add_u32 s43, s43, 458752
    s_mov_b32 s91, 0x10000
    s_mov_b32 exec_lo, 4294967295
    s_mov_b32 exec_hi, 0
    s_branch L_poll_40_1
L_poll_40:
    buffer_load_dword v160, v161, s[36:39], s43 offen sc1
    s_waitcnt vmcnt(0)
L_poll_40_1:
    v_cmp_eq_u32 vcc, s101, v160
    s_nop 1
    s_cmp_eq_u64 vcc, exec
    s_cbranch_scc1 L_poll_40_ok
    s_sleep 2
    s_sub_u32 s91, s91, 1
    s_cbranch_scc0 L_poll_40
L_poll_40_ok:
    s_mov_b64 exec, -1
    s_lshl_b32 s46, s40, 2
    s_add_u32 s46, s46, s3
    s_mul_i32 s31, s46, 333824
    s_add_u32 s20, s14, 10440704
    s_addc_u32 s21, s15, 0
    s_mov_b32 s22, 10878976
    s_mov_b32 s23, 0x00020000
    buffer_load_dwordx4 v[176:179], v2, s[20:23], s31 offen offset:0 sc1
    buffer_load_dwordx4 v[180:183], v2, s[20:23], s31 offen offset:1024 sc1
    buffer_load_dwordx4 v[184:187], v2, s[20:23], s31 offen offset:2048 sc1
    buffer_load_dwordx4 v[188:191], v2, s[20:23], s31 offen offset:3072 sc1
    s_add_u32 s31, s31, 4096
    buffer_load_dwordx4 v[192:195], v2, s[20:23], s31 offen offset:0 sc1
    buffer_load_dwordx4 v[196:199], v2, s[20:23], s31 offen offset:1024 sc1
    buffer_load_dwordx4 v[200:203], v2, s[20:23], s31 offen offset:2048 sc1
    buffer_load_dwordx4 v[204:207], v2, s[20:23], s31 offen offset:3072 sc1
    s_add_u32 s31, s31, 4096
    buffer_load_dwordx4 v[208:211], v2, s[20:23], s31 offen offset:0 sc1
    buffer_load_dwordx4 v[212:215], v2, s[20:23], s31 offen offset:1024 sc1
    buffer_load_dwordx4 v[216:219], v2, s[20:23], s31 offen offset:2048 sc1
    buffer_load_dwordx4 v[220:223], v2, s[20:23], s31 offen offset:3072 sc1
    s_add_u32 s31, s31, 4096
    buffer_load_dwordx4 v[224:227], v2, s[20:23], s31 offen offset:0 sc1
    buffer_load_dwordx4 v[228:231], v2, s[20:23], s31 offen offset:1024 sc1
    buffer_load_dwordx4 v[232:235], v2, s[20:23], s31 offen offset:2048 sc1
    buffer_load_dwordx4 v[236:239], v2, s[20:23], s31 offen offset:3072 sc1
    s_add_u32 s31, s31, 4096
    buffer_load_dwordx4 v[240:243], v2, s[20:23], s31 offen offset:0 sc1
    buffer_load_dwordx4 v[244:247], v2, s[20:23], s31 offen offset:1024 sc1
    s_setprio 2
    v_add_u32 v3, 0x10000, v2
    v_add_u32 v4, 0x20000, v2
    s_mul_i32 s42, s3, 3
    s_lshr_b32 s43, s42, 1
    s_lshl_b32 s43, s43, 12
    s_and_b32 s44, s42, 1
    s_lshl_b32 s45, s44, 3
    s_add_u32 s43, s43, s45
    s_add_u32 s43, s43, 77824
    v_add_u32 v5, s43, v2
    s_mul_i32 s45, s44, 4080
    s_add_u32 s45, s45, 8
    v_add_u32 v6, s45, v5
    v_and_b32 v12, 15, v0
    v_lshrrev_b32 v13, 4, v0
    s_lshr_b32 s45, s3, 1
    v_lshl_add_u32 v13, v13, 1, s45
    v_and_b32 v14, 7, v0
    v_xor_b32 v13, v13, v14
    s_and_b32 s45, s3, 1
    s_lshl_b32 s45, s45, 3
    v_lshl_add_u32 v13, v13, 4, s45
    v_lshl_add_u32 v7, v12, 7, v13
    v_add_u32 v8, 0x8000, v7
    v_mov_b32 v10, 1
    v_mov_b32 v11, 151552
    s_barrier
    ds_read_b128 v[112:115], v2 offset:0
    ds_read_b128 v[116:119], v2 offset:18432
    ds_read_b128 v[120:123], v2 offset:36864
    ds_read_b128 v[124:127], v2 offset:55296
    ds_read_b128 v[128:131], v2 offset:1024
    ds_read_b128 v[132:135], v2 offset:19456
    ds_read_b128 v[136:139], v2 offset:37888
    ds_read_b128 v[140:143], v2 offset:56320
    s_waitcnt vmcnt(15) lgkmcnt(4)
    v_mfma_f32_16x16x32_bf16 v[16:19], v[176:179], v[112:115], 0
    buffer_load_dwordx4 v[248:251], v2, s[20:23], s31 offen offset:2048 sc1
    v_mfma_f32_16x16x32_bf16 v[20:23], v[176:179], v[116:119], 0
    ds_read_b128 v[144:147], v2 offset:2048
    v_mfma_f32_16x16x32_bf16 v[24:27], v[176:179], v[120:123], 0
    buffer_load_dwordx4 v[252:255], v2, s[20:23], s31 offen offset:3072 sc1
    v_mfma_f32_16x16x32_bf16 v[28:31], v[176:179], v[124:127], 0
    ds_read_b128 v[148:151], v2 offset:20480
    v_mfma_f32_16x16x32_bf16 v[32:35], v[180:183], v[112:115], 0
    s_add_u32 s31, s31, 4096
    buffer_load_dwordx4 v[176:179], v2, s[20:23], s31 offen offset:0 sc1
    v_mfma_f32_16x16x32_bf16 v[36:39], v[180:183], v[116:119], 0
    ds_read_b128 v[152:155], v2 offset:38912
    v_mfma_f32_16x16x32_bf16 v[40:43], v[180:183], v[120:123], 0
    v_mfma_f32_16x16x32_bf16 v[44:47], v[180:183], v[124:127], 0
    ds_read_b128 v[156:159], v2 offset:57344
    v_mfma_f32_16x16x32_bf16 v[48:51], v[184:187], v[112:115], 0
    buffer_load_dwordx4 v[180:183], v2, s[20:23], s31 offen offset:1024 sc1
    v_mfma_f32_16x16x32_bf16 v[52:55], v[184:187], v[116:119], 0
    v_mfma_f32_16x16x32_bf16 v[56:59], v[184:187], v[120:123], 0
    v_mfma_f32_16x16x32_bf16 v[60:63], v[184:187], v[124:127], 0
    s_barrier
    s_waitcnt vmcnt(16) lgkmcnt(4)
    v_mfma_f32_16x16x32_bf16 v[16:19], v[188:191], v[128:131], v[16:19]
    buffer_load_dwordx4 v[184:187], v2, s[20:23], s31 offen offset:2048 sc1
    v_mfma_f32_16x16x32_bf16 v[20:23], v[188:191], v[132:135], v[20:23]
    ds_read_b128 v[112:115], v2 offset:3072
    v_mfma_f32_16x16x32_bf16 v[24:27], v[188:191], v[136:139], v[24:27]
    v_mfma_f32_16x16x32_bf16 v[28:31], v[188:191], v[140:143], v[28:31]
    ds_read_b128 v[116:119], v2 offset:21504
    v_mfma_f32_16x16x32_bf16 v[32:35], v[192:195], v[128:131], v[32:35]
    buffer_load_dwordx4 v[188:191], v2, s[20:23], s31 offen offset:3072 sc1
    v_mfma_f32_16x16x32_bf16 v[36:39], v[192:195], v[132:135], v[36:39]
    ds_read_b128 v[120:123], v2 offset:39936
    v_mfma_f32_16x16x32_bf16 v[40:43], v[192:195], v[136:139], v[40:43]
    v_mfma_f32_16x16x32_bf16 v[44:47], v[192:195], v[140:143], v[44:47]
    ds_read_b128 v[124:127], v2 offset:58368
    v_mfma_f32_16x16x32_bf16 v[48:51], v[196:199], v[128:131], v[48:51]
    s_add_u32 s31, s31, 4096
    buffer_load_dwordx4 v[192:195], v2, s[20:23], s31 offen offset:0 sc1
    v_mfma_f32_16x16x32_bf16 v[52:55], v[196:199], v[132:135], v[52:55]
    v_mfma_f32_16x16x32_bf16 v[56:59], v[196:199], v[136:139], v[56:59]
    v_mfma_f32_16x16x32_bf16 v[60:63], v[196:199], v[140:143], v[60:63]
    s_waitcnt vmcnt(16) lgkmcnt(4)
    v_mfma_f32_16x16x32_bf16 v[16:19], v[200:203], v[144:147], v[16:19]
    buffer_load_dwordx4 v[196:199], v2, s[20:23], s31 offen offset:1024 sc1
    v_mfma_f32_16x16x32_bf16 v[20:23], v[200:203], v[148:151], v[20:23]
    ds_read_b128 v[128:131], v2 offset:4096
    v_mfma_f32_16x16x32_bf16 v[24:27], v[200:203], v[152:155], v[24:27]
    v_mfma_f32_16x16x32_bf16 v[28:31], v[200:203], v[156:159], v[28:31]
    ds_read_b128 v[132:135], v2 offset:22528
    v_mfma_f32_16x16x32_bf16 v[32:35], v[204:207], v[144:147], v[32:35]
    buffer_load_dwordx4 v[200:203], v2, s[20:23], s31 offen offset:2048 sc1
    v_mfma_f32_16x16x32_bf16 v[36:39], v[204:207], v[148:151], v[36:39]
    ds_read_b128 v[136:139], v2 offset:40960
    v_mfma_f32_16x16x32_bf16 v[40:43], v[204:207], v[152:155], v[40:43]
    v_mfma_f32_16x16x32_bf16 v[44:47], v[204:207], v[156:159], v[44:47]
    ds_read_b128 v[140:143], v2 offset:59392
    v_mfma_f32_16x16x32_bf16 v[48:51], v[208:211], v[144:147], v[48:51]
    buffer_load_dwordx4 v[204:207], v2, s[20:23], s31 offen offset:3072 sc1
    v_mfma_f32_16x16x32_bf16 v[52:55], v[208:211], v[148:151], v[52:55]
    v_mfma_f32_16x16x32_bf16 v[56:59], v[208:211], v[152:155], v[56:59]
    v_mfma_f32_16x16x32_bf16 v[60:63], v[208:211], v[156:159], v[60:63]
    s_waitcnt vmcnt(16) lgkmcnt(4)
    v_mfma_f32_16x16x32_bf16 v[16:19], v[212:215], v[112:115], v[16:19]
    s_add_u32 s31, s31, 4096
    buffer_load_dwordx4 v[208:211], v2, s[20:23], s31 offen offset:0 sc1
    v_mfma_f32_16x16x32_bf16 v[20:23], v[212:215], v[116:119], v[20:23]
    ds_read_b128 v[144:147], v2 offset:5120
    v_mfma_f32_16x16x32_bf16 v[24:27], v[212:215], v[120:123], v[24:27]
    v_mfma_f32_16x16x32_bf16 v[28:31], v[212:215], v[124:127], v[28:31]
    ds_read_b128 v[148:151], v2 offset:23552
    v_mfma_f32_16x16x32_bf16 v[32:35], v[216:219], v[112:115], v[32:35]
    buffer_load_dwordx4 v[212:215], v2, s[20:23], s31 offen offset:1024 sc1
    v_mfma_f32_16x16x32_bf16 v[36:39], v[216:219], v[116:119], v[36:39]
    ds_read_b128 v[152:155], v2 offset:41984
    v_mfma_f32_16x16x32_bf16 v[40:43], v[216:219], v[120:123], v[40:43]
    v_mfma_f32_16x16x32_bf16 v[44:47], v[216:219], v[124:127], v[44:47]
    ds_read_b128 v[156:159], v2 offset:60416
    v_mfma_f32_16x16x32_bf16 v[48:51], v[220:223], v[112:115], v[48:51]
    buffer_load_dwordx4 v[216:219], v2, s[20:23], s31 offen offset:2048 sc1
    v_mfma_f32_16x16x32_bf16 v[52:55], v[220:223], v[116:119], v[52:55]
    v_mfma_f32_16x16x32_bf16 v[56:59], v[220:223], v[120:123], v[56:59]
    v_mfma_f32_16x16x32_bf16 v[60:63], v[220:223], v[124:127], v[60:63]
    s_barrier
    s_waitcnt vmcnt(16) lgkmcnt(4)
    v_mfma_f32_16x16x32_bf16 v[16:19], v[224:227], v[128:131], v[16:19]
    buffer_load_dwordx4 v[220:223], v2, s[20:23], s31 offen offset:3072 sc1
    v_mfma_f32_16x16x32_bf16 v[20:23], v[224:227], v[132:135], v[20:23]
    ds_read_b128 v[112:115], v2 offset:6144
    v_mfma_f32_16x16x32_bf16 v[24:27], v[224:227], v[136:139], v[24:27]
    v_mfma_f32_16x16x32_bf16 v[28:31], v[224:227], v[140:143], v[28:31]
    ds_read_b128 v[116:119], v2 offset:24576
    v_mfma_f32_16x16x32_bf16 v[32:35], v[228:231], v[128:131], v[32:35]
    s_add_u32 s31, s31, 4096
    buffer_load_dwordx4 v[224:227], v2, s[20:23], s31 offen offset:0 sc1
    v_mfma_f32_16x16x32_bf16 v[36:39], v[228:231], v[132:135], v[36:39]
    ds_read_b128 v[120:123], v2 offset:43008
    v_mfma_f32_16x16x32_bf16 v[40:43], v[228:231], v[136:139], v[40:43]
    v_mfma_f32_16x16x32_bf16 v[44:47], v[228:231], v[140:143], v[44:47]
    ds_read_b128 v[124:127], v2 offset:61440
    v_mfma_f32_16x16x32_bf16 v[48:51], v[232:235], v[128:131], v[48:51]
    buffer_load_dwordx4 v[228:231], v2, s[20:23], s31 offen offset:1024 sc1
    v_mfma_f32_16x16x32_bf16 v[52:55], v[232:235], v[132:135], v[52:55]
    v_mfma_f32_16x16x32_bf16 v[56:59], v[232:235], v[136:139], v[56:59]
    v_mfma_f32_16x16x32_bf16 v[60:63], v[232:235], v[140:143], v[60:63]
    s_waitcnt vmcnt(16) lgkmcnt(4)
    v_mfma_f32_16x16x32_bf16 v[16:19], v[236:239], v[144:147], v[16:19]
    buffer_load_dwordx4 v[232:235], v2, s[20:23], s31 offen offset:2048 sc1
    v_mfma_f32_16x16x32_bf16 v[20:23], v[236:239], v[148:151], v[20:23]
    ds_read_b128 v[128:131], v2 offset:7168
    v_mfma_f32_16x16x32_bf16 v[24:27], v[236:239], v[152:155], v[24:27]
    v_mfma_f32_16x16x32_bf16 v[28:31], v[236:239], v[156:159], v[28:31]
    ds_read_b128 v[132:135], v2 offset:25600
    v_mfma_f32_16x16x32_bf16 v[32:35], v[240:243], v[144:147], v[32:35]
    buffer_load_dwordx4 v[236:239], v2, s[20:23], s31 offen offset:3072 sc1
    v_mfma_f32_16x16x32_bf16 v[36:39], v[240:243], v[148:151], v[36:39]
    ds_read_b128 v[136:139], v2 offset:44032
    v_mfma_f32_16x16x32_bf16 v[40:43], v[240:243], v[152:155], v[40:43]
    v_mfma_f32_16x16x32_bf16 v[44:47], v[240:243], v[156:159], v[44:47]
    ds_read_b128 v[140:143], v2 offset:62464
    v_mfma_f32_16x16x32_bf16 v[48:51], v[244:247], v[144:147], v[48:51]
    s_add_u32 s31, s31, 4096
    buffer_load_dwordx4 v[240:243], v2, s[20:23], s31 offen offset:0 sc1
    v_mfma_f32_16x16x32_bf16 v[52:55], v[244:247], v[148:151], v[52:55]
    v_mfma_f32_16x16x32_bf16 v[56:59], v[244:247], v[152:155], v[56:59]
    v_mfma_f32_16x16x32_bf16 v[60:63], v[244:247], v[156:159], v[60:63]
    s_waitcnt vmcnt(16) lgkmcnt(4)
    v_mfma_f32_16x16x32_bf16 v[16:19], v[248:251], v[112:115], v[16:19]
    buffer_load_dwordx4 v[244:247], v2, s[20:23], s31 offen offset:1024 sc1
    v_mfma_f32_16x16x32_bf16 v[20:23], v[248:251], v[116:119], v[20:23]
    ds_read_b128 v[144:147], v2 offset:8192
    v_mfma_f32_16x16x32_bf16 v[24:27], v[248:251], v[120:123], v[24:27]
    v_mfma_f32_16x16x32_bf16 v[28:31], v[248:251], v[124:127], v[28:31]
    ds_read_b128 v[148:151], v2 offset:26624
    v_mfma_f32_16x16x32_bf16 v[32:35], v[252:255], v[112:115], v[32:35]
    buffer_load_dwordx4 v[248:251], v2, s[20:23], s31 offen offset:2048 sc1
    v_mfma_f32_16x16x32_bf16 v[36:39], v[252:255], v[116:119], v[36:39]
    ds_read_b128 v[152:155], v2 offset:45056
    v_mfma_f32_16x16x32_bf16 v[40:43], v[252:255], v[120:123], v[40:43]
    v_mfma_f32_16x16x32_bf16 v[44:47], v[252:255], v[124:127], v[44:47]
    ds_read_b128 v[156:159], v2 offset:63488
    v_mfma_f32_16x16x32_bf16 v[48:51], v[176:179], v[112:115], v[48:51]
    buffer_load_dwordx4 v[252:255], v2, s[20:23], s31 offen offset:3072 sc1
    v_mfma_f32_16x16x32_bf16 v[52:55], v[176:179], v[116:119], v[52:55]
    v_mfma_f32_16x16x32_bf16 v[56:59], v[176:179], v[120:123], v[56:59]
    v_mfma_f32_16x16x32_bf16 v[60:63], v[176:179], v[124:127], v[60:63]
    s_barrier
    s_waitcnt vmcnt(16) lgkmcnt(4)
    v_mfma_f32_16x16x32_bf16 v[16:19], v[180:183], v[128:131], v[16:19]
    s_add_u32 s31, s31, 4096
    buffer_load_dwordx4 v[176:179], v2, s[20:23], s31 offen offset:0 sc1
    v_mfma_f32_16x16x32_bf16 v[20:23], v[180:183], v[132:135], v[20:23]
    ds_read_b128 v[112:115], v2 offset:9216
    v_mfma_f32_16x16x32_bf16 v[24:27], v[180:183], v[136:139], v[24:27]
    v_mfma_f32_16x16x32_bf16 v[28:31], v[180:183], v[140:143], v[28:31]
    ds_read_b128 v[116:119], v2 offset:27648
    v_mfma_f32_16x16x32_bf16 v[32:35], v[184:187], v[128:131], v[32:35]
    buffer_load_dwordx4 v[180:183], v2, s[20:23], s31 offen offset:1024 sc1
    v_mfma_f32_16x16x32_bf16 v[36:39], v[184:187], v[132:135], v[36:39]
    ds_read_b128 v[120:123], v2 offset:46080
    v_mfma_f32_16x16x32_bf16 v[40:43], v[184:187], v[136:139], v[40:43]
    v_mfma_f32_16x16x32_bf16 v[44:47], v[184:187], v[140:143], v[44:47]
    ds_read_b128 v[124:127], v2 offset:64512
    v_mfma_f32_16x16x32_bf16 v[48:51], v[188:191], v[128:131], v[48:51]
    buffer_load_dwordx4 v[184:187], v2, s[20:23], s31 offen offset:2048 sc1
    v_mfma_f32_16x16x32_bf16 v[52:55], v[188:191], v[132:135], v[52:55]
    v_mfma_f32_16x16x32_bf16 v[56:59], v[188:191], v[136:139], v[56:59]
    v_mfma_f32_16x16x32_bf16 v[60:63], v[188:191], v[140:143], v[60:63]
    s_waitcnt vmcnt(16) lgkmcnt(4)
    v_mfma_f32_16x16x32_bf16 v[16:19], v[192:195], v[144:147], v[16:19]
    buffer_load_dwordx4 v[188:191], v2, s[20:23], s31 offen offset:3072 sc1
    v_mfma_f32_16x16x32_bf16 v[20:23], v[192:195], v[148:151], v[20:23]
    ds_read_b128 v[128:131], v2 offset:10240
    v_mfma_f32_16x16x32_bf16 v[24:27], v[192:195], v[152:155], v[24:27]
    v_mfma_f32_16x16x32_bf16 v[28:31], v[192:195], v[156:159], v[28:31]
    ds_read_b128 v[132:135], v2 offset:28672
    v_mfma_f32_16x16x32_bf16 v[32:35], v[196:199], v[144:147], v[32:35]
    s_add_u32 s31, s31, 4096
    buffer_load_dwordx4 v[192:195], v2, s[20:23], s31 offen offset:0 sc1
    v_mfma_f32_16x16x32_bf16 v[36:39], v[196:199], v[148:151], v[36:39]
    ds_read_b128 v[136:139], v2 offset:47104
    v_mfma_f32_16x16x32_bf16 v[40:43], v[196:199], v[152:155], v[40:43]
    v_mfma_f32_16x16x32_bf16 v[44:47], v[196:199], v[156:159], v[44:47]
    ds_read_b128 v[140:143], v3 offset:0
    v_mfma_f32_16x16x32_bf16 v[48:51], v[200:203], v[144:147], v[48:51]
    buffer_load_dwordx4 v[196:199], v2, s[20:23], s31 offen offset:1024 sc1
    v_mfma_f32_16x16x32_bf16 v[52:55], v[200:203], v[148:151], v[52:55]
    v_mfma_f32_16x16x32_bf16 v[56:59], v[200:203], v[152:155], v[56:59]
    v_mfma_f32_16x16x32_bf16 v[60:63], v[200:203], v[156:159], v[60:63]
    s_waitcnt vmcnt(16) lgkmcnt(4)
    v_mfma_f32_16x16x32_bf16 v[16:19], v[204:207], v[112:115], v[16:19]
    buffer_load_dwordx4 v[200:203], v2, s[20:23], s31 offen offset:2048 sc1
    v_mfma_f32_16x16x32_bf16 v[20:23], v[204:207], v[116:119], v[20:23]
    ds_read_b128 v[144:147], v2 offset:11264
    v_mfma_f32_16x16x32_bf16 v[24:27], v[204:207], v[120:123], v[24:27]
    v_mfma_f32_16x16x32_bf16 v[28:31], v[204:207], v[124:127], v[28:31]
    ds_read_b128 v[148:151], v2 offset:29696
    v_mfma_f32_16x16x32_bf16 v[32:35], v[208:211], v[112:115], v[32:35]
    buffer_load_dwordx4 v[204:207], v2, s[20:23], s31 offen offset:3072 sc1
    v_mfma_f32_16x16x32_bf16 v[36:39], v[208:211], v[116:119], v[36:39]
    ds_read_b128 v[152:155], v2 offset:48128
    v_mfma_f32_16x16x32_bf16 v[40:43], v[208:211], v[120:123], v[40:43]
    v_mfma_f32_16x16x32_bf16 v[44:47], v[208:211], v[124:127], v[44:47]
    ds_read_b128 v[156:159], v3 offset:1024
    v_mfma_f32_16x16x32_bf16 v[48:51], v[212:215], v[112:115], v[48:51]
    s_add_u32 s31, s31, 4096
    buffer_load_dwordx4 v[208:211], v2, s[20:23], s31 offen offset:0 sc1
    v_mfma_f32_16x16x32_bf16 v[52:55], v[212:215], v[116:119], v[52:55]
    v_mfma_f32_16x16x32_bf16 v[56:59], v[212:215], v[120:123], v[56:59]
    v_mfma_f32_16x16x32_bf16 v[60:63], v[212:215], v[124:127], v[60:63]
    s_barrier
    s_waitcnt vmcnt(16) lgkmcnt(4)
    v_mfma_f32_16x16x32_bf16 v[16:19], v[216:219], v[128:131], v[16:19]
    buffer_load_dwordx4 v[212:215], v2, s[20:23], s31 offen offset:1024 sc1
    v_mfma_f32_16x16x32_bf16 v[20:23], v[216:219], v[132:135], v[20:23]
    ds_read_b128 v[112:115], v2 offset:12288
    v_mfma_f32_16x16x32_bf16 v[24:27], v[216:219], v[136:139], v[24:27]
    v_mfma_f32_16x16x32_bf16 v[28:31], v[216:219], v[140:143], v[28:31]
    ds_read_b128 v[116:119], v2 offset:30720
    v_mfma_f32_16x16x32_bf16 v[32:35], v[220:223], v[128:131], v[32:35]
    buffer_load_dwordx4 v[216:219], v2, s[20:23], s31 offen offset:2048 sc1
    v_mfma_f32_16x16x32_bf16 v[36:39], v[220:223], v[132:135], v[36:39]
    ds_read_b128 v[120:123], v2 offset:49152
    v_mfma_f32_16x16x32_bf16 v[40:43], v[220:223], v[136:139], v[40:43]
    v_mfma_f32_16x16x32_bf16 v[44:47], v[220:223], v[140:143], v[44:47]
    ds_read_b128 v[124:127], v3 offset:2048
    v_mfma_f32_16x16x32_bf16 v[48:51], v[224:227], v[128:131], v[48:51]
    buffer_load_dwordx4 v[220:223], v2, s[20:23], s31 offen offset:3072 sc1
    v_mfma_f32_16x16x32_bf16 v[52:55], v[224:227], v[132:135], v[52:55]
    v_mfma_f32_16x16x32_bf16 v[56:59], v[224:227], v[136:139], v[56:59]
    v_mfma_f32_16x16x32_bf16 v[60:63], v[224:227], v[140:143], v[60:63]
    s_waitcnt vmcnt(16) lgkmcnt(4)
    v_mfma_f32_16x16x32_bf16 v[16:19], v[228:231], v[144:147], v[16:19]
    s_add_u32 s31, s31, 4096
    buffer_load_dwordx4 v[224:227], v2, s[20:23], s31 offen offset:0 sc1
    v_mfma_f32_16x16x32_bf16 v[20:23], v[228:231], v[148:151], v[20:23]
    ds_read_b128 v[128:131], v2 offset:13312
    v_mfma_f32_16x16x32_bf16 v[24:27], v[228:231], v[152:155], v[24:27]
    v_mfma_f32_16x16x32_bf16 v[28:31], v[228:231], v[156:159], v[28:31]
    ds_read_b128 v[132:135], v2 offset:31744
    v_mfma_f32_16x16x32_bf16 v[32:35], v[232:235], v[144:147], v[32:35]
    buffer_load_dwordx4 v[228:231], v2, s[20:23], s31 offen offset:1024 sc1
    v_mfma_f32_16x16x32_bf16 v[36:39], v[232:235], v[148:151], v[36:39]
    ds_read_b128 v[136:139], v2 offset:50176
    v_mfma_f32_16x16x32_bf16 v[40:43], v[232:235], v[152:155], v[40:43]
    v_mfma_f32_16x16x32_bf16 v[44:47], v[232:235], v[156:159], v[44:47]
    ds_read_b128 v[140:143], v3 offset:3072
    v_mfma_f32_16x16x32_bf16 v[48:51], v[236:239], v[144:147], v[48:51]
    buffer_load_dwordx4 v[232:235], v2, s[20:23], s31 offen offset:2048 sc1
    v_mfma_f32_16x16x32_bf16 v[52:55], v[236:239], v[148:151], v[52:55]
    v_mfma_f32_16x16x32_bf16 v[56:59], v[236:239], v[152:155], v[56:59]
    v_mfma_f32_16x16x32_bf16 v[60:63], v[236:239], v[156:159], v[60:63]
    s_waitcnt vmcnt(16) lgkmcnt(4)
    v_mfma_f32_16x16x32_bf16 v[16:19], v[240:243], v[112:115], v[16:19]
    buffer_load_dwordx4 v[236:239], v2, s[20:23], s31 offen offset:3072 sc1
    v_mfma_f32_16x16x32_bf16 v[20:23], v[240:243], v[116:119], v[20:23]
    ds_read_b128 v[144:147], v2 offset:14336
    v_mfma_f32_16x16x32_bf16 v[24:27], v[240:243], v[120:123], v[24:27]
    v_mfma_f32_16x16x32_bf16 v[28:31], v[240:243], v[124:127], v[28:31]
    ds_read_b128 v[148:151], v2 offset:32768
    v_mfma_f32_16x16x32_bf16 v[32:35], v[244:247], v[112:115], v[32:35]
    s_add_u32 s31, s31, 4096
    buffer_load_dwordx4 v[240:243], v2, s[20:23], s31 offen offset:0 sc1
    v_mfma_f32_16x16x32_bf16 v[36:39], v[244:247], v[116:119], v[36:39]
    ds_read_b128 v[152:155], v2 offset:51200
    v_mfma_f32_16x16x32_bf16 v[40:43], v[244:247], v[120:123], v[40:43]
    v_mfma_f32_16x16x32_bf16 v[44:47], v[244:247], v[124:127], v[44:47]
    ds_read_b128 v[156:159], v3 offset:4096
    v_mfma_f32_16x16x32_bf16 v[48:51], v[248:251], v[112:115], v[48:51]
    buffer_load_dwordx4 v[244:247], v2, s[20:23], s31 offen offset:1024 sc1
    v_mfma_f32_16x16x32_bf16 v[52:55], v[248:251], v[116:119], v[52:55]
    v_mfma_f32_16x16x32_bf16 v[56:59], v[248:251], v[120:123], v[56:59]
    v_mfma_f32_16x16x32_bf16 v[60:63], v[248:251], v[124:127], v[60:63]
    s_barrier
    s_waitcnt vmcnt(16) lgkmcnt(4)
    v_mfma_f32_16x16x32_bf16 v[16:19], v[252:255], v[128:131], v[16:19]
    buffer_load_dwordx4 v[248:251], v2, s[20:23], s31 offen offset:2048 sc1
    v_mfma_f32_16x16x32_bf16 v[20:23], v[252:255], v[132:135], v[20:23]
    ds_read_b128 v[112:115], v2 offset:15360
    v_mfma_f32_16x16x32_bf16 v[24:27], v[252:255], v[136:139], v[24:27]
    v_mfma_f32_16x16x32_bf16 v[28:31], v[252:255], v[140:143], v[28:31]
    ds_read_b128 v[116:119], v2 offset:33792
    v_mfma_f32_16x16x32_bf16 v[32:35], v[176:179], v[128:131], v[32:35]
    buffer_load_dwordx4 v[252:255], v2, s[20:23], s31 offen offset:3072 sc1
    v_mfma_f32_16x16x32_bf16 v[36:39], v[176:179], v[132:135], v[36:39]
    ds_read_b128 v[120:123], v2 offset:52224
    v_mfma_f32_16x16x32_bf16 v[40:43], v[176:179], v[136:139], v[40:43]
    v_mfma_f32_16x16x32_bf16 v[44:47], v[176:179], v[140:143], v[44:47]
    ds_read_b128 v[124:127], v3 offset:5120
    v_mfma_f32_16x16x32_bf16 v[48:51], v[180:183], v[128:131], v[48:51]
    s_add_u32 s31, s31, 4096
    buffer_load_dwordx4 v[176:179], v2, s[20:23], s31 offen offset:0 sc1
    v_mfma_f32_16x16x32_bf16 v[52:55], v[180:183], v[132:135], v[52:55]
    v_mfma_f32_16x16x32_bf16 v[56:59], v[180:183], v[136:139], v[56:59]
    v_mfma_f32_16x16x32_bf16 v[60:63], v[180:183], v[140:143], v[60:63]
    s_waitcnt vmcnt(16) lgkmcnt(4)
    v_mfma_f32_16x16x32_bf16 v[16:19], v[184:187], v[144:147], v[16:19]
    buffer_load_dwordx4 v[180:183], v2, s[20:23], s31 offen offset:1024 sc1
    v_mfma_f32_16x16x32_bf16 v[20:23], v[184:187], v[148:151], v[20:23]
    ds_read_b128 v[128:131], v2 offset:16384
    v_mfma_f32_16x16x32_bf16 v[24:27], v[184:187], v[152:155], v[24:27]
    v_mfma_f32_16x16x32_bf16 v[28:31], v[184:187], v[156:159], v[28:31]
    ds_read_b128 v[132:135], v2 offset:34816
    v_mfma_f32_16x16x32_bf16 v[32:35], v[188:191], v[144:147], v[32:35]
    buffer_load_dwordx4 v[184:187], v2, s[20:23], s31 offen offset:2048 sc1
    v_mfma_f32_16x16x32_bf16 v[36:39], v[188:191], v[148:151], v[36:39]
    ds_read_b128 v[136:139], v2 offset:53248
    v_mfma_f32_16x16x32_bf16 v[40:43], v[188:191], v[152:155], v[40:43]
    v_mfma_f32_16x16x32_bf16 v[44:47], v[188:191], v[156:159], v[44:47]
    ds_read_b128 v[140:143], v3 offset:6144
    v_mfma_f32_16x16x32_bf16 v[48:51], v[192:195], v[144:147], v[48:51]
    buffer_load_dwordx4 v[188:191], v2, s[20:23], s31 offen offset:3072 sc1
    v_mfma_f32_16x16x32_bf16 v[52:55], v[192:195], v[148:151], v[52:55]
    v_mfma_f32_16x16x32_bf16 v[56:59], v[192:195], v[152:155], v[56:59]
    v_mfma_f32_16x16x32_bf16 v[60:63], v[192:195], v[156:159], v[60:63]
    s_waitcnt vmcnt(16) lgkmcnt(4)
    v_mfma_f32_16x16x32_bf16 v[16:19], v[196:199], v[112:115], v[16:19]
    s_add_u32 s31, s31, 4096
    buffer_load_dwordx4 v[192:195], v2, s[20:23], s31 offen offset:0 sc1
    v_mfma_f32_16x16x32_bf16 v[20:23], v[196:199], v[116:119], v[20:23]
    ds_read_b128 v[144:147], v2 offset:17408
    v_mfma_f32_16x16x32_bf16 v[24:27], v[196:199], v[120:123], v[24:27]
    v_mfma_f32_16x16x32_bf16 v[28:31], v[196:199], v[124:127], v[28:31]
    ds_read_b128 v[148:151], v2 offset:35840
    v_mfma_f32_16x16x32_bf16 v[32:35], v[200:203], v[112:115], v[32:35]
    buffer_load_dwordx4 v[196:199], v2, s[20:23], s31 offen offset:1024 sc1
    v_mfma_f32_16x16x32_bf16 v[36:39], v[200:203], v[116:119], v[36:39]
    ds_read_b128 v[152:155], v2 offset:54272
    v_mfma_f32_16x16x32_bf16 v[40:43], v[200:203], v[120:123], v[40:43]
    v_mfma_f32_16x16x32_bf16 v[44:47], v[200:203], v[124:127], v[44:47]
    ds_read_b128 v[156:159], v3 offset:7168
    v_mfma_f32_16x16x32_bf16 v[48:51], v[204:207], v[112:115], v[48:51]
    buffer_load_dwordx4 v[200:203], v2, s[20:23], s31 offen offset:2048 sc1
    v_mfma_f32_16x16x32_bf16 v[52:55], v[204:207], v[116:119], v[52:55]
    v_mfma_f32_16x16x32_bf16 v[56:59], v[204:207], v[120:123], v[56:59]
    v_mfma_f32_16x16x32_bf16 v[60:63], v[204:207], v[124:127], v[60:63]
    s_waitcnt vmcnt(16) lgkmcnt(4)
    v_mfma_f32_16x16x32_bf16 v[16:19], v[208:211], v[128:131], v[16:19]
    buffer_load_dwordx4 v[204:207], v2, s[20:23], s31 offen offset:3072 sc1
    v_mfma_f32_16x16x32_bf16 v[20:23], v[208:211], v[132:135], v[20:23]
    ds_read_b128 v[112:115], v2 offset:0
    v_mfma_f32_16x16x32_bf16 v[24:27], v[208:211], v[136:139], v[24:27]
    v_mfma_f32_16x16x32_bf16 v[28:31], v[208:211], v[140:143], v[28:31]
    ds_read_b128 v[116:119], v2 offset:18432
    v_mfma_f32_16x16x32_bf16 v[32:35], v[212:215], v[128:131], v[32:35]
    s_add_u32 s31, s31, 4096
    buffer_load_dwordx4 v[208:211], v2, s[20:23], s31 offen offset:0 sc1
    v_mfma_f32_16x16x32_bf16 v[36:39], v[212:215], v[132:135], v[36:39]
    ds_read_b128 v[120:123], v2 offset:36864
    v_mfma_f32_16x16x32_bf16 v[40:43], v[212:215], v[136:139], v[40:43]
    v_mfma_f32_16x16x32_bf16 v[44:47], v[212:215], v[140:143], v[44:47]
    ds_read_b128 v[124:127], v2 offset:55296
    v_mfma_f32_16x16x32_bf16 v[48:51], v[216:219], v[128:131], v[48:51]
    buffer_load_dwordx4 v[212:215], v2, s[20:23], s31 offen offset:1024 sc1
    v_mfma_f32_16x16x32_bf16 v[52:55], v[216:219], v[132:135], v[52:55]
    v_mfma_f32_16x16x32_bf16 v[56:59], v[216:219], v[136:139], v[56:59]
    v_mfma_f32_16x16x32_bf16 v[60:63], v[216:219], v[140:143], v[60:63]
    s_waitcnt vmcnt(16) lgkmcnt(4)
    v_mfma_f32_16x16x32_bf16 v[16:19], v[220:223], v[144:147], v[16:19]
    buffer_load_dwordx4 v[216:219], v2, s[20:23], s31 offen offset:2048 sc1
    v_mfma_f32_16x16x32_bf16 v[20:23], v[220:223], v[148:151], v[20:23]
    ds_read_b128 v[128:131], v2 offset:1024
    v_mfma_f32_16x16x32_bf16 v[24:27], v[220:223], v[152:155], v[24:27]
    v_mfma_f32_16x16x32_bf16 v[28:31], v[220:223], v[156:159], v[28:31]
    ds_read_b128 v[132:135], v2 offset:19456
    v_mfma_f32_16x16x32_bf16 v[32:35], v[224:227], v[144:147], v[32:35]
    buffer_load_dwordx4 v[220:223], v2, s[20:23], s31 offen offset:3072 sc1
    v_mfma_f32_16x16x32_bf16 v[36:39], v[224:227], v[148:151], v[36:39]
    ds_read_b128 v[136:139], v2 offset:37888
    v_mfma_f32_16x16x32_bf16 v[40:43], v[224:227], v[152:155], v[40:43]
    v_mfma_f32_16x16x32_bf16 v[44:47], v[224:227], v[156:159], v[44:47]
    ds_read_b128 v[140:143], v2 offset:56320
    v_mfma_f32_16x16x32_bf16 v[48:51], v[228:231], v[144:147], v[48:51]
    s_add_u32 s31, s31, 4096
    buffer_load_dwordx4 v[224:227], v2, s[20:23], s31 offen offset:0 sc1
    v_mfma_f32_16x16x32_bf16 v[52:55], v[228:231], v[148:151], v[52:55]
    v_mfma_f32_16x16x32_bf16 v[56:59], v[228:231], v[152:155], v[56:59]
    v_mfma_f32_16x16x32_bf16 v[60:63], v[228:231], v[156:159], v[60:63]
    s_waitcnt vmcnt(16) lgkmcnt(4)
    v_mfma_f32_16x16x32_bf16 v[64:67], v[232:235], v[112:115], 0
    buffer_load_dwordx4 v[228:231], v2, s[20:23], s31 offen offset:1024 sc1
    v_mfma_f32_16x16x32_bf16 v[68:71], v[232:235], v[116:119], 0
    ds_read_b128 v[144:147], v2 offset:2048
    v_mfma_f32_16x16x32_bf16 v[72:75], v[232:235], v[120:123], 0
    v_mfma_f32_16x16x32_bf16 v[76:79], v[232:235], v[124:127], 0
    ds_read_b128 v[148:151], v2 offset:20480
    v_mfma_f32_16x16x32_bf16 v[80:83], v[236:239], v[112:115], 0
    buffer_load_dwordx4 v[232:235], v2, s[20:23], s31 offen offset:2048 sc1
    v_mfma_f32_16x16x32_bf16 v[84:87], v[236:239], v[116:119], 0
    ds_read_b128 v[152:155], v2 offset:38912
    v_mfma_f32_16x16x32_bf16 v[88:91], v[236:239], v[120:123], 0
    v_mfma_f32_16x16x32_bf16 v[92:95], v[236:239], v[124:127], 0
    ds_read_b128 v[156:159], v2 offset:57344
    v_mfma_f32_16x16x32_bf16 v[96:99], v[240:243], v[112:115], 0
    buffer_load_dwordx4 v[236:239], v2, s[20:23], s31 offen offset:3072 sc1
    v_mfma_f32_16x16x32_bf16 v[100:103], v[240:243], v[116:119], 0
    v_cvt_pk_bf16_f32 v160, v16, v17
    v_cvt_pk_bf16_f32 v161, v18, v19
    v_mfma_f32_16x16x32_bf16 v[104:107], v[240:243], v[120:123], 0
    v_pk_max_i16 v160, v160, 0
    v_pk_max_i16 v161, v161, 0
    v_mfma_f32_16x16x32_bf16 v[108:111], v[240:243], v[124:127], 0
    ds_write_b64 v5, v[160:161] offset:0
    v_cvt_pk_bf16_f32 v162, v20, v21
    s_waitcnt vmcnt(16) lgkmcnt(5)
    v_mfma_f32_16x16x32_bf16 v[64:67], v[244:247], v[128:131], v[64:67]
    s_add_u32 s31, s31, 4096
    buffer_load_dwordx4 v[240:243], v2, s[20:23], s31 offen offset:0 sc1
    v_mfma_f32_16x16x32_bf16 v[68:71], v[244:247], v[132:135], v[68:71]
    ds_read_b128 v[112:115], v2 offset:3072
    v_cvt_pk_bf16_f32 v163, v22, v23
    v_mfma_f32_16x16x32_bf16 v[72:75], v[244:247], v[136:139], v[72:75]
    v_pk_max_i16 v162, v162, 0
    v_pk_max_i16 v163, v163, 0
    v_mfma_f32_16x16x32_bf16 v[76:79], v[244:247], v[140:143], v[76:79]
    ds_read_b128 v[116:119], v2 offset:21504
    ds_write_b64 v5, v[162:163] offset:1024
    v_mfma_f32_16x16x32_bf16 v[80:83], v[248:251], v[128:131], v[80:83]
    buffer_load_dwordx4 v[244:247], v2, s[20:23], s31 offen offset:1024 sc1
    v_mfma_f32_16x16x32_bf16 v[84:87], v[248:251], v[132:135], v[84:87]
    ds_read_b128 v[120:123], v2 offset:39936
    v_cvt_pk_bf16_f32 v164, v24, v25
    v_mfma_f32_16x16x32_bf16 v[88:91], v[248:251], v[136:139], v[88:91]
    v_cvt_pk_bf16_f32 v165, v26, v27
    v_pk_max_i16 v164, v164, 0
    v_mfma_f32_16x16x32_bf16 v[92:95], v[248:251], v[140:143], v[92:95]
    ds_read_b128 v[124:127], v2 offset:58368
    v_pk_max_i16 v165, v165, 0
    v_mfma_f32_16x16x32_bf16 v[96:99], v[252:255], v[128:131], v[96:99]
    buffer_load_dwordx4 v[248:251], v2, s[20:23], s31 offen offset:2048 sc1
    v_mfma_f32_16x16x32_bf16 v[100:103], v[252:255], v[132:135], v[100:103]
    ds_write_b64 v5, v[164:165] offset:2048
    v_cvt_pk_bf16_f32 v166, v28, v29
    v_mfma_f32_16x16x32_bf16 v[104:107], v[252:255], v[136:139], v[104:107]
    v_cvt_pk_bf16_f32 v167, v30, v31
    v_pk_max_i16 v166, v166, 0
    v_mfma_f32_16x16x32_bf16 v[108:111], v[252:255], v[140:143], v[108:111]
    v_pk_max_i16 v167, v167, 0
    ds_write_b64 v5, v[166:167] offset:3072
    s_waitcnt vmcnt(16) lgkmcnt(8)
    v_mfma_f32_16x16x32_bf16 v[64:67], v[176:179], v[144:147], v[64:67]
    buffer_load_dwordx4 v[252:255], v2, s[20:23], s31 offen offset:3072 sc1
    v_mfma_f32_16x16x32_bf16 v[68:71], v[176:179], v[148:151], v[68:71]
    ds_read_b128 v[128:131], v2 offset:4096
    v_cvt_pk_bf16_f32 v168, v32, v33
    v_mfma_f32_16x16x32_bf16 v[72:75], v[176:179], v[152:155], v[72:75]
    v_cvt_pk_bf16_f32 v169, v34, v35
    v_pk_max_i16 v168, v168, 0
    v_mfma_f32_16x16x32_bf16 v[76:79], v[176:179], v[156:159], v[76:79]
    ds_read_b128 v[132:135], v2 offset:22528
    v_pk_max_i16 v169, v169, 0
    v_mfma_f32_16x16x32_bf16 v[80:83], v[180:183], v[144:147], v[80:83]
    s_add_u32 s31, s31, 4096
    buffer_load_dwordx4 v[176:179], v2, s[20:23], s31 offen offset:0 sc1
    v_mfma_f32_16x16x32_bf16 v[84:87], v[180:183], v[148:151], v[84:87]
    ds_read_b128 v[136:139], v2 offset:40960
    ds_write_b64 v6, v[168:169] offset:0
    v_mfma_f32_16x16x32_bf16 v[88:91], v[180:183], v[152:155], v[88:91]
    v_cvt_pk_bf16_f32 v170, v36, v37
    v_cvt_pk_bf16_f32 v171, v38, v39
    v_mfma_f32_16x16x32_bf16 v[92:95], v[180:183], v[156:159], v[92:95]
    ds_read_b128 v[140:143], v2 offset:59392
    v_pk_max_i16 v170, v170, 0
    v_mfma_f32_16x16x32_bf16 v[96:99], v[184:187], v[144:147], v[96:99]
    buffer_load_dwordx4 v[180:183], v2, s[20:23], s31 offen offset:1024 sc1
    v_mfma_f32_16x16x32_bf16 v[100:103], v[184:187], v[148:151], v[100:103]
    v_pk_max_i16 v171, v171, 0
    ds_write_b64 v6, v[170:171] offset:1024
    v_mfma_f32_16x16x32_bf16 v[104:107], v[184:187], v[152:155], v[104:107]
    v_cvt_pk_bf16_f32 v172, v40, v41
    v_cvt_pk_bf16_f32 v173, v42, v43
    v_mfma_f32_16x16x32_bf16 v[108:111], v[184:187], v[156:159], v[108:111]
    v_pk_max_i16 v172, v172, 0
    v_pk_max_i16 v173, v173, 0
    s_waitcnt vmcnt(16) lgkmcnt(8)
    v_mfma_f32_16x16x32_bf16 v[64:67], v[188:191], v[112:115], v[64:67]
    buffer_load_dwordx4 v[184:187], v2, s[20:23], s31 offen offset:2048 sc1
    v_mfma_f32_16x16x32_bf16 v[68:71], v[188:191], v[116:119], v[68:71]
    ds_read_b128 v[144:147], v2 offset:5120
    ds_write_b64 v6, v[172:173] offset:2048
    v_mfma_f32_16x16x32_bf16 v[72:75], v[188:191], v[120:123], v[72:75]
    v_cvt_pk_bf16_f32 v174, v44, v45
    v_cvt_pk_bf16_f32 v175, v46, v47
    v_mfma_f32_16x16x32_bf16 v[76:79], v[188:191], v[124:127], v[76:79]
    ds_read_b128 v[148:151], v2 offset:23552
    v_pk_max_i16 v174, v174, 0
    v_mfma_f32_16x16x32_bf16 v[80:83], v[192:195], v[112:115], v[80:83]
    buffer_load_dwordx4 v[188:191], v2, s[20:23], s31 offen offset:3072 sc1
    v_mfma_f32_16x16x32_bf16 v[84:87], v[192:195], v[116:119], v[84:87]
    ds_read_b128 v[152:155], v2 offset:41984
    v_pk_max_i16 v175, v175, 0
    v_mfma_f32_16x16x32_bf16 v[88:91], v[192:195], v[120:123], v[88:91]
    ds_write_b64 v6, v[174:175] offset:3072
    v_cvt_pk_bf16_f32 v160, v48, v49
    v_mfma_f32_16x16x32_bf16 v[92:95], v[192:195], v[124:127], v[92:95]
    ds_read_b128 v[156:159], v2 offset:60416
    v_cvt_pk_bf16_f32 v161, v50, v51
    v_mfma_f32_16x16x32_bf16 v[96:99], v[196:199], v[112:115], v[96:99]
    s_add_u32 s31, s31, 4096
    buffer_load_dwordx4 v[192:195], v2, s[20:23], s31 offen offset:0 sc1
    v_mfma_f32_16x16x32_bf16 v[100:103], v[196:199], v[116:119], v[100:103]
    v_pk_max_i16 v160, v160, 0
    v_pk_max_i16 v161, v161, 0
    v_mfma_f32_16x16x32_bf16 v[104:107], v[196:199], v[120:123], v[104:107]
    ds_write_b64 v5, v[160:161] offset:4096
    v_cvt_pk_bf16_f32 v162, v52, v53
    v_mfma_f32_16x16x32_bf16 v[108:111], v[196:199], v[124:127], v[108:111]
    v_cvt_pk_bf16_f32 v163, v54, v55
    v_pk_max_i16 v162, v162, 0
    s_waitcnt vmcnt(16) lgkmcnt(8)
    v_mfma_f32_16x16x32_bf16 v[64:67], v[200:203], v[128:131], v[64:67]
    buffer_load_dwordx4 v[196:199], v2, s[20:23], s31 offen offset:1024 sc1
    v_mfma_f32_16x16x32_bf16 v[68:71], v[200:203], v[132:135], v[68:71]
    ds_read_b128 v[112:115], v2 offset:6144
    v_pk_max_i16 v163, v163, 0
    v_mfma_f32_16x16x32_bf16 v[72:75], v[200:203], v[136:139], v[72:75]
    ds_write_b64 v5, v[162:163] offset:5120
    v_cvt_pk_bf16_f32 v164, v56, v57
    v_mfma_f32_16x16x32_bf16 v[76:79], v[200:203], v[140:143], v[76:79]
    ds_read_b128 v[116:119], v2 offset:24576
    v_cvt_pk_bf16_f32 v165, v58, v59
    v_mfma_f32_16x16x32_bf16 v[80:83], v[204:207], v[128:131], v[80:83]
    buffer_load_dwordx4 v[200:203], v2, s[20:23], s31 offen offset:2048 sc1
    v_mfma_f32_16x16x32_bf16 v[84:87], v[204:207], v[132:135], v[84:87]
    ds_read_b128 v[120:123], v2 offset:43008
    v_pk_max_i16 v164, v164, 0
    v_mfma_f32_16x16x32_bf16 v[88:91], v[204:207], v[136:139], v[88:91]
    v_pk_max_i16 v165, v165, 0
    ds_write_b64 v5, v[164:165] offset:6144
    v_mfma_f32_16x16x32_bf16 v[92:95], v[204:207], v[140:143], v[92:95]
    ds_read_b128 v[124:127], v2 offset:61440
    v_cvt_pk_bf16_f32 v166, v60, v61
    v_mfma_f32_16x16x32_bf16 v[96:99], v[208:211], v[128:131], v[96:99]
    buffer_load_dwordx4 v[204:207], v2, s[20:23], s31 offen offset:3072 sc1
    v_mfma_f32_16x16x32_bf16 v[100:103], v[208:211], v[132:135], v[100:103]
    v_cvt_pk_bf16_f32 v167, v62, v63
    v_pk_max_i16 v166, v166, 0
    v_mfma_f32_16x16x32_bf16 v[104:107], v[208:211], v[136:139], v[104:107]
    v_pk_max_i16 v167, v167, 0
    ds_write_b64 v5, v[166:167] offset:7168
    v_mfma_f32_16x16x32_bf16 v[108:111], v[208:211], v[140:143], v[108:111]
    s_waitcnt vmcnt(16) lgkmcnt(8)
    v_mfma_f32_16x16x32_bf16 v[64:67], v[212:215], v[144:147], v[64:67]
    s_add_u32 s31, s31, 4096
    buffer_load_dwordx4 v[208:211], v2, s[20:23], s31 offen offset:0 sc1
    v_mfma_f32_16x16x32_bf16 v[68:71], v[212:215], v[148:151], v[68:71]
    ds_read_b128 v[128:131], v2 offset:7168
    v_mfma_f32_16x16x32_bf16 v[72:75], v[212:215], v[152:155], v[72:75]
    v_mfma_f32_16x16x32_bf16 v[76:79], v[212:215], v[156:159], v[76:79]
    ds_read_b128 v[132:135], v2 offset:25600
    v_mfma_f32_16x16x32_bf16 v[80:83], v[216:219], v[144:147], v[80:83]
    buffer_load_dwordx4 v[212:215], v2, s[20:23], s31 offen offset:1024 sc1
    v_mfma_f32_16x16x32_bf16 v[84:87], v[216:219], v[148:151], v[84:87]
    ds_read_b128 v[136:139], v2 offset:44032
    v_mfma_f32_16x16x32_bf16 v[88:91], v[216:219], v[152:155], v[88:91]
    v_mfma_f32_16x16x32_bf16 v[92:95], v[216:219], v[156:159], v[92:95]
    ds_read_b128 v[140:143], v2 offset:62464
    v_mfma_f32_16x16x32_bf16 v[96:99], v[220:223], v[144:147], v[96:99]
    buffer_load_dwordx4 v[216:219], v2, s[20:23], s31 offen offset:2048 sc1
    v_mfma_f32_16x16x32_bf16 v[100:103], v[220:223], v[148:151], v[100:103]
    v_mfma_f32_16x16x32_bf16 v[104:107], v[220:223], v[152:155], v[104:107]
    v_mfma_f32_16x16x32_bf16 v[108:111], v[220:223], v[156:159], v[108:111]
    s_waitcnt vmcnt(16) lgkmcnt(5)
    v_mfma_f32_16x16x32_bf16 v[64:67], v[224:227], v[112:115], v[64:67]
    buffer_load_dwordx4 v[220:223], v2, s[20:23], s31 offen offset:3072 sc1
    v_mfma_f32_16x16x32_bf16 v[68:71], v[224:227], v[116:119], v[68:71]
    ds_read_b128 v[144:147], v2 offset:8192
    v_mfma_f32_16x16x32_bf16 v[72:75], v[224:227], v[120:123], v[72:75]
    v_mfma_f32_16x16x32_bf16 v[76:79], v[224:227], v[124:127], v[76:79]
    ds_read_b128 v[148:151], v2 offset:26624
    v_mfma_f32_16x16x32_bf16 v[80:83], v[228:231], v[112:115], v[80:83]
    s_add_u32 s31, s31, 4096
    buffer_load_dwordx4 v[224:227], v2, s[20:23], s31 offen offset:0 sc1
    v_mfma_f32_16x16x32_bf16 v[84:87], v[228:231], v[116:119], v[84:87]
    ds_read_b128 v[152:155], v2 offset:45056
    v_mfma_f32_16x16x32_bf16 v[88:91], v[228:231], v[120:123], v[88:91]
    v_mfma_f32_16x16x32_bf16 v[92:95], v[228:231], v[124:127], v[92:95]
    ds_read_b128 v[156:159], v2 offset:63488
    v_mfma_f32_16x16x32_bf16 v[96:99], v[232:235], v[112:115], v[96:99]
    buffer_load_dwordx4 v[228:231], v2, s[20:23], s31 offen offset:1024 sc1
    v_mfma_f32_16x16x32_bf16 v[100:103], v[232:235], v[116:119], v[100:103]
    v_mfma_f32_16x16x32_bf16 v[104:107], v[232:235], v[120:123], v[104:107]
    v_mfma_f32_16x16x32_bf16 v[108:111], v[232:235], v[124:127], v[108:111]
    s_waitcnt vmcnt(16) lgkmcnt(4)
    v_mfma_f32_16x16x32_bf16 v[64:67], v[236:239], v[128:131], v[64:67]
    buffer_load_dwordx4 v[232:235], v2, s[20:23], s31 offen offset:2048 sc1
    v_mfma_f32_16x16x32_bf16 v[68:71], v[236:239], v[132:135], v[68:71]
    ds_read_b128 v[112:115], v2 offset:9216
    v_mfma_f32_16x16x32_bf16 v[72:75], v[236:239], v[136:139], v[72:75]
    v_mfma_f32_16x16x32_bf16 v[76:79], v[236:239], v[140:143], v[76:79]
    ds_read_b128 v[116:119], v2 offset:27648
    v_mfma_f32_16x16x32_bf16 v[80:83], v[240:243], v[128:131], v[80:83]
    buffer_load_dwordx4 v[236:239], v2, s[20:23], s31 offen offset:3072 sc1
    v_mfma_f32_16x16x32_bf16 v[84:87], v[240:243], v[132:135], v[84:87]
    ds_read_b128 v[120:123], v2 offset:46080
    v_mfma_f32_16x16x32_bf16 v[88:91], v[240:243], v[136:139], v[88:91]
    v_mfma_f32_16x16x32_bf16 v[92:95], v[240:243], v[140:143], v[92:95]
    ds_read_b128 v[124:127], v2 offset:64512
    v_mfma_f32_16x16x32_bf16 v[96:99], v[244:247], v[128:131], v[96:99]
    s_add_u32 s31, s31, 4096
    buffer_load_dwordx4 v[240:243], v2, s[20:23], s31 offen offset:0 sc1
    v_mfma_f32_16x16x32_bf16 v[100:103], v[244:247], v[132:135], v[100:103]
    v_mfma_f32_16x16x32_bf16 v[104:107], v[244:247], v[136:139], v[104:107]
    v_mfma_f32_16x16x32_bf16 v[108:111], v[244:247], v[140:143], v[108:111]
    s_waitcnt vmcnt(16) lgkmcnt(4)
    v_mfma_f32_16x16x32_bf16 v[64:67], v[248:251], v[144:147], v[64:67]
    buffer_load_dwordx4 v[244:247], v2, s[20:23], s31 offen offset:1024 sc1
    v_mfma_f32_16x16x32_bf16 v[68:71], v[248:251], v[148:151], v[68:71]
    ds_read_b128 v[128:131], v2 offset:10240
    v_mfma_f32_16x16x32_bf16 v[72:75], v[248:251], v[152:155], v[72:75]
    v_mfma_f32_16x16x32_bf16 v[76:79], v[248:251], v[156:159], v[76:79]
    ds_read_b128 v[132:135], v2 offset:28672
    v_mfma_f32_16x16x32_bf16 v[80:83], v[252:255], v[144:147], v[80:83]
    buffer_load_dwordx4 v[248:251], v2, s[20:23], s31 offen offset:2048 sc1
    v_mfma_f32_16x16x32_bf16 v[84:87], v[252:255], v[148:151], v[84:87]
    ds_read_b128 v[136:139], v2 offset:47104
    v_mfma_f32_16x16x32_bf16 v[88:91], v[252:255], v[152:155], v[88:91]
    v_mfma_f32_16x16x32_bf16 v[92:95], v[252:255], v[156:159], v[92:95]
    ds_read_b128 v[140:143], v3 offset:0
    v_mfma_f32_16x16x32_bf16 v[96:99], v[176:179], v[144:147], v[96:99]
    buffer_load_dwordx4 v[252:255], v2, s[20:23], s31 offen offset:3072 sc1
    v_mfma_f32_16x16x32_bf16 v[100:103], v[176:179], v[148:151], v[100:103]
    v_mfma_f32_16x16x32_bf16 v[104:107], v[176:179], v[152:155], v[104:107]
    v_mfma_f32_16x16x32_bf16 v[108:111], v[176:179], v[156:159], v[108:111]
    s_waitcnt vmcnt(16) lgkmcnt(4)
    v_mfma_f32_16x16x32_bf16 v[64:67], v[180:183], v[112:115], v[64:67]
    s_add_u32 s31, s31, 4096
    buffer_load_dwordx4 v[176:179], v2, s[20:23], s31 offen offset:0 sc1
    v_mfma_f32_16x16x32_bf16 v[68:71], v[180:183], v[116:119], v[68:71]
    ds_read_b128 v[144:147], v2 offset:11264
    v_mfma_f32_16x16x32_bf16 v[72:75], v[180:183], v[120:123], v[72:75]
    v_mfma_f32_16x16x32_bf16 v[76:79], v[180:183], v[124:127], v[76:79]
    ds_read_b128 v[148:151], v2 offset:29696
    v_mfma_f32_16x16x32_bf16 v[80:83], v[184:187], v[112:115], v[80:83]
    buffer_load_dwordx4 v[180:183], v2, s[20:23], s31 offen offset:1024 sc1
    v_mfma_f32_16x16x32_bf16 v[84:87], v[184:187], v[116:119], v[84:87]
    ds_read_b128 v[152:155], v2 offset:48128
    v_mfma_f32_16x16x32_bf16 v[88:91], v[184:187], v[120:123], v[88:91]
    v_mfma_f32_16x16x32_bf16 v[92:95], v[184:187], v[124:127], v[92:95]
    ds_read_b128 v[156:159], v3 offset:1024
    v_mfma_f32_16x16x32_bf16 v[96:99], v[188:191], v[112:115], v[96:99]
    buffer_load_dwordx4 v[184:187], v2, s[20:23], s31 offen offset:2048 sc1
    v_mfma_f32_16x16x32_bf16 v[100:103], v[188:191], v[116:119], v[100:103]
    v_mfma_f32_16x16x32_bf16 v[104:107], v[188:191], v[120:123], v[104:107]
    v_mfma_f32_16x16x32_bf16 v[108:111], v[188:191], v[124:127], v[108:111]
    s_waitcnt vmcnt(16) lgkmcnt(4)
    v_mfma_f32_16x16x32_bf16 v[64:67], v[192:195], v[128:131], v[64:67]
    buffer_load_dwordx4 v[188:191], v2, s[20:23], s31 offen offset:3072 sc1
    v_mfma_f32_16x16x32_bf16 v[68:71], v[192:195], v[132:135], v[68:71]
    ds_read_b128 v[112:115], v2 offset:12288
    v_mfma_f32_16x16x32_bf16 v[72:75], v[192:195], v[136:139], v[72:75]
    v_mfma_f32_16x16x32_bf16 v[76:79], v[192:195], v[140:143], v[76:79]
    ds_read_b128 v[116:119], v2 offset:30720
    v_mfma_f32_16x16x32_bf16 v[80:83], v[196:199], v[128:131], v[80:83]
    s_add_u32 s31, s31, 4096
    buffer_load_dwordx4 v[192:195], v2, s[20:23], s31 offen offset:0 sc1
    v_mfma_f32_16x16x32_bf16 v[84:87], v[196:199], v[132:135], v[84:87]
    ds_read_b128 v[120:123], v2 offset:49152
    v_mfma_f32_16x16x32_bf16 v[88:91], v[196:199], v[136:139], v[88:91]
    v_mfma_f32_16x16x32_bf16 v[92:95], v[196:199], v[140:143], v[92:95]
    ds_read_b128 v[124:127], v3 offset:2048
    v_mfma_f32_16x16x32_bf16 v[96:99], v[200:203], v[128:131], v[96:99]
    buffer_load_dwordx4 v[196:199], v2, s[20:23], s31 offen offset:1024 sc1
    v_mfma_f32_16x16x32_bf16 v[100:103], v[200:203], v[132:135], v[100:103]
    v_mfma_f32_16x16x32_bf16 v[104:107], v[200:203], v[136:139], v[104:107]
    v_mfma_f32_16x16x32_bf16 v[108:111], v[200:203], v[140:143], v[108:111]
    s_waitcnt vmcnt(16) lgkmcnt(4)
    v_mfma_f32_16x16x32_bf16 v[64:67], v[204:207], v[144:147], v[64:67]
    buffer_load_dwordx4 v[200:203], v2, s[20:23], s31 offen offset:2048 sc1
    v_mfma_f32_16x16x32_bf16 v[68:71], v[204:207], v[148:151], v[68:71]
    ds_read_b128 v[128:131], v2 offset:13312
    v_mfma_f32_16x16x32_bf16 v[72:75], v[204:207], v[152:155], v[72:75]
    v_mfma_f32_16x16x32_bf16 v[76:79], v[204:207], v[156:159], v[76:79]
    ds_read_b128 v[132:135], v2 offset:31744
    v_mfma_f32_16x16x32_bf16 v[80:83], v[208:211], v[144:147], v[80:83]
    buffer_load_dwordx4 v[204:207], v2, s[20:23], s31 offen offset:3072 sc1
    v_mfma_f32_16x16x32_bf16 v[84:87], v[208:211], v[148:151], v[84:87]
    ds_read_b128 v[136:139], v2 offset:50176
    v_mfma_f32_16x16x32_bf16 v[88:91], v[208:211], v[152:155], v[88:91]
    v_mfma_f32_16x16x32_bf16 v[92:95], v[208:211], v[156:159], v[92:95]
    ds_read_b128 v[140:143], v3 offset:3072
    v_mfma_f32_16x16x32_bf16 v[96:99], v[212:215], v[144:147], v[96:99]
    s_add_u32 s31, s31, 4096
    buffer_load_dwordx4 v[208:211], v2, s[20:23], s31 offen offset:0 sc1
    v_mfma_f32_16x16x32_bf16 v[100:103], v[212:215], v[148:151], v[100:103]
    v_mfma_f32_16x16x32_bf16 v[104:107], v[212:215], v[152:155], v[104:107]
    v_mfma_f32_16x16x32_bf16 v[108:111], v[212:215], v[156:159], v[108:111]
    s_waitcnt vmcnt(16) lgkmcnt(4)
    v_mfma_f32_16x16x32_bf16 v[64:67], v[216:219], v[112:115], v[64:67]
    buffer_load_dwordx4 v[212:215], v2, s[20:23], s31 offen offset:1024 sc1
    v_mfma_f32_16x16x32_bf16 v[68:71], v[216:219], v[116:119], v[68:71]
    ds_read_b128 v[144:147], v2 offset:14336
    v_mfma_f32_16x16x32_bf16 v[72:75], v[216:219], v[120:123], v[72:75]
    v_mfma_f32_16x16x32_bf16 v[76:79], v[216:219], v[124:127], v[76:79]
    ds_read_b128 v[148:151], v2 offset:32768
    v_mfma_f32_16x16x32_bf16 v[80:83], v[220:223], v[112:115], v[80:83]
    buffer_load_dwordx4 v[216:219], v2, s[20:23], s31 offen offset:2048 sc1
    v_mfma_f32_16x16x32_bf16 v[84:87], v[220:223], v[116:119], v[84:87]
    ds_read_b128 v[152:155], v2 offset:51200
    v_mfma_f32_16x16x32_bf16 v[88:91], v[220:223], v[120:123], v[88:91]
    v_mfma_f32_16x16x32_bf16 v[92:95], v[220:223], v[124:127], v[92:95]
    ds_read_b128 v[156:159], v3 offset:4096
    v_mfma_f32_16x16x32_bf16 v[96:99], v[224:227], v[112:115], v[96:99]
    buffer_load_dwordx4 v[220:223], v2, s[20:23], s31 offen offset:3072 sc1
    v_mfma_f32_16x16x32_bf16 v[100:103], v[224:227], v[116:119], v[100:103]
    v_mfma_f32_16x16x32_bf16 v[104:107], v[224:227], v[120:123], v[104:107]
    v_mfma_f32_16x16x32_bf16 v[108:111], v[224:227], v[124:127], v[108:111]
    s_waitcnt vmcnt(16) lgkmcnt(4)
    v_mfma_f32_16x16x32_bf16 v[64:67], v[228:231], v[128:131], v[64:67]
    s_add_u32 s31, s31, 4096
    buffer_load_dwordx4 v[224:227], v2, s[20:23], s31 offen offset:0 sc1
    v_mfma_f32_16x16x32_bf16 v[68:71], v[228:231], v[132:135], v[68:71]
    ds_read_b128 v[112:115], v2 offset:15360
    v_mfma_f32_16x16x32_bf16 v[72:75], v[228:231], v[136:139], v[72:75]
    v_mfma_f32_16x16x32_bf16 v[76:79], v[228:231], v[140:143], v[76:79]
    ds_read_b128 v[116:119], v2 offset:33792
    v_mfma_f32_16x16x32_bf16 v[80:83], v[232:235], v[128:131], v[80:83]
    buffer_load_dwordx4 v[228:231], v2, s[20:23], s31 offen offset:1024 sc1
    v_mfma_f32_16x16x32_bf16 v[84:87], v[232:235], v[132:135], v[84:87]
    ds_read_b128 v[120:123], v2 offset:52224
    v_mfma_f32_16x16x32_bf16 v[88:91], v[232:235], v[136:139], v[88:91]
    v_mfma_f32_16x16x32_bf16 v[92:95], v[232:235], v[140:143], v[92:95]
    ds_read_b128 v[124:127], v3 offset:5120
    v_mfma_f32_16x16x32_bf16 v[96:99], v[236:239], v[128:131], v[96:99]
    buffer_load_dwordx4 v[232:235], v2, s[20:23], s31 offen offset:2048 sc1
    v_mfma_f32_16x16x32_bf16 v[100:103], v[236:239], v[132:135], v[100:103]
    v_mfma_f32_16x16x32_bf16 v[104:107], v[236:239], v[136:139], v[104:107]
    v_mfma_f32_16x16x32_bf16 v[108:111], v[236:239], v[140:143], v[108:111]
    s_waitcnt vmcnt(16) lgkmcnt(4)
    v_mfma_f32_16x16x32_bf16 v[64:67], v[240:243], v[144:147], v[64:67]
    buffer_load_dwordx4 v[236:239], v2, s[20:23], s31 offen offset:3072 sc1
    v_mfma_f32_16x16x32_bf16 v[68:71], v[240:243], v[148:151], v[68:71]
    ds_read_b128 v[128:131], v2 offset:16384
    v_mfma_f32_16x16x32_bf16 v[72:75], v[240:243], v[152:155], v[72:75]
    v_mfma_f32_16x16x32_bf16 v[76:79], v[240:243], v[156:159], v[76:79]
    ds_read_b128 v[132:135], v2 offset:34816
    v_mfma_f32_16x16x32_bf16 v[80:83], v[244:247], v[144:147], v[80:83]
    s_add_u32 s31, s31, 4096
    buffer_load_dwordx4 v[240:243], v2, s[20:23], s31 offen offset:0 sc1
    v_mfma_f32_16x16x32_bf16 v[84:87], v[244:247], v[148:151], v[84:87]
    ds_read_b128 v[136:139], v2 offset:53248
    v_mfma_f32_16x16x32_bf16 v[88:91], v[244:247], v[152:155], v[88:91]
    v_mfma_f32_16x16x32_bf16 v[92:95], v[244:247], v[156:159], v[92:95]
    ds_read_b128 v[140:143], v3 offset:6144
    v_mfma_f32_16x16x32_bf16 v[96:99], v[248:251], v[144:147], v[96:99]
    buffer_load_dwordx4 v[244:247], v2, s[20:23], s31 offen offset:1024 sc1
    v_mfma_f32_16x16x32_bf16 v[100:103], v[248:251], v[148:151], v[100:103]
    v_mfma_f32_16x16x32_bf16 v[104:107], v[248:251], v[152:155], v[104:107]
    v_mfma_f32_16x16x32_bf16 v[108:111], v[248:251], v[156:159], v[108:111]
    s_waitcnt vmcnt(16) lgkmcnt(4)
    v_mfma_f32_16x16x32_bf16 v[64:67], v[252:255], v[112:115], v[64:67]
    buffer_load_dwordx4 v[248:251], v2, s[20:23], s31 offen offset:2048 sc1
    v_mfma_f32_16x16x32_bf16 v[68:71], v[252:255], v[116:119], v[68:71]
    ds_read_b128 v[144:147], v2 offset:17408
    v_mfma_f32_16x16x32_bf16 v[72:75], v[252:255], v[120:123], v[72:75]
    v_mfma_f32_16x16x32_bf16 v[76:79], v[252:255], v[124:127], v[76:79]
    ds_read_b128 v[148:151], v2 offset:35840
    v_mfma_f32_16x16x32_bf16 v[80:83], v[176:179], v[112:115], v[80:83]
    buffer_load_dwordx4 v[252:255], v2, s[20:23], s31 offen offset:3072 sc1
    v_mfma_f32_16x16x32_bf16 v[84:87], v[176:179], v[116:119], v[84:87]
    ds_read_b128 v[152:155], v2 offset:54272
    v_mfma_f32_16x16x32_bf16 v[88:91], v[176:179], v[120:123], v[88:91]
    v_mfma_f32_16x16x32_bf16 v[92:95], v[176:179], v[124:127], v[92:95]
    ds_read_b128 v[156:159], v3 offset:7168
    v_mfma_f32_16x16x32_bf16 v[96:99], v[180:183], v[112:115], v[96:99]
    s_add_u32 s31, s31, 4096
    buffer_load_dwordx4 v[176:179], v2, s[20:23], s31 offen offset:0 sc1
    v_mfma_f32_16x16x32_bf16 v[100:103], v[180:183], v[116:119], v[100:103]
    v_mfma_f32_16x16x32_bf16 v[104:107], v[180:183], v[120:123], v[104:107]
    v_mfma_f32_16x16x32_bf16 v[108:111], v[180:183], v[124:127], v[108:111]
    s_waitcnt vmcnt(16) lgkmcnt(4)
    v_mfma_f32_16x16x32_bf16 v[64:67], v[184:187], v[128:131], v[64:67]
    buffer_load_dwordx4 v[180:183], v2, s[20:23], s31 offen offset:1024 sc1
    v_mfma_f32_16x16x32_bf16 v[68:71], v[184:187], v[132:135], v[68:71]
    ds_read_b128 v[112:115], v2 offset:0
    v_mfma_f32_16x16x32_bf16 v[72:75], v[184:187], v[136:139], v[72:75]
    v_mfma_f32_16x16x32_bf16 v[76:79], v[184:187], v[140:143], v[76:79]
    ds_read_b128 v[116:119], v2 offset:18432
    v_mfma_f32_16x16x32_bf16 v[80:83], v[188:191], v[128:131], v[80:83]
    buffer_load_dwordx4 v[184:187], v2, s[20:23], s31 offen offset:2048 sc1
    v_mfma_f32_16x16x32_bf16 v[84:87], v[188:191], v[132:135], v[84:87]
    ds_read_b128 v[120:123], v2 offset:36864
    v_mfma_f32_16x16x32_bf16 v[88:91], v[188:191], v[136:139], v[88:91]
    v_mfma_f32_16x16x32_bf16 v[92:95], v[188:191], v[140:143], v[92:95]
    ds_read_b128 v[124:127], v2 offset:55296
    v_mfma_f32_16x16x32_bf16 v[96:99], v[192:195], v[128:131], v[96:99]
    buffer_load_dwordx4 v[188:191], v2, s[20:23], s31 offen offset:3072 sc1
    v_mfma_f32_16x16x32_bf16 v[100:103], v[192:195], v[132:135], v[100:103]
    v_mfma_f32_16x16x32_bf16 v[104:107], v[192:195], v[136:139], v[104:107]
    v_mfma_f32_16x16x32_bf16 v[108:111], v[192:195], v[140:143], v[108:111]
    s_waitcnt vmcnt(16) lgkmcnt(4)
    v_mfma_f32_16x16x32_bf16 v[64:67], v[196:199], v[144:147], v[64:67]
    s_add_u32 s31, s31, 4096
    buffer_load_dwordx4 v[192:195], v2, s[20:23], s31 offen offset:0 sc1
    v_mfma_f32_16x16x32_bf16 v[68:71], v[196:199], v[148:151], v[68:71]
    ds_read_b128 v[128:131], v2 offset:1024
    v_mfma_f32_16x16x32_bf16 v[72:75], v[196:199], v[152:155], v[72:75]
    v_mfma_f32_16x16x32_bf16 v[76:79], v[196:199], v[156:159], v[76:79]
    ds_read_b128 v[132:135], v2 offset:19456
    v_mfma_f32_16x16x32_bf16 v[80:83], v[200:203], v[144:147], v[80:83]
    buffer_load_dwordx4 v[196:199], v2, s[20:23], s31 offen offset:1024 sc1
    v_mfma_f32_16x16x32_bf16 v[84:87], v[200:203], v[148:151], v[84:87]
    ds_read_b128 v[136:139], v2 offset:37888
    v_mfma_f32_16x16x32_bf16 v[88:91], v[200:203], v[152:155], v[88:91]
    v_mfma_f32_16x16x32_bf16 v[92:95], v[200:203], v[156:159], v[92:95]
    ds_read_b128 v[140:143], v2 offset:56320
    v_mfma_f32_16x16x32_bf16 v[96:99], v[204:207], v[144:147], v[96:99]
    buffer_load_dwordx4 v[200:203], v2, s[20:23], s31 offen offset:2048 sc1
    v_mfma_f32_16x16x32_bf16 v[100:103], v[204:207], v[148:151], v[100:103]
    v_mfma_f32_16x16x32_bf16 v[104:107], v[204:207], v[152:155], v[104:107]
    v_mfma_f32_16x16x32_bf16 v[108:111], v[204:207], v[156:159], v[108:111]
    s_waitcnt vmcnt(16) lgkmcnt(4)
    v_mfma_f32_16x16x32_bf16 v[16:19], v[208:211], v[112:115], 0
    buffer_load_dwordx4 v[204:207], v2, s[20:23], s31 offen offset:3072 sc1
    v_mfma_f32_16x16x32_bf16 v[20:23], v[208:211], v[116:119], 0
    ds_read_b128 v[144:147], v2 offset:2048
    v_mfma_f32_16x16x32_bf16 v[24:27], v[208:211], v[120:123], 0
    v_mfma_f32_16x16x32_bf16 v[28:31], v[208:211], v[124:127], 0
    ds_read_b128 v[148:151], v2 offset:20480
    v_mfma_f32_16x16x32_bf16 v[32:35], v[212:215], v[112:115], 0
    s_add_u32 s31, s31, 4096
    buffer_load_dwordx4 v[208:211], v2, s[20:23], s31 offen offset:0 sc1
    v_mfma_f32_16x16x32_bf16 v[36:39], v[212:215], v[116:119], 0
    ds_read_b128 v[152:155], v2 offset:38912
    v_mfma_f32_16x16x32_bf16 v[40:43], v[212:215], v[120:123], 0
    v_mfma_f32_16x16x32_bf16 v[44:47], v[212:215], v[124:127], 0
    ds_read_b128 v[156:159], v2 offset:57344
    v_mfma_f32_16x16x32_bf16 v[48:51], v[216:219], v[112:115], 0
    buffer_load_dwordx4 v[212:215], v2, s[20:23], s31 offen offset:1024 sc1
    v_mfma_f32_16x16x32_bf16 v[52:55], v[216:219], v[116:119], 0
    v_cvt_pk_bf16_f32 v160, v64, v65
    v_cvt_pk_bf16_f32 v161, v66, v67
    v_mfma_f32_16x16x32_bf16 v[56:59], v[216:219], v[120:123], 0
    v_pk_max_i16 v160, v160, 0
    v_pk_max_i16 v161, v161, 0
    v_mfma_f32_16x16x32_bf16 v[60:63], v[216:219], v[124:127], 0
    ds_write_b64 v5, v[160:161] offset:24576
    v_cvt_pk_bf16_f32 v162, v68, v69
    s_waitcnt vmcnt(16) lgkmcnt(5)
    v_mfma_f32_16x16x32_bf16 v[16:19], v[220:223], v[128:131], v[16:19]
    buffer_load_dwordx4 v[216:219], v2, s[20:23], s31 offen offset:2048 sc1
    v_mfma_f32_16x16x32_bf16 v[20:23], v[220:223], v[132:135], v[20:23]
    ds_read_b128 v[112:115], v2 offset:3072
    v_cvt_pk_bf16_f32 v163, v70, v71
    v_mfma_f32_16x16x32_bf16 v[24:27], v[220:223], v[136:139], v[24:27]
    v_pk_max_i16 v162, v162, 0
    v_pk_max_i16 v163, v163, 0
    v_mfma_f32_16x16x32_bf16 v[28:31], v[220:223], v[140:143], v[28:31]
    ds_read_b128 v[116:119], v2 offset:21504
    ds_write_b64 v5, v[162:163] offset:25600
    v_mfma_f32_16x16x32_bf16 v[32:35], v[224:227], v[128:131], v[32:35]
    buffer_load_dwordx4 v[220:223], v2, s[20:23], s31 offen offset:3072 sc1
    v_mfma_f32_16x16x32_bf16 v[36:39], v[224:227], v[132:135], v[36:39]
    ds_read_b128 v[120:123], v2 offset:39936
    v_cvt_pk_bf16_f32 v164, v72, v73
    v_mfma_f32_16x16x32_bf16 v[40:43], v[224:227], v[136:139], v[40:43]
    v_cvt_pk_bf16_f32 v165, v74, v75
    v_pk_max_i16 v164, v164, 0
    v_mfma_f32_16x16x32_bf16 v[44:47], v[224:227], v[140:143], v[44:47]
    ds_read_b128 v[124:127], v2 offset:58368
    v_pk_max_i16 v165, v165, 0
    v_mfma_f32_16x16x32_bf16 v[48:51], v[228:231], v[128:131], v[48:51]
    s_add_u32 s31, s31, 4096
    buffer_load_dwordx4 v[224:227], v2, s[20:23], s31 offen offset:0 sc1
    v_mfma_f32_16x16x32_bf16 v[52:55], v[228:231], v[132:135], v[52:55]
    ds_write_b64 v5, v[164:165] offset:26624
    v_cvt_pk_bf16_f32 v166, v76, v77
    v_mfma_f32_16x16x32_bf16 v[56:59], v[228:231], v[136:139], v[56:59]
    v_cvt_pk_bf16_f32 v167, v78, v79
    v_pk_max_i16 v166, v166, 0
    v_mfma_f32_16x16x32_bf16 v[60:63], v[228:231], v[140:143], v[60:63]
    v_pk_max_i16 v167, v167, 0
    ds_write_b64 v5, v[166:167] offset:27648
    s_waitcnt vmcnt(16) lgkmcnt(8)
    v_mfma_f32_16x16x32_bf16 v[16:19], v[232:235], v[144:147], v[16:19]
    buffer_load_dwordx4 v[228:231], v2, s[20:23], s31 offen offset:1024 sc1
    v_mfma_f32_16x16x32_bf16 v[20:23], v[232:235], v[148:151], v[20:23]
    ds_read_b128 v[128:131], v2 offset:4096
    v_cvt_pk_bf16_f32 v168, v80, v81
    v_mfma_f32_16x16x32_bf16 v[24:27], v[232:235], v[152:155], v[24:27]
    v_cvt_pk_bf16_f32 v169, v82, v83
    v_pk_max_i16 v168, v168, 0
    v_mfma_f32_16x16x32_bf16 v[28:31], v[232:235], v[156:159], v[28:31]
    ds_read_b128 v[132:135], v2 offset:22528
    v_pk_max_i16 v169, v169, 0
    v_mfma_f32_16x16x32_bf16 v[32:35], v[236:239], v[144:147], v[32:35]
    buffer_load_dwordx4 v[232:235], v2, s[20:23], s31 offen offset:2048 sc1
    v_mfma_f32_16x16x32_bf16 v[36:39], v[236:239], v[148:151], v[36:39]
    ds_read_b128 v[136:139], v2 offset:40960
    ds_write_b64 v6, v[168:169] offset:24576
    v_mfma_f32_16x16x32_bf16 v[40:43], v[236:239], v[152:155], v[40:43]
    v_cvt_pk_bf16_f32 v170, v84, v85
    v_cvt_pk_bf16_f32 v171, v86, v87
    v_mfma_f32_16x16x32_bf16 v[44:47], v[236:239], v[156:159], v[44:47]
    ds_read_b128 v[140:143], v2 offset:59392
    v_pk_max_i16 v170, v170, 0
    v_mfma_f32_16x16x32_bf16 v[48:51], v[240:243], v[144:147], v[48:51]
    buffer_load_dwordx4 v[236:239], v2, s[20:23], s31 offen offset:3072 sc1
    v_mfma_f32_16x16x32_bf16 v[52:55], v[240:243], v[148:151], v[52:55]
    v_pk_max_i16 v171, v171, 0
    ds_write_b64 v6, v[170:171] offset:25600
    v_mfma_f32_16x16x32_bf16 v[56:59], v[240:243], v[152:155], v[56:59]
    v_cvt_pk_bf16_f32 v172, v88, v89
    v_cvt_pk_bf16_f32 v173, v90, v91
    v_mfma_f32_16x16x32_bf16 v[60:63], v[240:243], v[156:159], v[60:63]
    v_pk_max_i16 v172, v172, 0
    v_pk_max_i16 v173, v173, 0
    s_waitcnt vmcnt(16) lgkmcnt(8)
    v_mfma_f32_16x16x32_bf16 v[16:19], v[244:247], v[112:115], v[16:19]
    s_add_u32 s31, s31, 4096
    buffer_load_dwordx4 v[240:243], v2, s[20:23], s31 offen offset:0 sc1
    v_mfma_f32_16x16x32_bf16 v[20:23], v[244:247], v[116:119], v[20:23]
    ds_read_b128 v[144:147], v2 offset:5120
    ds_write_b64 v6, v[172:173] offset:26624
    v_mfma_f32_16x16x32_bf16 v[24:27], v[244:247], v[120:123], v[24:27]
    v_cvt_pk_bf16_f32 v174, v92, v93
    v_cvt_pk_bf16_f32 v175, v94, v95
    v_mfma_f32_16x16x32_bf16 v[28:31], v[244:247], v[124:127], v[28:31]
    ds_read_b128 v[148:151], v2 offset:23552
    v_pk_max_i16 v174, v174, 0
    v_mfma_f32_16x16x32_bf16 v[32:35], v[248:251], v[112:115], v[32:35]
    buffer_load_dwordx4 v[244:247], v2, s[20:23], s31 offen offset:1024 sc1
    v_mfma_f32_16x16x32_bf16 v[36:39], v[248:251], v[116:119], v[36:39]
    ds_read_b128 v[152:155], v2 offset:41984
    v_pk_max_i16 v175, v175, 0
    v_mfma_f32_16x16x32_bf16 v[40:43], v[248:251], v[120:123], v[40:43]
    ds_write_b64 v6, v[174:175] offset:27648
    v_cvt_pk_bf16_f32 v160, v96, v97
    v_mfma_f32_16x16x32_bf16 v[44:47], v[248:251], v[124:127], v[44:47]
    ds_read_b128 v[156:159], v2 offset:60416
    v_cvt_pk_bf16_f32 v161, v98, v99
    v_mfma_f32_16x16x32_bf16 v[48:51], v[252:255], v[112:115], v[48:51]
    buffer_load_dwordx4 v[248:251], v2, s[20:23], s31 offen offset:2048 sc1
    v_mfma_f32_16x16x32_bf16 v[52:55], v[252:255], v[116:119], v[52:55]
    v_pk_max_i16 v160, v160, 0
    v_pk_max_i16 v161, v161, 0
    v_mfma_f32_16x16x32_bf16 v[56:59], v[252:255], v[120:123], v[56:59]
    ds_write_b64 v5, v[160:161] offset:28672
    v_cvt_pk_bf16_f32 v162, v100, v101
    v_mfma_f32_16x16x32_bf16 v[60:63], v[252:255], v[124:127], v[60:63]
    v_cvt_pk_bf16_f32 v163, v102, v103
    v_pk_max_i16 v162, v162, 0
    s_waitcnt vmcnt(16) lgkmcnt(8)
    v_mfma_f32_16x16x32_bf16 v[16:19], v[176:179], v[128:131], v[16:19]
    buffer_load_dwordx4 v[252:255], v2, s[20:23], s31 offen offset:3072 sc1
    v_mfma_f32_16x16x32_bf16 v[20:23], v[176:179], v[132:135], v[20:23]
    ds_read_b128 v[112:115], v2 offset:6144
    v_pk_max_i16 v163, v163, 0
    v_mfma_f32_16x16x32_bf16 v[24:27], v[176:179], v[136:139], v[24:27]
    ds_write_b64 v5, v[162:163] offset:29696
    v_cvt_pk_bf16_f32 v164, v104, v105
    v_mfma_f32_16x16x32_bf16 v[28:31], v[176:179], v[140:143], v[28:31]
    ds_read_b128 v[116:119], v2 offset:24576
    v_cvt_pk_bf16_f32 v165, v106, v107
    v_mfma_f32_16x16x32_bf16 v[32:35], v[180:183], v[128:131], v[32:35]
    s_add_u32 s31, s31, 4096
    buffer_load_dwordx4 v[176:179], v2, s[20:23], s31 offen offset:0 sc1
    v_mfma_f32_16x16x32_bf16 v[36:39], v[180:183], v[132:135], v[36:39]
    ds_read_b128 v[120:123], v2 offset:43008
    v_pk_max_i16 v164, v164, 0
    v_mfma_f32_16x16x32_bf16 v[40:43], v[180:183], v[136:139], v[40:43]
    v_pk_max_i16 v165, v165, 0
    ds_write_b64 v5, v[164:165] offset:30720
    v_mfma_f32_16x16x32_bf16 v[44:47], v[180:183], v[140:143], v[44:47]
    ds_read_b128 v[124:127], v2 offset:61440
    v_cvt_pk_bf16_f32 v166, v108, v109
    v_mfma_f32_16x16x32_bf16 v[48:51], v[184:187], v[128:131], v[48:51]
    buffer_load_dwordx4 v[180:183], v2, s[20:23], s31 offen offset:1024 sc1
    v_mfma_f32_16x16x32_bf16 v[52:55], v[184:187], v[132:135], v[52:55]
    v_cvt_pk_bf16_f32 v167, v110, v111
    v_pk_max_i16 v166, v166, 0
    v_mfma_f32_16x16x32_bf16 v[56:59], v[184:187], v[136:139], v[56:59]
    v_pk_max_i16 v167, v167, 0
    ds_write_b64 v5, v[166:167] offset:31744
    v_mfma_f32_16x16x32_bf16 v[60:63], v[184:187], v[140:143], v[60:63]
    s_waitcnt vmcnt(16) lgkmcnt(8)
    v_mfma_f32_16x16x32_bf16 v[16:19], v[188:191], v[144:147], v[16:19]
    buffer_load_dwordx4 v[184:187], v2, s[20:23], s31 offen offset:2048 sc1
    v_mfma_f32_16x16x32_bf16 v[20:23], v[188:191], v[148:151], v[20:23]
    ds_read_b128 v[128:131], v2 offset:7168
    v_mfma_f32_16x16x32_bf16 v[24:27], v[188:191], v[152:155], v[24:27]
    v_mfma_f32_16x16x32_bf16 v[28:31], v[188:191], v[156:159], v[28:31]
    ds_read_b128 v[132:135], v2 offset:25600
    v_mfma_f32_16x16x32_bf16 v[32:35], v[192:195], v[144:147], v[32:35]
    buffer_load_dwordx4 v[188:191], v2, s[20:23], s31 offen offset:3072 sc1
    v_mfma_f32_16x16x32_bf16 v[36:39], v[192:195], v[148:151], v[36:39]
    ds_read_b128 v[136:139], v2 offset:44032
    v_mfma_f32_16x16x32_bf16 v[40:43], v[192:195], v[152:155], v[40:43]
    v_mfma_f32_16x16x32_bf16 v[44:47], v[192:195], v[156:159], v[44:47]
    ds_read_b128 v[140:143], v2 offset:62464
    v_mfma_f32_16x16x32_bf16 v[48:51], v[196:199], v[144:147], v[48:51]
    s_add_u32 s31, s31, 4096
    buffer_load_dwordx4 v[192:195], v2, s[20:23], s31 offen offset:0 sc1
    v_mfma_f32_16x16x32_bf16 v[52:55], v[196:199], v[148:151], v[52:55]
    v_mfma_f32_16x16x32_bf16 v[56:59], v[196:199], v[152:155], v[56:59]
    v_mfma_f32_16x16x32_bf16 v[60:63], v[196:199], v[156:159], v[60:63]
    s_waitcnt vmcnt(16) lgkmcnt(5)
    v_mfma_f32_16x16x32_bf16 v[16:19], v[200:203], v[112:115], v[16:19]
    buffer_load_dwordx4 v[196:199], v2, s[20:23], s31 offen offset:1024 sc1
    v_mfma_f32_16x16x32_bf16 v[20:23], v[200:203], v[116:119], v[20:23]
    ds_read_b128 v[144:147], v2 offset:8192
    v_mfma_f32_16x16x32_bf16 v[24:27], v[200:203], v[120:123], v[24:27]
    v_mfma_f32_16x16x32_bf16 v[28:31], v[200:203], v[124:127], v[28:31]
    ds_read_b128 v[148:151], v2 offset:26624
    v_mfma_f32_16x16x32_bf16 v[32:35], v[204:207], v[112:115], v[32:35]
    buffer_load_dwordx4 v[200:203], v2, s[20:23], s31 offen offset:2048 sc1
    v_mfma_f32_16x16x32_bf16 v[36:39], v[204:207], v[116:119], v[36:39]
    ds_read_b128 v[152:155], v2 offset:45056
    v_mfma_f32_16x16x32_bf16 v[40:43], v[204:207], v[120:123], v[40:43]
    v_mfma_f32_16x16x32_bf16 v[44:47], v[204:207], v[124:127], v[44:47]
    ds_read_b128 v[156:159], v2 offset:63488
    v_mfma_f32_16x16x32_bf16 v[48:51], v[208:211], v[112:115], v[48:51]
    buffer_load_dwordx4 v[204:207], v2, s[20:23], s31 offen offset:3072 sc1
    v_mfma_f32_16x16x32_bf16 v[52:55], v[208:211], v[116:119], v[52:55]
    v_mfma_f32_16x16x32_bf16 v[56:59], v[208:211], v[120:123], v[56:59]
    v_mfma_f32_16x16x32_bf16 v[60:63], v[208:211], v[124:127], v[60:63]
    s_waitcnt vmcnt(16) lgkmcnt(4)
    v_mfma_f32_16x16x32_bf16 v[16:19], v[212:215], v[128:131], v[16:19]
    s_add_u32 s31, s31, 4096
    buffer_load_dwordx4 v[208:211], v2, s[20:23], s31 offen offset:0 sc1
    v_mfma_f32_16x16x32_bf16 v[20:23], v[212:215], v[132:135], v[20:23]
    ds_read_b128 v[112:115], v2 offset:9216
    v_mfma_f32_16x16x32_bf16 v[24:27], v[212:215], v[136:139], v[24:27]
    v_mfma_f32_16x16x32_bf16 v[28:31], v[212:215], v[140:143], v[28:31]
    ds_read_b128 v[116:119], v2 offset:27648
    v_mfma_f32_16x16x32_bf16 v[32:35], v[216:219], v[128:131], v[32:35]
    buffer_load_dwordx4 v[212:215], v2, s[20:23], s31 offen offset:1024 sc1
    v_mfma_f32_16x16x32_bf16 v[36:39], v[216:219], v[132:135], v[36:39]
    ds_read_b128 v[120:123], v2 offset:46080
    v_mfma_f32_16x16x32_bf16 v[40:43], v[216:219], v[136:139], v[40:43]
    v_mfma_f32_16x16x32_bf16 v[44:47], v[216:219], v[140:143], v[44:47]
    ds_read_b128 v[124:127], v2 offset:64512
    v_mfma_f32_16x16x32_bf16 v[48:51], v[220:223], v[128:131], v[48:51]
    buffer_load_dwordx4 v[216:219], v2, s[20:23], s31 offen offset:2048 sc1
    v_mfma_f32_16x16x32_bf16 v[52:55], v[220:223], v[132:135], v[52:55]
    v_mfma_f32_16x16x32_bf16 v[56:59], v[220:223], v[136:139], v[56:59]
    v_mfma_f32_16x16x32_bf16 v[60:63], v[220:223], v[140:143], v[60:63]
    s_waitcnt vmcnt(16) lgkmcnt(4)
    v_mfma_f32_16x16x32_bf16 v[16:19], v[224:227], v[144:147], v[16:19]
    buffer_load_dwordx4 v[220:223], v2, s[20:23], s31 offen offset:3072 sc1
    v_mfma_f32_16x16x32_bf16 v[20:23], v[224:227], v[148:151], v[20:23]
    ds_read_b128 v[128:131], v2 offset:10240
    v_mfma_f32_16x16x32_bf16 v[24:27], v[224:227], v[152:155], v[24:27]
    v_mfma_f32_16x16x32_bf16 v[28:31], v[224:227], v[156:159], v[28:31]
    ds_read_b128 v[132:135], v2 offset:28672
    v_mfma_f32_16x16x32_bf16 v[32:35], v[228:231], v[144:147], v[32:35]
    s_add_u32 s31, s31, 4096
    buffer_load_dwordx4 v[224:227], v2, s[20:23], s31 offen offset:0 sc1
    v_mfma_f32_16x16x32_bf16 v[36:39], v[228:231], v[148:151], v[36:39]
    ds_read_b128 v[136:139], v2 offset:47104
    v_mfma_f32_16x16x32_bf16 v[40:43], v[228:231], v[152:155], v[40:43]
    v_mfma_f32_16x16x32_bf16 v[44:47], v[228:231], v[156:159], v[44:47]
    ds_read_b128 v[140:143], v3 offset:0
    v_mfma_f32_16x16x32_bf16 v[48:51], v[232:235], v[144:147], v[48:51]
    buffer_load_dwordx4 v[228:231], v2, s[20:23], s31 offen offset:1024 sc1
    v_mfma_f32_16x16x32_bf16 v[52:55], v[232:235], v[148:151], v[52:55]
    v_mfma_f32_16x16x32_bf16 v[56:59], v[232:235], v[152:155], v[56:59]
    v_mfma_f32_16x16x32_bf16 v[60:63], v[232:235], v[156:159], v[60:63]
    s_waitcnt vmcnt(16) lgkmcnt(4)
    v_mfma_f32_16x16x32_bf16 v[16:19], v[236:239], v[112:115], v[16:19]
    buffer_load_dwordx4 v[232:235], v2, s[20:23], s31 offen offset:2048 sc1
    v_mfma_f32_16x16x32_bf16 v[20:23], v[236:239], v[116:119], v[20:23]
    ds_read_b128 v[144:147], v2 offset:11264
    v_mfma_f32_16x16x32_bf16 v[24:27], v[236:239], v[120:123], v[24:27]
    v_mfma_f32_16x16x32_bf16 v[28:31], v[236:239], v[124:127], v[28:31]
    ds_read_b128 v[148:151], v2 offset:29696
    v_mfma_f32_16x16x32_bf16 v[32:35], v[240:243], v[112:115], v[32:35]
    buffer_load_dwordx4 v[236:239], v2, s[20:23], s31 offen offset:3072 sc1
    v_mfma_f32_16x16x32_bf16 v[36:39], v[240:243], v[116:119], v[36:39]
    ds_read_b128 v[152:155], v2 offset:48128
    v_mfma_f32_16x16x32_bf16 v[40:43], v[240:243], v[120:123], v[40:43]
    v_mfma_f32_16x16x32_bf16 v[44:47], v[240:243], v[124:127], v[44:47]
    ds_read_b128 v[156:159], v3 offset:1024
    v_mfma_f32_16x16x32_bf16 v[48:51], v[244:247], v[112:115], v[48:51]
    s_add_u32 s31, s31, 4096
    buffer_load_dwordx4 v[240:243], v2, s[20:23], s31 offen offset:0 sc1
    v_mfma_f32_16x16x32_bf16 v[52:55], v[244:247], v[116:119], v[52:55]
    v_mfma_f32_16x16x32_bf16 v[56:59], v[244:247], v[120:123], v[56:59]
    v_mfma_f32_16x16x32_bf16 v[60:63], v[244:247], v[124:127], v[60:63]
    s_waitcnt vmcnt(16) lgkmcnt(4)
    v_mfma_f32_16x16x32_bf16 v[16:19], v[248:251], v[128:131], v[16:19]
    buffer_load_dwordx4 v[244:247], v2, s[20:23], s31 offen offset:1024 sc1
    v_mfma_f32_16x16x32_bf16 v[20:23], v[248:251], v[132:135], v[20:23]
    ds_read_b128 v[112:115], v2 offset:12288
    v_mfma_f32_16x16x32_bf16 v[24:27], v[248:251], v[136:139], v[24:27]
    v_mfma_f32_16x16x32_bf16 v[28:31], v[248:251], v[140:143], v[28:31]
    ds_read_b128 v[116:119], v2 offset:30720
    v_mfma_f32_16x16x32_bf16 v[32:35], v[252:255], v[128:131], v[32:35]
    buffer_load_dwordx4 v[248:251], v2, s[20:23], s31 offen offset:2048 sc1
    v_mfma_f32_16x16x32_bf16 v[36:39], v[252:255], v[132:135], v[36:39]
    ds_read_b128 v[120:123], v2 offset:49152
    v_mfma_f32_16x16x32_bf16 v[40:43], v[252:255], v[136:139], v[40:43]
    v_mfma_f32_16x16x32_bf16 v[44:47], v[252:255], v[140:143], v[44:47]
    ds_read_b128 v[124:127], v3 offset:2048
    v_mfma_f32_16x16x32_bf16 v[48:51], v[176:179], v[128:131], v[48:51]
    buffer_load_dwordx4 v[252:255], v2, s[20:23], s31 offen offset:3072 sc1
    v_mfma_f32_16x16x32_bf16 v[52:55], v[176:179], v[132:135], v[52:55]
    v_mfma_f32_16x16x32_bf16 v[56:59], v[176:179], v[136:139], v[56:59]
    v_mfma_f32_16x16x32_bf16 v[60:63], v[176:179], v[140:143], v[60:63]
    s_waitcnt vmcnt(16) lgkmcnt(4)
    v_mfma_f32_16x16x32_bf16 v[16:19], v[180:183], v[144:147], v[16:19]
    s_add_u32 s31, s31, 4096
    buffer_load_dwordx4 v[176:179], v2, s[20:23], s31 offen offset:0 sc1
    v_mfma_f32_16x16x32_bf16 v[20:23], v[180:183], v[148:151], v[20:23]
    ds_read_b128 v[128:131], v2 offset:13312
    v_mfma_f32_16x16x32_bf16 v[24:27], v[180:183], v[152:155], v[24:27]
    v_mfma_f32_16x16x32_bf16 v[28:31], v[180:183], v[156:159], v[28:31]
    ds_read_b128 v[132:135], v2 offset:31744
    v_mfma_f32_16x16x32_bf16 v[32:35], v[184:187], v[144:147], v[32:35]
    buffer_load_dwordx4 v[180:183], v2, s[20:23], s31 offen offset:1024 sc1
    v_mfma_f32_16x16x32_bf16 v[36:39], v[184:187], v[148:151], v[36:39]
    ds_read_b128 v[136:139], v2 offset:50176
    v_mfma_f32_16x16x32_bf16 v[40:43], v[184:187], v[152:155], v[40:43]
    v_mfma_f32_16x16x32_bf16 v[44:47], v[184:187], v[156:159], v[44:47]
    ds_read_b128 v[140:143], v3 offset:3072
    v_mfma_f32_16x16x32_bf16 v[48:51], v[188:191], v[144:147], v[48:51]
    buffer_load_dwordx4 v[184:187], v2, s[20:23], s31 offen offset:2048 sc1
    v_mfma_f32_16x16x32_bf16 v[52:55], v[188:191], v[148:151], v[52:55]
    v_mfma_f32_16x16x32_bf16 v[56:59], v[188:191], v[152:155], v[56:59]
    v_mfma_f32_16x16x32_bf16 v[60:63], v[188:191], v[156:159], v[60:63]
    s_waitcnt vmcnt(16) lgkmcnt(4)
    v_mfma_f32_16x16x32_bf16 v[16:19], v[192:195], v[112:115], v[16:19]
    buffer_load_dwordx4 v[188:191], v2, s[20:23], s31 offen offset:3072 sc1
    v_mfma_f32_16x16x32_bf16 v[20:23], v[192:195], v[116:119], v[20:23]
    ds_read_b128 v[144:147], v2 offset:14336
    v_mfma_f32_16x16x32_bf16 v[24:27], v[192:195], v[120:123], v[24:27]
    v_mfma_f32_16x16x32_bf16 v[28:31], v[192:195], v[124:127], v[28:31]
    ds_read_b128 v[148:151], v2 offset:32768
    v_mfma_f32_16x16x32_bf16 v[32:35], v[196:199], v[112:115], v[32:35]
    s_add_u32 s31, s31, 4096
    buffer_load_dwordx4 v[192:195], v2, s[20:23], s31 offen offset:0 sc1
    v_mfma_f32_16x16x32_bf16 v[36:39], v[196:199], v[116:119], v[36:39]
    ds_read_b128 v[152:155], v2 offset:51200
    v_mfma_f32_16x16x32_bf16 v[40:43], v[196:199], v[120:123], v[40:43]
    v_mfma_f32_16x16x32_bf16 v[44:47], v[196:199], v[124:127], v[44:47]
    ds_read_b128 v[156:159], v3 offset:4096
    v_mfma_f32_16x16x32_bf16 v[48:51], v[200:203], v[112:115], v[48:51]
    buffer_load_dwordx4 v[196:199], v2, s[20:23], s31 offen offset:1024 sc1
    v_mfma_f32_16x16x32_bf16 v[52:55], v[200:203], v[116:119], v[52:55]
    v_mfma_f32_16x16x32_bf16 v[56:59], v[200:203], v[120:123], v[56:59]
    v_mfma_f32_16x16x32_bf16 v[60:63], v[200:203], v[124:127], v[60:63]
    s_waitcnt vmcnt(16) lgkmcnt(4)
    v_mfma_f32_16x16x32_bf16 v[16:19], v[204:207], v[128:131], v[16:19]
    buffer_load_dwordx4 v[200:203], v2, s[20:23], s31 offen offset:2048 sc1
    v_mfma_f32_16x16x32_bf16 v[20:23], v[204:207], v[132:135], v[20:23]
    ds_read_b128 v[112:115], v2 offset:15360
    v_mfma_f32_16x16x32_bf16 v[24:27], v[204:207], v[136:139], v[24:27]
    v_mfma_f32_16x16x32_bf16 v[28:31], v[204:207], v[140:143], v[28:31]
    ds_read_b128 v[116:119], v2 offset:33792
    v_mfma_f32_16x16x32_bf16 v[32:35], v[208:211], v[128:131], v[32:35]
    buffer_load_dwordx4 v[204:207], v2, s[20:23], s31 offen offset:3072 sc1
    v_mfma_f32_16x16x32_bf16 v[36:39], v[208:211], v[132:135], v[36:39]
    ds_read_b128 v[120:123], v2 offset:52224
    v_mfma_f32_16x16x32_bf16 v[40:43], v[208:211], v[136:139], v[40:43]
    v_mfma_f32_16x16x32_bf16 v[44:47], v[208:211], v[140:143], v[44:47]
    ds_read_b128 v[124:127], v3 offset:5120
    v_mfma_f32_16x16x32_bf16 v[48:51], v[212:215], v[128:131], v[48:51]
    s_add_u32 s31, s31, 4096
    buffer_load_dwordx4 v[208:211], v2, s[20:23], s31 offen offset:0 sc1
    v_mfma_f32_16x16x32_bf16 v[52:55], v[212:215], v[132:135], v[52:55]
    v_mfma_f32_16x16x32_bf16 v[56:59], v[212:215], v[136:139], v[56:59]
    v_mfma_f32_16x16x32_bf16 v[60:63], v[212:215], v[140:143], v[60:63]
    s_waitcnt vmcnt(16) lgkmcnt(4)
    v_mfma_f32_16x16x32_bf16 v[16:19], v[216:219], v[144:147], v[16:19]
    buffer_load_dwordx4 v[212:215], v2, s[20:23], s31 offen offset:1024 sc1
    v_mfma_f32_16x16x32_bf16 v[20:23], v[216:219], v[148:151], v[20:23]
    ds_read_b128 v[128:131], v2 offset:16384
    v_mfma_f32_16x16x32_bf16 v[24:27], v[216:219], v[152:155], v[24:27]
    v_mfma_f32_16x16x32_bf16 v[28:31], v[216:219], v[156:159], v[28:31]
    ds_read_b128 v[132:135], v2 offset:34816
    v_mfma_f32_16x16x32_bf16 v[32:35], v[220:223], v[144:147], v[32:35]
    buffer_load_dwordx4 v[216:219], v2, s[20:23], s31 offen offset:2048 sc1
    v_mfma_f32_16x16x32_bf16 v[36:39], v[220:223], v[148:151], v[36:39]
    ds_read_b128 v[136:139], v2 offset:53248
    v_mfma_f32_16x16x32_bf16 v[40:43], v[220:223], v[152:155], v[40:43]
    v_mfma_f32_16x16x32_bf16 v[44:47], v[220:223], v[156:159], v[44:47]
    ds_read_b128 v[140:143], v3 offset:6144
    v_mfma_f32_16x16x32_bf16 v[48:51], v[224:227], v[144:147], v[48:51]
    buffer_load_dwordx4 v[220:223], v2, s[20:23], s31 offen offset:3072 sc1
    v_mfma_f32_16x16x32_bf16 v[52:55], v[224:227], v[148:151], v[52:55]
    v_mfma_f32_16x16x32_bf16 v[56:59], v[224:227], v[152:155], v[56:59]
    v_mfma_f32_16x16x32_bf16 v[60:63], v[224:227], v[156:159], v[60:63]
    s_waitcnt vmcnt(16) lgkmcnt(4)
    v_mfma_f32_16x16x32_bf16 v[16:19], v[228:231], v[112:115], v[16:19]
    s_add_u32 s31, s31, 4096
    buffer_load_dwordx4 v[224:227], v2, s[20:23], s31 offen offset:0 sc1
    v_mfma_f32_16x16x32_bf16 v[20:23], v[228:231], v[116:119], v[20:23]
    ds_read_b128 v[144:147], v2 offset:17408
    v_mfma_f32_16x16x32_bf16 v[24:27], v[228:231], v[120:123], v[24:27]
    v_mfma_f32_16x16x32_bf16 v[28:31], v[228:231], v[124:127], v[28:31]
    ds_read_b128 v[148:151], v2 offset:35840
    v_mfma_f32_16x16x32_bf16 v[32:35], v[232:235], v[112:115], v[32:35]
    buffer_load_dwordx4 v[228:231], v2, s[20:23], s31 offen offset:1024 sc1
    v_mfma_f32_16x16x32_bf16 v[36:39], v[232:235], v[116:119], v[36:39]
    ds_read_b128 v[152:155], v2 offset:54272
    v_mfma_f32_16x16x32_bf16 v[40:43], v[232:235], v[120:123], v[40:43]
    v_mfma_f32_16x16x32_bf16 v[44:47], v[232:235], v[124:127], v[44:47]
    ds_read_b128 v[156:159], v3 offset:7168
    v_mfma_f32_16x16x32_bf16 v[48:51], v[236:239], v[112:115], v[48:51]
    buffer_load_dwordx4 v[232:235], v2, s[20:23], s31 offen offset:2048 sc1
    v_mfma_f32_16x16x32_bf16 v[52:55], v[236:239], v[116:119], v[52:55]
    v_mfma_f32_16x16x32_bf16 v[56:59], v[236:239], v[120:123], v[56:59]
    v_mfma_f32_16x16x32_bf16 v[60:63], v[236:239], v[124:127], v[60:63]
    s_barrier
    s_waitcnt vmcnt(16) lgkmcnt(4)
    v_mfma_f32_16x16x32_bf16 v[16:19], v[240:243], v[128:131], v[16:19]
    buffer_load_dwordx4 v[236:239], v2, s[20:23], s31 offen offset:3072 sc1
    v_mfma_f32_16x16x32_bf16 v[20:23], v[240:243], v[132:135], v[20:23]
    ds_read_b128 v[112:115], v3 offset:12288
    v_mfma_f32_16x16x32_bf16 v[24:27], v[240:243], v[136:139], v[24:27]
    v_mfma_f32_16x16x32_bf16 v[28:31], v[240:243], v[140:143], v[28:31]
    ds_read_b128 v[116:119], v3 offset:13312
    v_mfma_f32_16x16x32_bf16 v[32:35], v[244:247], v[128:131], v[32:35]
    s_add_u32 s31, s31, 4096
    buffer_load_dwordx4 v[240:243], v2, s[20:23], s31 offen offset:0 sc1
    v_mfma_f32_16x16x32_bf16 v[36:39], v[244:247], v[132:135], v[36:39]
    ds_read_b128 v[120:123], v3 offset:14336
    v_mfma_f32_16x16x32_bf16 v[40:43], v[244:247], v[136:139], v[40:43]
    v_mfma_f32_16x16x32_bf16 v[44:47], v[244:247], v[140:143], v[44:47]
    ds_read_b128 v[124:127], v3 offset:15360
    v_mfma_f32_16x16x32_bf16 v[48:51], v[248:251], v[128:131], v[48:51]
    buffer_load_dwordx4 v[244:247], v2, s[20:23], s31 offen offset:1024 sc1
    v_mfma_f32_16x16x32_bf16 v[52:55], v[248:251], v[132:135], v[52:55]
    v_mfma_f32_16x16x32_bf16 v[56:59], v[248:251], v[136:139], v[56:59]
    v_mfma_f32_16x16x32_bf16 v[60:63], v[248:251], v[140:143], v[60:63]
    s_waitcnt vmcnt(16) lgkmcnt(4)
    v_mfma_f32_16x16x32_bf16 v[16:19], v[252:255], v[144:147], v[16:19]
    buffer_load_dwordx4 v[248:251], v2, s[20:23], s31 offen offset:2048 sc1
    v_mfma_f32_16x16x32_bf16 v[20:23], v[252:255], v[148:151], v[20:23]
    ds_read_b128 v[128:131], v3 offset:16384
    v_mfma_f32_16x16x32_bf16 v[24:27], v[252:255], v[152:155], v[24:27]
    v_mfma_f32_16x16x32_bf16 v[28:31], v[252:255], v[156:159], v[28:31]
    ds_read_b128 v[132:135], v3 offset:17408
    v_mfma_f32_16x16x32_bf16 v[32:35], v[176:179], v[144:147], v[32:35]
    buffer_load_dwordx4 v[252:255], v2, s[20:23], s31 offen offset:3072 sc1
    v_mfma_f32_16x16x32_bf16 v[36:39], v[176:179], v[148:151], v[36:39]
    ds_read_b128 v[136:139], v3 offset:18432
    v_mfma_f32_16x16x32_bf16 v[40:43], v[176:179], v[152:155], v[40:43]
    v_mfma_f32_16x16x32_bf16 v[44:47], v[176:179], v[156:159], v[44:47]
    ds_read_b128 v[140:143], v3 offset:19456
    v_mfma_f32_16x16x32_bf16 v[48:51], v[180:183], v[144:147], v[48:51]
    s_add_u32 s31, s31, 4096
    buffer_load_dwordx4 v[176:179], v2, s[20:23], s31 offen offset:0 sc1
    v_mfma_f32_16x16x32_bf16 v[52:55], v[180:183], v[148:151], v[52:55]
    v_mfma_f32_16x16x32_bf16 v[56:59], v[180:183], v[152:155], v[56:59]
    v_mfma_f32_16x16x32_bf16 v[60:63], v[180:183], v[156:159], v[60:63]
    s_waitcnt vmcnt(17) lgkmcnt(4)
    v_mfma_f32_16x16x32_bf16 v[64:67], v[184:187], v[112:115], 0
    buffer_load_dwordx4 v[180:183], v2, s[20:23], s31 offen offset:1024 sc1
    v_mfma_f32_16x16x32_bf16 v[68:71], v[184:187], v[116:119], 0
    ds_read_b128 v[144:147], v3 offset:20480
    v_mfma_f32_16x16x32_bf16 v[72:75], v[184:187], v[120:123], 0
    v_mfma_f32_16x16x32_bf16 v[76:79], v[184:187], v[124:127], 0
    ds_read_b128 v[148:151], v3 offset:21504
    v_mfma_f32_16x16x32_bf16 v[80:83], v[188:191], v[112:115], 0
    buffer_load_dwordx4 v[184:187], v2, s[20:23], s31 offen offset:2048 sc1
    v_mfma_f32_16x16x32_bf16 v[84:87], v[188:191], v[116:119], 0
    ds_read_b128 v[152:155], v3 offset:22528
    v_mfma_f32_16x16x32_bf16 v[88:91], v[188:191], v[120:123], 0
    v_mfma_f32_16x16x32_bf16 v[92:95], v[188:191], v[124:127], 0
    ds_read_b128 v[156:159], v3 offset:23552
    s_waitcnt vmcnt(17) lgkmcnt(4)
    v_mfma_f32_16x16x32_bf16 v[64:67], v[192:195], v[128:131], v[64:67]
    buffer_load_dwordx4 v[188:191], v2, s[20:23], s31 offen offset:3072 sc1
    v_mfma_f32_16x16x32_bf16 v[68:71], v[192:195], v[132:135], v[68:71]
    ds_read_b128 v[112:115], v3 offset:24576
    v_cvt_pk_bf16_f32 v160, v16, v17
    v_mfma_f32_16x16x32_bf16 v[72:75], v[192:195], v[136:139], v[72:75]
    v_cvt_pk_bf16_f32 v161, v18, v19
    v_pk_max_i16 v160, v160, 0
    v_mfma_f32_16x16x32_bf16 v[76:79], v[192:195], v[140:143], v[76:79]
    ds_read_b128 v[116:119], v3 offset:25600
    v_pk_max_i16 v161, v161, 0
    v_mfma_f32_16x16x32_bf16 v[80:83], v[196:199], v[128:131], v[80:83]
    s_add_u32 s31, s31, 4096
    buffer_load_dwordx4 v[192:195], v2, s[20:23], s31 offen offset:0 sc1
    v_mfma_f32_16x16x32_bf16 v[84:87], v[196:199], v[132:135], v[84:87]
    ds_read_b128 v[120:123], v3 offset:26624
    ds_write_b64 v5, v[160:161] offset:49152
    v_mfma_f32_16x16x32_bf16 v[88:91], v[196:199], v[136:139], v[88:91]
    v_cvt_pk_bf16_f32 v162, v20, v21
    v_cvt_pk_bf16_f32 v163, v22, v23
    v_mfma_f32_16x16x32_bf16 v[92:95], v[196:199], v[140:143], v[92:95]
    ds_read_b128 v[124:127], v3 offset:27648
    v_pk_max_i16 v162, v162, 0
    s_waitcnt vmcnt(17) lgkmcnt(5)
    v_mfma_f32_16x16x32_bf16 v[64:67], v[200:203], v[144:147], v[64:67]
    buffer_load_dwordx4 v[196:199], v2, s[20:23], s31 offen offset:1024 sc1
    v_mfma_f32_16x16x32_bf16 v[68:71], v[200:203], v[148:151], v[68:71]
    ds_read_b128 v[128:131], v3 offset:28672
    v_pk_max_i16 v163, v163, 0
    v_mfma_f32_16x16x32_bf16 v[72:75], v[200:203], v[152:155], v[72:75]
    ds_write_b64 v5, v[162:163] offset:50176
    v_cvt_pk_bf16_f32 v164, v24, v25
    v_mfma_f32_16x16x32_bf16 v[76:79], v[200:203], v[156:159], v[76:79]
    ds_read_b128 v[132:135], v3 offset:29696
    v_cvt_pk_bf16_f32 v165, v26, v27
    v_mfma_f32_16x16x32_bf16 v[80:83], v[204:207], v[144:147], v[80:83]
    buffer_load_dwordx4 v[200:203], v2, s[20:23], s31 offen offset:2048 sc1
    v_mfma_f32_16x16x32_bf16 v[84:87], v[204:207], v[148:151], v[84:87]
    ds_read_b128 v[136:139], v3 offset:30720
    v_pk_max_i16 v164, v164, 0
    v_mfma_f32_16x16x32_bf16 v[88:91], v[204:207], v[152:155], v[88:91]
    v_pk_max_i16 v165, v165, 0
    ds_write_b64 v5, v[164:165] offset:51200
    v_mfma_f32_16x16x32_bf16 v[92:95], v[204:207], v[156:159], v[92:95]
    ds_read_b128 v[140:143], v3 offset:31744
    v_cvt_pk_bf16_f32 v166, v28, v29
    s_waitcnt vmcnt(17) lgkmcnt(6)
    v_mfma_f32_16x16x32_bf16 v[64:67], v[208:211], v[112:115], v[64:67]
    buffer_load_dwordx4 v[204:207], v2, s[20:23], s31 offen offset:3072 sc1
    v_mfma_f32_16x16x32_bf16 v[68:71], v[208:211], v[116:119], v[68:71]
    ds_read_b128 v[144:147], v3 offset:32768
    v_cvt_pk_bf16_f32 v167, v30, v31
    v_mfma_f32_16x16x32_bf16 v[72:75], v[208:211], v[120:123], v[72:75]
    v_pk_max_i16 v166, v166, 0
    v_pk_max_i16 v167, v167, 0
    v_mfma_f32_16x16x32_bf16 v[76:79], v[208:211], v[124:127], v[76:79]
    ds_read_b128 v[148:151], v3 offset:33792
    ds_write_b64 v5, v[166:167] offset:52224
    v_mfma_f32_16x16x32_bf16 v[80:83], v[212:215], v[112:115], v[80:83]
    s_add_u32 s31, s31, 4096
    buffer_load_dwordx4 v[208:211], v2, s[20:23], s31 offen offset:0 sc1
    v_mfma_f32_16x16x32_bf16 v[84:87], v[212:215], v[116:119], v[84:87]
    ds_read_b128 v[152:155], v3 offset:34816
    v_cvt_pk_bf16_f32 v168, v32, v33
    v_mfma_f32_16x16x32_bf16 v[88:91], v[212:215], v[120:123], v[88:91]
    v_cvt_pk_bf16_f32 v169, v34, v35
    v_pk_max_i16 v168, v168, 0
    v_mfma_f32_16x16x32_bf16 v[92:95], v[212:215], v[124:127], v[92:95]
    ds_read_b128 v[156:159], v3 offset:35840
    v_pk_max_i16 v169, v169, 0
    s_waitcnt vmcnt(17) lgkmcnt(5)
    v_mfma_f32_16x16x32_bf16 v[64:67], v[216:219], v[128:131], v[64:67]
    buffer_load_dwordx4 v[212:215], v2, s[20:23], s31 offen offset:1024 sc1
    v_mfma_f32_16x16x32_bf16 v[68:71], v[216:219], v[132:135], v[68:71]
    ds_read_b128 v[112:115], v3 offset:36864
    ds_write_b64 v6, v[168:169] offset:49152
    v_mfma_f32_16x16x32_bf16 v[72:75], v[216:219], v[136:139], v[72:75]
    v_cvt_pk_bf16_f32 v170, v36, v37
    v_cvt_pk_bf16_f32 v171, v38, v39
    v_mfma_f32_16x16x32_bf16 v[76:79], v[216:219], v[140:143], v[76:79]
    ds_read_b128 v[116:119], v3 offset:37888
    v_pk_max_i16 v170, v170, 0
    v_mfma_f32_16x16x32_bf16 v[80:83], v[220:223], v[128:131], v[80:83]
    buffer_load_dwordx4 v[216:219], v2, s[20:23], s31 offen offset:2048 sc1
    v_mfma_f32_16x16x32_bf16 v[84:87], v[220:223], v[132:135], v[84:87]
    ds_read_b128 v[120:123], v3 offset:38912
    v_pk_max_i16 v171, v171, 0
    v_mfma_f32_16x16x32_bf16 v[88:91], v[220:223], v[136:139], v[88:91]
    ds_write_b64 v6, v[170:171] offset:50176
    v_cvt_pk_bf16_f32 v172, v40, v41
    v_mfma_f32_16x16x32_bf16 v[92:95], v[220:223], v[140:143], v[92:95]
    ds_read_b128 v[124:127], v3 offset:39936
    v_cvt_pk_bf16_f32 v173, v42, v43
    s_waitcnt vmcnt(17) lgkmcnt(6)
    v_mfma_f32_16x16x32_bf16 v[64:67], v[224:227], v[144:147], v[64:67]
    buffer_load_dwordx4 v[220:223], v2, s[20:23], s31 offen offset:3072 sc1
    v_mfma_f32_16x16x32_bf16 v[68:71], v[224:227], v[148:151], v[68:71]
    ds_read_b128 v[128:131], v3 offset:40960
    v_pk_max_i16 v172, v172, 0
    v_mfma_f32_16x16x32_bf16 v[72:75], v[224:227], v[152:155], v[72:75]
    v_pk_max_i16 v173, v173, 0
    ds_write_b64 v6, v[172:173] offset:51200
    v_mfma_f32_16x16x32_bf16 v[76:79], v[224:227], v[156:159], v[76:79]
    ds_read_b128 v[132:135], v3 offset:41984
    v_cvt_pk_bf16_f32 v174, v44, v45
    v_mfma_f32_16x16x32_bf16 v[80:83], v[228:231], v[144:147], v[80:83]
    s_add_u32 s31, s31, 4096
    buffer_load_dwordx4 v[224:227], v2, s[20:23], s31 offen offset:0 sc1
    v_mfma_f32_16x16x32_bf16 v[84:87], v[228:231], v[148:151], v[84:87]
    ds_read_b128 v[136:139], v3 offset:43008
    v_cvt_pk_bf16_f32 v175, v46, v47
    v_mfma_f32_16x16x32_bf16 v[88:91], v[228:231], v[152:155], v[88:91]
    v_pk_max_i16 v174, v174, 0
    v_pk_max_i16 v175, v175, 0
    v_mfma_f32_16x16x32_bf16 v[92:95], v[228:231], v[156:159], v[92:95]
    ds_read_b128 v[140:143], v3 offset:44032
    ds_write_b64 v6, v[174:175] offset:52224
    s_waitcnt vmcnt(17) lgkmcnt(6)
    v_mfma_f32_16x16x32_bf16 v[64:67], v[232:235], v[112:115], v[64:67]
    buffer_load_dwordx4 v[228:231], v2, s[20:23], s31 offen offset:1024 sc1
    v_mfma_f32_16x16x32_bf16 v[68:71], v[232:235], v[116:119], v[68:71]
    ds_read_b128 v[144:147], v3 offset:45056
    v_cvt_pk_bf16_f32 v160, v48, v49
    v_mfma_f32_16x16x32_bf16 v[72:75], v[232:235], v[120:123], v[72:75]
    v_cvt_pk_bf16_f32 v161, v50, v51
    v_pk_max_i16 v160, v160, 0
    v_mfma_f32_16x16x32_bf16 v[76:79], v[232:235], v[124:127], v[76:79]
    ds_read_b128 v[148:151], v3 offset:46080
    v_pk_max_i16 v161, v161, 0
    v_mfma_f32_16x16x32_bf16 v[80:83], v[236:239], v[112:115], v[80:83]
    buffer_load_dwordx4 v[232:235], v2, s[20:23], s31 offen offset:2048 sc1
    v_mfma_f32_16x16x32_bf16 v[84:87], v[236:239], v[116:119], v[84:87]
    ds_read_b128 v[152:155], v3 offset:47104
    ds_write_b64 v5, v[160:161] offset:53248
    v_mfma_f32_16x16x32_bf16 v[88:91], v[236:239], v[120:123], v[88:91]
    v_cvt_pk_bf16_f32 v162, v52, v53
    v_cvt_pk_bf16_f32 v163, v54, v55
    v_mfma_f32_16x16x32_bf16 v[92:95], v[236:239], v[124:127], v[92:95]
    ds_read_b128 v[156:159], v3 offset:48128
    v_pk_max_i16 v162, v162, 0
    s_waitcnt vmcnt(17) lgkmcnt(6)
    v_mfma_f32_16x16x32_bf16 v[64:67], v[240:243], v[128:131], v[64:67]
    buffer_load_dwordx4 v[236:239], v2, s[20:23], s31 offen offset:3072 sc1
    v_mfma_f32_16x16x32_bf16 v[68:71], v[240:243], v[132:135], v[68:71]
    ds_read_b128 v[112:115], v3 offset:49152
    v_pk_max_i16 v163, v163, 0
    v_mfma_f32_16x16x32_bf16 v[72:75], v[240:243], v[136:139], v[72:75]
    ds_write_b64 v5, v[162:163] offset:54272
    v_cvt_pk_bf16_f32 v164, v56, v57
    v_mfma_f32_16x16x32_bf16 v[76:79], v[240:243], v[140:143], v[76:79]
    ds_read_b128 v[116:119], v3 offset:50176
    v_cvt_pk_bf16_f32 v165, v58, v59
    v_mfma_f32_16x16x32_bf16 v[80:83], v[244:247], v[128:131], v[80:83]
    s_add_u32 s31, s31, 4096
    buffer_load_dwordx4 v[240:243], v2, s[20:23], s31 offen offset:0 sc1
    v_mfma_f32_16x16x32_bf16 v[84:87], v[244:247], v[132:135], v[84:87]
    ds_read_b128 v[120:123], v3 offset:51200
    v_pk_max_i16 v164, v164, 0
    v_mfma_f32_16x16x32_bf16 v[88:91], v[244:247], v[136:139], v[88:91]
    v_pk_max_i16 v165, v165, 0
    ds_write_b64 v5, v[164:165] offset:55296
    v_mfma_f32_16x16x32_bf16 v[92:95], v[244:247], v[140:143], v[92:95]
    ds_read_b128 v[124:127], v3 offset:52224
    v_cvt_pk_bf16_f32 v166, v60, v61
    s_waitcnt vmcnt(17) lgkmcnt(6)
    v_mfma_f32_16x16x32_bf16 v[64:67], v[248:251], v[144:147], v[64:67]
    buffer_load_dwordx4 v[244:247], v2, s[20:23], s31 offen offset:1024 sc1
    v_mfma_f32_16x16x32_bf16 v[68:71], v[248:251], v[148:151], v[68:71]
    ds_read_b128 v[128:131], v3 offset:53248
    v_cvt_pk_bf16_f32 v167, v62, v63
    v_mfma_f32_16x16x32_bf16 v[72:75], v[248:251], v[152:155], v[72:75]
    v_pk_max_i16 v166, v166, 0
    v_pk_max_i16 v167, v167, 0
    v_mfma_f32_16x16x32_bf16 v[76:79], v[248:251], v[156:159], v[76:79]
    ds_read_b128 v[132:135], v3 offset:54272
    ds_write_b64 v5, v[166:167] offset:56320
    v_mfma_f32_16x16x32_bf16 v[80:83], v[252:255], v[144:147], v[80:83]
    buffer_load_dwordx4 v[248:251], v2, s[20:23], s31 offen offset:2048 sc1
    v_mfma_f32_16x16x32_bf16 v[84:87], v[252:255], v[148:151], v[84:87]
    ds_read_b128 v[136:139], v3 offset:55296
    v_mfma_f32_16x16x32_bf16 v[88:91], v[252:255], v[152:155], v[88:91]
    v_mfma_f32_16x16x32_bf16 v[92:95], v[252:255], v[156:159], v[92:95]
    ds_read_b128 v[140:143], v3 offset:56320
    s_waitcnt vmcnt(17) lgkmcnt(5)
    v_mfma_f32_16x16x32_bf16 v[64:67], v[176:179], v[112:115], v[64:67]
    buffer_load_dwordx4 v[252:255], v2, s[20:23], s31 offen offset:3072 sc1
    v_mfma_f32_16x16x32_bf16 v[68:71], v[176:179], v[116:119], v[68:71]
    ds_read_b128 v[144:147], v3 offset:57344
    v_mfma_f32_16x16x32_bf16 v[72:75], v[176:179], v[120:123], v[72:75]
    v_mfma_f32_16x16x32_bf16 v[76:79], v[176:179], v[124:127], v[76:79]
    ds_read_b128 v[148:151], v3 offset:58368
    v_mfma_f32_16x16x32_bf16 v[80:83], v[180:183], v[112:115], v[80:83]
    s_add_u32 s31, s31, 4096
    buffer_load_dwordx4 v[176:179], v2, s[20:23], s31 offen offset:0 sc1
    v_mfma_f32_16x16x32_bf16 v[84:87], v[180:183], v[116:119], v[84:87]
    ds_read_b128 v[152:155], v3 offset:59392
    v_mfma_f32_16x16x32_bf16 v[88:91], v[180:183], v[120:123], v[88:91]
    v_mfma_f32_16x16x32_bf16 v[92:95], v[180:183], v[124:127], v[92:95]
    ds_read_b128 v[156:159], v3 offset:60416
    s_waitcnt lgkmcnt(6)
    s_barrier
    s_waitcnt vmcnt(17) lgkmcnt(4)
    v_mfma_f32_16x16x32_bf16 v[64:67], v[184:187], v[128:131], v[64:67]
    buffer_load_dwordx4 v[180:183], v2, s[20:23], s31 offen offset:1024 sc1
    v_mfma_f32_16x16x32_bf16 v[68:71], v[184:187], v[132:135], v[68:71]
    ds_read_b128 v[112:115], v3 offset:61440
    v_mfma_f32_16x16x32_bf16 v[72:75], v[184:187], v[136:139], v[72:75]
    v_mfma_f32_16x16x32_bf16 v[76:79], v[184:187], v[140:143], v[76:79]
    ds_read_b128 v[116:119], v3 offset:62464
    v_mfma_f32_16x16x32_bf16 v[80:83], v[188:191], v[128:131], v[80:83]
    buffer_load_dwordx4 v[184:187], v2, s[20:23], s31 offen offset:2048 sc1
    v_mfma_f32_16x16x32_bf16 v[84:87], v[188:191], v[132:135], v[84:87]
    ds_read_b128 v[120:123], v3 offset:63488
    v_mfma_f32_16x16x32_bf16 v[88:91], v[188:191], v[136:139], v[88:91]
    v_mfma_f32_16x16x32_bf16 v[92:95], v[188:191], v[140:143], v[92:95]
    ds_read_b128 v[124:127], v3 offset:64512
    s_waitcnt vmcnt(17) lgkmcnt(4)
    v_mfma_f32_16x16x32_bf16 v[64:67], v[192:195], v[144:147], v[64:67]
    buffer_load_dwordx4 v[188:191], v2, s[20:23], s31 offen offset:3072 sc1
    v_mfma_f32_16x16x32_bf16 v[68:71], v[192:195], v[148:151], v[68:71]
    ds_read_b128 v[128:131], v4 offset:0
    v_mfma_f32_16x16x32_bf16 v[72:75], v[192:195], v[152:155], v[72:75]
    v_mfma_f32_16x16x32_bf16 v[76:79], v[192:195], v[156:159], v[76:79]
    ds_read_b128 v[132:135], v4 offset:1024
    v_mfma_f32_16x16x32_bf16 v[80:83], v[196:199], v[144:147], v[80:83]
    s_add_u32 s31, s31, 4096
    buffer_load_dwordx4 v[192:195], v2, s[20:23], s31 offen offset:0 sc1
    v_mfma_f32_16x16x32_bf16 v[84:87], v[196:199], v[148:151], v[84:87]
    ds_read_b128 v[136:139], v4 offset:2048
    v_mfma_f32_16x16x32_bf16 v[88:91], v[196:199], v[152:155], v[88:91]
    v_mfma_f32_16x16x32_bf16 v[92:95], v[196:199], v[156:159], v[92:95]
    ds_read_b128 v[140:143], v4 offset:3072
    s_waitcnt vmcnt(17) lgkmcnt(4)
    v_mfma_f32_16x16x32_bf16 v[64:67], v[200:203], v[112:115], v[64:67]
    buffer_load_dwordx4 v[196:199], v2, s[20:23], s31 offen offset:1024 sc1
    v_mfma_f32_16x16x32_bf16 v[68:71], v[200:203], v[116:119], v[68:71]
    ds_read_b128 v[144:147], v4 offset:4096
    v_mfma_f32_16x16x32_bf16 v[72:75], v[200:203], v[120:123], v[72:75]
    v_mfma_f32_16x16x32_bf16 v[76:79], v[200:203], v[124:127], v[76:79]
    ds_read_b128 v[148:151], v4 offset:5120
    v_mfma_f32_16x16x32_bf16 v[80:83], v[204:207], v[112:115], v[80:83]
    buffer_load_dwordx4 v[200:203], v2, s[20:23], s31 offen offset:2048 sc1
    v_mfma_f32_16x16x32_bf16 v[84:87], v[204:207], v[116:119], v[84:87]
    ds_read_b128 v[152:155], v4 offset:6144
    v_mfma_f32_16x16x32_bf16 v[88:91], v[204:207], v[120:123], v[88:91]
    v_mfma_f32_16x16x32_bf16 v[92:95], v[204:207], v[124:127], v[92:95]
    ds_read_b128 v[156:159], v4 offset:7168
    s_waitcnt vmcnt(17) lgkmcnt(4)
    v_mfma_f32_16x16x32_bf16 v[64:67], v[208:211], v[128:131], v[64:67]
    buffer_load_dwordx4 v[204:207], v2, s[20:23], s31 offen offset:3072 sc1
    v_mfma_f32_16x16x32_bf16 v[68:71], v[208:211], v[132:135], v[68:71]
    ds_read_b128 v[112:115], v4 offset:8192
    v_mfma_f32_16x16x32_bf16 v[72:75], v[208:211], v[136:139], v[72:75]
    v_mfma_f32_16x16x32_bf16 v[76:79], v[208:211], v[140:143], v[76:79]
    ds_read_b128 v[116:119], v4 offset:9216
    v_mfma_f32_16x16x32_bf16 v[80:83], v[212:215], v[128:131], v[80:83]
    s_add_u32 s31, s31, 4096
    buffer_load_dwordx4 v[208:211], v2, s[20:23], s31 offen offset:0 sc1
    v_mfma_f32_16x16x32_bf16 v[84:87], v[212:215], v[132:135], v[84:87]
    ds_read_b128 v[120:123], v4 offset:10240
    v_mfma_f32_16x16x32_bf16 v[88:91], v[212:215], v[136:139], v[88:91]
    v_mfma_f32_16x16x32_bf16 v[92:95], v[212:215], v[140:143], v[92:95]
    ds_read_b128 v[124:127], v4 offset:11264
    s_waitcnt vmcnt(17) lgkmcnt(4)
    v_mfma_f32_16x16x32_bf16 v[64:67], v[216:219], v[144:147], v[64:67]
    buffer_load_dwordx4 v[212:215], v2, s[20:23], s31 offen offset:1024 sc1
    v_mfma_f32_16x16x32_bf16 v[68:71], v[216:219], v[148:151], v[68:71]
    ds_read_b128 v[128:131], v4 offset:12288
    v_mfma_f32_16x16x32_bf16 v[72:75], v[216:219], v[152:155], v[72:75]
    v_mfma_f32_16x16x32_bf16 v[76:79], v[216:219], v[156:159], v[76:79]
    ds_read_b128 v[132:135], v4 offset:13312
    v_mfma_f32_16x16x32_bf16 v[80:83], v[220:223], v[144:147], v[80:83]
    buffer_load_dwordx4 v[216:219], v2, s[20:23], s31 offen offset:2048 sc1
    v_mfma_f32_16x16x32_bf16 v[84:87], v[220:223], v[148:151], v[84:87]
    ds_read_b128 v[136:139], v4 offset:14336
    v_mfma_f32_16x16x32_bf16 v[88:91], v[220:223], v[152:155], v[88:91]
    v_mfma_f32_16x16x32_bf16 v[92:95], v[220:223], v[156:159], v[92:95]
    ds_read_b128 v[140:143], v4 offset:15360
    s_waitcnt vmcnt(17) lgkmcnt(4)
    v_mfma_f32_16x16x32_bf16 v[64:67], v[224:227], v[112:115], v[64:67]
    buffer_load_dwordx4 v[220:223], v2, s[20:23], s31 offen offset:3072 sc1
    v_mfma_f32_16x16x32_bf16 v[68:71], v[224:227], v[116:119], v[68:71]
    ds_read_b128 v[144:147], v4 offset:16384
    v_mfma_f32_16x16x32_bf16 v[72:75], v[224:227], v[120:123], v[72:75]
    v_mfma_f32_16x16x32_bf16 v[76:79], v[224:227], v[124:127], v[76:79]
    ds_read_b128 v[148:151], v4 offset:17408
    v_mfma_f32_16x16x32_bf16 v[80:83], v[228:231], v[112:115], v[80:83]
    s_add_u32 s31, s31, 4096
    buffer_load_dwordx4 v[224:227], v2, s[20:23], s31 offen offset:0 sc1
    v_mfma_f32_16x16x32_bf16 v[84:87], v[228:231], v[116:119], v[84:87]
    ds_read_b128 v[152:155], v4 offset:18432
    v_mfma_f32_16x16x32_bf16 v[88:91], v[228:231], v[120:123], v[88:91]
    v_mfma_f32_16x16x32_bf16 v[92:95], v[228:231], v[124:127], v[92:95]
    ds_read_b128 v[156:159], v4 offset:19456
    s_waitcnt vmcnt(17) lgkmcnt(4)
    v_mfma_f32_16x16x32_bf16 v[64:67], v[232:235], v[128:131], v[64:67]
    buffer_load_dwordx4 v[228:231], v2, s[20:23], s31 offen offset:1024 sc1
    v_mfma_f32_16x16x32_bf16 v[68:71], v[232:235], v[132:135], v[68:71]
    ds_read_b128 v[112:115], v3 offset:12288
    v_mfma_f32_16x16x32_bf16 v[72:75], v[232:235], v[136:139], v[72:75]
    v_mfma_f32_16x16x32_bf16 v[76:79], v[232:235], v[140:143], v[76:79]
    ds_read_b128 v[116:119], v3 offset:13312
    v_mfma_f32_16x16x32_bf16 v[80:83], v[236:239], v[128:131], v[80:83]
    buffer_load_dwordx4 v[232:235], v2, s[20:23], s31 offen offset:2048 sc1
    v_mfma_f32_16x16x32_bf16 v[84:87], v[236:239], v[132:135], v[84:87]
    ds_read_b128 v[120:123], v3 offset:14336
    v_mfma_f32_16x16x32_bf16 v[88:91], v[236:239], v[136:139], v[88:91]
    v_mfma_f32_16x16x32_bf16 v[92:95], v[236:239], v[140:143], v[92:95]
    ds_read_b128 v[124:127], v3 offset:15360
    s_waitcnt vmcnt(17) lgkmcnt(4)
    v_mfma_f32_16x16x32_bf16 v[64:67], v[240:243], v[144:147], v[64:67]
    buffer_load_dwordx4 v[236:239], v2, s[20:23], s31 offen offset:3072 sc1
    v_mfma_f32_16x16x32_bf16 v[68:71], v[240:243], v[148:151], v[68:71]
    ds_read_b128 v[128:131], v3 offset:16384
    v_mfma_f32_16x16x32_bf16 v[72:75], v[240:243], v[152:155], v[72:75]
    v_mfma_f32_16x16x32_bf16 v[76:79], v[240:243], v[156:159], v[76:79]
    ds_read_b128 v[132:135], v3 offset:17408
    v_mfma_f32_16x16x32_bf16 v[80:83], v[244:247], v[144:147], v[80:83]
    s_add_u32 s31, s31, 4096
    buffer_load_dwordx4 v[240:243], v2, s[20:23], s31 offen offset:0 sc1
    v_mfma_f32_16x16x32_bf16 v[84:87], v[244:247], v[148:151], v[84:87]
    ds_read_b128 v[136:139], v3 offset:18432
    v_mfma_f32_16x16x32_bf16 v[88:91], v[244:247], v[152:155], v[88:91]
    v_mfma_f32_16x16x32_bf16 v[92:95], v[244:247], v[156:159], v[92:95]
    ds_read_b128 v[140:143], v3 offset:19456
    s_waitcnt vmcnt(17) lgkmcnt(4)
    v_mfma_f32_16x16x32_bf16 v[16:19], v[248:251], v[112:115], 0
    buffer_load_dwordx4 v[244:247], v2, s[20:23], s31 offen offset:1024 sc1
    v_mfma_f32_16x16x32_bf16 v[20:23], v[248:251], v[116:119], 0
    ds_read_b128 v[144:147], v3 offset:20480
    v_mfma_f32_16x16x32_bf16 v[24:27], v[248:251], v[120:123], 0
    v_mfma_f32_16x16x32_bf16 v[28:31], v[248:251], v[124:127], 0
    ds_read_b128 v[148:151], v3 offset:21504
    v_cvt_pk_bf16_f32 v160, v64, v65
    v_cvt_pk_bf16_f32 v161, v66, v67
    ds_write_b64 v7, v[160:161] offset:0
    v_mfma_f32_16x16x32_bf16 v[32:35], v[252:255], v[112:115], 0
    buffer_load_dwordx4 v[248:251], v2, s[20:23], s31 offen offset:2048 sc1
    v_cvt_pk_bf16_f32 v162, v68, v69
    v_cvt_pk_bf16_f32 v163, v70, v71
    v_mfma_f32_16x16x32_bf16 v[36:39], v[252:255], v[116:119], 0
    ds_read_b128 v[152:155], v3 offset:22528
    ds_write_b64 v7, v[162:163] offset:2048
    v_cvt_pk_bf16_f32 v164, v72, v73
    v_cvt_pk_bf16_f32 v165, v74, v75
    v_mfma_f32_16x16x32_bf16 v[40:43], v[252:255], v[120:123], 0
    ds_write_b64 v7, v[164:165] offset:4096
    v_cvt_pk_bf16_f32 v166, v76, v77
    v_cvt_pk_bf16_f32 v167, v78, v79
    ds_write_b64 v7, v[166:167] offset:6144
    v_mfma_f32_16x16x32_bf16 v[44:47], v[252:255], v[124:127], 0
    ds_read_b128 v[156:159], v3 offset:23552
    s_mov_b64 exec, 1
    ds_add_u32 v11, v10 offset:0
    s_mov_b64 exec, -1
    v_cvt_pk_bf16_f32 v168, v80, v81
    v_cvt_pk_bf16_f32 v169, v82, v83
    s_waitcnt vmcnt(17) lgkmcnt(9)
    v_mfma_f32_16x16x32_bf16 v[16:19], v[176:179], v[128:131], v[16:19]
    buffer_load_dwordx4 v[252:255], v2, s[20:23], s31 offen offset:3072 sc1
    ds_write_b64 v7, v[168:169] offset:8192
    v_cvt_pk_bf16_f32 v170, v84, v85
    v_mfma_f32_16x16x32_bf16 v[20:23], v[176:179], v[132:135], v[20:23]
    ds_read_b128 v[112:115], v3 offset:24576
    v_cvt_pk_bf16_f32 v171, v86, v87
    ds_write_b64 v7, v[170:171] offset:10240
    v_cvt_pk_bf16_f32 v172, v88, v89
    v_mfma_f32_16x16x32_bf16 v[24:27], v[176:179], v[136:139], v[24:27]
    v_cvt_pk_bf16_f32 v173, v90, v91
    ds_write_b64 v7, v[172:173] offset:12288
    v_cvt_pk_bf16_f32 v174, v92, v93
    v_cvt_pk_bf16_f32 v175, v94, v95
    v_mfma_f32_16x16x32_bf16 v[28:31], v[176:179], v[140:143], v[28:31]
    ds_read_b128 v[116:119], v3 offset:25600
    ds_write_b64 v7, v[174:175] offset:14336
    s_mov_b64 exec, 1
    ds_add_u32 v11, v10 offset:4
    s_mov_b64 exec, -1
    v_mfma_f32_16x16x32_bf16 v[32:35], v[180:183], v[128:131], v[32:35]
    s_add_u32 s31, s31, 4096
    buffer_load_dwordx4 v[176:179], v2, s[20:23], s31 offen offset:0 sc1
    v_mfma_f32_16x16x32_bf16 v[36:39], v[180:183], v[132:135], v[36:39]
    ds_read_b128 v[120:123], v3 offset:26624
    v_mfma_f32_16x16x32_bf16 v[40:43], v[180:183], v[136:139], v[40:43]
    v_mfma_f32_16x16x32_bf16 v[44:47], v[180:183], v[140:143], v[44:47]
    ds_read_b128 v[124:127], v3 offset:27648
    s_waitcnt vmcnt(17) lgkmcnt(10)
    v_mfma_f32_16x16x32_bf16 v[16:19], v[184:187], v[144:147], v[16:19]
    buffer_load_dwordx4 v[180:183], v2, s[20:23], s31 offen offset:1024 sc1
    v_mfma_f32_16x16x32_bf16 v[20:23], v[184:187], v[148:151], v[20:23]
    ds_read_b128 v[128:131], v3 offset:28672
    v_mfma_f32_16x16x32_bf16 v[24:27], v[184:187], v[152:155], v[24:27]
    v_mfma_f32_16x16x32_bf16 v[28:31], v[184:187], v[156:159], v[28:31]
    ds_read_b128 v[132:135], v3 offset:29696
    v_mfma_f32_16x16x32_bf16 v[32:35], v[188:191], v[144:147], v[32:35]
    buffer_load_dwordx4 v[184:187], v2, s[20:23], s31 offen offset:2048 sc1
    v_mfma_f32_16x16x32_bf16 v[36:39], v[188:191], v[148:151], v[36:39]
    ds_read_b128 v[136:139], v3 offset:30720
    v_mfma_f32_16x16x32_bf16 v[40:43], v[188:191], v[152:155], v[40:43]
    v_mfma_f32_16x16x32_bf16 v[44:47], v[188:191], v[156:159], v[44:47]
    ds_read_b128 v[140:143], v3 offset:31744
    s_waitcnt vmcnt(17) lgkmcnt(4)
    v_mfma_f32_16x16x32_bf16 v[16:19], v[192:195], v[112:115], v[16:19]
    buffer_load_dwordx4 v[188:191], v2, s[20:23], s31 offen offset:3072 sc1
    v_mfma_f32_16x16x32_bf16 v[20:23], v[192:195], v[116:119], v[20:23]
    ds_read_b128 v[144:147], v3 offset:32768
    v_mfma_f32_16x16x32_bf16 v[24:27], v[192:195], v[120:123], v[24:27]
    v_mfma_f32_16x16x32_bf16 v[28:31], v[192:195], v[124:127], v[28:31]
    ds_read_b128 v[148:151], v3 offset:33792
    v_mfma_f32_16x16x32_bf16 v[32:35], v[196:199], v[112:115], v[32:35]
    s_add_u32 s31, s31, 4096
    buffer_load_dwordx4 v[192:195], v2, s[20:23], s31 offen offset:0 sc1
    v_mfma_f32_16x16x32_bf16 v[36:39], v[196:199], v[116:119], v[36:39]
    ds_read_b128 v[152:155], v3 offset:34816
    v_mfma_f32_16x16x32_bf16 v[40:43], v[196:199], v[120:123], v[40:43]
    v_mfma_f32_16x16x32_bf16 v[44:47], v[196:199], v[124:127], v[44:47]
    ds_read_b128 v[156:159], v3 offset:35840
    s_waitcnt vmcnt(17) lgkmcnt(4)
    v_mfma_f32_16x16x32_bf16 v[16:19], v[200:203], v[128:131], v[16:19]
    buffer_load_dwordx4 v[196:199], v2, s[20:23], s31 offen offset:1024 sc1
    v_mfma_f32_16x16x32_bf16 v[20:23], v[200:203], v[132:135], v[20:23]
    ds_read_b128 v[112:115], v3 offset:36864
    v_mfma_f32_16x16x32_bf16 v[24:27], v[200:203], v[136:139], v[24:27]
    v_mfma_f32_16x16x32_bf16 v[28:31], v[200:203], v[140:143], v[28:31]
    ds_read_b128 v[116:119], v3 offset:37888
    v_mfma_f32_16x16x32_bf16 v[32:35], v[204:207], v[128:131], v[32:35]
    buffer_load_dwordx4 v[200:203], v2, s[20:23], s31 offen offset:2048 sc1
    v_mfma_f32_16x16x32_bf16 v[36:39], v[204:207], v[132:135], v[36:39]
    ds_read_b128 v[120:123], v3 offset:38912
    v_mfma_f32_16x16x32_bf16 v[40:43], v[204:207], v[136:139], v[40:43]
    v_mfma_f32_16x16x32_bf16 v[44:47], v[204:207], v[140:143], v[44:47]
    ds_read_b128 v[124:127], v3 offset:39936
    s_waitcnt vmcnt(17) lgkmcnt(4)
    v_mfma_f32_16x16x32_bf16 v[16:19], v[208:211], v[144:147], v[16:19]
    buffer_load_dwordx4 v[204:207], v2, s[20:23], s31 offen offset:3072 sc1
    v_mfma_f32_16x16x32_bf16 v[20:23], v[208:211], v[148:151], v[20:23]
    ds_read_b128 v[128:131], v3 offset:40960
    v_mfma_f32_16x16x32_bf16 v[24:27], v[208:211], v[152:155], v[24:27]
    v_mfma_f32_16x16x32_bf16 v[28:31], v[208:211], v[156:159], v[28:31]
    ds_read_b128 v[132:135], v3 offset:41984
    v_mfma_f32_16x16x32_bf16 v[32:35], v[212:215], v[144:147], v[32:35]
    s_add_u32 s31, s31, 4096
    buffer_load_dwordx4 v[208:211], v2, s[20:23], s31 offen offset:0 sc1
    v_mfma_f32_16x16x32_bf16 v[36:39], v[212:215], v[148:151], v[36:39]
    ds_read_b128 v[136:139], v3 offset:43008
    v_mfma_f32_16x16x32_bf16 v[40:43], v[212:215], v[152:155], v[40:43]
    v_mfma_f32_16x16x32_bf16 v[44:47], v[212:215], v[156:159], v[44:47]
    ds_read_b128 v[140:143], v3 offset:44032
    s_waitcnt vmcnt(17) lgkmcnt(4)
    v_mfma_f32_16x16x32_bf16 v[16:19], v[216:219], v[112:115], v[16:19]
    buffer_load_dwordx4 v[212:215], v2, s[20:23], s31 offen offset:1024 sc1
    v_mfma_f32_16x16x32_bf16 v[20:23], v[216:219], v[116:119], v[20:23]
    ds_read_b128 v[144:147], v3 offset:45056
    v_mfma_f32_16x16x32_bf16 v[24:27], v[216:219], v[120:123], v[24:27]
    v_mfma_f32_16x16x32_bf16 v[28:31], v[216:219], v[124:127], v[28:31]
    ds_read_b128 v[148:151], v3 offset:46080
    v_mfma_f32_16x16x32_bf16 v[32:35], v[220:223], v[112:115], v[32:35]
    buffer_load_dwordx4 v[216:219], v2, s[20:23], s31 offen offset:2048 sc1
    v_mfma_f32_16x16x32_bf16 v[36:39], v[220:223], v[116:119], v[36:39]
    ds_read_b128 v[152:155], v3 offset:47104
    v_mfma_f32_16x16x32_bf16 v[40:43], v[220:223], v[120:123], v[40:43]
    v_mfma_f32_16x16x32_bf16 v[44:47], v[220:223], v[124:127], v[44:47]
    ds_read_b128 v[156:159], v3 offset:48128
    s_waitcnt vmcnt(17) lgkmcnt(4)
    v_mfma_f32_16x16x32_bf16 v[16:19], v[224:227], v[128:131], v[16:19]
    buffer_load_dwordx4 v[220:223], v2, s[20:23], s31 offen offset:3072 sc1
    v_mfma_f32_16x16x32_bf16 v[20:23], v[224:227], v[132:135], v[20:23]
    ds_read_b128 v[112:115], v3 offset:49152
    v_mfma_f32_16x16x32_bf16 v[24:27], v[224:227], v[136:139], v[24:27]
    v_mfma_f32_16x16x32_bf16 v[28:31], v[224:227], v[140:143], v[28:31]
    ds_read_b128 v[116:119], v3 offset:50176
    v_mfma_f32_16x16x32_bf16 v[32:35], v[228:231], v[128:131], v[32:35]
    s_add_u32 s31, s31, 4096
    buffer_load_dwordx4 v[224:227], v2, s[20:23], s31 offen offset:0 sc1
    v_mfma_f32_16x16x32_bf16 v[36:39], v[228:231], v[132:135], v[36:39]
    ds_read_b128 v[120:123], v3 offset:51200
    v_mfma_f32_16x16x32_bf16 v[40:43], v[228:231], v[136:139], v[40:43]
    v_mfma_f32_16x16x32_bf16 v[44:47], v[228:231], v[140:143], v[44:47]
    ds_read_b128 v[124:127], v3 offset:52224
    s_waitcnt vmcnt(17) lgkmcnt(4)
    v_mfma_f32_16x16x32_bf16 v[16:19], v[232:235], v[144:147], v[16:19]
    buffer_load_dwordx4 v[228:231], v2, s[20:23], s31 offen offset:1024 sc1
    v_mfma_f32_16x16x32_bf16 v[20:23], v[232:235], v[148:151], v[20:23]
    ds_read_b128 v[128:131], v3 offset:53248
    v_mfma_f32_16x16x32_bf16 v[24:27], v[232:235], v[152:155], v[24:27]
    v_mfma_f32_16x16x32_bf16 v[28:31], v[232:235], v[156:159], v[28:31]
    ds_read_b128 v[132:135], v3 offset:54272
    v_mfma_f32_16x16x32_bf16 v[32:35], v[236:239], v[144:147], v[32:35]
    buffer_load_dwordx4 v[232:235], v2, s[20:23], s31 offen offset:2048 sc1
    v_mfma_f32_16x16x32_bf16 v[36:39], v[236:239], v[148:151], v[36:39]
    ds_read_b128 v[136:139], v3 offset:55296
    v_mfma_f32_16x16x32_bf16 v[40:43], v[236:239], v[152:155], v[40:43]
    v_mfma_f32_16x16x32_bf16 v[44:47], v[236:239], v[156:159], v[44:47]
    ds_read_b128 v[140:143], v3 offset:56320
    s_waitcnt vmcnt(17) lgkmcnt(4)
    v_mfma_f32_16x16x32_bf16 v[16:19], v[240:243], v[112:115], v[16:19]
    buffer_load_dwordx4 v[236:239], v2, s[20:23], s31 offen offset:3072 sc1
    v_mfma_f32_16x16x32_bf16 v[20:23], v[240:243], v[116:119], v[20:23]
    ds_read_b128 v[144:147], v3 offset:57344
    v_mfma_f32_16x16x32_bf16 v[24:27], v[240:243], v[120:123], v[24:27]
    v_mfma_f32_16x16x32_bf16 v[28:31], v[240:243], v[124:127], v[28:31]
    ds_read_b128 v[148:151], v3 offset:58368
    v_mfma_f32_16x16x32_bf16 v[32:35], v[244:247], v[112:115], v[32:35]
    s_add_u32 s31, s31, 4096
    buffer_load_dwordx4 v[240:243], v2, s[20:23], s31 offen offset:0 sc1
    v_mfma_f32_16x16x32_bf16 v[36:39], v[244:247], v[116:119], v[36:39]
    ds_read_b128 v[152:155], v3 offset:59392
    v_mfma_f32_16x16x32_bf16 v[40:43], v[244:247], v[120:123], v[40:43]
    v_mfma_f32_16x16x32_bf16 v[44:47], v[244:247], v[124:127], v[44:47]
    ds_read_b128 v[156:159], v3 offset:60416
    s_waitcnt vmcnt(17) lgkmcnt(4)
    v_mfma_f32_16x16x32_bf16 v[16:19], v[248:251], v[128:131], v[16:19]
    buffer_load_dwordx4 v[244:247], v2, s[20:23], s31 offen offset:1024 sc1
    v_mfma_f32_16x16x32_bf16 v[20:23], v[248:251], v[132:135], v[20:23]
    ds_read_b128 v[112:115], v3 offset:61440
    v_mfma_f32_16x16x32_bf16 v[24:27], v[248:251], v[136:139], v[24:27]
    v_mfma_f32_16x16x32_bf16 v[28:31], v[248:251], v[140:143], v[28:31]
    ds_read_b128 v[116:119], v3 offset:62464
    v_mfma_f32_16x16x32_bf16 v[32:35], v[252:255], v[128:131], v[32:35]
    buffer_load_dwordx4 v[248:251], v2, s[20:23], s31 offen offset:2048 sc1
    v_mfma_f32_16x16x32_bf16 v[36:39], v[252:255], v[132:135], v[36:39]
    ds_read_b128 v[120:123], v3 offset:63488
    v_mfma_f32_16x16x32_bf16 v[40:43], v[252:255], v[136:139], v[40:43]
    v_mfma_f32_16x16x32_bf16 v[44:47], v[252:255], v[140:143], v[44:47]
    ds_read_b128 v[124:127], v3 offset:64512
    s_waitcnt vmcnt(17) lgkmcnt(4)
    v_mfma_f32_16x16x32_bf16 v[16:19], v[176:179], v[144:147], v[16:19]
    buffer_load_dwordx4 v[252:255], v2, s[20:23], s31 offen offset:3072 sc1
    v_mfma_f32_16x16x32_bf16 v[20:23], v[176:179], v[148:151], v[20:23]
    ds_read_b128 v[128:131], v4 offset:0
    v_mfma_f32_16x16x32_bf16 v[24:27], v[176:179], v[152:155], v[24:27]
    v_mfma_f32_16x16x32_bf16 v[28:31], v[176:179], v[156:159], v[28:31]
    ds_read_b128 v[132:135], v4 offset:1024
    v_mfma_f32_16x16x32_bf16 v[32:35], v[180:183], v[144:147], v[32:35]
    s_add_u32 s31, s31, 4096
    buffer_load_dwordx4 v[176:179], v2, s[20:23], s31 offen offset:0 sc1
    v_mfma_f32_16x16x32_bf16 v[36:39], v[180:183], v[148:151], v[36:39]
    ds_read_b128 v[136:139], v4 offset:2048
    v_mfma_f32_16x16x32_bf16 v[40:43], v[180:183], v[152:155], v[40:43]
    v_mfma_f32_16x16x32_bf16 v[44:47], v[180:183], v[156:159], v[44:47]
    ds_read_b128 v[140:143], v4 offset:3072
    s_waitcnt vmcnt(17) lgkmcnt(4)
    v_mfma_f32_16x16x32_bf16 v[16:19], v[184:187], v[112:115], v[16:19]
    buffer_load_dwordx4 v[180:183], v2, s[20:23], s31 offen offset:1024 sc1
    v_mfma_f32_16x16x32_bf16 v[20:23], v[184:187], v[116:119], v[20:23]
    ds_read_b128 v[144:147], v4 offset:4096
    v_mfma_f32_16x16x32_bf16 v[24:27], v[184:187], v[120:123], v[24:27]
    v_mfma_f32_16x16x32_bf16 v[28:31], v[184:187], v[124:127], v[28:31]
    ds_read_b128 v[148:151], v4 offset:5120
    v_mfma_f32_16x16x32_bf16 v[32:35], v[188:191], v[112:115], v[32:35]
    buffer_load_dwordx4 v[184:187], v2, s[20:23], s31 offen offset:2048 sc1
    v_mfma_f32_16x16x32_bf16 v[36:39], v[188:191], v[116:119], v[36:39]
    ds_read_b128 v[152:155], v4 offset:6144
    v_mfma_f32_16x16x32_bf16 v[40:43], v[188:191], v[120:123], v[40:43]
    v_mfma_f32_16x16x32_bf16 v[44:47], v[188:191], v[124:127], v[44:47]
    ds_read_b128 v[156:159], v4 offset:7168
    s_waitcnt vmcnt(17) lgkmcnt(4)
    v_mfma_f32_16x16x32_bf16 v[16:19], v[192:195], v[128:131], v[16:19]
    buffer_load_dwordx4 v[188:191], v2, s[20:23], s31 offen offset:3072 sc1
    v_mfma_f32_16x16x32_bf16 v[20:23], v[192:195], v[132:135], v[20:23]
    ds_read_b128 v[112:115], v4 offset:8192
    v_mfma_f32_16x16x32_bf16 v[24:27], v[192:195], v[136:139], v[24:27]
    v_mfma_f32_16x16x32_bf16 v[28:31], v[192:195], v[140:143], v[28:31]
    ds_read_b128 v[116:119], v4 offset:9216
    v_mfma_f32_16x16x32_bf16 v[32:35], v[196:199], v[128:131], v[32:35]
    s_add_u32 s31, s31, 4096
    buffer_load_dwordx4 v[192:195], v2, s[20:23], s31 offen offset:0 sc1
    v_mfma_f32_16x16x32_bf16 v[36:39], v[196:199], v[132:135], v[36:39]
    ds_read_b128 v[120:123], v4 offset:10240
    v_mfma_f32_16x16x32_bf16 v[40:43], v[196:199], v[136:139], v[40:43]
    v_mfma_f32_16x16x32_bf16 v[44:47], v[196:199], v[140:143], v[44:47]
    ds_read_b128 v[124:127], v4 offset:11264
    s_waitcnt vmcnt(17) lgkmcnt(4)
    v_mfma_f32_16x16x32_bf16 v[16:19], v[200:203], v[144:147], v[16:19]
    buffer_load_dwordx4 v[196:199], v2, s[20:23], s31 offen offset:1024 sc1
    v_mfma_f32_16x16x32_bf16 v[20:23], v[200:203], v[148:151], v[20:23]
    ds_read_b128 v[128:131], v4 offset:12288
    v_mfma_f32_16x16x32_bf16 v[24:27], v[200:203], v[152:155], v[24:27]
    v_mfma_f32_16x16x32_bf16 v[28:31], v[200:203], v[156:159], v[28:31]
    ds_read_b128 v[132:135], v4 offset:13312
    v_mfma_f32_16x16x32_bf16 v[32:35], v[204:207], v[144:147], v[32:35]
    buffer_load_dwordx4 v[200:203], v2, s[20:23], s31 offen offset:2048 sc1
    v_mfma_f32_16x16x32_bf16 v[36:39], v[204:207], v[148:151], v[36:39]
    ds_read_b128 v[136:139], v4 offset:14336
    v_mfma_f32_16x16x32_bf16 v[40:43], v[204:207], v[152:155], v[40:43]
    v_mfma_f32_16x16x32_bf16 v[44:47], v[204:207], v[156:159], v[44:47]
    ds_read_b128 v[140:143], v4 offset:15360
    s_waitcnt vmcnt(17) lgkmcnt(4)
    v_mfma_f32_16x16x32_bf16 v[16:19], v[208:211], v[112:115], v[16:19]
    buffer_load_dwordx4 v[204:207], v2, s[20:23], s31 offen offset:3072 sc1
    v_mfma_f32_16x16x32_bf16 v[20:23], v[208:211], v[116:119], v[20:23]
    ds_read_b128 v[144:147], v4 offset:16384
    v_mfma_f32_16x16x32_bf16 v[24:27], v[208:211], v[120:123], v[24:27]
    v_mfma_f32_16x16x32_bf16 v[28:31], v[208:211], v[124:127], v[28:31]
    ds_read_b128 v[148:151], v4 offset:17408
    v_mfma_f32_16x16x32_bf16 v[32:35], v[212:215], v[112:115], v[32:35]
    s_add_u32 s31, s31, 4096
    buffer_load_dwordx4 v[208:211], v2, s[20:23], s31 offen offset:0 sc1
    v_mfma_f32_16x16x32_bf16 v[36:39], v[212:215], v[116:119], v[36:39]
    ds_read_b128 v[152:155], v4 offset:18432
    v_mfma_f32_16x16x32_bf16 v[40:43], v[212:215], v[120:123], v[40:43]
    v_mfma_f32_16x16x32_bf16 v[44:47], v[212:215], v[124:127], v[44:47]
    ds_read_b128 v[156:159], v4 offset:19456
    s_waitcnt vmcnt(17) lgkmcnt(4)
    v_mfma_f32_16x16x32_bf16 v[16:19], v[216:219], v[128:131], v[16:19]
    buffer_load_dwordx4 v[212:215], v2, s[20:23], s31 offen offset:1024 sc1
    v_mfma_f32_16x16x32_bf16 v[20:23], v[216:219], v[132:135], v[20:23]
    ds_read_b128 v[112:115], v3 offset:12288
    v_mfma_f32_16x16x32_bf16 v[24:27], v[216:219], v[136:139], v[24:27]
    v_mfma_f32_16x16x32_bf16 v[28:31], v[216:219], v[140:143], v[28:31]
    ds_read_b128 v[116:119], v3 offset:13312
    v_mfma_f32_16x16x32_bf16 v[32:35], v[220:223], v[128:131], v[32:35]
    buffer_load_dwordx4 v[216:219], v2, s[20:23], s31 offen offset:2048 sc1
    v_mfma_f32_16x16x32_bf16 v[36:39], v[220:223], v[132:135], v[36:39]
    ds_read_b128 v[120:123], v3 offset:14336
    v_mfma_f32_16x16x32_bf16 v[40:43], v[220:223], v[136:139], v[40:43]
    v_mfma_f32_16x16x32_bf16 v[44:47], v[220:223], v[140:143], v[44:47]
    ds_read_b128 v[124:127], v3 offset:15360
    s_waitcnt vmcnt(17) lgkmcnt(4)
    v_mfma_f32_16x16x32_bf16 v[16:19], v[224:227], v[144:147], v[16:19]
    buffer_load_dwordx4 v[220:223], v2, s[20:23], s31 offen offset:3072 sc1
    v_mfma_f32_16x16x32_bf16 v[20:23], v[224:227], v[148:151], v[20:23]
    ds_read_b128 v[128:131], v3 offset:16384
    v_mfma_f32_16x16x32_bf16 v[24:27], v[224:227], v[152:155], v[24:27]
    v_mfma_f32_16x16x32_bf16 v[28:31], v[224:227], v[156:159], v[28:31]
    ds_read_b128 v[132:135], v3 offset:17408
    v_mfma_f32_16x16x32_bf16 v[32:35], v[228:231], v[144:147], v[32:35]
    s_add_u32 s31, s31, 4096
    buffer_load_dwordx4 v[224:227], v2, s[20:23], s31 offen offset:0 sc1
    v_mfma_f32_16x16x32_bf16 v[36:39], v[228:231], v[148:151], v[36:39]
    ds_read_b128 v[136:139], v3 offset:18432
    v_mfma_f32_16x16x32_bf16 v[40:43], v[228:231], v[152:155], v[40:43]
    v_mfma_f32_16x16x32_bf16 v[44:47], v[228:231], v[156:159], v[44:47]
    ds_read_b128 v[140:143], v3 offset:19456
    s_waitcnt vmcnt(17) lgkmcnt(4)
    v_mfma_f32_16x16x32_bf16 v[64:67], v[232:235], v[112:115], 0
    buffer_load_dwordx4 v[228:231], v2, s[20:23], s31 offen offset:1024 sc1
    v_mfma_f32_16x16x32_bf16 v[68:71], v[232:235], v[116:119], 0
    ds_read_b128 v[144:147], v3 offset:20480
    v_mfma_f32_16x16x32_bf16 v[72:75], v[232:235], v[120:123], 0
    v_mfma_f32_16x16x32_bf16 v[76:79], v[232:235], v[124:127], 0
    ds_read_b128 v[148:151], v3 offset:21504
    v_cvt_pk_bf16_f32 v160, v16, v17
    v_cvt_pk_bf16_f32 v161, v18, v19
    ds_write_b64 v7, v[160:161] offset:16384
    v_mfma_f32_16x16x32_bf16 v[80:83], v[236:239], v[112:115], 0
    buffer_load_dwordx4 v[232:235], v2, s[20:23], s31 offen offset:2048 sc1
    v_cvt_pk_bf16_f32 v162, v20, v21
    v_cvt_pk_bf16_f32 v163, v22, v23
    v_mfma_f32_16x16x32_bf16 v[84:87], v[236:239], v[116:119], 0
    ds_read_b128 v[152:155], v3 offset:22528
    ds_write_b64 v7, v[162:163] offset:18432
    v_cvt_pk_bf16_f32 v164, v24, v25
    v_cvt_pk_bf16_f32 v165, v26, v27
    v_mfma_f32_16x16x32_bf16 v[88:91], v[236:239], v[120:123], 0
    ds_write_b64 v7, v[164:165] offset:20480
    v_cvt_pk_bf16_f32 v166, v28, v29
    v_cvt_pk_bf16_f32 v167, v30, v31
    ds_write_b64 v7, v[166:167] offset:22528
    v_mfma_f32_16x16x32_bf16 v[92:95], v[236:239], v[124:127], 0
    ds_read_b128 v[156:159], v3 offset:23552
    s_mov_b64 exec, 1
    ds_add_u32 v11, v10 offset:8
    s_mov_b64 exec, -1
    v_cvt_pk_bf16_f32 v168, v32, v33
    v_cvt_pk_bf16_f32 v169, v34, v35
    s_waitcnt vmcnt(17) lgkmcnt(9)
    v_mfma_f32_16x16x32_bf16 v[64:67], v[240:243], v[128:131], v[64:67]
    buffer_load_dwordx4 v[236:239], v2, s[20:23], s31 offen offset:3072 sc1
    ds_write_b64 v7, v[168:169] offset:24576
    v_cvt_pk_bf16_f32 v170, v36, v37
    v_mfma_f32_16x16x32_bf16 v[68:71], v[240:243], v[132:135], v[68:71]
    ds_read_b128 v[112:115], v3 offset:24576
    v_cvt_pk_bf16_f32 v171, v38, v39
    ds_write_b64 v7, v[170:171] offset:26624
    v_cvt_pk_bf16_f32 v172, v40, v41
    v_mfma_f32_16x16x32_bf16 v[72:75], v[240:243], v[136:139], v[72:75]
    v_cvt_pk_bf16_f32 v173, v42, v43
    ds_write_b64 v7, v[172:173] offset:28672
    v_cvt_pk_bf16_f32 v174, v44, v45
    v_cvt_pk_bf16_f32 v175, v46, v47
    v_mfma_f32_16x16x32_bf16 v[76:79], v[240:243], v[140:143], v[76:79]
    ds_read_b128 v[116:119], v3 offset:25600
    ds_write_b64 v7, v[174:175] offset:30720
    s_mov_b64 exec, 1
    ds_add_u32 v11, v10 offset:12
    s_mov_b64 exec, -1
    v_mfma_f32_16x16x32_bf16 v[80:83], v[244:247], v[128:131], v[80:83]
    s_add_u32 s31, s31, 4096
    buffer_load_dwordx4 v[240:243], v2, s[20:23], s31 offen offset:0 sc1
    v_mfma_f32_16x16x32_bf16 v[84:87], v[244:247], v[132:135], v[84:87]
    ds_read_b128 v[120:123], v3 offset:26624
    v_mfma_f32_16x16x32_bf16 v[88:91], v[244:247], v[136:139], v[88:91]
    v_mfma_f32_16x16x32_bf16 v[92:95], v[244:247], v[140:143], v[92:95]
    ds_read_b128 v[124:127], v3 offset:27648
    s_waitcnt vmcnt(17) lgkmcnt(10)
    v_mfma_f32_16x16x32_bf16 v[64:67], v[248:251], v[144:147], v[64:67]
    buffer_load_dwordx4 v[244:247], v2, s[20:23], s31 offen offset:1024 sc1
    v_mfma_f32_16x16x32_bf16 v[68:71], v[248:251], v[148:151], v[68:71]
    ds_read_b128 v[128:131], v3 offset:28672
    v_mfma_f32_16x16x32_bf16 v[72:75], v[248:251], v[152:155], v[72:75]
    v_mfma_f32_16x16x32_bf16 v[76:79], v[248:251], v[156:159], v[76:79]
    ds_read_b128 v[132:135], v3 offset:29696
    v_mfma_f32_16x16x32_bf16 v[80:83], v[252:255], v[144:147], v[80:83]
    buffer_load_dwordx4 v[248:251], v2, s[20:23], s31 offen offset:2048 sc1
    v_mfma_f32_16x16x32_bf16 v[84:87], v[252:255], v[148:151], v[84:87]
    ds_read_b128 v[136:139], v3 offset:30720
    v_mfma_f32_16x16x32_bf16 v[88:91], v[252:255], v[152:155], v[88:91]
    v_mfma_f32_16x16x32_bf16 v[92:95], v[252:255], v[156:159], v[92:95]
    ds_read_b128 v[140:143], v3 offset:31744
    s_waitcnt vmcnt(17) lgkmcnt(4)
    v_mfma_f32_16x16x32_bf16 v[64:67], v[176:179], v[112:115], v[64:67]
    buffer_load_dwordx4 v[252:255], v2, s[20:23], s31 offen offset:3072 sc1
    v_mfma_f32_16x16x32_bf16 v[68:71], v[176:179], v[116:119], v[68:71]
    ds_read_b128 v[144:147], v3 offset:32768
    v_mfma_f32_16x16x32_bf16 v[72:75], v[176:179], v[120:123], v[72:75]
    v_mfma_f32_16x16x32_bf16 v[76:79], v[176:179], v[124:127], v[76:79]
    ds_read_b128 v[148:151], v3 offset:33792
    v_mfma_f32_16x16x32_bf16 v[80:83], v[180:183], v[112:115], v[80:83]
    s_add_u32 s31, s31, 4096
    buffer_load_dwordx4 v[176:179], v2, s[20:23], s31 offen offset:0 sc1
    v_mfma_f32_16x16x32_bf16 v[84:87], v[180:183], v[116:119], v[84:87]
    ds_read_b128 v[152:155], v3 offset:34816
    v_mfma_f32_16x16x32_bf16 v[88:91], v[180:183], v[120:123], v[88:91]
    v_mfma_f32_16x16x32_bf16 v[92:95], v[180:183], v[124:127], v[92:95]
    ds_read_b128 v[156:159], v3 offset:35840
    s_waitcnt vmcnt(17) lgkmcnt(4)
    v_mfma_f32_16x16x32_bf16 v[64:67], v[184:187], v[128:131], v[64:67]
    buffer_load_dwordx4 v[180:183], v2, s[20:23], s31 offen offset:1024 sc1
    v_mfma_f32_16x16x32_bf16 v[68:71], v[184:187], v[132:135], v[68:71]
    ds_read_b128 v[112:115], v3 offset:36864
    v_mfma_f32_16x16x32_bf16 v[72:75], v[184:187], v[136:139], v[72:75]
    v_mfma_f32_16x16x32_bf16 v[76:79], v[184:187], v[140:143], v[76:79]
    ds_read_b128 v[116:119], v3 offset:37888
    v_mfma_f32_16x16x32_bf16 v[80:83], v[188:191], v[128:131], v[80:83]
    buffer_load_dwordx4 v[184:187], v2, s[20:23], s31 offen offset:2048 sc1
    v_mfma_f32_16x16x32_bf16 v[84:87], v[188:191], v[132:135], v[84:87]
    ds_read_b128 v[120:123], v3 offset:38912
    v_mfma_f32_16x16x32_bf16 v[88:91], v[188:191], v[136:139], v[88:91]
    v_mfma_f32_16x16x32_bf16 v[92:95], v[188:191], v[140:143], v[92:95]
    ds_read_b128 v[124:127], v3 offset:39936
    s_waitcnt vmcnt(17) lgkmcnt(4)
    v_mfma_f32_16x16x32_bf16 v[64:67], v[192:195], v[144:147], v[64:67]
    buffer_load_dwordx4 v[188:191], v2, s[20:23], s31 offen offset:3072 sc1
    v_mfma_f32_16x16x32_bf16 v[68:71], v[192:195], v[148:151], v[68:71]
    ds_read_b128 v[128:131], v3 offset:40960
    v_mfma_f32_16x16x32_bf16 v[72:75], v[192:195], v[152:155], v[72:75]
    v_mfma_f32_16x16x32_bf16 v[76:79], v[192:195], v[156:159], v[76:79]
    ds_read_b128 v[132:135], v3 offset:41984
    v_mfma_f32_16x16x32_bf16 v[80:83], v[196:199], v[144:147], v[80:83]
    s_add_u32 s31, s31, 4096
    buffer_load_dwordx4 v[192:195], v2, s[20:23], s31 offen offset:0 sc1
    v_mfma_f32_16x16x32_bf16 v[84:87], v[196:199], v[148:151], v[84:87]
    ds_read_b128 v[136:139], v3 offset:43008
    v_mfma_f32_16x16x32_bf16 v[88:91], v[196:199], v[152:155], v[88:91]
    v_mfma_f32_16x16x32_bf16 v[92:95], v[196:199], v[156:159], v[92:95]
    ds_read_b128 v[140:143], v3 offset:44032
    s_waitcnt vmcnt(17) lgkmcnt(4)
    v_mfma_f32_16x16x32_bf16 v[64:67], v[200:203], v[112:115], v[64:67]
    buffer_load_dwordx4 v[196:199], v2, s[20:23], s31 offen offset:1024 sc1
    v_mfma_f32_16x16x32_bf16 v[68:71], v[200:203], v[116:119], v[68:71]
    ds_read_b128 v[144:147], v3 offset:45056
    v_mfma_f32_16x16x32_bf16 v[72:75], v[200:203], v[120:123], v[72:75]
    v_mfma_f32_16x16x32_bf16 v[76:79], v[200:203], v[124:127], v[76:79]
    ds_read_b128 v[148:151], v3 offset:46080
    v_mfma_f32_16x16x32_bf16 v[80:83], v[204:207], v[112:115], v[80:83]
    buffer_load_dwordx4 v[200:203], v2, s[20:23], s31 offen offset:2048 sc1
    v_mfma_f32_16x16x32_bf16 v[84:87], v[204:207], v[116:119], v[84:87]
    ds_read_b128 v[152:155], v3 offset:47104
    v_mfma_f32_16x16x32_bf16 v[88:91], v[204:207], v[120:123], v[88:91]
    v_mfma_f32_16x16x32_bf16 v[92:95], v[204:207], v[124:127], v[92:95]
    ds_read_b128 v[156:159], v3 offset:48128
    s_waitcnt vmcnt(17) lgkmcnt(4)
    v_mfma_f32_16x16x32_bf16 v[64:67], v[208:211], v[128:131], v[64:67]
    buffer_load_dwordx4 v[204:207], v2, s[20:23], s31 offen offset:3072 sc1
    v_mfma_f32_16x16x32_bf16 v[68:71], v[208:211], v[132:135], v[68:71]
    ds_read_b128 v[112:115], v3 offset:49152
    v_mfma_f32_16x16x32_bf16 v[72:75], v[208:211], v[136:139], v[72:75]
    v_mfma_f32_16x16x32_bf16 v[76:79], v[208:211], v[140:143], v[76:79]
    ds_read_b128 v[116:119], v3 offset:50176
    v_mfma_f32_16x16x32_bf16 v[80:83], v[212:215], v[128:131], v[80:83]
    s_add_u32 s31, s31, 4096
    buffer_load_dwordx4 v[208:211], v2, s[20:23], s31 offen offset:0 sc1
    v_mfma_f32_16x16x32_bf16 v[84:87], v[212:215], v[132:135], v[84:87]
    ds_read_b128 v[120:123], v3 offset:51200
    v_mfma_f32_16x16x32_bf16 v[88:91], v[212:215], v[136:139], v[88:91]
    v_mfma_f32_16x16x32_bf16 v[92:95], v[212:215], v[140:143], v[92:95]
    ds_read_b128 v[124:127], v3 offset:52224
    s_waitcnt vmcnt(17) lgkmcnt(4)
    v_mfma_f32_16x16x32_bf16 v[64:67], v[216:219], v[144:147], v[64:67]
    buffer_load_dwordx4 v[212:215], v2, s[20:23], s31 offen offset:1024 sc1
    v_mfma_f32_16x16x32_bf16 v[68:71], v[216:219], v[148:151], v[68:71]
    ds_read_b128 v[128:131], v3 offset:53248
    v_mfma_f32_16x16x32_bf16 v[72:75], v[216:219], v[152:155], v[72:75]
    v_mfma_f32_16x16x32_bf16 v[76:79], v[216:219], v[156:159], v[76:79]
    ds_read_b128 v[132:135], v3 offset:54272
    v_mfma_f32_16x16x32_bf16 v[80:83], v[220:223], v[144:147], v[80:83]
    buffer_load_dwordx4 v[216:219], v2, s[20:23], s31 offen offset:2048 sc1
    v_mfma_f32_16x16x32_bf16 v[84:87], v[220:223], v[148:151], v[84:87]
    ds_read_b128 v[136:139], v3 offset:55296
    v_mfma_f32_16x16x32_bf16 v[88:91], v[220:223], v[152:155], v[88:91]
    v_mfma_f32_16x16x32_bf16 v[92:95], v[220:223], v[156:159], v[92:95]
    ds_read_b128 v[140:143], v3 offset:56320
    s_waitcnt vmcnt(17) lgkmcnt(4)
    v_mfma_f32_16x16x32_bf16 v[64:67], v[224:227], v[112:115], v[64:67]
    buffer_load_dwordx4 v[220:223], v2, s[20:23], s31 offen offset:3072 sc1
    v_mfma_f32_16x16x32_bf16 v[68:71], v[224:227], v[116:119], v[68:71]
    ds_read_b128 v[144:147], v3 offset:57344
    v_mfma_f32_16x16x32_bf16 v[72:75], v[224:227], v[120:123], v[72:75]
    v_mfma_f32_16x16x32_bf16 v[76:79], v[224:227], v[124:127], v[76:79]
    ds_read_b128 v[148:151], v3 offset:58368
    v_mfma_f32_16x16x32_bf16 v[80:83], v[228:231], v[112:115], v[80:83]
    s_add_u32 s31, s31, 4096
    buffer_load_dwordx4 v[224:227], v2, s[20:23], s31 offen offset:0 sc1
    v_mfma_f32_16x16x32_bf16 v[84:87], v[228:231], v[116:119], v[84:87]
    ds_read_b128 v[152:155], v3 offset:59392
    v_mfma_f32_16x16x32_bf16 v[88:91], v[228:231], v[120:123], v[88:91]
    v_mfma_f32_16x16x32_bf16 v[92:95], v[228:231], v[124:127], v[92:95]
    ds_read_b128 v[156:159], v3 offset:60416
    s_waitcnt vmcnt(17) lgkmcnt(4)
    v_mfma_f32_16x16x32_bf16 v[64:67], v[232:235], v[128:131], v[64:67]
    buffer_load_dwordx4 v[228:231], v2, s[20:23], s31 offen offset:1024 sc1
    v_mfma_f32_16x16x32_bf16 v[68:71], v[232:235], v[132:135], v[68:71]
    ds_read_b128 v[112:115], v3 offset:61440
    v_mfma_f32_16x16x32_bf16 v[72:75], v[232:235], v[136:139], v[72:75]
    v_mfma_f32_16x16x32_bf16 v[76:79], v[232:235], v[140:143], v[76:79]
    ds_read_b128 v[116:119], v3 offset:62464
    v_mfma_f32_16x16x32_bf16 v[80:83], v[236:239], v[128:131], v[80:83]
    buffer_load_dwordx4 v[232:235], v2, s[20:23], s31 offen offset:2048 sc1
    v_mfma_f32_16x16x32_bf16 v[84:87], v[236:239], v[132:135], v[84:87]
    ds_read_b128 v[120:123], v3 offset:63488
    v_mfma_f32_16x16x32_bf16 v[88:91], v[236:239], v[136:139], v[88:91]
    v_mfma_f32_16x16x32_bf16 v[92:95], v[236:239], v[140:143], v[92:95]
    ds_read_b128 v[124:127], v3 offset:64512
    s_waitcnt vmcnt(17) lgkmcnt(4)
    v_mfma_f32_16x16x32_bf16 v[64:67], v[240:243], v[144:147], v[64:67]
    buffer_load_dwordx4 v[236:239], v2, s[20:23], s31 offen offset:3072 sc1
    v_mfma_f32_16x16x32_bf16 v[68:71], v[240:243], v[148:151], v[68:71]
    ds_read_b128 v[128:131], v4 offset:0
    v_mfma_f32_16x16x32_bf16 v[72:75], v[240:243], v[152:155], v[72:75]
    v_mfma_f32_16x16x32_bf16 v[76:79], v[240:243], v[156:159], v[76:79]
    ds_read_b128 v[132:135], v4 offset:1024
    v_mfma_f32_16x16x32_bf16 v[80:83], v[244:247], v[144:147], v[80:83]
    s_add_u32 s31, s31, 4096
    buffer_load_dwordx4 v[240:243], v2, s[20:23], s31 offen offset:0 sc1
    v_mfma_f32_16x16x32_bf16 v[84:87], v[244:247], v[148:151], v[84:87]
    ds_read_b128 v[136:139], v4 offset:2048
    v_mfma_f32_16x16x32_bf16 v[88:91], v[244:247], v[152:155], v[88:91]
    v_mfma_f32_16x16x32_bf16 v[92:95], v[244:247], v[156:159], v[92:95]
    ds_read_b128 v[140:143], v4 offset:3072
    s_waitcnt vmcnt(17) lgkmcnt(4)
    v_mfma_f32_16x16x32_bf16 v[64:67], v[248:251], v[112:115], v[64:67]
    buffer_load_dwordx4 v[244:247], v2, s[20:23], s31 offen offset:1024 sc1
    v_mfma_f32_16x16x32_bf16 v[68:71], v[248:251], v[116:119], v[68:71]
    ds_read_b128 v[144:147], v4 offset:4096
    v_mfma_f32_16x16x32_bf16 v[72:75], v[248:251], v[120:123], v[72:75]
    v_mfma_f32_16x16x32_bf16 v[76:79], v[248:251], v[124:127], v[76:79]
    ds_read_b128 v[148:151], v4 offset:5120
    v_mfma_f32_16x16x32_bf16 v[80:83], v[252:255], v[112:115], v[80:83]
    buffer_load_dwordx4 v[248:251], v2, s[20:23], s31 offen offset:2048 sc1
    v_mfma_f32_16x16x32_bf16 v[84:87], v[252:255], v[116:119], v[84:87]
    ds_read_b128 v[152:155], v4 offset:6144
    v_mfma_f32_16x16x32_bf16 v[88:91], v[252:255], v[120:123], v[88:91]
    v_mfma_f32_16x16x32_bf16 v[92:95], v[252:255], v[124:127], v[92:95]
    ds_read_b128 v[156:159], v4 offset:7168
    s_waitcnt vmcnt(17) lgkmcnt(4)
    v_mfma_f32_16x16x32_bf16 v[64:67], v[176:179], v[128:131], v[64:67]
    buffer_load_dwordx4 v[252:255], v2, s[20:23], s31 offen offset:3072 sc1
    v_mfma_f32_16x16x32_bf16 v[68:71], v[176:179], v[132:135], v[68:71]
    ds_read_b128 v[112:115], v4 offset:8192
    v_mfma_f32_16x16x32_bf16 v[72:75], v[176:179], v[136:139], v[72:75]
    v_mfma_f32_16x16x32_bf16 v[76:79], v[176:179], v[140:143], v[76:79]
    ds_read_b128 v[116:119], v4 offset:9216
    v_mfma_f32_16x16x32_bf16 v[80:83], v[180:183], v[128:131], v[80:83]
    s_add_u32 s31, s31, 4096
    buffer_load_dwordx4 v[176:179], v2, s[20:23], s31 offen offset:0 sc1
    v_mfma_f32_16x16x32_bf16 v[84:87], v[180:183], v[132:135], v[84:87]
    ds_read_b128 v[120:123], v4 offset:10240
    v_mfma_f32_16x16x32_bf16 v[88:91], v[180:183], v[136:139], v[88:91]
    v_mfma_f32_16x16x32_bf16 v[92:95], v[180:183], v[140:143], v[92:95]
    ds_read_b128 v[124:127], v4 offset:11264
    s_waitcnt vmcnt(17) lgkmcnt(4)
    v_mfma_f32_16x16x32_bf16 v[64:67], v[184:187], v[144:147], v[64:67]
    buffer_load_dwordx4 v[180:183], v2, s[20:23], s31 offen offset:1024 sc1
    v_mfma_f32_16x16x32_bf16 v[68:71], v[184:187], v[148:151], v[68:71]
    ds_read_b128 v[128:131], v4 offset:12288
    v_mfma_f32_16x16x32_bf16 v[72:75], v[184:187], v[152:155], v[72:75]
    v_mfma_f32_16x16x32_bf16 v[76:79], v[184:187], v[156:159], v[76:79]
    ds_read_b128 v[132:135], v4 offset:13312
    v_mfma_f32_16x16x32_bf16 v[80:83], v[188:191], v[144:147], v[80:83]
    buffer_load_dwordx4 v[184:187], v2, s[20:23], s31 offen offset:2048 sc1
    v_mfma_f32_16x16x32_bf16 v[84:87], v[188:191], v[148:151], v[84:87]
    ds_read_b128 v[136:139], v4 offset:14336
    v_mfma_f32_16x16x32_bf16 v[88:91], v[188:191], v[152:155], v[88:91]
    v_mfma_f32_16x16x32_bf16 v[92:95], v[188:191], v[156:159], v[92:95]
    ds_read_b128 v[140:143], v4 offset:15360
    s_waitcnt vmcnt(17) lgkmcnt(4)
    v_mfma_f32_16x16x32_bf16 v[64:67], v[192:195], v[112:115], v[64:67]
    buffer_load_dwordx4 v[188:191], v2, s[20:23], s31 offen offset:3072 sc1
    v_mfma_f32_16x16x32_bf16 v[68:71], v[192:195], v[116:119], v[68:71]
    ds_read_b128 v[144:147], v4 offset:16384
    v_mfma_f32_16x16x32_bf16 v[72:75], v[192:195], v[120:123], v[72:75]
    v_mfma_f32_16x16x32_bf16 v[76:79], v[192:195], v[124:127], v[76:79]
    ds_read_b128 v[148:151], v4 offset:17408
    v_mfma_f32_16x16x32_bf16 v[80:83], v[196:199], v[112:115], v[80:83]
    s_add_u32 s31, s31, 4096
    buffer_load_dwordx4 v[192:195], v2, s[20:23], s31 offen offset:0 sc1
    v_mfma_f32_16x16x32_bf16 v[84:87], v[196:199], v[116:119], v[84:87]
    ds_read_b128 v[152:155], v4 offset:18432
    v_mfma_f32_16x16x32_bf16 v[88:91], v[196:199], v[120:123], v[88:91]
    v_mfma_f32_16x16x32_bf16 v[92:95], v[196:199], v[124:127], v[92:95]
    ds_read_b128 v[156:159], v4 offset:19456
    s_waitcnt vmcnt(17) lgkmcnt(4)
    v_mfma_f32_16x16x32_bf16 v[64:67], v[200:203], v[128:131], v[64:67]
    buffer_load_dwordx4 v[196:199], v2, s[20:23], s31 offen offset:1024 sc1
    v_mfma_f32_16x16x32_bf16 v[68:71], v[200:203], v[132:135], v[68:71]
    ds_read_b128 v[112:115], v3 offset:12288
    v_mfma_f32_16x16x32_bf16 v[72:75], v[200:203], v[136:139], v[72:75]
    v_mfma_f32_16x16x32_bf16 v[76:79], v[200:203], v[140:143], v[76:79]
    ds_read_b128 v[116:119], v3 offset:13312
    v_mfma_f32_16x16x32_bf16 v[80:83], v[204:207], v[128:131], v[80:83]
    buffer_load_dwordx4 v[200:203], v2, s[20:23], s31 offen offset:2048 sc1
    v_mfma_f32_16x16x32_bf16 v[84:87], v[204:207], v[132:135], v[84:87]
    ds_read_b128 v[120:123], v3 offset:14336
    v_mfma_f32_16x16x32_bf16 v[88:91], v[204:207], v[136:139], v[88:91]
    v_mfma_f32_16x16x32_bf16 v[92:95], v[204:207], v[140:143], v[92:95]
    ds_read_b128 v[124:127], v3 offset:15360
    s_waitcnt vmcnt(17) lgkmcnt(4)
    v_mfma_f32_16x16x32_bf16 v[64:67], v[208:211], v[144:147], v[64:67]
    buffer_load_dwordx4 v[204:207], v2, s[20:23], s31 offen offset:3072 sc1
    v_mfma_f32_16x16x32_bf16 v[68:71], v[208:211], v[148:151], v[68:71]
    ds_read_b128 v[128:131], v3 offset:16384
    v_mfma_f32_16x16x32_bf16 v[72:75], v[208:211], v[152:155], v[72:75]
    v_mfma_f32_16x16x32_bf16 v[76:79], v[208:211], v[156:159], v[76:79]
    ds_read_b128 v[132:135], v3 offset:17408
    v_mfma_f32_16x16x32_bf16 v[80:83], v[212:215], v[144:147], v[80:83]
    s_add_u32 s31, s31, 4096
    buffer_load_dwordx4 v[208:211], v2, s[20:23], s31 offen offset:0 sc1
    v_mfma_f32_16x16x32_bf16 v[84:87], v[212:215], v[148:151], v[84:87]
    ds_read_b128 v[136:139], v3 offset:18432
    v_mfma_f32_16x16x32_bf16 v[88:91], v[212:215], v[152:155], v[88:91]
    v_mfma_f32_16x16x32_bf16 v[92:95], v[212:215], v[156:159], v[92:95]
    ds_read_b128 v[140:143], v3 offset:19456
    s_waitcnt vmcnt(18) lgkmcnt(4)
    v_mfma_f32_16x16x32_bf16 v[16:19], v[216:219], v[112:115], 0
    buffer_load_dwordx4 v[212:215], v2, s[20:23], s31 offen offset:1024 sc1
    ds_read_b128 v[144:147], v3 offset:20480
    v_mfma_f32_16x16x32_bf16 v[20:23], v[216:219], v[116:119], 0
    ds_read_b128 v[148:151], v3 offset:21504
    v_mfma_f32_16x16x32_bf16 v[24:27], v[216:219], v[120:123], 0
    ds_read_b128 v[152:155], v3 offset:22528
    v_mfma_f32_16x16x32_bf16 v[28:31], v[216:219], v[124:127], 0
    ds_read_b128 v[156:159], v3 offset:23552
    v_cvt_pk_bf16_f32 v160, v64, v65
    v_cvt_pk_bf16_f32 v161, v66, v67
    ds_write_b64 v8, v[160:161] offset:0
    s_waitcnt vmcnt(18) lgkmcnt(5)
    v_mfma_f32_16x16x32_bf16 v[16:19], v[220:223], v[128:131], v[16:19]
    buffer_load_dwordx4 v[216:219], v2, s[20:23], s31 offen offset:2048 sc1
    ds_read_b128 v[112:115], v3 offset:24576
    v_cvt_pk_bf16_f32 v162, v68, v69
    v_mfma_f32_16x16x32_bf16 v[20:23], v[220:223], v[132:135], v[20:23]
    ds_read_b128 v[116:119], v3 offset:25600
    v_cvt_pk_bf16_f32 v163, v70, v71
    ds_write_b64 v8, v[162:163] offset:2048
    v_cvt_pk_bf16_f32 v164, v72, v73
    v_mfma_f32_16x16x32_bf16 v[24:27], v[220:223], v[136:139], v[24:27]
    ds_read_b128 v[120:123], v3 offset:26624
    v_cvt_pk_bf16_f32 v165, v74, v75
    ds_write_b64 v8, v[164:165] offset:4096
    v_cvt_pk_bf16_f32 v166, v76, v77
    v_mfma_f32_16x16x32_bf16 v[28:31], v[220:223], v[140:143], v[28:31]
    ds_read_b128 v[124:127], v3 offset:27648
    v_cvt_pk_bf16_f32 v167, v78, v79
    ds_write_b64 v8, v[166:167] offset:6144
    s_mov_b64 exec, 1
    ds_add_u32 v11, v10 offset:16
    s_mov_b64 exec, -1
    s_waitcnt vmcnt(18) lgkmcnt(9)
    v_mfma_f32_16x16x32_bf16 v[16:19], v[224:227], v[144:147], v[16:19]
    buffer_load_dwordx4 v[220:223], v2, s[20:23], s31 offen offset:3072 sc1
    ds_read_b128 v[128:131], v3 offset:28672
    v_cvt_pk_bf16_f32 v168, v80, v81
    v_mfma_f32_16x16x32_bf16 v[20:23], v[224:227], v[148:151], v[20:23]
    ds_read_b128 v[132:135], v3 offset:29696
    v_cvt_pk_bf16_f32 v169, v82, v83
    ds_write_b64 v8, v[168:169] offset:8192
    v_cvt_pk_bf16_f32 v170, v84, v85
    v_mfma_f32_16x16x32_bf16 v[24:27], v[224:227], v[152:155], v[24:27]
    ds_read_b128 v[136:139], v3 offset:30720
    v_cvt_pk_bf16_f32 v171, v86, v87
    ds_write_b64 v8, v[170:171] offset:10240
    v_cvt_pk_bf16_f32 v172, v88, v89
    v_mfma_f32_16x16x32_bf16 v[28:31], v[224:227], v[156:159], v[28:31]
    ds_read_b128 v[140:143], v3 offset:31744
    v_cvt_pk_bf16_f32 v173, v90, v91
    ds_write_b64 v8, v[172:173] offset:12288
    v_cvt_pk_bf16_f32 v174, v92, v93
    s_waitcnt vmcnt(18) lgkmcnt(9)
    v_mfma_f32_16x16x32_bf16 v[16:19], v[228:231], v[112:115], v[16:19]
    s_add_u32 s31, s31, 4096
    buffer_load_dwordx4 v[224:227], v2, s[20:23], s31 offen offset:0 sc1
    ds_read_b128 v[144:147], v3 offset:32768
    v_cvt_pk_bf16_f32 v175, v94, v95
    v_mfma_f32_16x16x32_bf16 v[20:23], v[228:231], v[116:119], v[20:23]
    ds_read_b128 v[148:151], v3 offset:33792
    ds_write_b64 v8, v[174:175] offset:14336
    s_mov_b64 exec, 1
    ds_add_u32 v11, v10 offset:20
    s_mov_b64 exec, -1
    v_mfma_f32_16x16x32_bf16 v[24:27], v[228:231], v[120:123], v[24:27]
    ds_read_b128 v[152:155], v3 offset:34816
    v_mfma_f32_16x16x32_bf16 v[28:31], v[228:231], v[124:127], v[28:31]
    ds_read_b128 v[156:159], v3 offset:35840
    s_waitcnt vmcnt(18) lgkmcnt(7)
    v_mfma_f32_16x16x32_bf16 v[16:19], v[232:235], v[128:131], v[16:19]
    buffer_load_dwordx4 v[228:231], v2, s[20:23], s31 offen offset:1024 sc1
    ds_read_b128 v[112:115], v3 offset:36864
    v_mfma_f32_16x16x32_bf16 v[20:23], v[232:235], v[132:135], v[20:23]
    ds_read_b128 v[116:119], v3 offset:37888
    v_mfma_f32_16x16x32_bf16 v[24:27], v[232:235], v[136:139], v[24:27]
    ds_read_b128 v[120:123], v3 offset:38912
    v_mfma_f32_16x16x32_bf16 v[28:31], v[232:235], v[140:143], v[28:31]
    ds_read_b128 v[124:127], v3 offset:39936
    s_waitcnt vmcnt(18) lgkmcnt(4)
    v_mfma_f32_16x16x32_bf16 v[16:19], v[236:239], v[144:147], v[16:19]
    buffer_load_dwordx4 v[232:235], v2, s[20:23], s31 offen offset:2048 sc1
    ds_read_b128 v[128:131], v3 offset:40960
    v_mfma_f32_16x16x32_bf16 v[20:23], v[236:239], v[148:151], v[20:23]
    ds_read_b128 v[132:135], v3 offset:41984
    v_mfma_f32_16x16x32_bf16 v[24:27], v[236:239], v[152:155], v[24:27]
    ds_read_b128 v[136:139], v3 offset:43008
    v_mfma_f32_16x16x32_bf16 v[28:31], v[236:239], v[156:159], v[28:31]
    ds_read_b128 v[140:143], v3 offset:44032
    s_waitcnt vmcnt(18) lgkmcnt(4)
    v_mfma_f32_16x16x32_bf16 v[16:19], v[240:243], v[112:115], v[16:19]
    buffer_load_dwordx4 v[236:239], v2, s[20:23], s31 offen offset:3072 sc1
    ds_read_b128 v[144:147], v3 offset:45056
    v_mfma_f32_16x16x32_bf16 v[20:23], v[240:243], v[116:119], v[20:23]
    ds_read_b128 v[148:151], v3 offset:46080
    v_mfma_f32_16x16x32_bf16 v[24:27], v[240:243], v[120:123], v[24:27]
    ds_read_b128 v[152:155], v3 offset:47104
    v_mfma_f32_16x16x32_bf16 v[28:31], v[240:243], v[124:127], v[28:31]
    ds_read_b128 v[156:159], v3 offset:48128
    s_waitcnt vmcnt(18) lgkmcnt(4)
    v_mfma_f32_16x16x32_bf16 v[16:19], v[244:247], v[128:131], v[16:19]
    s_add_u32 s31, s31, 4096
    buffer_load_dwordx4 v[240:243], v2, s[20:23], s31 offen offset:0 sc1
    ds_read_b128 v[112:115], v3 offset:49152
    v_mfma_f32_16x16x32_bf16 v[20:23], v[244:247], v[132:135], v[20:23]
    ds_read_b128 v[116:119], v3 offset:50176
    v_mfma_f32_16x16x32_bf16 v[24:27], v[244:247], v[136:139], v[24:27]
    ds_read_b128 v[120:123], v3 offset:51200
    v_mfma_f32_16x16x32_bf16 v[28:31], v[244:247], v[140:143], v[28:31]
    ds_read_b128 v[124:127], v3 offset:52224
    s_waitcnt vmcnt(18) lgkmcnt(4)
    v_mfma_f32_16x16x32_bf16 v[16:19], v[248:251], v[144:147], v[16:19]
    buffer_load_dwordx4 v[244:247], v2, s[20:23], s31 offen offset:1024 sc1
    ds_read_b128 v[128:131], v3 offset:53248
    v_mfma_f32_16x16x32_bf16 v[20:23], v[248:251], v[148:151], v[20:23]
    ds_read_b128 v[132:135], v3 offset:54272
    v_mfma_f32_16x16x32_bf16 v[24:27], v[248:251], v[152:155], v[24:27]
    ds_read_b128 v[136:139], v3 offset:55296
    v_mfma_f32_16x16x32_bf16 v[28:31], v[248:251], v[156:159], v[28:31]
    ds_read_b128 v[140:143], v3 offset:56320
    s_waitcnt vmcnt(18) lgkmcnt(4)
    v_mfma_f32_16x16x32_bf16 v[16:19], v[252:255], v[112:115], v[16:19]
    buffer_load_dwordx4 v[248:251], v2, s[20:23], s31 offen offset:2048 sc1
    ds_read_b128 v[144:147], v3 offset:57344
    v_mfma_f32_16x16x32_bf16 v[20:23], v[252:255], v[116:119], v[20:23]
    ds_read_b128 v[148:151], v3 offset:58368
    v_mfma_f32_16x16x32_bf16 v[24:27], v[252:255], v[120:123], v[24:27]
    ds_read_b128 v[152:155], v3 offset:59392
    v_mfma_f32_16x16x32_bf16 v[28:31], v[252:255], v[124:127], v[28:31]
    ds_read_b128 v[156:159], v3 offset:60416
    s_waitcnt vmcnt(18) lgkmcnt(4)
    v_mfma_f32_16x16x32_bf16 v[16:19], v[176:179], v[128:131], v[16:19]
    buffer_load_dwordx4 v[252:255], v2, s[20:23], s31 offen offset:3072 sc1
    ds_read_b128 v[112:115], v3 offset:61440
    v_mfma_f32_16x16x32_bf16 v[20:23], v[176:179], v[132:135], v[20:23]
    ds_read_b128 v[116:119], v3 offset:62464
    v_mfma_f32_16x16x32_bf16 v[24:27], v[176:179], v[136:139], v[24:27]
    ds_read_b128 v[120:123], v3 offset:63488
    v_mfma_f32_16x16x32_bf16 v[28:31], v[176:179], v[140:143], v[28:31]
    ds_read_b128 v[124:127], v3 offset:64512
    s_waitcnt vmcnt(18) lgkmcnt(4)
    v_mfma_f32_16x16x32_bf16 v[16:19], v[180:183], v[144:147], v[16:19]
    s_add_u32 s31, s31, 4096
    buffer_load_dwordx4 v[176:179], v2, s[20:23], s31 offen offset:0 sc1
    ds_read_b128 v[128:131], v4 offset:0
    v_mfma_f32_16x16x32_bf16 v[20:23], v[180:183], v[148:151], v[20:23]
    ds_read_b128 v[132:135], v4 offset:1024
    v_mfma_f32_16x16x32_bf16 v[24:27], v[180:183], v[152:155], v[24:27]
    ds_read_b128 v[136:139], v4 offset:2048
    v_mfma_f32_16x16x32_bf16 v[28:31], v[180:183], v[156:159], v[28:31]
    ds_read_b128 v[140:143], v4 offset:3072
    s_waitcnt vmcnt(18) lgkmcnt(4)
    v_mfma_f32_16x16x32_bf16 v[16:19], v[184:187], v[112:115], v[16:19]
    buffer_load_dwordx4 v[180:183], v2, s[20:23], s31 offen offset:1024 sc1
    ds_read_b128 v[144:147], v4 offset:4096
    v_mfma_f32_16x16x32_bf16 v[20:23], v[184:187], v[116:119], v[20:23]
    ds_read_b128 v[148:151], v4 offset:5120
    v_mfma_f32_16x16x32_bf16 v[24:27], v[184:187], v[120:123], v[24:27]
    ds_read_b128 v[152:155], v4 offset:6144
    v_mfma_f32_16x16x32_bf16 v[28:31], v[184:187], v[124:127], v[28:31]
    ds_read_b128 v[156:159], v4 offset:7168
    s_waitcnt vmcnt(18) lgkmcnt(4)
    v_mfma_f32_16x16x32_bf16 v[16:19], v[188:191], v[128:131], v[16:19]
    buffer_load_dwordx4 v[184:187], v2, s[20:23], s31 offen offset:2048 sc1
    ds_read_b128 v[112:115], v4 offset:8192
    v_mfma_f32_16x16x32_bf16 v[20:23], v[188:191], v[132:135], v[20:23]
    ds_read_b128 v[116:119], v4 offset:9216
    v_mfma_f32_16x16x32_bf16 v[24:27], v[188:191], v[136:139], v[24:27]
    ds_read_b128 v[120:123], v4 offset:10240
    v_mfma_f32_16x16x32_bf16 v[28:31], v[188:191], v[140:143], v[28:31]
    ds_read_b128 v[124:127], v4 offset:11264
    s_waitcnt vmcnt(18) lgkmcnt(4)
    v_mfma_f32_16x16x32_bf16 v[16:19], v[192:195], v[144:147], v[16:19]
    buffer_load_dwordx4 v[188:191], v2, s[20:23], s31 offen offset:3072 sc1
    ds_read_b128 v[128:131], v4 offset:12288
    v_mfma_f32_16x16x32_bf16 v[20:23], v[192:195], v[148:151], v[20:23]
    ds_read_b128 v[132:135], v4 offset:13312
    v_mfma_f32_16x16x32_bf16 v[24:27], v[192:195], v[152:155], v[24:27]
    ds_read_b128 v[136:139], v4 offset:14336
    v_mfma_f32_16x16x32_bf16 v[28:31], v[192:195], v[156:159], v[28:31]
    ds_read_b128 v[140:143], v4 offset:15360
    s_waitcnt vmcnt(18) lgkmcnt(4)
    v_mfma_f32_16x16x32_bf16 v[16:19], v[196:199], v[112:115], v[16:19]
    s_add_u32 s31, s31, 4096
    buffer_load_dwordx4 v[192:195], v2, s[20:23], s31 offen offset:0 sc1
    ds_read_b128 v[144:147], v4 offset:16384
    v_mfma_f32_16x16x32_bf16 v[20:23], v[196:199], v[116:119], v[20:23]
    ds_read_b128 v[148:151], v4 offset:17408
    v_mfma_f32_16x16x32_bf16 v[24:27], v[196:199], v[120:123], v[24:27]
    ds_read_b128 v[152:155], v4 offset:18432
    v_mfma_f32_16x16x32_bf16 v[28:31], v[196:199], v[124:127], v[28:31]
    ds_read_b128 v[156:159], v4 offset:19456
    s_waitcnt vmcnt(18) lgkmcnt(4)
    v_mfma_f32_16x16x32_bf16 v[16:19], v[200:203], v[128:131], v[16:19]
    buffer_load_dwordx4 v[196:199], v2, s[20:23], s31 offen offset:1024 sc1
    ds_read_b128 v[112:115], v3 offset:12288
    v_mfma_f32_16x16x32_bf16 v[20:23], v[200:203], v[132:135], v[20:23]
    ds_read_b128 v[116:119], v3 offset:13312
    v_mfma_f32_16x16x32_bf16 v[24:27], v[200:203], v[136:139], v[24:27]
    ds_read_b128 v[120:123], v3 offset:14336
    v_mfma_f32_16x16x32_bf16 v[28:31], v[200:203], v[140:143], v[28:31]
    ds_read_b128 v[124:127], v3 offset:15360
    s_waitcnt vmcnt(18) lgkmcnt(4)
    v_mfma_f32_16x16x32_bf16 v[16:19], v[204:207], v[144:147], v[16:19]
    buffer_load_dwordx4 v[200:203], v2, s[20:23], s31 offen offset:2048 sc1
    ds_read_b128 v[128:131], v3 offset:16384
    v_mfma_f32_16x16x32_bf16 v[20:23], v[204:207], v[148:151], v[20:23]
    ds_read_b128 v[132:135], v3 offset:17408
    v_mfma_f32_16x16x32_bf16 v[24:27], v[204:207], v[152:155], v[24:27]
    ds_read_b128 v[136:139], v3 offset:18432
    v_mfma_f32_16x16x32_bf16 v[28:31], v[204:207], v[156:159], v[28:31]
    ds_read_b128 v[140:143], v3 offset:19456
    s_waitcnt vmcnt(18) lgkmcnt(4)
    v_mfma_f32_16x16x32_bf16 v[64:67], v[208:211], v[112:115], 0
    buffer_load_dwordx4 v[204:207], v2, s[20:23], s31 offen offset:3072 sc1
    ds_read_b128 v[144:147], v3 offset:20480
    v_mfma_f32_16x16x32_bf16 v[68:71], v[208:211], v[116:119], 0
    ds_read_b128 v[148:151], v3 offset:21504
    v_mfma_f32_16x16x32_bf16 v[72:75], v[208:211], v[120:123], 0
    ds_read_b128 v[152:155], v3 offset:22528
    v_mfma_f32_16x16x32_bf16 v[76:79], v[208:211], v[124:127], 0
    ds_read_b128 v[156:159], v3 offset:23552
    v_cvt_pk_bf16_f32 v160, v16, v17
    v_cvt_pk_bf16_f32 v161, v18, v19
    ds_write_b64 v8, v[160:161] offset:16384
    s_waitcnt vmcnt(18) lgkmcnt(5)
    v_mfma_f32_16x16x32_bf16 v[64:67], v[212:215], v[128:131], v[64:67]
    s_add_u32 s31, s31, 4096
    buffer_load_dwordx4 v[208:211], v2, s[20:23], s31 offen offset:0 sc1
    ds_read_b128 v[112:115], v3 offset:24576
    v_cvt_pk_bf16_f32 v162, v20, v21
    v_mfma_f32_16x16x32_bf16 v[68:71], v[212:215], v[132:135], v[68:71]
    ds_read_b128 v[116:119], v3 offset:25600
    v_cvt_pk_bf16_f32 v163, v22, v23
    ds_write_b64 v8, v[162:163] offset:18432
    v_cvt_pk_bf16_f32 v164, v24, v25
    v_mfma_f32_16x16x32_bf16 v[72:75], v[212:215], v[136:139], v[72:75]
    ds_read_b128 v[120:123], v3 offset:26624
    v_cvt_pk_bf16_f32 v165, v26, v27
    ds_write_b64 v8, v[164:165] offset:20480
    v_cvt_pk_bf16_f32 v166, v28, v29
    v_mfma_f32_16x16x32_bf16 v[76:79], v[212:215], v[140:143], v[76:79]
    ds_read_b128 v[124:127], v3 offset:27648
    v_cvt_pk_bf16_f32 v167, v30, v31
    ds_write_b64 v8, v[166:167] offset:22528
    s_mov_b64 exec, 1
    ds_add_u32 v11, v10 offset:24
    s_mov_b64 exec, -1
    s_waitcnt vmcnt(18) lgkmcnt(9)
    v_mfma_f32_16x16x32_bf16 v[64:67], v[216:219], v[144:147], v[64:67]
    buffer_load_dwordx4 v[212:215], v2, s[20:23], s31 offen offset:1024 sc1
    ds_read_b128 v[128:131], v3 offset:28672
    v_mfma_f32_16x16x32_bf16 v[68:71], v[216:219], v[148:151], v[68:71]
    ds_read_b128 v[132:135], v3 offset:29696
    v_mfma_f32_16x16x32_bf16 v[72:75], v[216:219], v[152:155], v[72:75]
    ds_read_b128 v[136:139], v3 offset:30720
    v_mfma_f32_16x16x32_bf16 v[76:79], v[216:219], v[156:159], v[76:79]
    ds_read_b128 v[140:143], v3 offset:31744
    s_waitcnt vmcnt(18) lgkmcnt(6)
    v_mfma_f32_16x16x32_bf16 v[64:67], v[220:223], v[112:115], v[64:67]
    buffer_load_dwordx4 v[216:219], v2, s[20:23], s31 offen offset:2048 sc1
    ds_read_b128 v[144:147], v3 offset:32768
    v_mfma_f32_16x16x32_bf16 v[68:71], v[220:223], v[116:119], v[68:71]
    ds_read_b128 v[148:151], v3 offset:33792
    v_mfma_f32_16x16x32_bf16 v[72:75], v[220:223], v[120:123], v[72:75]
    ds_read_b128 v[152:155], v3 offset:34816
    v_mfma_f32_16x16x32_bf16 v[76:79], v[220:223], v[124:127], v[76:79]
    ds_read_b128 v[156:159], v3 offset:35840
    s_waitcnt vmcnt(18) lgkmcnt(4)
    v_mfma_f32_16x16x32_bf16 v[64:67], v[224:227], v[128:131], v[64:67]
    buffer_load_dwordx4 v[220:223], v2, s[20:23], s31 offen offset:3072 sc1
    ds_read_b128 v[112:115], v3 offset:36864
    v_mfma_f32_16x16x32_bf16 v[68:71], v[224:227], v[132:135], v[68:71]
    ds_read_b128 v[116:119], v3 offset:37888
    v_mfma_f32_16x16x32_bf16 v[72:75], v[224:227], v[136:139], v[72:75]
    ds_read_b128 v[120:123], v3 offset:38912
    v_mfma_f32_16x16x32_bf16 v[76:79], v[224:227], v[140:143], v[76:79]
    ds_read_b128 v[124:127], v3 offset:39936
    s_waitcnt vmcnt(18) lgkmcnt(4)
    v_mfma_f32_16x16x32_bf16 v[64:67], v[228:231], v[144:147], v[64:67]
    s_add_u32 s31, s31, 4096
    buffer_load_dwordx4 v[224:227], v2, s[20:23], s31 offen offset:0 sc1
    ds_read_b128 v[128:131], v3 offset:40960
    v_mfma_f32_16x16x32_bf16 v[68:71], v[228:231], v[148:151], v[68:71]
    ds_read_b128 v[132:135], v3 offset:41984
    v_mfma_f32_16x16x32_bf16 v[72:75], v[228:231], v[152:155], v[72:75]
    ds_read_b128 v[136:139], v3 offset:43008
    v_mfma_f32_16x16x32_bf16 v[76:79], v[228:231], v[156:159], v[76:79]
    ds_read_b128 v[140:143], v3 offset:44032
    s_waitcnt vmcnt(18) lgkmcnt(4)
    v_mfma_f32_16x16x32_bf16 v[64:67], v[232:235], v[112:115], v[64:67]
    buffer_load_dwordx4 v[228:231], v2, s[20:23], s31 offen offset:1024 sc1
    ds_read_b128 v[144:147], v3 offset:45056
    v_mfma_f32_16x16x32_bf16 v[68:71], v[232:235], v[116:119], v[68:71]
    ds_read_b128 v[148:151], v3 offset:46080
    v_mfma_f32_16x16x32_bf16 v[72:75], v[232:235], v[120:123], v[72:75]
    ds_read_b128 v[152:155], v3 offset:47104
    v_mfma_f32_16x16x32_bf16 v[76:79], v[232:235], v[124:127], v[76:79]
    ds_read_b128 v[156:159], v3 offset:48128
    s_waitcnt vmcnt(18) lgkmcnt(4)
    v_mfma_f32_16x16x32_bf16 v[64:67], v[236:239], v[128:131], v[64:67]
    buffer_load_dwordx4 v[232:235], v2, s[20:23], s31 offen offset:2048 sc1
    ds_read_b128 v[112:115], v3 offset:49152
    v_mfma_f32_16x16x32_bf16 v[68:71], v[236:239], v[132:135], v[68:71]
    ds_read_b128 v[116:119], v3 offset:50176
    v_mfma_f32_16x16x32_bf16 v[72:75], v[236:239], v[136:139], v[72:75]
    ds_read_b128 v[120:123], v3 offset:51200
    v_mfma_f32_16x16x32_bf16 v[76:79], v[236:239], v[140:143], v[76:79]
    ds_read_b128 v[124:127], v3 offset:52224
    s_waitcnt vmcnt(18) lgkmcnt(4)
    v_mfma_f32_16x16x32_bf16 v[64:67], v[240:243], v[144:147], v[64:67]
    buffer_load_dwordx4 v[236:239], v2, s[20:23], s31 offen offset:3072 sc1
    ds_read_b128 v[128:131], v3 offset:53248
    v_mfma_f32_16x16x32_bf16 v[68:71], v[240:243], v[148:151], v[68:71]
    ds_read_b128 v[132:135], v3 offset:54272
    v_mfma_f32_16x16x32_bf16 v[72:75], v[240:243], v[152:155], v[72:75]
    ds_read_b128 v[136:139], v3 offset:55296
    v_mfma_f32_16x16x32_bf16 v[76:79], v[240:243], v[156:159], v[76:79]
    ds_read_b128 v[140:143], v3 offset:56320
    s_waitcnt vmcnt(18) lgkmcnt(4)
    v_mfma_f32_16x16x32_bf16 v[64:67], v[244:247], v[112:115], v[64:67]
    s_add_u32 s31, s31, 4096
    buffer_load_dwordx4 v[240:243], v2, s[20:23], s31 offen offset:0 sc1
    ds_read_b128 v[144:147], v3 offset:57344
    v_mfma_f32_16x16x32_bf16 v[68:71], v[244:247], v[116:119], v[68:71]
    ds_read_b128 v[148:151], v3 offset:58368
    v_mfma_f32_16x16x32_bf16 v[72:75], v[244:247], v[120:123], v[72:75]
    ds_read_b128 v[152:155], v3 offset:59392
    v_mfma_f32_16x16x32_bf16 v[76:79], v[244:247], v[124:127], v[76:79]
    ds_read_b128 v[156:159], v3 offset:60416
    s_waitcnt vmcnt(18) lgkmcnt(4)
    v_mfma_f32_16x16x32_bf16 v[64:67], v[248:251], v[128:131], v[64:67]
    buffer_load_dwordx4 v[244:247], v2, s[20:23], s31 offen offset:1024 sc1
    ds_read_b128 v[112:115], v3 offset:61440
    v_mfma_f32_16x16x32_bf16 v[68:71], v[248:251], v[132:135], v[68:71]
    ds_read_b128 v[116:119], v3 offset:62464
    v_mfma_f32_16x16x32_bf16 v[72:75], v[248:251], v[136:139], v[72:75]
    ds_read_b128 v[120:123], v3 offset:63488
    v_mfma_f32_16x16x32_bf16 v[76:79], v[248:251], v[140:143], v[76:79]
    ds_read_b128 v[124:127], v3 offset:64512
    s_waitcnt vmcnt(18) lgkmcnt(4)
    v_mfma_f32_16x16x32_bf16 v[64:67], v[252:255], v[144:147], v[64:67]
    buffer_load_dwordx4 v[248:251], v2, s[20:23], s31 offen offset:2048 sc1
    ds_read_b128 v[128:131], v4 offset:0
    v_mfma_f32_16x16x32_bf16 v[68:71], v[252:255], v[148:151], v[68:71]
    ds_read_b128 v[132:135], v4 offset:1024
    v_mfma_f32_16x16x32_bf16 v[72:75], v[252:255], v[152:155], v[72:75]
    ds_read_b128 v[136:139], v4 offset:2048
    v_mfma_f32_16x16x32_bf16 v[76:79], v[252:255], v[156:159], v[76:79]
    ds_read_b128 v[140:143], v4 offset:3072
    s_waitcnt vmcnt(18) lgkmcnt(4)
    v_mfma_f32_16x16x32_bf16 v[64:67], v[176:179], v[112:115], v[64:67]
    buffer_load_dwordx4 v[252:255], v2, s[20:23], s31 offen offset:3072 sc1
    ds_read_b128 v[144:147], v4 offset:4096
    v_mfma_f32_16x16x32_bf16 v[68:71], v[176:179], v[116:119], v[68:71]
    ds_read_b128 v[148:151], v4 offset:5120
    v_mfma_f32_16x16x32_bf16 v[72:75], v[176:179], v[120:123], v[72:75]
    ds_read_b128 v[152:155], v4 offset:6144
    v_mfma_f32_16x16x32_bf16 v[76:79], v[176:179], v[124:127], v[76:79]
    ds_read_b128 v[156:159], v4 offset:7168
    s_waitcnt vmcnt(18) lgkmcnt(4)
    v_mfma_f32_16x16x32_bf16 v[64:67], v[180:183], v[128:131], v[64:67]
    s_add_u32 s31, s31, 4096
    buffer_load_dwordx4 v[176:179], v2, s[20:23], s31 offen offset:0 sc1
    ds_read_b128 v[112:115], v4 offset:8192
    v_mfma_f32_16x16x32_bf16 v[68:71], v[180:183], v[132:135], v[68:71]
    ds_read_b128 v[116:119], v4 offset:9216
    v_mfma_f32_16x16x32_bf16 v[72:75], v[180:183], v[136:139], v[72:75]
    ds_read_b128 v[120:123], v4 offset:10240
    v_mfma_f32_16x16x32_bf16 v[76:79], v[180:183], v[140:143], v[76:79]
    ds_read_b128 v[124:127], v4 offset:11264
    s_waitcnt vmcnt(18) lgkmcnt(4)
    v_mfma_f32_16x16x32_bf16 v[64:67], v[184:187], v[144:147], v[64:67]
    buffer_load_dwordx4 v[180:183], v2, s[20:23], s31 offen offset:1024 sc1
    ds_read_b128 v[128:131], v4 offset:12288
    v_mfma_f32_16x16x32_bf16 v[68:71], v[184:187], v[148:151], v[68:71]
    ds_read_b128 v[132:135], v4 offset:13312
    v_mfma_f32_16x16x32_bf16 v[72:75], v[184:187], v[152:155], v[72:75]
    ds_read_b128 v[136:139], v4 offset:14336
    v_mfma_f32_16x16x32_bf16 v[76:79], v[184:187], v[156:159], v[76:79]
    ds_read_b128 v[140:143], v4 offset:15360
    s_waitcnt vmcnt(18) lgkmcnt(4)
    v_mfma_f32_16x16x32_bf16 v[64:67], v[188:191], v[112:115], v[64:67]
    buffer_load_dwordx4 v[184:187], v2, s[20:23], s31 offen offset:2048 sc1
    ds_read_b128 v[144:147], v4 offset:16384
    v_mfma_f32_16x16x32_bf16 v[68:71], v[188:191], v[116:119], v[68:71]
    ds_read_b128 v[148:151], v4 offset:17408
    v_mfma_f32_16x16x32_bf16 v[72:75], v[188:191], v[120:123], v[72:75]
    ds_read_b128 v[152:155], v4 offset:18432
    v_mfma_f32_16x16x32_bf16 v[76:79], v[188:191], v[124:127], v[76:79]
    ds_read_b128 v[156:159], v4 offset:19456
    s_waitcnt vmcnt(18) lgkmcnt(4)
    v_mfma_f32_16x16x32_bf16 v[64:67], v[192:195], v[128:131], v[64:67]
    buffer_load_dwordx4 v[188:191], v2, s[20:23], s31 offen offset:3072 sc1
    ds_read_b128 v[112:115], v3 offset:12288
    v_mfma_f32_16x16x32_bf16 v[68:71], v[192:195], v[132:135], v[68:71]
    ds_read_b128 v[116:119], v3 offset:13312
    v_mfma_f32_16x16x32_bf16 v[72:75], v[192:195], v[136:139], v[72:75]
    ds_read_b128 v[120:123], v3 offset:14336
    v_mfma_f32_16x16x32_bf16 v[76:79], v[192:195], v[140:143], v[76:79]
    ds_read_b128 v[124:127], v3 offset:15360
    s_waitcnt vmcnt(18) lgkmcnt(4)
    v_mfma_f32_16x16x32_bf16 v[64:67], v[196:199], v[144:147], v[64:67]
    ds_read_b128 v[128:131], v3 offset:16384
    v_mfma_f32_16x16x32_bf16 v[68:71], v[196:199], v[148:151], v[68:71]
    ds_read_b128 v[132:135], v3 offset:17408
    v_mfma_f32_16x16x32_bf16 v[72:75], v[196:199], v[152:155], v[72:75]
    ds_read_b128 v[136:139], v3 offset:18432
    v_mfma_f32_16x16x32_bf16 v[76:79], v[196:199], v[156:159], v[76:79]
    ds_read_b128 v[140:143], v3 offset:19456
    s_waitcnt vmcnt(17) lgkmcnt(4)
    v_mfma_f32_16x16x32_bf16 v[16:19], v[200:203], v[112:115], 0
    ds_read_b128 v[144:147], v3 offset:20480
    v_mfma_f32_16x16x32_bf16 v[20:23], v[200:203], v[116:119], 0
    ds_read_b128 v[148:151], v3 offset:21504
    v_mfma_f32_16x16x32_bf16 v[24:27], v[200:203], v[120:123], 0
    ds_read_b128 v[152:155], v3 offset:22528
    v_mfma_f32_16x16x32_bf16 v[28:31], v[200:203], v[124:127], 0
    ds_read_b128 v[156:159], v3 offset:23552
    v_cvt_pk_bf16_f32 v160, v64, v65
    v_cvt_pk_bf16_f32 v161, v66, v67
    ds_write_b64 v8, v[160:161] offset:24576
    s_waitcnt vmcnt(16) lgkmcnt(5)
    v_mfma_f32_16x16x32_bf16 v[16:19], v[204:207], v[128:131], v[16:19]
    ds_read_b128 v[112:115], v3 offset:24576
    v_cvt_pk_bf16_f32 v162, v68, v69
    v_cvt_pk_bf16_f32 v163, v70, v71
    v_mfma_f32_16x16x32_bf16 v[20:23], v[204:207], v[132:135], v[20:23]
    ds_read_b128 v[116:119], v3 offset:25600
    ds_write_b64 v8, v[162:163] offset:26624
    v_cvt_pk_bf16_f32 v164, v72, v73
    v_cvt_pk_bf16_f32 v165, v74, v75
    v_mfma_f32_16x16x32_bf16 v[24:27], v[204:207], v[136:139], v[24:27]
    ds_read_b128 v[120:123], v3 offset:26624
    ds_write_b64 v8, v[164:165] offset:28672
    v_cvt_pk_bf16_f32 v166, v76, v77
    v_cvt_pk_bf16_f32 v167, v78, v79
    v_mfma_f32_16x16x32_bf16 v[28:31], v[204:207], v[140:143], v[28:31]
    ds_read_b128 v[124:127], v3 offset:27648
    ds_write_b64 v8, v[166:167] offset:30720
    s_mov_b64 exec, 1
    ds_add_u32 v11, v10 offset:28
    s_mov_b64 exec, -1
    s_waitcnt vmcnt(15) lgkmcnt(9)
    v_mfma_f32_16x16x32_bf16 v[16:19], v[208:211], v[144:147], v[16:19]
    ds_read_b128 v[128:131], v3 offset:28672
    v_mfma_f32_16x16x32_bf16 v[20:23], v[208:211], v[148:151], v[20:23]
    ds_read_b128 v[132:135], v3 offset:29696
    v_mfma_f32_16x16x32_bf16 v[24:27], v[208:211], v[152:155], v[24:27]
    ds_read_b128 v[136:139], v3 offset:30720
    v_mfma_f32_16x16x32_bf16 v[28:31], v[208:211], v[156:159], v[28:31]
    ds_read_b128 v[140:143], v3 offset:31744
    s_waitcnt vmcnt(14) lgkmcnt(6)
    v_mfma_f32_16x16x32_bf16 v[16:19], v[212:215], v[112:115], v[16:19]
    ds_read_b128 v[144:147], v3 offset:32768
    v_mfma_f32_16x16x32_bf16 v[20:23], v[212:215], v[116:119], v[20:23]
    ds_read_b128 v[148:151], v3 offset:33792
    v_mfma_f32_16x16x32_bf16 v[24:27], v[212:215], v[120:123], v[24:27]
    ds_read_b128 v[152:155], v3 offset:34816
    v_mfma_f32_16x16x32_bf16 v[28:31], v[212:215], v[124:127], v[28:31]
    ds_read_b128 v[156:159], v3 offset:35840
    s_waitcnt vmcnt(13) lgkmcnt(4)
    v_mfma_f32_16x16x32_bf16 v[16:19], v[216:219], v[128:131], v[16:19]
    ds_read_b128 v[112:115], v3 offset:36864
    v_mfma_f32_16x16x32_bf16 v[20:23], v[216:219], v[132:135], v[20:23]
    ds_read_b128 v[116:119], v3 offset:37888
    v_mfma_f32_16x16x32_bf16 v[24:27], v[216:219], v[136:139], v[24:27]
    ds_read_b128 v[120:123], v3 offset:38912
    v_mfma_f32_16x16x32_bf16 v[28:31], v[216:219], v[140:143], v[28:31]
    ds_read_b128 v[124:127], v3 offset:39936
    s_waitcnt vmcnt(12) lgkmcnt(4)
    v_mfma_f32_16x16x32_bf16 v[16:19], v[220:223], v[144:147], v[16:19]
    ds_read_b128 v[128:131], v3 offset:40960
    v_mfma_f32_16x16x32_bf16 v[20:23], v[220:223], v[148:151], v[20:23]
    ds_read_b128 v[132:135], v3 offset:41984
    v_mfma_f32_16x16x32_bf16 v[24:27], v[220:223], v[152:155], v[24:27]
    ds_read_b128 v[136:139], v3 offset:43008
    v_mfma_f32_16x16x32_bf16 v[28:31], v[220:223], v[156:159], v[28:31]
    ds_read_b128 v[140:143], v3 offset:44032
    s_waitcnt vmcnt(11) lgkmcnt(4)
    v_mfma_f32_16x16x32_bf16 v[16:19], v[224:227], v[112:115], v[16:19]
    ds_read_b128 v[144:147], v3 offset:45056
    v_mfma_f32_16x16x32_bf16 v[20:23], v[224:227], v[116:119], v[20:23]
    ds_read_b128 v[148:151], v3 offset:46080
    v_mfma_f32_16x16x32_bf16 v[24:27], v[224:227], v[120:123], v[24:27]
    ds_read_b128 v[152:155], v3 offset:47104
    v_mfma_f32_16x16x32_bf16 v[28:31], v[224:227], v[124:127], v[28:31]
    ds_read_b128 v[156:159], v3 offset:48128
    s_waitcnt vmcnt(10) lgkmcnt(4)
    v_mfma_f32_16x16x32_bf16 v[16:19], v[228:231], v[128:131], v[16:19]
    ds_read_b128 v[112:115], v3 offset:49152
    v_mfma_f32_16x16x32_bf16 v[20:23], v[228:231], v[132:135], v[20:23]
    ds_read_b128 v[116:119], v3 offset:50176
    v_mfma_f32_16x16x32_bf16 v[24:27], v[228:231], v[136:139], v[24:27]
    ds_read_b128 v[120:123], v3 offset:51200
    v_mfma_f32_16x16x32_bf16 v[28:31], v[228:231], v[140:143], v[28:31]
    ds_read_b128 v[124:127], v3 offset:52224
    s_waitcnt vmcnt(9) lgkmcnt(4)
    v_mfma_f32_16x16x32_bf16 v[16:19], v[232:235], v[144:147], v[16:19]
    ds_read_b128 v[128:131], v3 offset:53248
    v_mfma_f32_16x16x32_bf16 v[20:23], v[232:235], v[148:151], v[20:23]
    ds_read_b128 v[132:135], v3 offset:54272
    v_mfma_f32_16x16x32_bf16 v[24:27], v[232:235], v[152:155], v[24:27]
    ds_read_b128 v[136:139], v3 offset:55296
    v_mfma_f32_16x16x32_bf16 v[28:31], v[232:235], v[156:159], v[28:31]
    ds_read_b128 v[140:143], v3 offset:56320
    s_waitcnt vmcnt(8) lgkmcnt(4)
    v_mfma_f32_16x16x32_bf16 v[16:19], v[236:239], v[112:115], v[16:19]
    ds_read_b128 v[144:147], v3 offset:57344
    v_mfma_f32_16x16x32_bf16 v[20:23], v[236:239], v[116:119], v[20:23]
    ds_read_b128 v[148:151], v3 offset:58368
    v_mfma_f32_16x16x32_bf16 v[24:27], v[236:239], v[120:123], v[24:27]
    ds_read_b128 v[152:155], v3 offset:59392
    v_mfma_f32_16x16x32_bf16 v[28:31], v[236:239], v[124:127], v[28:31]
    ds_read_b128 v[156:159], v3 offset:60416
    s_waitcnt vmcnt(7) lgkmcnt(4)
    v_mfma_f32_16x16x32_bf16 v[16:19], v[240:243], v[128:131], v[16:19]
    ds_read_b128 v[112:115], v3 offset:61440
    v_mfma_f32_16x16x32_bf16 v[20:23], v[240:243], v[132:135], v[20:23]
    ds_read_b128 v[116:119], v3 offset:62464
    v_mfma_f32_16x16x32_bf16 v[24:27], v[240:243], v[136:139], v[24:27]
    ds_read_b128 v[120:123], v3 offset:63488
    v_mfma_f32_16x16x32_bf16 v[28:31], v[240:243], v[140:143], v[28:31]
    ds_read_b128 v[124:127], v3 offset:64512
    s_waitcnt vmcnt(6) lgkmcnt(4)
    v_mfma_f32_16x16x32_bf16 v[16:19], v[244:247], v[144:147], v[16:19]
    ds_read_b128 v[128:131], v4 offset:0
    v_mfma_f32_16x16x32_bf16 v[20:23], v[244:247], v[148:151], v[20:23]
    ds_read_b128 v[132:135], v4 offset:1024
    v_mfma_f32_16x16x32_bf16 v[24:27], v[244:247], v[152:155], v[24:27]
    ds_read_b128 v[136:139], v4 offset:2048
    v_mfma_f32_16x16x32_bf16 v[28:31], v[244:247], v[156:159], v[28:31]
    ds_read_b128 v[140:143], v4 offset:3072
    s_waitcnt vmcnt(5) lgkmcnt(4)
    v_mfma_f32_16x16x32_bf16 v[16:19], v[248:251], v[112:115], v[16:19]
    ds_read_b128 v[144:147], v4 offset:4096
    v_mfma_f32_16x16x32_bf16 v[20:23], v[248:251], v[116:119], v[20:23]
    ds_read_b128 v[148:151], v4 offset:5120
    v_mfma_f32_16x16x32_bf16 v[24:27], v[248:251], v[120:123], v[24:27]
    ds_read_b128 v[152:155], v4 offset:6144
    v_mfma_f32_16x16x32_bf16 v[28:31], v[248:251], v[124:127], v[28:31]
    ds_read_b128 v[156:159], v4 offset:7168
    s_waitcnt vmcnt(4) lgkmcnt(4)
    v_mfma_f32_16x16x32_bf16 v[16:19], v[252:255], v[128:131], v[16:19]
    ds_read_b128 v[112:115], v4 offset:8192
    v_mfma_f32_16x16x32_bf16 v[20:23], v[252:255], v[132:135], v[20:23]
    ds_read_b128 v[116:119], v4 offset:9216
    v_mfma_f32_16x16x32_bf16 v[24:27], v[252:255], v[136:139], v[24:27]
    ds_read_b128 v[120:123], v4 offset:10240
    v_mfma_f32_16x16x32_bf16 v[28:31], v[252:255], v[140:143], v[28:31]
    ds_read_b128 v[124:127], v4 offset:11264
    s_waitcnt vmcnt(3) lgkmcnt(4)
    v_mfma_f32_16x16x32_bf16 v[16:19], v[176:179], v[144:147], v[16:19]
    ds_read_b128 v[128:131], v4 offset:12288
    v_mfma_f32_16x16x32_bf16 v[20:23], v[176:179], v[148:151], v[20:23]
    ds_read_b128 v[132:135], v4 offset:13312
    v_mfma_f32_16x16x32_bf16 v[24:27], v[176:179], v[152:155], v[24:27]
    ds_read_b128 v[136:139], v4 offset:14336
    v_mfma_f32_16x16x32_bf16 v[28:31], v[176:179], v[156:159], v[28:31]
    ds_read_b128 v[140:143], v4 offset:15360
    s_waitcnt vmcnt(2) lgkmcnt(4)
    v_mfma_f32_16x16x32_bf16 v[16:19], v[180:183], v[112:115], v[16:19]
    ds_read_b128 v[144:147], v4 offset:16384
    v_mfma_f32_16x16x32_bf16 v[20:23], v[180:183], v[116:119], v[20:23]
    ds_read_b128 v[148:151], v4 offset:17408
    v_mfma_f32_16x16x32_bf16 v[24:27], v[180:183], v[120:123], v[24:27]
    ds_read_b128 v[152:155], v4 offset:18432
    v_mfma_f32_16x16x32_bf16 v[28:31], v[180:183], v[124:127], v[28:31]
    ds_read_b128 v[156:159], v4 offset:19456
    s_waitcnt vmcnt(1) lgkmcnt(4)
    v_mfma_f32_16x16x32_bf16 v[16:19], v[184:187], v[128:131], v[16:19]
    v_mfma_f32_16x16x32_bf16 v[20:23], v[184:187], v[132:135], v[20:23]
    v_mfma_f32_16x16x32_bf16 v[24:27], v[184:187], v[136:139], v[24:27]
    v_mfma_f32_16x16x32_bf16 v[28:31], v[184:187], v[140:143], v[28:31]
    s_waitcnt vmcnt(0) lgkmcnt(0)
    v_mfma_f32_16x16x32_bf16 v[16:19], v[188:191], v[144:147], v[16:19]
    v_mfma_f32_16x16x32_bf16 v[20:23], v[188:191], v[148:151], v[20:23]
    v_mfma_f32_16x16x32_bf16 v[24:27], v[188:191], v[152:155], v[24:27]
    v_mfma_f32_16x16x32_bf16 v[28:31], v[188:191], v[156:159], v[28:31]
    s_nop 7
    v_cvt_pk_bf16_f32 v160, v16, v17
    v_cvt_pk_bf16_f32 v161, v18, v19
    ds_write_b64 v8, v[160:161] offset:32768
    v_cvt_pk_bf16_f32 v162, v20, v21
    v_cvt_pk_bf16_f32 v163, v22, v23
    ds_write_b64 v8, v[162:163] offset:34816
    v_cvt_pk_bf16_f32 v164, v24, v25
    v_cvt_pk_bf16_f32 v165, v26, v27
    ds_write_b64 v8, v[164:165] offset:36864
    v_cvt_pk_bf16_f32 v166, v28, v29
    v_cvt_pk_bf16_f32 v167, v30, v31
    ds_write_b64 v8, v[166:167] offset:38912
    s_mov_b64 exec, 1
    ds_add_rtn_u32 v175, v11, v10 offset:32
    s_mov_b64 exec, -1
    s_branch K4_last
K4_helper:
    s_setprio 0
    s_mov_b32 s40, s34
    s_mov_b32 s41, s35
    s_mul_i32 s30, s41, 73728
    s_mul_i32 s90, s33, 18432
    s_add_u32 s30, s30, s90
    s_add_u32 s16, s14, 4890624
    s_addc_u32 s17, s15, 0
    s_mov_b32 s18, 2359296
    s_mov_b32 s19, 0x00020000
    s_lshl_b32 s43, s41, 2
    s_add_u32 s43, s43, s33
    s_lshl_b32 s43, s43, 10
    s_add_u32 s43, s43, 327680
    v_lshlrev_b32 v12, 7, v0
    s_mov_b32 s91, 0x10000
    s_mov_b32 exec_lo, 3
    s_mov_b32 exec_hi, 0
L_poll_41:
    buffer_load_dword v13, v12, s[36:39], s43 offen sc1
    s_waitcnt vmcnt(0)
L_poll_41_1:
    v_cmp_eq_u32 vcc, s101, v13
    s_nop 1
    s_cmp_eq_u64 vcc, exec
    s_cbranch_scc1 L_poll_41_ok
    s_sleep 1
    s_sub_u32 s91, s91, 1
    s_cbranch_scc0 L_poll_41
L_poll_41_ok:
    s_mov_b64 exec, -1
    s_mov_b32 m0, s90
    s_add_u32 s90, s90, 4096
    buffer_load_dwordx4 v2, s[16:19], s30 offen offset:0 sc1 lds
    buffer_load_dwordx4 v2, s[16:19], s30 offen offset:1024 sc1 lds
    buffer_load_dwordx4 v2, s[16:19], s30 offen offset:2048 sc1 lds
    buffer_load_dwordx4 v2, s[16:19], s30 offen offset:3072 sc1 lds
    s_add_u32 s30, s30, 4096
    s_mov_b32 m0, s90
    s_add_u32 s90, s90, 4096
    buffer_load_dwordx4 v2, s[16:19], s30 offen offset:0 sc1 lds
    buffer_load_dwordx4 v2, s[16:19], s30 offen offset:1024 sc1 lds
    s_mov_b64 exec, 63
    buffer_load_dword v13, v12, s[36:39], s43 offen sc1
    s_mov_b64 exec, -1
    s_waitcnt vmcnt(0)
    s_barrier
    s_mov_b32 s91, 0x10000
    s_mov_b32 exec_lo, 63
    s_mov_b32 exec_hi, 0
    s_branch L_poll_42_1
L_poll_42:
    buffer_load_dword v13, v12, s[36:39], s43 offen sc1
    s_waitcnt vmcnt(0)
L_poll_42_1:
    v_cmp_eq_u32 vcc, s101, v13
    s_nop 1
    s_cmp_eq_u64 vcc, exec
    s_cbranch_scc1 L_poll_42_ok
    s_sleep 1
    s_sub_u32 s91, s91, 1
    s_cbranch_scc0 L_poll_42
L_poll_42_ok:
    s_mov_b64 exec, -1
    buffer_load_dwordx4 v2, s[16:19], s30 offen offset:2048 sc1 lds
    buffer_load_dwordx4 v2, s[16:19], s30 offen offset:3072 sc1 lds
    s_add_u32 s30, s30, 4096
    s_mov_b32 m0, s90
    s_add_u32 s90, s90, 4096
    buffer_load_dwordx4 v2, s[16:19], s30 offen offset:0 sc1 lds
    s_waitcnt vmcnt(3)
    s_barrier
    buffer_load_dwordx4 v2, s[16:19], s30 offen offset:1024 sc1 lds
    buffer_load_dwordx4 v2, s[16:19], s30 offen offset:2048 sc1 lds
    buffer_load_dwordx4 v2, s[16:19], s30 offen offset:3072 sc1 lds
    s_add_u32 s30, s30, 4096
    s_waitcnt vmcnt(3)
    s_barrier
    s_mov_b32 m0, s90
    s_add_u32 s90, s90, 4096
    buffer_load_dwordx4 v2, s[16:19], s30 offen offset:0 sc1 lds
    buffer_load_dwordx4 v2, s[16:19], s30 offen offset:1024 sc1 lds
    buffer_load_dwordx4 v2, s[16:19], s30 offen offset:2048 sc1 lds
    s_waitcnt vmcnt(3)
    s_barrier
    buffer_load_dwordx4 v2, s[16:19], s30 offen offset:3072 sc1 lds
    s_add_u32 s30, s30, 4096
    s_mov_b32 m0, s90
    s_add_u32 s90, s90, 4096
    buffer_load_dwordx4 v2, s[16:19], s30 offen offset:0 sc1 lds
    buffer_load_dwordx4 v2, s[16:19], s30 offen offset:1024 sc1 lds
    s_waitcnt vmcnt(3)
    s_barrier
    s_waitcnt vmcnt(0)
    s_barrier
    s_cmp_lg_u32 s2, 0
    s_cbranch_scc1 K4_nep
    s_cmp_lg_u32 s33, 3
    s_cbranch_scc1 K4_nep
    s_mov_b32 s74, s34
    s_mov_b32 s34, 0
K4_epl:
    s_lshl_b32 s43, s34, 12
    s_add_u32 s43, s43, 458752
    s_mov_b32 s91, 0x10000
    s_mov_b32 exec_lo, 4294967295
    s_mov_b32 exec_hi, 0
L_poll_43:
    buffer_load_dword v160, v161, s[36:39], s43 offen sc1
    s_waitcnt vmcnt(0)
L_poll_43_1:
    v_cmp_eq_u32 vcc, s101, v160
    s_nop 1
    s_cmp_eq_u64 vcc, exec
    s_cbranch_scc1 L_poll_43_ok
    s_sleep 2
    s_sub_u32 s91, s91, 1
    s_cbranch_scc0 L_poll_43
L_poll_43_ok:
    s_mov_b64 exec, -1
    s_add_u32 s34, s34, 1
    s_cmp_lt_u32 s34, 8
    s_cbranch_scc1 K4_epl
    s_mov_b32 s34, s74
    v_mov_b32 v13, s101
    v_mov_b32 v14, 0
    s_mov_b32 s52, s14
    s_mov_b32 s53, s15
    s_mov_b32 s54, 128
    s_mov_b32 s55, 0x00020000
    s_mov_b64 exec, 1
    buffer_store_dword v13, v14, s[52:55], 0 offen sc1
    s_mov_b64 exec, -1
K4_nep:
    s_cmp_ge_u32 s33, 2
    s_cbranch_scc1 K4_own
    s_barrier
    s_barrier
K4_pubs:
    s_add_u32 s24, s14, 21319680
    s_addc_u32 s25, s15, 0
    s_mov_b32 s26, 18874368
    s_mov_b32 s27, 0x00020000
    s_mov_b32 s42, s33
    v_lshrrev_b32 v5, 3, v0
    v_and_b32 v6, 7, v0
    v_xor_b32 v7, v5, v6
    v_lshlrev_b32 v7, 4, v7
    v_lshl_add_u32 v7, v5, 7, v7
    s_lshl_b32 s44, s42, 13
    v_add_u32 v7, s44, v7
    s_lshl_b32 s44, s42, 2
    s_add_u32 s44, s44, 151552
    v_mov_b32 v4, s44
    s_mul_i32 s49, s41, 9
    s_add_u32 s49, s49, s42
    s_lshl_b32 s47, s49, 16
    s_lshl_b32 s51, s49, 10
    s_lshl_b32 s44, s40, 13
    s_add_u32 s47, s47, s44
    s_lshl_b32 s44, s40, 7
    s_add_u32 s51, s51, s44
    v_lshlrev_b32 v18, 2, v0
    v_mov_b32 v13, s101
    s_mov_b32 s75, s40
K4_pub:
    s_add_u32 s44, s40, s42
    s_and_b32 s44, s44, 7
    s_cmp_eq_u32 s42, 0
    s_cselect_b32 s44, 8, s44
    s_cselect_b32 s45, s40, s42
    s_cselect_b32 s75, s40, 64
    s_mul_i32 s49, s41, 9
    s_add_u32 s49, s49, s44
    s_lshl_b32 s49, s49, 3
    s_add_u32 s49, s49, s45
    s_lshl_b32 s47, s49, 13
    s_lshl_b32 s51, s49, 7
    s_mov_b32 s72, 0x40000
K4_pw:
    ds_read_b32 v3, v4
    s_waitcnt lgkmcnt(0)
    v_readfirstlane_b32 s70, v3
    s_cmp_ge_u32 s70, 4
    s_cbranch_scc1 K4_pw_ok
    s_sleep 2
    s_sub_u32 s72, s72, 1
    s_cbranch_scc0 K4_pw
K4_pw_ok:
    ds_read_b128 v[48:51], v7 offset:0
    ds_read_b128 v[52:55], v7 offset:1024
    ds_read_b128 v[56:59], v7 offset:2048
    ds_read_b128 v[60:63], v7 offset:3072
    ds_read_b128 v[64:67], v7 offset:4096
    ds_read_b128 v[68:71], v7 offset:5120
    ds_read_b128 v[72:75], v7 offset:6144
    ds_read_b128 v[76:79], v7 offset:7168
    s_add_u32 s71, s47, 4096
    s_cmp_eq_u32 s75, 0
    s_cbranch_scc1 K4_ps0
    s_waitcnt lgkmcnt(7)
    buffer_store_dwordx4 v[48:51], v2, s[24:27], s47 offen offset:0 sc1
K4_ps0:
    s_cmp_eq_u32 s75, 1
    s_cbranch_scc1 K4_ps1
    s_waitcnt lgkmcnt(6)
    buffer_store_dwordx4 v[52:55], v2, s[24:27], s47 offen offset:1024 sc1
K4_ps1:
    s_cmp_eq_u32 s75, 2
    s_cbranch_scc1 K4_ps2
    s_waitcnt lgkmcnt(5)
    buffer_store_dwordx4 v[56:59], v2, s[24:27], s47 offen offset:2048 sc1
K4_ps2:
    s_cmp_eq_u32 s75, 3
    s_cbranch_scc1 K4_ps3
    s_waitcnt lgkmcnt(4)
    buffer_store_dwordx4 v[60:63], v2, s[24:27], s47 offen offset:3072 sc1
K4_ps3:
    s_cmp_eq_u32 s75, 4
    s_cbranch_scc1 K4_ps4
    s_waitcnt lgkmcnt(3)
    buffer_store_dwordx4 v[64:67], v2, s[24:27], s71 offen offset:0 sc1
K4_ps4:
    s_cmp_eq_u32 s75, 5
    s_cbranch_scc1 K4_ps5
    s_waitcnt lgkmcnt(2)
    buffer_store_dwordx4 v[68:71], v2, s[24:27], s71 offen offset:1024 sc1
K4_ps5:
    s_cmp_eq_u32 s75, 6
    s_cbranch_scc1 K4_ps6
    s_waitcnt lgkmcnt(1)
    buffer_store_dwordx4 v[72:75], v2, s[24:27], s71 offen offset:2048 sc1
K4_ps6:
    s_cmp_eq_u32 s75, 7
    s_cbranch_scc1 K4_ps7
    s_waitcnt lgkmcnt(0)
    buffer_store_dwordx4 v[76:79], v2, s[24:27], s71 offen offset:3072 sc1
K4_ps7:
    v_mov_b32 v3, 4
    s_mov_b64 exec, 1
    ds_add_u32 v4, v3
    s_mov_b64 exec, -1
    s_waitcnt vmcnt(0) lgkmcnt(0)
    s_mov_b32 exec_lo, -1
    s_mov_b32 exec_hi, 0
    buffer_store_dword v13, v18, s[36:39], s51 offen sc1
    s_mov_b64 exec, -1
    s_add_u32 s42, s42, 2
    s_add_u32 s47, s47, 131072
    s_add_u32 s51, s51, 2048
    v_add_u32 v7, 16384, v7
    v_add_u32 v4, 8, v4
    s_cmp_lt_u32 s42, 8
    s_cbranch_scc1 K4_pub
K4_work:
    v_mov_b32 v14, 151552
    v_mov_b32 v15, 1
    s_mov_b64 exec, 1
    ds_add_rtn_u32 v3, v14, v15 offset:40
    s_mov_b64 exec, -1
    s_waitcnt lgkmcnt(0)
    v_readfirstlane_b32 s42, v3
    s_cmp_ge_u32 s42, 1
    s_cbranch_scc1 K4_fin
    s_mov_b32 s76, s42
    s_mov_b32 s42, 8
    s_add_u32 s16, s14, 4890624
    s_addc_u32 s17, s15, 0
    s_mov_b32 s18, 2359296
    s_mov_b32 s19, 0x00020000
    s_add_u32 s24, s14, 21319680
    s_addc_u32 s25, s15, 0
    s_mov_b32 s26, 18874368
    s_mov_b32 s27, 0x00020000
    s_add_u32 s56, s14, 7249920
    s_addc_u32 s57, s15, 0
    s_mov_b32 s58, 131072
    s_mov_b32 s59, 0x00020000
    s_mov_b32 s60, s4
    s_mov_b32 s61, s5
    s_mov_b32 s62, 2359296
    s_mov_b32 s63, 0x00020000
    v_lshrrev_b32 v5, 3, v0
    v_and_b32 v6, 7, v0
    v_xor_b32 v7, v5, v6
    v_lshlrev_b32 v7, 4, v7
    v_lshl_add_u32 v7, v5, 7, v7
    s_lshl_b32 s43, s40, 3
    v_add_u32 v8, s43, v5
    v_lshrrev_b32 v19, 4, v8
    v_lshlrev_b32 v19, 10, v19
    v_and_b32 v16, 15, v8
    v_lshl_add_u32 v19, v16, 2, v19
    s_lshl_b32 s65, s41, 12
    buffer_load_dword v140, v19, s[56:59], s65 offen offset:64 sc1
    buffer_load_dword v144, v19, s[56:59], s65 offen offset:0 sc1
    buffer_load_dword v145, v19, s[56:59], s65 offen offset:128 sc1
    buffer_load_dword v146, v19, s[56:59], s65 offen offset:256 sc1
    buffer_load_dword v147, v19, s[56:59], s65 offen offset:384 sc1
    buffer_load_dword v148, v19, s[56:59], s65 offen offset:512 sc1
    buffer_load_dword v149, v19, s[56:59], s65 offen offset:640 sc1
    s_lshl_b32 s44, s40, 10
    v_add_u32 v9, s44, v7
    v_lshlrev_b32 v12, 7, v0
    v_lshrrev_b32 v10, 4, v8
    v_mul_u32_u24 v10, 18432, v10
    v_lshl_add_u32 v10, v6, 8, v10
    v_and_b32 v11, 15, v8
    v_lshl_add_u32 v10, v11, 4, v10
    v_mul_u32_u24 v11, 1152, v8
    v_lshl_add_u32 v11, v6, 4, v11
    v_and_b32 v19, 1, v0
    v_cmp_eq_u32 s[66:67], 1, v19
    s_mov_b32 s68, 0x00003f80
    s_mov_b32 s69, 0x3f800000
    s_mov_b32 s74, 0
K4_red:
    s_mul_i32 s30, s41, 73728
    s_lshl_b32 s44, s42, 11
    s_add_u32 s30, s30, s44
    buffer_load_dwordx4 v[20:23], v10, s[16:19], s30 offen sc1
    s_mul_i32 s64, s41, 73728
    s_lshl_b32 s44, s42, 7
    s_add_u32 s64, s64, s44
    s_lshl_b32 s44, s76, 13
    v_add_u32 v7, s44, v9
    s_lshl_b32 s44, s76, 2
    s_add_u32 s44, s44, 151552
    v_mov_b32 v4, s44
    s_mul_i32 s49, s41, 9
    s_add_u32 s49, s49, s42
    s_lshl_b32 s71, s49, 16
    s_lshl_b32 s51, s49, 10
    s_lshl_b32 s44, s40, 10
    s_add_u32 s71, s71, s44
    s_mov_b32 s72, 0x40000
K4_rw:
    ds_read_b32 v3, v4
    s_waitcnt lgkmcnt(0)
    v_readfirstlane_b32 s70, v3
    s_cmp_ge_u32 s70, 4
    s_cbranch_scc1 K4_rw_ok
    s_sleep 4
    s_sub_u32 s72, s72, 1
    s_cbranch_scc0 K4_rw
K4_rw_ok:
    s_mov_b32 s91, 0x10000
    s_mov_b32 exec_lo, 255
    s_mov_b32 exec_hi, 0
L_poll_44:
    buffer_load_dword v3, v12, s[36:39], s51 offen sc1
    s_waitcnt vmcnt(0)
L_poll_44_1:
    v_cmp_eq_u32 vcc, s101, v3
    s_nop 1
    s_cmp_eq_u64 vcc, exec
    s_cbranch_scc1 L_poll_44_ok
    s_sleep 2
    s_sub_u32 s91, s91, 1
    s_cbranch_scc0 L_poll_44
L_poll_44_ok:
    s_mov_b64 exec, -1
    s_cmp_eq_u32 s40, 0
    s_cbranch_scc1 K4_ro0
    buffer_load_dwordx4 v[48:51], v2, s[24:27], s71 offen sc1
    s_branch K4_rp0
K4_ro0:
    ds_read_b128 v[48:51], v7
K4_rp0:
    s_add_u32 s71, s71, 8192
    s_cmp_eq_u32 s40, 1
    s_cbranch_scc1 K4_ro1
    buffer_load_dwordx4 v[52:55], v2, s[24:27], s71 offen sc1
    s_branch K4_rp1
K4_ro1:
    ds_read_b128 v[52:55], v7
K4_rp1:
    s_add_u32 s71, s71, 8192
    s_cmp_eq_u32 s40, 2
    s_cbranch_scc1 K4_ro2
    buffer_load_dwordx4 v[56:59], v2, s[24:27], s71 offen sc1
    s_branch K4_rp2
K4_ro2:
    ds_read_b128 v[56:59], v7
K4_rp2:
    s_add_u32 s71, s71, 8192
    s_cmp_eq_u32 s40, 3
    s_cbranch_scc1 K4_ro3
    buffer_load_dwordx4 v[60:63], v2, s[24:27], s71 offen sc1
    s_branch K4_rp3
K4_ro3:
    ds_read_b128 v[60:63], v7
K4_rp3:
    s_add_u32 s71, s71, 8192
    s_cmp_eq_u32 s40, 4
    s_cbranch_scc1 K4_ro4
    buffer_load_dwordx4 v[64:67], v2, s[24:27], s71 offen sc1
    s_branch K4_rp4
K4_ro4:
    ds_read_b128 v[64:67], v7
K4_rp4:
    s_add_u32 s71, s71, 8192
    s_cmp_eq_u32 s40, 5
    s_cbranch_scc1 K4_ro5
    buffer_load_dwordx4 v[68:71], v2, s[24:27], s71 offen sc1
    s_branch K4_rp5
K4_ro5:
    ds_read_b128 v[68:71], v7
K4_rp5:
    s_add_u32 s71, s71, 8192
    s_cmp_eq_u32 s40, 6
    s_cbranch_scc1 K4_ro6
    buffer_load_dwordx4 v[72:75], v2, s[24:27], s71 offen sc1
    s_branch K4_rp6
K4_ro6:
    ds_read_b128 v[72:75], v7
K4_rp6:
    s_add_u32 s71, s71, 8192
    s_cmp_eq_u32 s40, 7
    s_cbranch_scc1 K4_ro7
    buffer_load_dwordx4 v[76:79], v2, s[24:27], s71 offen sc1
    s_branch K4_rp7
K4_ro7:
    ds_read_b128 v[76:79], v7
K4_rp7:
    s_add_u32 s71, s71, 8192
    s_cmp_lg_u32 s74, 0
    s_cbranch_scc1 K4_hs
    s_mov_b32 s74, 1
    v_add_f32 v144, v144, v145
    v_add_f32 v146, v146, v147
    v_add_f32 v148, v148, v149
    v_add_f32 v144, v144, v146
    v_add_f32 v144, v144, v148
    v_mov_b32 v145, 925353388
    v_fmac_f32 v145, 987991609, v144
    v_rsq_f32 v142, v145
K4_hs:
    v_lshlrev_b32 v24, 16, v20
    v_and_b32 v25, 0xffff0000, v20
    v_add_f32 v24, v24, v140
    v_add_f32 v25, v25, v140
    v_lshlrev_b32 v26, 16, v21
    v_and_b32 v27, 0xffff0000, v21
    v_add_f32 v26, v26, v140
    v_add_f32 v27, v27, v140
    v_lshlrev_b32 v28, 16, v22
    v_and_b32 v29, 0xffff0000, v22
    v_add_f32 v28, v28, v140
    v_add_f32 v29, v29, v140
    v_lshlrev_b32 v30, 16, v23
    v_and_b32 v31, 0xffff0000, v23
    v_add_f32 v30, v30, v140
    v_add_f32 v31, v31, v140
    s_waitcnt lgkmcnt(0)
    s_waitcnt vmcnt(6)
    v_lshlrev_b32 v112, 16, v48
    v_and_b32 v114, 0xffff0000, v48
    v_lshlrev_b32 v116, 16, v49
    v_and_b32 v118, 0xffff0000, v49
    v_lshlrev_b32 v113, 16, v50
    v_and_b32 v115, 0xffff0000, v50
    v_lshlrev_b32 v117, 16, v51
    v_and_b32 v119, 0xffff0000, v51
    s_waitcnt vmcnt(5)
    v_lshlrev_b32 v16, 16, v52
    v_and_b32 v52, 0xffff0000, v52
    v_add_f32 v112, v112, v16
    v_add_f32 v114, v114, v52
    v_lshlrev_b32 v16, 16, v53
    v_and_b32 v53, 0xffff0000, v53
    v_add_f32 v116, v116, v16
    v_add_f32 v118, v118, v53
    v_lshlrev_b32 v16, 16, v54
    v_and_b32 v54, 0xffff0000, v54
    v_add_f32 v113, v113, v16
    v_add_f32 v115, v115, v54
    v_lshlrev_b32 v16, 16, v55
    v_and_b32 v55, 0xffff0000, v55
    v_add_f32 v117, v117, v16
    v_add_f32 v119, v119, v55
    s_waitcnt vmcnt(4)
    v_lshlrev_b32 v16, 16, v56
    v_and_b32 v56, 0xffff0000, v56
    v_add_f32 v112, v112, v16
    v_add_f32 v114, v114, v56
    v_lshlrev_b32 v16, 16, v57
    v_and_b32 v57, 0xffff0000, v57
    v_add_f32 v116, v116, v16
    v_add_f32 v118, v118, v57
    v_lshlrev_b32 v16, 16, v58
    v_and_b32 v58, 0xffff0000, v58
    v_add_f32 v113, v113, v16
    v_add_f32 v115, v115, v58
    v_lshlrev_b32 v16, 16, v59
    v_and_b32 v59, 0xffff0000, v59
    v_add_f32 v117, v117, v16
    v_add_f32 v119, v119, v59
    s_waitcnt vmcnt(3)
    v_lshlrev_b32 v16, 16, v60
    v_and_b32 v60, 0xffff0000, v60
    v_add_f32 v112, v112, v16
    v_add_f32 v114, v114, v60
    v_lshlrev_b32 v16, 16, v61
    v_and_b32 v61, 0xffff0000, v61
    v_add_f32 v116, v116, v16
    v_add_f32 v118, v118, v61
    v_lshlrev_b32 v16, 16, v62
    v_and_b32 v62, 0xffff0000, v62
    v_add_f32 v113, v113, v16
    v_add_f32 v115, v115, v62
    v_lshlrev_b32 v16, 16, v63
    v_and_b32 v63, 0xffff0000, v63
    v_add_f32 v117, v117, v16
    v_add_f32 v119, v119, v63
    s_waitcnt vmcnt(2)
    v_lshlrev_b32 v16, 16, v64
    v_and_b32 v64, 0xffff0000, v64
    v_add_f32 v112, v112, v16
    v_add_f32 v114, v114, v64
    v_lshlrev_b32 v16, 16, v65
    v_and_b32 v65, 0xffff0000, v65
    v_add_f32 v116, v116, v16
    v_add_f32 v118, v118, v65
    v_lshlrev_b32 v16, 16, v66
    v_and_b32 v66, 0xffff0000, v66
    v_add_f32 v113, v113, v16
    v_add_f32 v115, v115, v66
    v_lshlrev_b32 v16, 16, v67
    v_and_b32 v67, 0xffff0000, v67
    v_add_f32 v117, v117, v16
    v_add_f32 v119, v119, v67
    s_waitcnt vmcnt(1)
    v_lshlrev_b32 v16, 16, v68
    v_and_b32 v68, 0xffff0000, v68
    v_add_f32 v112, v112, v16
    v_add_f32 v114, v114, v68
    v_lshlrev_b32 v16, 16, v69
    v_and_b32 v69, 0xffff0000, v69
    v_add_f32 v116, v116, v16
    v_add_f32 v118, v118, v69
    v_lshlrev_b32 v16, 16, v70
    v_and_b32 v70, 0xffff0000, v70
    v_add_f32 v113, v113, v16
    v_add_f32 v115, v115, v70
    v_lshlrev_b32 v16, 16, v71
    v_and_b32 v71, 0xffff0000, v71
    v_add_f32 v117, v117, v16
    v_add_f32 v119, v119, v71
    s_waitcnt vmcnt(0)
    v_lshlrev_b32 v16, 16, v72
    v_and_b32 v72, 0xffff0000, v72
    v_add_f32 v112, v112, v16
    v_add_f32 v114, v114, v72
    v_lshlrev_b32 v16, 16, v73
    v_and_b32 v73, 0xffff0000, v73
    v_add_f32 v116, v116, v16
    v_add_f32 v118, v118, v73
    v_lshlrev_b32 v16, 16, v74
    v_and_b32 v74, 0xffff0000, v74
    v_add_f32 v113, v113, v16
    v_add_f32 v115, v115, v74
    v_lshlrev_b32 v16, 16, v75
    v_and_b32 v75, 0xffff0000, v75
    v_add_f32 v117, v117, v16
    v_add_f32 v119, v119, v75
    s_waitcnt vmcnt(0)
    v_lshlrev_b32 v16, 16, v76
    v_and_b32 v76, 0xffff0000, v76
    v_add_f32 v112, v112, v16
    v_add_f32 v114, v114, v76
    v_lshlrev_b32 v16, 16, v77
    v_and_b32 v77, 0xffff0000, v77
    v_add_f32 v116, v116, v16
    v_add_f32 v118, v118, v77
    v_lshlrev_b32 v16, 16, v78
    v_and_b32 v78, 0xffff0000, v78
    v_add_f32 v113, v113, v16
    v_add_f32 v115, v115, v78
    v_lshlrev_b32 v16, 16, v79
    v_and_b32 v79, 0xffff0000, v79
    v_add_f32 v117, v117, v16
    v_add_f32 v119, v119, v79
    s_nop 2
    v_cndmask_b32 v120, v116, v112, s[66:67]
    v_cndmask_b32 v124, v112, v116, s[66:67]
    v_cndmask_b32 v121, v117, v113, s[66:67]
    v_cndmask_b32 v125, v113, v117, s[66:67]
    v_cndmask_b32 v122, v118, v114, s[66:67]
    v_cndmask_b32 v126, v114, v118, s[66:67]
    v_cndmask_b32 v123, v119, v115, s[66:67]
    v_cndmask_b32 v127, v115, v119, s[66:67]
    s_nop 1
    v_mov_b32_dpp v128, v120 quad_perm:[1,0,3,2] row_mask:0xf bank_mask:0xf
    v_mov_b32_dpp v129, v121 quad_perm:[1,0,3,2] row_mask:0xf bank_mask:0xf
    v_mov_b32_dpp v130, v122 quad_perm:[1,0,3,2] row_mask:0xf bank_mask:0xf
    v_mov_b32_dpp v131, v123 quad_perm:[1,0,3,2] row_mask:0xf bank_mask:0xf
    v_cndmask_b32 v112, v124, v128, s[66:67]
    v_cndmask_b32 v114, v128, v124, s[66:67]
    v_cndmask_b32 v113, v125, v129, s[66:67]
    v_cndmask_b32 v115, v129, v125, s[66:67]
    v_cndmask_b32 v116, v126, v130, s[66:67]
    v_cndmask_b32 v118, v130, v126, s[66:67]
    v_cndmask_b32 v117, v127, v131, s[66:67]
    v_cndmask_b32 v119, v131, v127, s[66:67]
    v_fmac_f32 v24, v112, v142
    v_fmac_f32 v25, v113, v142
    v_cvt_pk_bf16_f32 v40, v24, v25
    v_fmac_f32 v26, v114, v142
    v_fmac_f32 v27, v115, v142
    v_cvt_pk_bf16_f32 v41, v26, v27
    v_fmac_f32 v28, v116, v142
    v_fmac_f32 v29, v117, v142
    v_cvt_pk_bf16_f32 v42, v28, v29
    v_fmac_f32 v30, v118, v142
    v_fmac_f32 v31, v119, v142
    v_cvt_pk_bf16_f32 v43, v30, v31
    buffer_store_dwordx4 v[40:43], v11, s[60:63], s64 offen
    s_mov_b64 exec, 1
    ds_add_rtn_u32 v3, v14, v15 offset:40
    s_mov_b64 exec, -1
    s_waitcnt lgkmcnt(0)
    v_readfirstlane_b32 s42, v3
    s_cmp_ge_u32 s42, 1
    s_cbranch_scc1 K4_fin
    s_mov_b32 s76, s42
    s_mov_b32 s42, 8
    s_branch K4_red
K4_own:
    s_sub_u32 s33, s33, 2
    s_add_u32 s24, s14, 21319680
    s_addc_u32 s25, s15, 0
    s_mov_b32 s26, 18874368
    s_mov_b32 s27, 0x00020000
    s_add_u32 s56, s14, 7249920
    s_addc_u32 s57, s15, 0
    s_mov_b32 s58, 131072
    s_mov_b32 s59, 0x00020000
    s_mov_b32 s60, s4
    s_mov_b32 s61, s5
    s_mov_b32 s62, 2359296
    s_mov_b32 s63, 0x00020000
    v_lshrrev_b32 v5, 3, v0
    v_and_b32 v6, 7, v0
    v_xor_b32 v7, v5, v6
    v_lshlrev_b32 v7, 4, v7
    v_lshl_add_u32 v7, v5, 7, v7
    v_lshlrev_b32 v19, 2, v5
    s_lshl_b32 s65, s41, 12
    s_lshl_b32 s44, s33, 11
    s_add_u32 s65, s65, s44
    buffer_load_dword v180, v19, s[56:59], s65 offen offset:64 sc1
    buffer_load_dword v184, v19, s[56:59], s65 offen offset:0 sc1
    buffer_load_dword v185, v19, s[56:59], s65 offen offset:128 sc1
    buffer_load_dword v186, v19, s[56:59], s65 offen offset:256 sc1
    buffer_load_dword v187, v19, s[56:59], s65 offen offset:384 sc1
    buffer_load_dword v188, v19, s[56:59], s65 offen offset:512 sc1
    buffer_load_dword v189, v19, s[56:59], s65 offen offset:640 sc1
    buffer_load_dword v181, v19, s[56:59], s65 offen offset:96 sc1
    buffer_load_dword v190, v19, s[56:59], s65 offen offset:32 sc1
    buffer_load_dword v191, v19, s[56:59], s65 offen offset:160 sc1
    buffer_load_dword v192, v19, s[56:59], s65 offen offset:288 sc1
    buffer_load_dword v193, v19, s[56:59], s65 offen offset:416 sc1
    buffer_load_dword v194, v19, s[56:59], s65 offen offset:544 sc1
    buffer_load_dword v195, v19, s[56:59], s65 offen offset:672 sc1
    buffer_load_dword v182, v19, s[56:59], s65 offen offset:1088 sc1
    buffer_load_dword v196, v19, s[56:59], s65 offen offset:1024 sc1
    buffer_load_dword v197, v19, s[56:59], s65 offen offset:1152 sc1
    buffer_load_dword v198, v19, s[56:59], s65 offen offset:1280 sc1
    buffer_load_dword v199, v19, s[56:59], s65 offen offset:1408 sc1
    buffer_load_dword v200, v19, s[56:59], s65 offen offset:1536 sc1
    buffer_load_dword v201, v19, s[56:59], s65 offen offset:1664 sc1
    buffer_load_dword v183, v19, s[56:59], s65 offen offset:1120 sc1
    buffer_load_dword v202, v19, s[56:59], s65 offen offset:1056 sc1
    buffer_load_dword v203, v19, s[56:59], s65 offen offset:1184 sc1
    buffer_load_dword v204, v19, s[56:59], s65 offen offset:1312 sc1
    buffer_load_dword v205, v19, s[56:59], s65 offen offset:1440 sc1
    buffer_load_dword v206, v19, s[56:59], s65 offen offset:1568 sc1
    buffer_load_dword v207, v19, s[56:59], s65 offen offset:1696 sc1
    v_lshlrev_b32 v10, 8, v6
    v_lshl_add_u32 v10, v5, 4, v10
    s_mul_i32 s30, s41, 73728
    s_mul_i32 s44, s33, 36864
    s_add_u32 s30, s30, s44
    s_lshl_b32 s44, s40, 11
    s_add_u32 s30, s30, s44
    s_add_u32 s44, s30, 18432
    buffer_load_dwordx4 v[48:51], v10, s[16:19], s30 offen offset:0 sc1
    buffer_load_dwordx4 v[52:55], v10, s[16:19], s30 offen offset:128 sc1
    buffer_load_dwordx4 v[56:59], v10, s[16:19], s44 offen offset:0 sc1
    buffer_load_dwordx4 v[60:63], v10, s[16:19], s44 offen offset:128 sc1
    v_mul_u32_u24 v11, 1152, v5
    v_lshl_add_u32 v11, v6, 4, v11
    s_mul_i32 s64, s41, 73728
    s_mul_i32 s44, s33, 36864
    s_add_u32 s64, s64, s44
    s_lshl_b32 s44, s40, 7
    s_add_u32 s64, s64, s44
    s_lshl_b32 s44, s33, 12
    s_add_u32 s44, s44, 65536
    v_add_u32 v7, s44, v7
    v_lshlrev_b32 v12, 7, v0
    v_and_b32 v19, 1, v0
    v_cmp_eq_u32 s[66:67], 1, v19
    s_mul_i32 s49, s41, 9
    s_add_u32 s49, s49, s40
    s_lshl_b32 s47, s49, 16
    s_lshl_b32 s51, s49, 10
    s_lshl_b32 s44, s33, 12
    s_add_u32 s47, s47, s44
    s_waitcnt vmcnt(0)
    v_add_f32 v184, v184, v185
    v_add_f32 v186, v186, v187
    v_add_f32 v188, v188, v189
    v_add_f32 v184, v184, v186
    v_add_f32 v184, v184, v188
    v_mov_b32 v185, 925353388
    v_fmac_f32 v185, 987991609, v184
    v_rsq_f32 v176, v185
    v_lshlrev_b32 v144, 16, v48
    v_and_b32 v145, 0xffff0000, v48
    v_add_f32 v144, v144, v180
    v_add_f32 v145, v145, v180
    v_lshlrev_b32 v146, 16, v49
    v_and_b32 v147, 0xffff0000, v49
    v_add_f32 v146, v146, v180
    v_add_f32 v147, v147, v180
    v_lshlrev_b32 v148, 16, v50
    v_and_b32 v149, 0xffff0000, v50
    v_add_f32 v148, v148, v180
    v_add_f32 v149, v149, v180
    v_lshlrev_b32 v150, 16, v51
    v_and_b32 v151, 0xffff0000, v51
    v_add_f32 v150, v150, v180
    v_add_f32 v151, v151, v180
    v_add_f32 v190, v190, v191
    v_add_f32 v192, v192, v193
    v_add_f32 v194, v194, v195
    v_add_f32 v190, v190, v192
    v_add_f32 v190, v190, v194
    v_mov_b32 v191, 925353388
    v_fmac_f32 v191, 987991609, v190
    v_rsq_f32 v177, v191
    v_lshlrev_b32 v152, 16, v52
    v_and_b32 v153, 0xffff0000, v52
    v_add_f32 v152, v152, v181
    v_add_f32 v153, v153, v181
    v_lshlrev_b32 v154, 16, v53
    v_and_b32 v155, 0xffff0000, v53
    v_add_f32 v154, v154, v181
    v_add_f32 v155, v155, v181
    v_lshlrev_b32 v156, 16, v54
    v_and_b32 v157, 0xffff0000, v54
    v_add_f32 v156, v156, v181
    v_add_f32 v157, v157, v181
    v_lshlrev_b32 v158, 16, v55
    v_and_b32 v159, 0xffff0000, v55
    v_add_f32 v158, v158, v181
    v_add_f32 v159, v159, v181
    v_add_f32 v196, v196, v197
    v_add_f32 v198, v198, v199
    v_add_f32 v200, v200, v201
    v_add_f32 v196, v196, v198
    v_add_f32 v196, v196, v200
    v_mov_b32 v197, 925353388
    v_fmac_f32 v197, 987991609, v196
    v_rsq_f32 v178, v197
    v_lshlrev_b32 v160, 16, v56
    v_and_b32 v161, 0xffff0000, v56
    v_add_f32 v160, v160, v182
    v_add_f32 v161, v161, v182
    v_lshlrev_b32 v162, 16, v57
    v_and_b32 v163, 0xffff0000, v57
    v_add_f32 v162, v162, v182
    v_add_f32 v163, v163, v182
    v_lshlrev_b32 v164, 16, v58
    v_and_b32 v165, 0xffff0000, v58
    v_add_f32 v164, v164, v182
    v_add_f32 v165, v165, v182
    v_lshlrev_b32 v166, 16, v59
    v_and_b32 v167, 0xffff0000, v59
    v_add_f32 v166, v166, v182
    v_add_f32 v167, v167, v182
    v_add_f32 v202, v202, v203
    v_add_f32 v204, v204, v205
    v_add_f32 v206, v206, v207
    v_add_f32 v202, v202, v204
    v_add_f32 v202, v202, v206
    v_mov_b32 v203, 925353388
    v_fmac_f32 v203, 987991609, v202
    v_rsq_f32 v179, v203
    v_lshlrev_b32 v168, 16, v60
    v_and_b32 v169, 0xffff0000, v60
    v_add_f32 v168, v168, v183
    v_add_f32 v169, v169, v183
    v_lshlrev_b32 v170, 16, v61
    v_and_b32 v171, 0xffff0000, v61
    v_add_f32 v170, v170, v183
    v_add_f32 v171, v171, v183
    v_lshlrev_b32 v172, 16, v62
    v_and_b32 v173, 0xffff0000, v62
    v_add_f32 v172, v172, v183
    v_add_f32 v173, v173, v183
    v_lshlrev_b32 v174, 16, v63
    v_and_b32 v175, 0xffff0000, v63
    v_add_f32 v174, v174, v183
    v_add_f32 v175, v175, v183
    s_barrier
    s_barrier
    v_mov_b32 v4, 151556
    s_mov_b32 s72, 0x40000
K4_ow0:
    ds_read_b32 v3, v4
    s_waitcnt lgkmcnt(0)
    v_readfirstlane_b32 s70, v3
    s_cmp_ge_u32 s70, 4
    s_cbranch_scc1 K4_ow0_ok
    s_sleep 2
    s_sub_u32 s72, s72, 1
    s_cbranch_scc0 K4_ow0
K4_ow0_ok:
    s_add_u32 s43, s51, 128
    s_mov_b32 s91, 0x10000
    s_mov_b32 exec_lo, 1
    s_mov_b32 exec_hi, 0
L_poll_45:
    buffer_load_dword v3, v12, s[36:39], s43 offen sc1
    s_waitcnt vmcnt(0)
L_poll_45_1:
    v_cmp_eq_u32 vcc, s101, v3
    s_nop 1
    s_cmp_eq_u64 vcc, exec
    s_cbranch_scc1 L_poll_45_ok
    s_sleep 2
    s_sub_u32 s91, s91, 1
    s_cbranch_scc0 L_poll_45
L_poll_45_ok:
    s_mov_b64 exec, -1
    s_add_u32 s71, s47, 8192
    buffer_load_dwordx4 v[48:51], v2, s[24:27], s71 offen offset:0 sc1
    buffer_load_dwordx4 v[52:55], v2, s[24:27], s71 offen offset:1024 sc1
    buffer_load_dwordx4 v[56:59], v2, s[24:27], s71 offen offset:2048 sc1
    buffer_load_dwordx4 v[60:63], v2, s[24:27], s71 offen offset:3072 sc1
    s_waitcnt vmcnt(3)
    v_lshlrev_b32 v112, 16, v48
    v_and_b32 v114, 0xffff0000, v48
    v_lshlrev_b32 v116, 16, v49
    v_and_b32 v118, 0xffff0000, v49
    v_lshlrev_b32 v113, 16, v50
    v_and_b32 v115, 0xffff0000, v50
    v_lshlrev_b32 v117, 16, v51
    v_and_b32 v119, 0xffff0000, v51
    s_waitcnt vmcnt(2)
    v_lshlrev_b32 v120, 16, v52
    v_and_b32 v122, 0xffff0000, v52
    v_lshlrev_b32 v124, 16, v53
    v_and_b32 v126, 0xffff0000, v53
    v_lshlrev_b32 v121, 16, v54
    v_and_b32 v123, 0xffff0000, v54
    v_lshlrev_b32 v125, 16, v55
    v_and_b32 v127, 0xffff0000, v55
    s_waitcnt vmcnt(1)
    v_lshlrev_b32 v128, 16, v56
    v_and_b32 v130, 0xffff0000, v56
    v_lshlrev_b32 v132, 16, v57
    v_and_b32 v134, 0xffff0000, v57
    v_lshlrev_b32 v129, 16, v58
    v_and_b32 v131, 0xffff0000, v58
    v_lshlrev_b32 v133, 16, v59
    v_and_b32 v135, 0xffff0000, v59
    s_waitcnt vmcnt(0)
    v_lshlrev_b32 v136, 16, v60
    v_and_b32 v138, 0xffff0000, v60
    v_lshlrev_b32 v140, 16, v61
    v_and_b32 v142, 0xffff0000, v61
    v_lshlrev_b32 v137, 16, v62
    v_and_b32 v139, 0xffff0000, v62
    v_lshlrev_b32 v141, 16, v63
    v_and_b32 v143, 0xffff0000, v63
    v_mov_b32 v4, 151564
    s_mov_b32 s72, 0x40000
K4_ow1:
    ds_read_b32 v3, v4
    s_waitcnt lgkmcnt(0)
    v_readfirstlane_b32 s70, v3
    s_cmp_ge_u32 s70, 4
    s_cbranch_scc1 K4_ow1_ok
    s_sleep 2
    s_sub_u32 s72, s72, 1
    s_cbranch_scc0 K4_ow1
K4_ow1_ok:
    s_add_u32 s43, s51, 256
    s_mov_b32 s91, 0x10000
    s_mov_b32 exec_lo, 3
    s_mov_b32 exec_hi, 0
L_poll_46:
    buffer_load_dword v3, v12, s[36:39], s43 offen sc1
    s_waitcnt vmcnt(0)
L_poll_46_1:
    v_cmp_eq_u32 vcc, s101, v3
    s_nop 1
    s_cmp_eq_u64 vcc, exec
    s_cbranch_scc1 L_poll_46_ok
    s_sleep 2
    s_sub_u32 s91, s91, 1
    s_cbranch_scc0 L_poll_46
L_poll_46_ok:
    s_mov_b64 exec, -1
    s_add_u32 s71, s47, 16384
    buffer_load_dwordx4 v[48:51], v2, s[24:27], s71 offen offset:0 sc1
    buffer_load_dwordx4 v[52:55], v2, s[24:27], s71 offen offset:1024 sc1
    buffer_load_dwordx4 v[56:59], v2, s[24:27], s71 offen offset:2048 sc1
    buffer_load_dwordx4 v[60:63], v2, s[24:27], s71 offen offset:3072 sc1
    s_add_u32 s71, s47, 24576
    buffer_load_dwordx4 v[64:67], v2, s[24:27], s71 offen offset:0 sc1
    buffer_load_dwordx4 v[68:71], v2, s[24:27], s71 offen offset:1024 sc1
    buffer_load_dwordx4 v[72:75], v2, s[24:27], s71 offen offset:2048 sc1
    buffer_load_dwordx4 v[76:79], v2, s[24:27], s71 offen offset:3072 sc1
    s_waitcnt vmcnt(7)
    v_lshlrev_b32 v16, 16, v48
    v_and_b32 v48, 0xffff0000, v48
    v_add_f32 v112, v112, v16
    v_add_f32 v114, v114, v48
    v_lshlrev_b32 v16, 16, v49
    v_and_b32 v49, 0xffff0000, v49
    v_add_f32 v116, v116, v16
    v_add_f32 v118, v118, v49
    v_lshlrev_b32 v16, 16, v50
    v_and_b32 v50, 0xffff0000, v50
    v_add_f32 v113, v113, v16
    v_add_f32 v115, v115, v50
    v_lshlrev_b32 v16, 16, v51
    v_and_b32 v51, 0xffff0000, v51
    v_add_f32 v117, v117, v16
    v_add_f32 v119, v119, v51
    s_waitcnt vmcnt(6)
    v_lshlrev_b32 v16, 16, v52
    v_and_b32 v52, 0xffff0000, v52
    v_add_f32 v120, v120, v16
    v_add_f32 v122, v122, v52
    v_lshlrev_b32 v16, 16, v53
    v_and_b32 v53, 0xffff0000, v53
    v_add_f32 v124, v124, v16
    v_add_f32 v126, v126, v53
    v_lshlrev_b32 v16, 16, v54
    v_and_b32 v54, 0xffff0000, v54
    v_add_f32 v121, v121, v16
    v_add_f32 v123, v123, v54
    v_lshlrev_b32 v16, 16, v55
    v_and_b32 v55, 0xffff0000, v55
    v_add_f32 v125, v125, v16
    v_add_f32 v127, v127, v55
    s_waitcnt vmcnt(5)
    v_lshlrev_b32 v16, 16, v56
    v_and_b32 v56, 0xffff0000, v56
    v_add_f32 v128, v128, v16
    v_add_f32 v130, v130, v56
    v_lshlrev_b32 v16, 16, v57
    v_and_b32 v57, 0xffff0000, v57
    v_add_f32 v132, v132, v16
    v_add_f32 v134, v134, v57
    v_lshlrev_b32 v16, 16, v58
    v_and_b32 v58, 0xffff0000, v58
    v_add_f32 v129, v129, v16
    v_add_f32 v131, v131, v58
    v_lshlrev_b32 v16, 16, v59
    v_and_b32 v59, 0xffff0000, v59
    v_add_f32 v133, v133, v16
    v_add_f32 v135, v135, v59
    s_waitcnt vmcnt(4)
    v_lshlrev_b32 v16, 16, v60
    v_and_b32 v60, 0xffff0000, v60
    v_add_f32 v136, v136, v16
    v_add_f32 v138, v138, v60
    v_lshlrev_b32 v16, 16, v61
    v_and_b32 v61, 0xffff0000, v61
    v_add_f32 v140, v140, v16
    v_add_f32 v142, v142, v61
    v_lshlrev_b32 v16, 16, v62
    v_and_b32 v62, 0xffff0000, v62
    v_add_f32 v137, v137, v16
    v_add_f32 v139, v139, v62
    v_lshlrev_b32 v16, 16, v63
    v_and_b32 v63, 0xffff0000, v63
    v_add_f32 v141, v141, v16
    v_add_f32 v143, v143, v63
    s_waitcnt vmcnt(3)
    v_lshlrev_b32 v16, 16, v64
    v_and_b32 v64, 0xffff0000, v64
    v_add_f32 v112, v112, v16
    v_add_f32 v114, v114, v64
    v_lshlrev_b32 v16, 16, v65
    v_and_b32 v65, 0xffff0000, v65
    v_add_f32 v116, v116, v16
    v_add_f32 v118, v118, v65
    v_lshlrev_b32 v16, 16, v66
    v_and_b32 v66, 0xffff0000, v66
    v_add_f32 v113, v113, v16
    v_add_f32 v115, v115, v66
    v_lshlrev_b32 v16, 16, v67
    v_and_b32 v67, 0xffff0000, v67
    v_add_f32 v117, v117, v16
    v_add_f32 v119, v119, v67
    s_waitcnt vmcnt(2)
    v_lshlrev_b32 v16, 16, v68
    v_and_b32 v68, 0xffff0000, v68
    v_add_f32 v120, v120, v16
    v_add_f32 v122, v122, v68
    v_lshlrev_b32 v16, 16, v69
    v_and_b32 v69, 0xffff0000, v69
    v_add_f32 v124, v124, v16
    v_add_f32 v126, v126, v69
    v_lshlrev_b32 v16, 16, v70
    v_and_b32 v70, 0xffff0000, v70
    v_add_f32 v121, v121, v16
    v_add_f32 v123, v123, v70
    v_lshlrev_b32 v16, 16, v71
    v_and_b32 v71, 0xffff0000, v71
    v_add_f32 v125, v125, v16
    v_add_f32 v127, v127, v71
    s_waitcnt vmcnt(1)
    v_lshlrev_b32 v16, 16, v72
    v_and_b32 v72, 0xffff0000, v72
    v_add_f32 v128, v128, v16
    v_add_f32 v130, v130, v72
    v_lshlrev_b32 v16, 16, v73
    v_and_b32 v73, 0xffff0000, v73
    v_add_f32 v132, v132, v16
    v_add_f32 v134, v134, v73
    v_lshlrev_b32 v16, 16, v74
    v_and_b32 v74, 0xffff0000, v74
    v_add_f32 v129, v129, v16
    v_add_f32 v131, v131, v74
    v_lshlrev_b32 v16, 16, v75
    v_and_b32 v75, 0xffff0000, v75
    v_add_f32 v133, v133, v16
    v_add_f32 v135, v135, v75
    s_waitcnt vmcnt(0)
    v_lshlrev_b32 v16, 16, v76
    v_and_b32 v76, 0xffff0000, v76
    v_add_f32 v136, v136, v16
    v_add_f32 v138, v138, v76
    v_lshlrev_b32 v16, 16, v77
    v_and_b32 v77, 0xffff0000, v77
    v_add_f32 v140, v140, v16
    v_add_f32 v142, v142, v77
    v_lshlrev_b32 v16, 16, v78
    v_and_b32 v78, 0xffff0000, v78
    v_add_f32 v137, v137, v16
    v_add_f32 v139, v139, v78
    v_lshlrev_b32 v16, 16, v79
    v_and_b32 v79, 0xffff0000, v79
    v_add_f32 v141, v141, v16
    v_add_f32 v143, v143, v79
    v_mov_b32 v4, 151568
    s_mov_b32 s72, 0x40000
K4_ow2:
    ds_read_b32 v3, v4
    s_waitcnt lgkmcnt(0)
    v_readfirstlane_b32 s70, v3
    s_cmp_ge_u32 s70, 4
    s_cbranch_scc1 K4_ow2_ok
    s_sleep 2
    s_sub_u32 s72, s72, 1
    s_cbranch_scc0 K4_ow2
K4_ow2_ok:
    s_add_u32 s43, s51, 512
    s_mov_b32 s91, 0x10000
    s_mov_b32 exec_lo, 1
    s_mov_b32 exec_hi, 0
L_poll_47:
    buffer_load_dword v3, v12, s[36:39], s43 offen sc1
    s_waitcnt vmcnt(0)
L_poll_47_1:
    v_cmp_eq_u32 vcc, s101, v3
    s_nop 1
    s_cmp_eq_u64 vcc, exec
    s_cbranch_scc1 L_poll_47_ok
    s_sleep 2
    s_sub_u32 s91, s91, 1
    s_cbranch_scc0 L_poll_47
L_poll_47_ok:
    s_mov_b64 exec, -1
    s_add_u32 s71, s47, 32768
    buffer_load_dwordx4 v[48:51], v2, s[24:27], s71 offen offset:0 sc1
    buffer_load_dwordx4 v[52:55], v2, s[24:27], s71 offen offset:1024 sc1
    buffer_load_dwordx4 v[56:59], v2, s[24:27], s71 offen offset:2048 sc1
    buffer_load_dwordx4 v[60:63], v2, s[24:27], s71 offen offset:3072 sc1
    s_waitcnt vmcnt(3)
    v_lshlrev_b32 v16, 16, v48
    v_and_b32 v48, 0xffff0000, v48
    v_add_f32 v112, v112, v16
    v_add_f32 v114, v114, v48
    v_lshlrev_b32 v16, 16, v49
    v_and_b32 v49, 0xffff0000, v49
    v_add_f32 v116, v116, v16
    v_add_f32 v118, v118, v49
    v_lshlrev_b32 v16, 16, v50
    v_and_b32 v50, 0xffff0000, v50
    v_add_f32 v113, v113, v16
    v_add_f32 v115, v115, v50
    v_lshlrev_b32 v16, 16, v51
    v_and_b32 v51, 0xffff0000, v51
    v_add_f32 v117, v117, v16
    v_add_f32 v119, v119, v51
    s_waitcnt vmcnt(2)
    v_lshlrev_b32 v16, 16, v52
    v_and_b32 v52, 0xffff0000, v52
    v_add_f32 v120, v120, v16
    v_add_f32 v122, v122, v52
    v_lshlrev_b32 v16, 16, v53
    v_and_b32 v53, 0xffff0000, v53
    v_add_f32 v124, v124, v16
    v_add_f32 v126, v126, v53
    v_lshlrev_b32 v16, 16, v54
    v_and_b32 v54, 0xffff0000, v54
    v_add_f32 v121, v121, v16
    v_add_f32 v123, v123, v54
    v_lshlrev_b32 v16, 16, v55
    v_and_b32 v55, 0xffff0000, v55
    v_add_f32 v125, v125, v16
    v_add_f32 v127, v127, v55
    s_waitcnt vmcnt(1)
    v_lshlrev_b32 v16, 16, v56
    v_and_b32 v56, 0xffff0000, v56
    v_add_f32 v128, v128, v16
    v_add_f32 v130, v130, v56
    v_lshlrev_b32 v16, 16, v57
    v_and_b32 v57, 0xffff0000, v57
    v_add_f32 v132, v132, v16
    v_add_f32 v134, v134, v57
    v_lshlrev_b32 v16, 16, v58
    v_and_b32 v58, 0xffff0000, v58
    v_add_f32 v129, v129, v16
    v_add_f32 v131, v131, v58
    v_lshlrev_b32 v16, 16, v59
    v_and_b32 v59, 0xffff0000, v59
    v_add_f32 v133, v133, v16
    v_add_f32 v135, v135, v59
    s_waitcnt vmcnt(0)
    v_lshlrev_b32 v16, 16, v60
    v_and_b32 v60, 0xffff0000, v60
    v_add_f32 v136, v136, v16
    v_add_f32 v138, v138, v60
    v_lshlrev_b32 v16, 16, v61
    v_and_b32 v61, 0xffff0000, v61
    v_add_f32 v140, v140, v16
    v_add_f32 v142, v142, v61
    v_lshlrev_b32 v16, 16, v62
    v_and_b32 v62, 0xffff0000, v62
    v_add_f32 v137, v137, v16
    v_add_f32 v139, v139, v62
    v_lshlrev_b32 v16, 16, v63
    v_and_b32 v63, 0xffff0000, v63
    v_add_f32 v141, v141, v16
    v_add_f32 v143, v143, v63
    v_cndmask_b32 v28, v116, v112, s[66:67]
    v_cndmask_b32 v32, v112, v116, s[66:67]
    v_cndmask_b32 v29, v117, v113, s[66:67]
    v_cndmask_b32 v33, v113, v117, s[66:67]
    v_cndmask_b32 v30, v118, v114, s[66:67]
    v_cndmask_b32 v34, v114, v118, s[66:67]
    v_cndmask_b32 v31, v119, v115, s[66:67]
    v_cndmask_b32 v35, v115, v119, s[66:67]
    s_nop 1
    v_mov_b32_dpp v36, v28 quad_perm:[1,0,3,2] row_mask:0xf bank_mask:0xf
    v_mov_b32_dpp v37, v29 quad_perm:[1,0,3,2] row_mask:0xf bank_mask:0xf
    v_mov_b32_dpp v38, v30 quad_perm:[1,0,3,2] row_mask:0xf bank_mask:0xf
    v_mov_b32_dpp v39, v31 quad_perm:[1,0,3,2] row_mask:0xf bank_mask:0xf
    v_cndmask_b32 v112, v32, v36, s[66:67]
    v_cndmask_b32 v114, v36, v32, s[66:67]
    v_cndmask_b32 v113, v33, v37, s[66:67]
    v_cndmask_b32 v115, v37, v33, s[66:67]
    v_cndmask_b32 v116, v34, v38, s[66:67]
    v_cndmask_b32 v118, v38, v34, s[66:67]
    v_cndmask_b32 v117, v35, v39, s[66:67]
    v_cndmask_b32 v119, v39, v35, s[66:67]
    v_fmac_f32 v144, v112, v176
    v_fmac_f32 v145, v113, v176
    v_fmac_f32 v146, v114, v176
    v_fmac_f32 v147, v115, v176
    v_fmac_f32 v148, v116, v176
    v_fmac_f32 v149, v117, v176
    v_fmac_f32 v150, v118, v176
    v_fmac_f32 v151, v119, v176
    v_cndmask_b32 v28, v124, v120, s[66:67]
    v_cndmask_b32 v32, v120, v124, s[66:67]
    v_cndmask_b32 v29, v125, v121, s[66:67]
    v_cndmask_b32 v33, v121, v125, s[66:67]
    v_cndmask_b32 v30, v126, v122, s[66:67]
    v_cndmask_b32 v34, v122, v126, s[66:67]
    v_cndmask_b32 v31, v127, v123, s[66:67]
    v_cndmask_b32 v35, v123, v127, s[66:67]
    s_nop 1
    v_mov_b32_dpp v36, v28 quad_perm:[1,0,3,2] row_mask:0xf bank_mask:0xf
    v_mov_b32_dpp v37, v29 quad_perm:[1,0,3,2] row_mask:0xf bank_mask:0xf
    v_mov_b32_dpp v38, v30 quad_perm:[1,0,3,2] row_mask:0xf bank_mask:0xf
    v_mov_b32_dpp v39, v31 quad_perm:[1,0,3,2] row_mask:0xf bank_mask:0xf
    v_cndmask_b32 v120, v32, v36, s[66:67]
    v_cndmask_b32 v122, v36, v32, s[66:67]
    v_cndmask_b32 v121, v33, v37, s[66:67]
    v_cndmask_b32 v123, v37, v33, s[66:67]
    v_cndmask_b32 v124, v34, v38, s[66:67]
    v_cndmask_b32 v126, v38, v34, s[66:67]
    v_cndmask_b32 v125, v35, v39, s[66:67]
    v_cndmask_b32 v127, v39, v35, s[66:67]
    v_fmac_f32 v152, v120, v177
    v_fmac_f32 v153, v121, v177
    v_fmac_f32 v154, v122, v177
    v_fmac_f32 v155, v123, v177
    v_fmac_f32 v156, v124, v177
    v_fmac_f32 v157, v125, v177
    v_fmac_f32 v158, v126, v177
    v_fmac_f32 v159, v127, v177
    v_cndmask_b32 v28, v132, v128, s[66:67]
    v_cndmask_b32 v32, v128, v132, s[66:67]
    v_cndmask_b32 v29, v133, v129, s[66:67]
    v_cndmask_b32 v33, v129, v133, s[66:67]
    v_cndmask_b32 v30, v134, v130, s[66:67]
    v_cndmask_b32 v34, v130, v134, s[66:67]
    v_cndmask_b32 v31, v135, v131, s[66:67]
    v_cndmask_b32 v35, v131, v135, s[66:67]
    s_nop 1
    v_mov_b32_dpp v36, v28 quad_perm:[1,0,3,2] row_mask:0xf bank_mask:0xf
    v_mov_b32_dpp v37, v29 quad_perm:[1,0,3,2] row_mask:0xf bank_mask:0xf
    v_mov_b32_dpp v38, v30 quad_perm:[1,0,3,2] row_mask:0xf bank_mask:0xf
    v_mov_b32_dpp v39, v31 quad_perm:[1,0,3,2] row_mask:0xf bank_mask:0xf
    v_cndmask_b32 v128, v32, v36, s[66:67]
    v_cndmask_b32 v130, v36, v32, s[66:67]
    v_cndmask_b32 v129, v33, v37, s[66:67]
    v_cndmask_b32 v131, v37, v33, s[66:67]
    v_cndmask_b32 v132, v34, v38, s[66:67]
    v_cndmask_b32 v134, v38, v34, s[66:67]
    v_cndmask_b32 v133, v35, v39, s[66:67]
    v_cndmask_b32 v135, v39, v35, s[66:67]
    v_fmac_f32 v160, v128, v178
    v_fmac_f32 v161, v129, v178
    v_fmac_f32 v162, v130, v178
    v_fmac_f32 v163, v131, v178
    v_fmac_f32 v164, v132, v178
    v_fmac_f32 v165, v133, v178
    v_fmac_f32 v166, v134, v178
    v_fmac_f32 v167, v135, v178
    v_cndmask_b32 v28, v140, v136, s[66:67]
    v_cndmask_b32 v32, v136, v140, s[66:67]
    v_cndmask_b32 v29, v141, v137, s[66:67]
    v_cndmask_b32 v33, v137, v141, s[66:67]
    v_cndmask_b32 v30, v142, v138, s[66:67]
    v_cndmask_b32 v34, v138, v142, s[66:67]
    v_cndmask_b32 v31, v143, v139, s[66:67]
    v_cndmask_b32 v35, v139, v143, s[66:67]
    s_nop 1
    v_mov_b32_dpp v36, v28 quad_perm:[1,0,3,2] row_mask:0xf bank_mask:0xf
    v_mov_b32_dpp v37, v29 quad_perm:[1,0,3,2] row_mask:0xf bank_mask:0xf
    v_mov_b32_dpp v38, v30 quad_perm:[1,0,3,2] row_mask:0xf bank_mask:0xf
    v_mov_b32_dpp v39, v31 quad_perm:[1,0,3,2] row_mask:0xf bank_mask:0xf
    v_cndmask_b32 v136, v32, v36, s[66:67]
    v_cndmask_b32 v138, v36, v32, s[66:67]
    v_cndmask_b32 v137, v33, v37, s[66:67]
    v_cndmask_b32 v139, v37, v33, s[66:67]
    v_cndmask_b32 v140, v34, v38, s[66:67]
    v_cndmask_b32 v142, v38, v34, s[66:67]
    v_cndmask_b32 v141, v35, v39, s[66:67]
    v_cndmask_b32 v143, v39, v35, s[66:67]
    v_fmac_f32 v168, v136, v179
    v_fmac_f32 v169, v137, v179
    v_fmac_f32 v170, v138, v179
    v_fmac_f32 v171, v139, v179
    v_fmac_f32 v172, v140, v179
    v_fmac_f32 v173, v141, v179
    v_fmac_f32 v174, v142, v179
    v_fmac_f32 v175, v143, v179
    s_lshl_b32 s44, s33, 2
    s_add_u32 s44, s44, 151556
    v_mov_b32 v4, s44
    s_mov_b32 s72, 0x40000
K4_orl:
    ds_read_b32 v3, v4
    s_waitcnt lgkmcnt(0)
    v_readfirstlane_b32 s70, v3
    s_cmp_ge_u32 s70, 8
    s_cbranch_scc1 K4_orl_ok
    s_sleep 2
    s_sub_u32 s72, s72, 1
    s_cbranch_scc0 K4_orl
K4_orl_ok:
    s_lshl_b32 s44, s33, 13
    s_add_u32 s44, s44, 8192
    v_add_u32 v8, s44, v2
    s_lshl_b32 s44, s33, 10
    s_add_u32 s44, s44, 73728
    v_lshlrev_b32 v9, 2, v0
    v_add_u32 v9, s44, v9
    ds_write_b128 v8, v[144:147] offset:0
    ds_write_b128 v8, v[148:151] offset:1024
    ds_write_b128 v8, v[152:155] offset:2048
    ds_write_b128 v8, v[156:159] offset:3072
    ds_write_b128 v8, v[160:163] offset:4096
    ds_write_b128 v8, v[164:167] offset:5120
    ds_write_b128 v8, v[168:171] offset:6144
    ds_write_b128 v8, v[172:175] offset:7168
    ds_write_b32 v9, v176 offset:0
    ds_write_b32 v9, v177 offset:256
    ds_write_b32 v9, v178 offset:512
    ds_write_b32 v9, v179 offset:768
    v_mov_b32 v4, 151600
    v_mov_b32 v3, 1
    s_mov_b64 exec, 1
    ds_add_u32 v4, v3
    s_mov_b64 exec, -1
    s_branch K4_work
K4_last:
    s_add_u32 s24, s14, 21319680
    s_addc_u32 s25, s15, 0
    s_mov_b32 s26, 18874368
    s_mov_b32 s27, 0x00020000
    s_mul_i32 s49, s41, 9
    s_add_u32 s49, s49, s40
    s_lshl_b32 s47, s49, 16
    s_lshl_b32 s51, s49, 10
    s_lshl_b32 s44, s3, 11
    s_add_u32 s47, s47, s44
    v_lshlrev_b32 v12, 7, v0
    s_add_u32 s43, s51, 640
    s_mov_b32 s91, 0x10000
    s_mov_b32 exec_lo, 7
    s_mov_b32 exec_hi, 0
L_poll_48:
    buffer_load_dword v3, v12, s[36:39], s43 offen sc1
    s_waitcnt vmcnt(0)
L_poll_48_1:
    v_cmp_eq_u32 vcc, s101, v3
    s_nop 1
    s_cmp_eq_u64 vcc, exec
    s_cbranch_scc1 L_poll_48_ok
    s_sleep 1
    s_sub_u32 s91, s91, 1
    s_cbranch_scc0 L_poll_48
L_poll_48_ok:
    s_mov_b64 exec, -1
    s_add_u32 s71, s47, 40960
    buffer_load_dwordx4 v[48:51], v2, s[24:27], s71 offen offset:0 sc1
    buffer_load_dwordx4 v[52:55], v2, s[24:27], s71 offen offset:1024 sc1
    s_add_u32 s71, s47, 49152
    buffer_load_dwordx4 v[56:59], v2, s[24:27], s71 offen offset:0 sc1
    buffer_load_dwordx4 v[60:63], v2, s[24:27], s71 offen offset:1024 sc1
    s_add_u32 s71, s47, 57344
    buffer_load_dwordx4 v[64:67], v2, s[24:27], s71 offen offset:0 sc1
    buffer_load_dwordx4 v[68:71], v2, s[24:27], s71 offen offset:1024 sc1
    s_mov_b32 s60, s4
    s_mov_b32 s61, s5
    s_mov_b32 s62, 2359296
    s_mov_b32 s63, 0x00020000
    v_lshrrev_b32 v5, 3, v0
    v_and_b32 v6, 7, v0
    v_xor_b32 v7, v5, v6
    v_lshlrev_b32 v7, 4, v7
    v_lshl_add_u32 v7, v5, 7, v7
    s_add_u32 s44, s44, 65536
    v_add_u32 v7, s44, v7
    v_and_b32 v19, 1, v0
    v_cmp_eq_u32 s[66:67], 1, v19
    v_mul_u32_u24 v11, 1152, v5
    v_lshl_add_u32 v11, v6, 4, v11
    s_mul_i32 s64, s41, 73728
    s_mul_i32 s44, s3, 18432
    s_add_u32 s64, s64, s44
    s_lshl_b32 s44, s40, 7
    s_add_u32 s64, s64, s44
    s_lshl_b32 s44, s3, 12
    s_add_u32 s44, s44, 8192
    v_add_u32 v8, s44, v2
    s_lshl_b32 s44, s3, 9
    s_add_u32 s44, s44, 73728
    v_lshlrev_b32 v9, 2, v0
    v_add_u32 v9, s44, v9
    v_mov_b32 v4, 151584
    s_mov_b32 s72, 0x40000
K4_l8:
    ds_read_b32 v3, v4
    s_waitcnt lgkmcnt(0)
    v_readfirstlane_b32 s70, v3
    s_cmp_ge_u32 s70, 4
    s_cbranch_scc1 K4_l8_ok
    s_sleep 1
    s_sub_u32 s72, s72, 1
    s_cbranch_scc0 K4_l8
K4_l8_ok:
    ds_read_b128 v[96:99], v7
    ds_read_b128 v[100:103], v7 offset:1024
    v_mov_b32 v4, 151600
    s_mov_b32 s72, 0x40000
K4_lr:
    ds_read_b32 v3, v4
    s_waitcnt lgkmcnt(0)
    v_readfirstlane_b32 s70, v3
    s_cmp_ge_u32 s70, 2
    s_cbranch_scc1 K4_lr_ok
    s_sleep 1
    s_sub_u32 s72, s72, 1
    s_cbranch_scc0 K4_lr
K4_lr_ok:
    ds_read_b128 v[144:147], v8 offset:0
    ds_read_b128 v[148:151], v8 offset:1024
    ds_read_b128 v[152:155], v8 offset:2048
    ds_read_b128 v[156:159], v8 offset:3072
    ds_read_b32 v176, v9
    ds_read_b32 v177, v9 offset:256
    v_lshlrev_b32 v112, 16, v96
    v_and_b32 v114, 0xffff0000, v96
    v_lshlrev_b32 v116, 16, v97
    v_and_b32 v118, 0xffff0000, v97
    v_lshlrev_b32 v113, 16, v98
    v_and_b32 v115, 0xffff0000, v98
    v_lshlrev_b32 v117, 16, v99
    v_and_b32 v119, 0xffff0000, v99
    v_lshlrev_b32 v120, 16, v100
    v_and_b32 v122, 0xffff0000, v100
    v_lshlrev_b32 v124, 16, v101
    v_and_b32 v126, 0xffff0000, v101
    v_lshlrev_b32 v121, 16, v102
    v_and_b32 v123, 0xffff0000, v102
    v_lshlrev_b32 v125, 16, v103
    v_and_b32 v127, 0xffff0000, v103
    s_waitcnt vmcnt(5)
    v_lshlrev_b32 v16, 16, v48
    v_and_b32 v48, 0xffff0000, v48
    v_add_f32 v112, v112, v16
    v_add_f32 v114, v114, v48
    v_lshlrev_b32 v16, 16, v49
    v_and_b32 v49, 0xffff0000, v49
    v_add_f32 v116, v116, v16
    v_add_f32 v118, v118, v49
    v_lshlrev_b32 v16, 16, v50
    v_and_b32 v50, 0xffff0000, v50
    v_add_f32 v113, v113, v16
    v_add_f32 v115, v115, v50
    v_lshlrev_b32 v16, 16, v51
    v_and_b32 v51, 0xffff0000, v51
    v_add_f32 v117, v117, v16
    v_add_f32 v119, v119, v51
    s_waitcnt vmcnt(4)
    v_lshlrev_b32 v16, 16, v52
    v_and_b32 v52, 0xffff0000, v52
    v_add_f32 v120, v120, v16
    v_add_f32 v122, v122, v52
    v_lshlrev_b32 v16, 16, v53
    v_and_b32 v53, 0xffff0000, v53
    v_add_f32 v124, v124, v16
    v_add_f32 v126, v126, v53
    v_lshlrev_b32 v16, 16, v54
    v_and_b32 v54, 0xffff0000, v54
    v_add_f32 v121, v121, v16
    v_add_f32 v123, v123, v54
    v_lshlrev_b32 v16, 16, v55
    v_and_b32 v55, 0xffff0000, v55
    v_add_f32 v125, v125, v16
    v_add_f32 v127, v127, v55
    s_waitcnt vmcnt(3)
    v_lshlrev_b32 v16, 16, v56
    v_and_b32 v56, 0xffff0000, v56
    v_add_f32 v112, v112, v16
    v_add_f32 v114, v114, v56
    v_lshlrev_b32 v16, 16, v57
    v_and_b32 v57, 0xffff0000, v57
    v_add_f32 v116, v116, v16
    v_add_f32 v118, v118, v57
    v_lshlrev_b32 v16, 16, v58
    v_and_b32 v58, 0xffff0000, v58
    v_add_f32 v113, v113, v16
    v_add_f32 v115, v115, v58
    v_lshlrev_b32 v16, 16, v59
    v_and_b32 v59, 0xffff0000, v59
    v_add_f32 v117, v117, v16
    v_add_f32 v119, v119, v59
    s_waitcnt vmcnt(2)
    v_lshlrev_b32 v16, 16, v60
    v_and_b32 v60, 0xffff0000, v60
    v_add_f32 v120, v120, v16
    v_add_f32 v122, v122, v60
    v_lshlrev_b32 v16, 16, v61
    v_and_b32 v61, 0xffff0000, v61
    v_add_f32 v124, v124, v16
    v_add_f32 v126, v126, v61
    v_lshlrev_b32 v16, 16, v62
    v_and_b32 v62, 0xffff0000, v62
    v_add_f32 v121, v121, v16
    v_add_f32 v123, v123, v62
    v_lshlrev_b32 v16, 16, v63
    v_and_b32 v63, 0xffff0000, v63
    v_add_f32 v125, v125, v16
    v_add_f32 v127, v127, v63
    s_waitcnt vmcnt(1)
    v_lshlrev_b32 v16, 16, v64
    v_and_b32 v64, 0xffff0000, v64
    v_add_f32 v112, v112, v16
    v_add_f32 v114, v114, v64
    v_lshlrev_b32 v16, 16, v65
    v_and_b32 v65, 0xffff0000, v65
    v_add_f32 v116, v116, v16
    v_add_f32 v118, v118, v65
    v_lshlrev_b32 v16, 16, v66
    v_and_b32 v66, 0xffff0000, v66
    v_add_f32 v113, v113, v16
    v_add_f32 v115, v115, v66
    v_lshlrev_b32 v16, 16, v67
    v_and_b32 v67, 0xffff0000, v67
    v_add_f32 v117, v117, v16
    v_add_f32 v119, v119, v67
    s_waitcnt vmcnt(0)
    v_lshlrev_b32 v16, 16, v68
    v_and_b32 v68, 0xffff0000, v68
    v_add_f32 v120, v120, v16
    v_add_f32 v122, v122, v68
    v_lshlrev_b32 v16, 16, v69
    v_and_b32 v69, 0xffff0000, v69
    v_add_f32 v124, v124, v16
    v_add_f32 v126, v126, v69
    v_lshlrev_b32 v16, 16, v70
    v_and_b32 v70, 0xffff0000, v70
    v_add_f32 v121, v121, v16
    v_add_f32 v123, v123, v70
    v_lshlrev_b32 v16, 16, v71
    v_and_b32 v71, 0xffff0000, v71
    v_add_f32 v125, v125, v16
    v_add_f32 v127, v127, v71
    s_waitcnt lgkmcnt(0)
    v_cndmask_b32 v28, v116, v112, s[66:67]
    v_cndmask_b32 v32, v112, v116, s[66:67]
    v_cndmask_b32 v29, v117, v113, s[66:67]
    v_cndmask_b32 v33, v113, v117, s[66:67]
    v_cndmask_b32 v30, v118, v114, s[66:67]
    v_cndmask_b32 v34, v114, v118, s[66:67]
    v_cndmask_b32 v31, v119, v115, s[66:67]
    v_cndmask_b32 v35, v115, v119, s[66:67]
    s_nop 1
    v_mov_b32_dpp v36, v28 quad_perm:[1,0,3,2] row_mask:0xf bank_mask:0xf
    v_mov_b32_dpp v37, v29 quad_perm:[1,0,3,2] row_mask:0xf bank_mask:0xf
    v_mov_b32_dpp v38, v30 quad_perm:[1,0,3,2] row_mask:0xf bank_mask:0xf
    v_mov_b32_dpp v39, v31 quad_perm:[1,0,3,2] row_mask:0xf bank_mask:0xf
    v_cndmask_b32 v112, v32, v36, s[66:67]
    v_cndmask_b32 v114, v36, v32, s[66:67]
    v_cndmask_b32 v113, v33, v37, s[66:67]
    v_cndmask_b32 v115, v37, v33, s[66:67]
    v_cndmask_b32 v116, v34, v38, s[66:67]
    v_cndmask_b32 v118, v38, v34, s[66:67]
    v_cndmask_b32 v117, v35, v39, s[66:67]
    v_cndmask_b32 v119, v39, v35, s[66:67]
    v_fmac_f32 v144, v112, v176
    v_fmac_f32 v145, v113, v176
    v_fmac_f32 v146, v114, v176
    v_fmac_f32 v147, v115, v176
    v_fmac_f32 v148, v116, v176
    v_fmac_f32 v149, v117, v176
    v_fmac_f32 v150, v118, v176
    v_fmac_f32 v151, v119, v176
    v_cvt_pk_bf16_f32 v96, v144, v145
    v_cvt_pk_bf16_f32 v97, v146, v147
    v_cvt_pk_bf16_f32 v98, v148, v149
    v_cvt_pk_bf16_f32 v99, v150, v151
    buffer_store_dwordx4 v[96:99], v11, s[60:63], s64 offen
    s_add_u32 s64, s64, 9216
    v_cndmask_b32 v28, v124, v120, s[66:67]
    v_cndmask_b32 v32, v120, v124, s[66:67]
    v_cndmask_b32 v29, v125, v121, s[66:67]
    v_cndmask_b32 v33, v121, v125, s[66:67]
    v_cndmask_b32 v30, v126, v122, s[66:67]
    v_cndmask_b32 v34, v122, v126, s[66:67]
    v_cndmask_b32 v31, v127, v123, s[66:67]
    v_cndmask_b32 v35, v123, v127, s[66:67]
    s_nop 1
    v_mov_b32_dpp v36, v28 quad_perm:[1,0,3,2] row_mask:0xf bank_mask:0xf
    v_mov_b32_dpp v37, v29 quad_perm:[1,0,3,2] row_mask:0xf bank_mask:0xf
    v_mov_b32_dpp v38, v30 quad_perm:[1,0,3,2] row_mask:0xf bank_mask:0xf
    v_mov_b32_dpp v39, v31 quad_perm:[1,0,3,2] row_mask:0xf bank_mask:0xf
    v_cndmask_b32 v120, v32, v36, s[66:67]
    v_cndmask_b32 v122, v36, v32, s[66:67]
    v_cndmask_b32 v121, v33, v37, s[66:67]
    v_cndmask_b32 v123, v37, v33, s[66:67]
    v_cndmask_b32 v124, v34, v38, s[66:67]
    v_cndmask_b32 v126, v38, v34, s[66:67]
    v_cndmask_b32 v125, v35, v39, s[66:67]
    v_cndmask_b32 v127, v39, v35, s[66:67]
    v_fmac_f32 v152, v120, v177
    v_fmac_f32 v153, v121, v177
    v_fmac_f32 v154, v122, v177
    v_fmac_f32 v155, v123, v177
    v_fmac_f32 v156, v124, v177
    v_fmac_f32 v157, v125, v177
    v_fmac_f32 v158, v126, v177
    v_fmac_f32 v159, v127, v177
    v_cvt_pk_bf16_f32 v100, v152, v153
    v_cvt_pk_bf16_f32 v101, v154, v155
    v_cvt_pk_bf16_f32 v102, v156, v157
    v_cvt_pk_bf16_f32 v103, v158, v159
    buffer_store_dwordx4 v[100:103], v11, s[60:63], s64 offen
    s_add_u32 s64, s64, 9216
K4_fin:
    s_endpgm
CODE_END:
.set CODE_PF_N, (CODE_END - K2_out + 8191) / 8192
.section .rodata,"a"
.p2align 6
.amdhsa_kernel sequential_preLN__grouped_kv_mqa__dense_activation_relu__prompt_kernel
  .amdhsa_next_free_vgpr 256
  .amdhsa_next_free_sgpr 102
  .amdhsa_accum_offset 256
  .amdhsa_group_segment_fixed_size 0
  .amdhsa_kernarg_size 88
  .amdhsa_user_sgpr_count 2
  .amdhsa_user_sgpr_kernarg_segment_ptr 1
  .amdhsa_system_sgpr_workgroup_id_x 1
.end_amdhsa_kernel
```
